```python
import torch

def _softmax(x, axis=-1):
    return torch.softmax(x, dim=axis)
def _gelu(x):
    return torch.nn.functional.gelu(x, approximate="tanh")
def _silu(x):
    return torch.nn.functional.silu(x)
def _sigmoid(x):
    return torch.sigmoid(x)
def _layernorm(x, axis=-1, eps=1e-5):
    m = x.mean(dim=axis, keepdim=True)
    v = x.var(dim=axis, keepdim=True, unbiased=False)
    return (x - m) / torch.sqrt(v + eps)
def _scatter_add(tgt, idx, src, axis=0):
    return tgt.clone().index_add_(axis, idx, src)
def _segment_sum(src, seg, n):
    out = torch.zeros((n,) + src.shape[1:], dtype=src.dtype)
    return out.index_add_(0, seg, src)
def _pad(x, pw):
    flat = tuple(v for pair in reversed(pw) for v in pair)
    return torch.nn.functional.pad(x, flat)

kernel_name = 'interleave_layers__mha_block_cached__glu_gated_bilinear__decode'

def setup_inputs():

    _w = (lambda a: (lambda t: t.to(torch.bfloat16) if t.is_floating_point() else t)(torch.as_tensor(a)))
    def _A_setup():
        B, Sq, D = 2, 1, 448
        H, Sk, Dh = 16, 8192, 256
        return {
            "x": _w((lambda *s: torch.randn(*s, dtype=torch.bfloat16) * 0.05)(B, Sq, D)),
            "k_cache": _w((lambda *s: torch.randn(*s, dtype=torch.bfloat16) * 0.8)(B, H, Sk, Dh)),
            "v_cache": _w((lambda *s: torch.randn(*s, dtype=torch.bfloat16) * 1.6)(B, H, Sk, Dh)),
            "wq": _w((lambda *s: torch.randn(*s, dtype=torch.bfloat16) * 0.8)(D, H * Dh) * (D ** -0.5)),
            "wo": _w((lambda *s: torch.randn(*s, dtype=torch.bfloat16) * 1.6)(H * Dh, D) * ((H * Dh) ** -0.5)),
        }
    _A_in = _A_setup()

    def _B_setup():
        B, S, D, F = 2, 1, 448, 1792
        return {
            "x": _w((lambda *s: torch.randn(*s, dtype=torch.bfloat16) * 0.05)(B, S, D)),
            "w_gate": _w((lambda *s: torch.randn(*s, dtype=torch.bfloat16) * 0.4)(D, F) * (D ** -0.5)),
            "w_up": _w((lambda *s: torch.randn(*s, dtype=torch.bfloat16) * 0.4)(D, F) * (D ** -0.5)),
            "w_down": _w((lambda *s: torch.randn(*s, dtype=torch.bfloat16) * 0.4)(F, D) * (F ** -0.5)),
        }
    _B_in = _B_setup()

    return {
        "A_x": _A_in["x"],
        "A_k_cache": _A_in["k_cache"],
        "A_v_cache": _A_in["v_cache"],
        "A_wq": _A_in["wq"],
        "A_wo": _A_in["wo"],
        "B_x": _B_in["x"],
        "B_w_gate": _B_in["w_gate"],
        "B_w_up": _B_in["w_up"],
        "B_w_down": _B_in["w_down"],
    }

def reference(A_x, A_k_cache, A_v_cache, A_wq, A_wo, B_x, B_w_gate, B_w_up, B_w_down):
    def _A_ref(x, k_cache, v_cache, wq, wo):
        B, Sq, D = x.shape
        H, Dh = 16, 256
        q = (lambda x, *d: x.permute(*d))((x @ wq).reshape(B, Sq, H, Dh), 0, 2, 1, 3)
        scores = torch.einsum("bhqd,bhkd->bhqk", q, k_cache) * (Dh ** -0.5)
        p = _softmax(scores, axis=-1)
        o = torch.einsum("bhqk,bhkd->bhqd", p, v_cache)
        return (lambda x, *d: x.permute(*d))(o, 0, 2, 1, 3).reshape(B, Sq, H * Dh) @ wo

    def _B_ref(x, w_gate, w_up, w_down):
        g = torch.einsum("bsd,df->bsf", x, w_gate)
        u = torch.einsum("bsd,df->bsf", x, w_up)
        h = g * u
        return torch.einsum("bsf,fd->bsd", h, w_down)

    x = A_x
    x = x + _A_ref(_layernorm(x, axis=-1), A_k_cache, A_v_cache, A_wq, A_wo)
    x = x + _B_ref(_layernorm(x, axis=-1), B_w_gate, B_w_up, B_w_down)
    x = x + _A_ref(_layernorm(x, axis=-1), A_k_cache, A_v_cache, A_wq, A_wo)
    x = x + _B_ref(_layernorm(x, axis=-1), B_w_gate, B_w_up, B_w_down)
    return x
```

```asm
; @launch grid=(256,1,1) block=(512,1,1) lds=163840
.amdgcn_target "amdgcn-amd-amdhsa--gfx950"
.text
.globl interleave_layers__mha_block_cached__glu_gated_bilinear__decode_kernel
.p2align 8
.type interleave_layers__mha_block_cached__glu_gated_bilinear__decode_kernel,@function
interleave_layers__mha_block_cached__glu_gated_bilinear__decode_kernel:
s_cmp_lt_u32 s2, 256
s_cbranch_scc1 L_start
s_endpgm
L_start:
s_nop 4
s_load_dwordx16 s[64:79], s[0:1], 0
s_load_dwordx8 s[80:87], s[0:1], 64
v_and_b32 v3, 63, v0
v_lshlrev_b32 v1, 4, v3
v_lshrrev_b32 v28, 6, v0
s_nop 0
v_readfirstlane_b32 s48, v28
s_mov_b32 s61, 0xff
s_mov_b32 s62, 0xffff0000
s_waitcnt lgkmcnt(0)
s_mov_b32 s32, s64
s_and_b32 s33, s65, 0xffff
s_mov_b32 s34, 0x700
s_mov_b32 s35, 0x20000
s_mov_b32 s4, s66
s_and_b32 s5, s67, 0xffff
s_mov_b32 s6, 0x8000000
s_mov_b32 s7, 0x20000
s_mov_b32 s8, s68
s_and_b32 s9, s69, 0xffff
s_mov_b32 s10, 0x8000000
s_mov_b32 s11, 0x20000
s_mov_b32 s12, s70
s_and_b32 s13, s71, 0xffff
s_mov_b32 s14, 0x380000
s_mov_b32 s15, 0x20000
s_mov_b32 s16, s72
s_and_b32 s17, s73, 0xffff
s_mov_b32 s18, 0x380000
s_mov_b32 s19, 0x20000
s_mov_b32 s20, s76
s_and_b32 s21, s77, 0xffff
s_mov_b32 s22, 0x188000
s_mov_b32 s23, 0x20000
s_mov_b32 s24, s78
s_and_b32 s25, s79, 0xffff
s_mov_b32 s26, 0x188000
s_mov_b32 s27, 0x20000
s_mov_b32 s28, s80
s_and_b32 s29, s81, 0xffff
s_mov_b32 s30, 0x188000
s_mov_b32 s31, 0x20000
s_mov_b32 s36, s82
s_and_b32 s37, s83, 0xffff
s_mov_b32 s38, 0x700
s_mov_b32 s39, 0x20000
s_mov_b32 s40, s84
s_and_b32 s41, s85, 0xffff
s_mov_b32 s42, 0x100
s_mov_b32 s43, 0x20000
s_mov_b32 s44, s86
s_and_b32 s45, s87, 0xffff
s_mov_b32 s46, 0x20000000
s_mov_b32 s47, 0x20000
s_mov_b32 s80, 0x05040100
s_mov_b32 s81, 0x07060302
s_cmp_lg_u32 s2, 0
s_cbranch_scc1 L_noepoch
s_cmp_lg_u32 s48, 7
s_cbranch_scc1 L_noepoch
v_mov_b32 v28, 0
s_memrealtime s[88:89]
s_waitcnt lgkmcnt(0)
v_mov_b32 v40, s88
v_mov_b32 v41, 1
v_mov_b32 v42, s89
v_mov_b32 v43, 1
s_mov_b64 exec, 1
buffer_store_dwordx4 v[40:43], v28, s[40:43], 0 offen sc1
s_waitcnt vmcnt(0)
s_mov_b64 exec, -1
L_noepoch:
s_nop 4
s_getpc_b64 s[90:91]
L_pc:
s_lshr_b32 s56, s2, 3
s_lshl_b32 s56, s56, 3
s_add_u32 s56, s56, s48
s_lshl_b32 s56, s56, 10
v_add_u32 v28, s56, v1
v_min_u32 v28, L_codeend-L_pc-16, v28
global_load_dwordx4 v[44:47], v28, s[90:91]
s_cmp_lt_u32 s2, 32
s_cbranch_scc1 L_chain
v_lshlrev_b32 v28, 2, v3
v_add_u32 v28, 0x4000, v28
v_mov_b32 v29, 0
ds_write_b32 v28, v29
s_waitcnt lgkmcnt(0)
s_barrier
s_sub_u32 s56, s2, 32
s_and_b32 s49, s56, 15
s_lshr_b32 s50, s56, 4
s_mul_i32 s53, s48, 17408
s_add_u32 s53, s53, 16640
v_add_u32 v2, s53, v1
s_lshl_b32 s51, s49, 22
s_mul_i32 s56, s50, 299008
s_add_u32 s51, s51, s56
s_cmp_eq_u32 s50, 13
s_cselect_b32 s56, 4096, 0
s_add_u32 s51, s51, s56
s_cmp_ge_u32 s50, 12
s_cselect_b32 s57, 2, 1
s_lshl_b32 s58, s48, 12
s_add_u32 s51, s51, s58
s_add_u32 s52, s51, 0x4000000
s_cmp_lt_u32 s48, s57
s_cbranch_scc1 L_typeB
s_setprio 3
s_add_u32 m0, s53, 0
s_add_u32 s56, s51, 0
buffer_load_dwordx4 v1, s[4:7], s56 offen nt lds
s_add_u32 m0, s53, 1024
s_add_u32 s56, s51, 1024
buffer_load_dwordx4 v1, s[4:7], s56 offen nt lds
s_add_u32 m0, s53, 2048
s_add_u32 s56, s51, 2048
buffer_load_dwordx4 v1, s[4:7], s56 offen nt lds
s_add_u32 m0, s53, 3072
s_add_u32 s56, s51, 3072
buffer_load_dwordx4 v1, s[4:7], s56 offen nt lds
s_waitcnt vmcnt(3)
s_add_u32 m0, s53, 4096
s_add_u32 s56, s51, 32768
buffer_load_dwordx4 v1, s[4:7], s56 offen nt lds
s_waitcnt vmcnt(3)
s_add_u32 m0, s53, 5120
s_add_u32 s56, s51, 33792
buffer_load_dwordx4 v1, s[4:7], s56 offen nt lds
s_waitcnt vmcnt(3)
s_add_u32 m0, s53, 6144
s_add_u32 s56, s51, 34816
buffer_load_dwordx4 v1, s[4:7], s56 offen nt lds
s_waitcnt vmcnt(3)
s_add_u32 m0, s53, 7168
s_add_u32 s56, s51, 35840
buffer_load_dwordx4 v1, s[4:7], s56 offen nt lds
s_waitcnt vmcnt(3)
s_add_u32 m0, s53, 8192
s_add_u32 s56, s51, 65536
buffer_load_dwordx4 v1, s[4:7], s56 offen nt lds
s_waitcnt vmcnt(3)
s_add_u32 m0, s53, 9216
s_add_u32 s56, s51, 66560
buffer_load_dwordx4 v1, s[4:7], s56 offen nt lds
s_waitcnt vmcnt(3)
s_add_u32 m0, s53, 10240
s_add_u32 s56, s51, 67584
buffer_load_dwordx4 v1, s[4:7], s56 offen nt lds
s_waitcnt vmcnt(3)
s_add_u32 m0, s53, 11264
s_add_u32 s56, s51, 68608
buffer_load_dwordx4 v1, s[4:7], s56 offen nt lds
s_waitcnt vmcnt(3)
s_add_u32 m0, s53, 12288
s_add_u32 s56, s51, 98304
buffer_load_dwordx4 v1, s[4:7], s56 offen nt lds
s_waitcnt vmcnt(3)
s_add_u32 m0, s53, 13312
s_add_u32 s56, s51, 99328
buffer_load_dwordx4 v1, s[4:7], s56 offen nt lds
s_waitcnt vmcnt(3)
s_add_u32 m0, s53, 14336
s_add_u32 s56, s51, 100352
buffer_load_dwordx4 v1, s[4:7], s56 offen nt lds
s_waitcnt vmcnt(3)
s_add_u32 m0, s53, 15360
s_add_u32 s56, s51, 101376
buffer_load_dwordx4 v1, s[4:7], s56 offen nt lds
s_waitcnt vmcnt(3)
s_add_u32 m0, s53, 16384
s_add_u32 s56, s51, 131072
buffer_load_dwordx4 v1, s[4:7], s56 offen nt lds
s_waitcnt vmcnt(3)
s_add_u32 s56, s51, 131072
buffer_load_dwordx4 v[84:87], v1, s[4:7], s56 offen offset:1024 nt
s_waitcnt vmcnt(3)
s_add_u32 s56, s51, 131072
buffer_load_dwordx4 v[88:91], v1, s[4:7], s56 offen offset:2048 nt
s_waitcnt vmcnt(3)
s_add_u32 s56, s51, 131072
buffer_load_dwordx4 v[92:95], v1, s[4:7], s56 offen offset:3072 nt
s_waitcnt vmcnt(3)
s_add_u32 s56, s51, 163840
buffer_load_dwordx4 v[96:99], v1, s[4:7], s56 offen offset:0 nt
s_waitcnt vmcnt(3)
s_add_u32 s56, s51, 163840
buffer_load_dwordx4 v[100:103], v1, s[4:7], s56 offen offset:1024 nt
s_waitcnt vmcnt(3)
s_add_u32 s56, s51, 163840
buffer_load_dwordx4 v[104:107], v1, s[4:7], s56 offen offset:2048 nt
s_waitcnt vmcnt(3)
s_add_u32 s56, s51, 163840
buffer_load_dwordx4 v[108:111], v1, s[4:7], s56 offen offset:3072 nt
s_waitcnt vmcnt(3)
s_add_u32 s56, s51, 196608
buffer_load_dwordx4 v[112:115], v1, s[4:7], s56 offen offset:0 nt
s_waitcnt vmcnt(3)
s_add_u32 s56, s51, 196608
buffer_load_dwordx4 v[116:119], v1, s[4:7], s56 offen offset:1024 nt
s_waitcnt vmcnt(3)
s_add_u32 s56, s51, 196608
buffer_load_dwordx4 v[120:123], v1, s[4:7], s56 offen offset:2048 nt
s_waitcnt vmcnt(3)
s_add_u32 s56, s51, 196608
buffer_load_dwordx4 v[124:127], v1, s[4:7], s56 offen offset:3072 nt
s_waitcnt vmcnt(3)
s_add_u32 s56, s51, 229376
buffer_load_dwordx4 v[128:131], v1, s[4:7], s56 offen offset:0 nt
s_waitcnt vmcnt(3)
s_add_u32 s56, s51, 229376
buffer_load_dwordx4 v[132:135], v1, s[4:7], s56 offen offset:1024 nt
s_waitcnt vmcnt(3)
s_add_u32 s56, s51, 229376
buffer_load_dwordx4 v[136:139], v1, s[4:7], s56 offen offset:2048 nt
s_waitcnt vmcnt(3)
s_add_u32 s56, s51, 229376
buffer_load_dwordx4 v[140:143], v1, s[4:7], s56 offen offset:3072 nt
s_waitcnt vmcnt(3)
s_add_u32 s56, s51, 262144
buffer_load_dwordx4 v[144:147], v1, s[4:7], s56 offen offset:0 nt
s_waitcnt vmcnt(3)
s_add_u32 s56, s51, 262144
buffer_load_dwordx4 v[148:151], v1, s[4:7], s56 offen offset:1024 nt
s_waitcnt vmcnt(3)
s_add_u32 s56, s51, 262144
buffer_load_dwordx4 v[152:155], v1, s[4:7], s56 offen offset:2048 nt
s_waitcnt vmcnt(3)
s_add_u32 s56, s51, 262144
buffer_load_dwordx4 v[156:159], v1, s[4:7], s56 offen offset:3072 nt
s_waitcnt vmcnt(3)
buffer_load_dwordx4 v[160:163], v1, s[8:11], s51 offen offset:0 nt
s_waitcnt vmcnt(3)
buffer_load_dwordx4 v[164:167], v1, s[8:11], s51 offen offset:1024 nt
s_waitcnt vmcnt(3)
buffer_load_dwordx4 v[168:171], v1, s[8:11], s51 offen offset:2048 nt
s_waitcnt vmcnt(3)
buffer_load_dwordx4 v[172:175], v1, s[8:11], s51 offen offset:3072 nt
s_waitcnt vmcnt(3)
s_add_u32 s56, s51, 32768
buffer_load_dwordx4 v[176:179], v1, s[8:11], s56 offen offset:0 nt
s_waitcnt vmcnt(3)
s_add_u32 s56, s51, 32768
buffer_load_dwordx4 v[180:183], v1, s[8:11], s56 offen offset:1024 nt
s_waitcnt vmcnt(3)
s_add_u32 s56, s51, 32768
buffer_load_dwordx4 v[184:187], v1, s[8:11], s56 offen offset:2048 nt
s_waitcnt vmcnt(3)
s_add_u32 s56, s51, 32768
buffer_load_dwordx4 v[188:191], v1, s[8:11], s56 offen offset:3072 nt
s_waitcnt vmcnt(3)
s_add_u32 s56, s51, 65536
buffer_load_dwordx4 v[192:195], v1, s[8:11], s56 offen offset:0 nt
s_waitcnt vmcnt(3)
s_add_u32 s56, s51, 65536
buffer_load_dwordx4 v[196:199], v1, s[8:11], s56 offen offset:1024 nt
v_and_b32 v32, 31, v3
v_lshlrev_b32 v32, 5, v32
s_lshl_b32 s56, s49, 10
s_add_u32 s56, s56, 0x400000
v_mov_b32 v33, 0
buffer_load_dwordx4 v[36:39], v33, s[40:43], 0 offen sc1
buffer_load_dwordx4 v[56:59], v32, s[44:47], s56 offen offset:0 sc1
buffer_load_dwordx4 v[60:63], v32, s[44:47], s56 offen offset:16 sc1
s_waitcnt vmcnt(3)
s_add_u32 s56, s51, 65536
buffer_load_dwordx4 v[200:203], v1, s[8:11], s56 offen offset:2048 nt
s_waitcnt vmcnt(3)
s_add_u32 s56, s51, 65536
buffer_load_dwordx4 v[204:207], v1, s[8:11], s56 offen offset:3072 nt
s_waitcnt vmcnt(3)
s_add_u32 s56, s51, 98304
buffer_load_dwordx4 v[208:211], v1, s[8:11], s56 offen offset:0 nt
s_waitcnt vmcnt(3)
s_add_u32 s56, s51, 98304
buffer_load_dwordx4 v[212:215], v1, s[8:11], s56 offen offset:1024 nt
s_waitcnt vmcnt(3)
s_add_u32 s56, s51, 98304
buffer_load_dwordx4 v[216:219], v1, s[8:11], s56 offen offset:2048 nt
s_waitcnt vmcnt(3)
s_add_u32 s56, s51, 98304
buffer_load_dwordx4 v[220:223], v1, s[8:11], s56 offen offset:3072 nt
v_mov_b32 v52, v36
v_and_b32 v28, v37, v39
v_xor_b32 v28, 1, v28
v_xor_b32 v29, v52, v56
v_or_b32 v28, v29, v28
v_xor_b32 v29, v52, v58
v_or_b32 v28, v29, v28
v_xor_b32 v29, v52, v60
v_or_b32 v28, v29, v28
v_xor_b32 v29, v52, v62
v_or_b32 v28, v29, v28
v_cmp_ne_u32 vcc, 0, v28
s_cbranch_vccz L_qburst_4
s_waitcnt vmcnt(3)
s_add_u32 s56, s51, 131072
buffer_load_dwordx4 v[224:227], v1, s[8:11], s56 offen offset:0 nt
s_waitcnt vmcnt(3)
s_add_u32 s56, s51, 131072
buffer_load_dwordx4 v[228:231], v1, s[8:11], s56 offen offset:1024 nt
s_waitcnt vmcnt(3)
s_add_u32 s56, s51, 131072
buffer_load_dwordx4 v[232:235], v1, s[8:11], s56 offen offset:2048 nt
s_waitcnt vmcnt(3)
s_add_u32 s56, s51, 131072
buffer_load_dwordx4 v[236:239], v1, s[8:11], s56 offen offset:3072 nt
s_waitcnt vmcnt(3)
s_add_u32 s56, s51, 163840
buffer_load_dwordx4 v[240:243], v1, s[8:11], s56 offen offset:0 nt
s_waitcnt vmcnt(3)
s_add_u32 s56, s51, 163840
buffer_load_dwordx4 v[244:247], v1, s[8:11], s56 offen offset:1024 nt
s_waitcnt vmcnt(3)
s_add_u32 s56, s51, 163840
buffer_load_dwordx4 v[248:251], v1, s[8:11], s56 offen offset:2048 nt
s_waitcnt vmcnt(3)
s_add_u32 s56, s51, 163840
buffer_load_dwordx4 v[252:255], v1, s[8:11], s56 offen offset:3072 nt
s_mov_b32 s60, 0
L_p_q_6:
s_nop 4
v_and_b32 v32, 31, v3
v_lshlrev_b32 v32, 5, v32
s_lshl_b32 s56, s49, 10
s_add_u32 s56, s56, 0x400000
v_mov_b32 v33, 0
buffer_load_dwordx4 v[36:39], v33, s[40:43], 0 offen sc1
buffer_load_dwordx4 v[56:59], v32, s[44:47], s56 offen offset:0 sc1
buffer_load_dwordx4 v[60:63], v32, s[44:47], s56 offen offset:16 sc1
s_waitcnt vmcnt(0)
v_mov_b32 v52, v36
v_and_b32 v28, v37, v39
v_xor_b32 v28, 1, v28
v_xor_b32 v29, v52, v56
v_or_b32 v28, v29, v28
v_xor_b32 v29, v52, v58
v_or_b32 v28, v29, v28
v_xor_b32 v29, v52, v60
v_or_b32 v28, v29, v28
v_xor_b32 v29, v52, v62
v_or_b32 v28, v29, v28
v_cmp_ne_u32 vcc, 0, v28
s_cbranch_vccz L_d_q_7
s_sleep 1
s_add_u32 s60, s60, 1
s_cmp_lt_u32 s60, 400000
s_cbranch_scc1 L_p_q_6
s_endpgm
L_d_q_7:
s_nop 4
s_branch L_qjoin_5
L_qburst_4:
s_nop 4
s_add_u32 s56, s51, 131072
buffer_load_dwordx4 v[224:227], v1, s[8:11], s56 offen offset:0 nt
s_add_u32 s56, s51, 131072
buffer_load_dwordx4 v[228:231], v1, s[8:11], s56 offen offset:1024 nt
s_add_u32 s56, s51, 131072
buffer_load_dwordx4 v[232:235], v1, s[8:11], s56 offen offset:2048 nt
s_add_u32 s56, s51, 131072
buffer_load_dwordx4 v[236:239], v1, s[8:11], s56 offen offset:3072 nt
s_add_u32 s56, s51, 163840
buffer_load_dwordx4 v[240:243], v1, s[8:11], s56 offen offset:0 nt
s_add_u32 s56, s51, 163840
buffer_load_dwordx4 v[244:247], v1, s[8:11], s56 offen offset:1024 nt
s_add_u32 s56, s51, 163840
buffer_load_dwordx4 v[248:251], v1, s[8:11], s56 offen offset:2048 nt
s_add_u32 s56, s51, 163840
buffer_load_dwordx4 v[252:255], v1, s[8:11], s56 offen offset:3072 nt
L_qjoin_5:
s_nop 4
v_mov_b32 v4, v57
v_mov_b32 v5, v59
v_mov_b32 v6, v61
v_mov_b32 v7, v63
ds_read_b128 v[36:39], v2 offset:0
ds_read_b128 v[40:43], v2 offset:1024
ds_read_b128 v[44:47], v2 offset:2048
ds_read_b128 v[48:51], v2 offset:3072
s_waitcnt lgkmcnt(0)
v_dot2_f32_bf16 v28, v36, v4, 0
v_dot2_f32_bf16 v29, v40, v4, 0
v_dot2_f32_bf16 v30, v44, v4, 0
v_dot2_f32_bf16 v31, v48, v4, 0
v_dot2_f32_bf16 v28, v37, v5, v28
v_dot2_f32_bf16 v29, v41, v5, v29
v_dot2_f32_bf16 v30, v45, v5, v30
v_dot2_f32_bf16 v31, v49, v5, v31
v_dot2_f32_bf16 v28, v38, v6, v28
v_dot2_f32_bf16 v29, v42, v6, v29
v_dot2_f32_bf16 v30, v46, v6, v30
v_dot2_f32_bf16 v31, v50, v6, v31
v_dot2_f32_bf16 v28, v39, v7, v28
v_dot2_f32_bf16 v29, v43, v7, v29
v_dot2_f32_bf16 v30, v47, v7, v30
v_dot2_f32_bf16 v31, v51, v7, v31
s_nop 0
v_permlane16_swap_b32 v28, v29
s_nop 0
v_permlane16_swap_b32 v30, v31
v_add_f32 v28, v28, v29
v_add_f32 v30, v30, v31
s_nop 0
v_add_f32_dpp v16, v28, v28 row_ror:8 row_mask:0xf bank_mask:0x3
v_add_f32_dpp v16, v30, v30 row_ror:8 row_mask:0xf bank_mask:0xc
s_waitcnt vmcnt(3)
ds_read_b128 v[36:39], v2 offset:4096
ds_read_b128 v[40:43], v2 offset:5120
ds_read_b128 v[44:47], v2 offset:6144
ds_read_b128 v[48:51], v2 offset:7168
s_waitcnt lgkmcnt(0)
v_dot2_f32_bf16 v28, v36, v4, 0
v_dot2_f32_bf16 v29, v40, v4, 0
v_dot2_f32_bf16 v30, v44, v4, 0
v_dot2_f32_bf16 v31, v48, v4, 0
v_dot2_f32_bf16 v28, v37, v5, v28
v_dot2_f32_bf16 v29, v41, v5, v29
v_dot2_f32_bf16 v30, v45, v5, v30
v_dot2_f32_bf16 v31, v49, v5, v31
v_dot2_f32_bf16 v28, v38, v6, v28
v_dot2_f32_bf16 v29, v42, v6, v29
v_dot2_f32_bf16 v30, v46, v6, v30
v_dot2_f32_bf16 v31, v50, v6, v31
v_dot2_f32_bf16 v28, v39, v7, v28
v_dot2_f32_bf16 v29, v43, v7, v29
v_dot2_f32_bf16 v30, v47, v7, v30
v_dot2_f32_bf16 v31, v51, v7, v31
s_nop 0
v_permlane16_swap_b32 v28, v29
s_nop 0
v_permlane16_swap_b32 v30, v31
v_add_f32 v28, v28, v29
v_add_f32 v30, v30, v31
s_nop 0
v_add_f32_dpp v17, v28, v28 row_ror:8 row_mask:0xf bank_mask:0x3
v_add_f32_dpp v17, v30, v30 row_ror:8 row_mask:0xf bank_mask:0xc
ds_read_b128 v[36:39], v2 offset:8192
ds_read_b128 v[40:43], v2 offset:9216
ds_read_b128 v[44:47], v2 offset:10240
ds_read_b128 v[48:51], v2 offset:11264
s_waitcnt lgkmcnt(0)
v_dot2_f32_bf16 v28, v36, v4, 0
v_dot2_f32_bf16 v29, v40, v4, 0
v_dot2_f32_bf16 v30, v44, v4, 0
v_dot2_f32_bf16 v31, v48, v4, 0
v_dot2_f32_bf16 v28, v37, v5, v28
v_dot2_f32_bf16 v29, v41, v5, v29
v_dot2_f32_bf16 v30, v45, v5, v30
v_dot2_f32_bf16 v31, v49, v5, v31
v_dot2_f32_bf16 v28, v38, v6, v28
v_dot2_f32_bf16 v29, v42, v6, v29
v_dot2_f32_bf16 v30, v46, v6, v30
v_dot2_f32_bf16 v31, v50, v6, v31
v_dot2_f32_bf16 v28, v39, v7, v28
v_dot2_f32_bf16 v29, v43, v7, v29
v_dot2_f32_bf16 v30, v47, v7, v30
v_dot2_f32_bf16 v31, v51, v7, v31
s_nop 0
v_permlane16_swap_b32 v28, v29
s_nop 0
v_permlane16_swap_b32 v30, v31
v_add_f32 v28, v28, v29
v_add_f32 v30, v30, v31
s_nop 0
v_add_f32_dpp v18, v28, v28 row_ror:8 row_mask:0xf bank_mask:0x3
v_add_f32_dpp v18, v30, v30 row_ror:8 row_mask:0xf bank_mask:0xc
ds_read_b128 v[36:39], v2 offset:12288
ds_read_b128 v[40:43], v2 offset:13312
ds_read_b128 v[44:47], v2 offset:14336
ds_read_b128 v[48:51], v2 offset:15360
s_waitcnt lgkmcnt(0)
v_dot2_f32_bf16 v28, v36, v4, 0
v_dot2_f32_bf16 v29, v40, v4, 0
v_dot2_f32_bf16 v30, v44, v4, 0
v_dot2_f32_bf16 v31, v48, v4, 0
v_dot2_f32_bf16 v28, v37, v5, v28
v_dot2_f32_bf16 v29, v41, v5, v29
v_dot2_f32_bf16 v30, v45, v5, v30
v_dot2_f32_bf16 v31, v49, v5, v31
v_dot2_f32_bf16 v28, v38, v6, v28
v_dot2_f32_bf16 v29, v42, v6, v29
v_dot2_f32_bf16 v30, v46, v6, v30
v_dot2_f32_bf16 v31, v50, v6, v31
v_dot2_f32_bf16 v28, v39, v7, v28
v_dot2_f32_bf16 v29, v43, v7, v29
v_dot2_f32_bf16 v30, v47, v7, v30
v_dot2_f32_bf16 v31, v51, v7, v31
s_nop 0
v_permlane16_swap_b32 v28, v29
s_nop 0
v_permlane16_swap_b32 v30, v31
v_add_f32 v28, v28, v29
v_add_f32 v30, v30, v31
s_nop 0
v_add_f32_dpp v19, v28, v28 row_ror:8 row_mask:0xf bank_mask:0x3
v_add_f32_dpp v19, v30, v30 row_ror:8 row_mask:0xf bank_mask:0xc
ds_read_b128 v[36:39], v2 offset:16384
s_waitcnt lgkmcnt(0)
v_dot2_f32_bf16 v28, v36, v4, 0
v_dot2_f32_bf16 v29, v84, v4, 0
v_dot2_f32_bf16 v30, v88, v4, 0
v_dot2_f32_bf16 v31, v92, v4, 0
v_dot2_f32_bf16 v28, v37, v5, v28
v_dot2_f32_bf16 v29, v85, v5, v29
v_dot2_f32_bf16 v30, v89, v5, v30
v_dot2_f32_bf16 v31, v93, v5, v31
v_dot2_f32_bf16 v28, v38, v6, v28
v_dot2_f32_bf16 v29, v86, v6, v29
v_dot2_f32_bf16 v30, v90, v6, v30
v_dot2_f32_bf16 v31, v94, v6, v31
v_dot2_f32_bf16 v28, v39, v7, v28
v_dot2_f32_bf16 v29, v87, v7, v29
v_dot2_f32_bf16 v30, v91, v7, v30
v_dot2_f32_bf16 v31, v95, v7, v31
s_nop 0
v_permlane16_swap_b32 v28, v29
s_nop 0
v_permlane16_swap_b32 v30, v31
v_add_f32 v28, v28, v29
v_add_f32 v30, v30, v31
s_nop 0
v_add_f32_dpp v20, v28, v28 row_ror:8 row_mask:0xf bank_mask:0x3
v_add_f32_dpp v20, v30, v30 row_ror:8 row_mask:0xf bank_mask:0xc
v_dot2_f32_bf16 v28, v96, v4, 0
v_dot2_f32_bf16 v29, v100, v4, 0
v_dot2_f32_bf16 v30, v104, v4, 0
v_dot2_f32_bf16 v31, v108, v4, 0
v_dot2_f32_bf16 v28, v97, v5, v28
v_dot2_f32_bf16 v29, v101, v5, v29
v_dot2_f32_bf16 v30, v105, v5, v30
v_dot2_f32_bf16 v31, v109, v5, v31
v_dot2_f32_bf16 v28, v98, v6, v28
v_dot2_f32_bf16 v29, v102, v6, v29
v_dot2_f32_bf16 v30, v106, v6, v30
v_dot2_f32_bf16 v31, v110, v6, v31
v_dot2_f32_bf16 v28, v99, v7, v28
v_dot2_f32_bf16 v29, v103, v7, v29
v_dot2_f32_bf16 v30, v107, v7, v30
v_dot2_f32_bf16 v31, v111, v7, v31
s_nop 0
v_permlane16_swap_b32 v28, v29
s_nop 0
v_permlane16_swap_b32 v30, v31
v_add_f32 v28, v28, v29
v_add_f32 v30, v30, v31
s_nop 0
v_add_f32_dpp v21, v28, v28 row_ror:8 row_mask:0xf bank_mask:0x3
v_add_f32_dpp v21, v30, v30 row_ror:8 row_mask:0xf bank_mask:0xc
v_dot2_f32_bf16 v28, v112, v4, 0
v_dot2_f32_bf16 v29, v116, v4, 0
v_dot2_f32_bf16 v30, v120, v4, 0
v_dot2_f32_bf16 v31, v124, v4, 0
v_dot2_f32_bf16 v28, v113, v5, v28
v_dot2_f32_bf16 v29, v117, v5, v29
v_dot2_f32_bf16 v30, v121, v5, v30
v_dot2_f32_bf16 v31, v125, v5, v31
v_dot2_f32_bf16 v28, v114, v6, v28
v_dot2_f32_bf16 v29, v118, v6, v29
v_dot2_f32_bf16 v30, v122, v6, v30
v_dot2_f32_bf16 v31, v126, v6, v31
v_dot2_f32_bf16 v28, v115, v7, v28
v_dot2_f32_bf16 v29, v119, v7, v29
v_dot2_f32_bf16 v30, v123, v7, v30
v_dot2_f32_bf16 v31, v127, v7, v31
s_nop 0
v_permlane16_swap_b32 v28, v29
s_nop 0
v_permlane16_swap_b32 v30, v31
v_add_f32 v28, v28, v29
v_add_f32 v30, v30, v31
s_nop 0
v_add_f32_dpp v22, v28, v28 row_ror:8 row_mask:0xf bank_mask:0x3
v_add_f32_dpp v22, v30, v30 row_ror:8 row_mask:0xf bank_mask:0xc
v_dot2_f32_bf16 v28, v128, v4, 0
v_dot2_f32_bf16 v29, v132, v4, 0
v_dot2_f32_bf16 v30, v136, v4, 0
v_dot2_f32_bf16 v31, v140, v4, 0
v_dot2_f32_bf16 v28, v129, v5, v28
v_dot2_f32_bf16 v29, v133, v5, v29
v_dot2_f32_bf16 v30, v137, v5, v30
v_dot2_f32_bf16 v31, v141, v5, v31
v_dot2_f32_bf16 v28, v130, v6, v28
v_dot2_f32_bf16 v29, v134, v6, v29
v_dot2_f32_bf16 v30, v138, v6, v30
v_dot2_f32_bf16 v31, v142, v6, v31
v_dot2_f32_bf16 v28, v131, v7, v28
v_dot2_f32_bf16 v29, v135, v7, v29
v_dot2_f32_bf16 v30, v139, v7, v30
v_dot2_f32_bf16 v31, v143, v7, v31
s_nop 0
v_permlane16_swap_b32 v28, v29
s_nop 0
v_permlane16_swap_b32 v30, v31
v_add_f32 v28, v28, v29
v_add_f32 v30, v30, v31
s_nop 0
v_add_f32_dpp v23, v28, v28 row_ror:8 row_mask:0xf bank_mask:0x3
v_add_f32_dpp v23, v30, v30 row_ror:8 row_mask:0xf bank_mask:0xc
v_dot2_f32_bf16 v28, v144, v4, 0
v_dot2_f32_bf16 v29, v148, v4, 0
v_dot2_f32_bf16 v30, v152, v4, 0
v_dot2_f32_bf16 v31, v156, v4, 0
v_dot2_f32_bf16 v28, v145, v5, v28
v_dot2_f32_bf16 v29, v149, v5, v29
v_dot2_f32_bf16 v30, v153, v5, v30
v_dot2_f32_bf16 v31, v157, v5, v31
v_dot2_f32_bf16 v28, v146, v6, v28
v_dot2_f32_bf16 v29, v150, v6, v29
v_dot2_f32_bf16 v30, v154, v6, v30
v_dot2_f32_bf16 v31, v158, v6, v31
v_dot2_f32_bf16 v28, v147, v7, v28
v_dot2_f32_bf16 v29, v151, v7, v29
v_dot2_f32_bf16 v30, v155, v7, v30
v_dot2_f32_bf16 v31, v159, v7, v31
s_nop 0
v_permlane16_swap_b32 v28, v29
s_nop 0
v_permlane16_swap_b32 v30, v31
v_add_f32 v28, v28, v29
v_add_f32 v30, v30, v31
s_nop 0
v_add_f32_dpp v24, v28, v28 row_ror:8 row_mask:0xf bank_mask:0x3
v_add_f32_dpp v24, v30, v30 row_ror:8 row_mask:0xf bank_mask:0xc
v_add_f32_dpp v16, v16, v16 quad_perm:[1,0,3,2]
v_add_f32_dpp v17, v17, v17 quad_perm:[1,0,3,2]
v_add_f32_dpp v18, v18, v18 quad_perm:[1,0,3,2]
v_add_f32_dpp v19, v19, v19 quad_perm:[1,0,3,2]
v_add_f32_dpp v20, v20, v20 quad_perm:[1,0,3,2]
v_add_f32_dpp v21, v21, v21 quad_perm:[1,0,3,2]
v_add_f32_dpp v22, v22, v22 quad_perm:[1,0,3,2]
v_add_f32_dpp v23, v23, v23 quad_perm:[1,0,3,2]
v_add_f32_dpp v24, v24, v24 quad_perm:[1,0,3,2]
v_add_f32_dpp v16, v16, v16 quad_perm:[2,3,0,1]
v_add_f32_dpp v17, v17, v17 quad_perm:[2,3,0,1]
v_add_f32_dpp v18, v18, v18 quad_perm:[2,3,0,1]
v_add_f32_dpp v19, v19, v19 quad_perm:[2,3,0,1]
v_add_f32_dpp v20, v20, v20 quad_perm:[2,3,0,1]
v_add_f32_dpp v21, v21, v21 quad_perm:[2,3,0,1]
v_add_f32_dpp v22, v22, v22 quad_perm:[2,3,0,1]
v_add_f32_dpp v23, v23, v23 quad_perm:[2,3,0,1]
v_add_f32_dpp v24, v24, v24 quad_perm:[2,3,0,1]
v_add_f32_dpp v16, v16, v16 row_half_mirror
v_add_f32_dpp v17, v17, v17 row_half_mirror
v_add_f32_dpp v18, v18, v18 row_half_mirror
v_add_f32_dpp v19, v19, v19 row_half_mirror
v_add_f32_dpp v20, v20, v20 row_half_mirror
v_add_f32_dpp v21, v21, v21 row_half_mirror
v_add_f32_dpp v22, v22, v22 row_half_mirror
v_add_f32_dpp v23, v23, v23 row_half_mirror
v_add_f32_dpp v24, v24, v24 row_half_mirror
v_cvt_pk_bf16_f32 v16, v16, v16
v_cvt_pk_bf16_f32 v17, v17, v17
v_cvt_pk_bf16_f32 v18, v18, v18
v_cvt_pk_bf16_f32 v19, v19, v19
v_cvt_pk_bf16_f32 v20, v20, v20
v_cvt_pk_bf16_f32 v21, v21, v21
v_cvt_pk_bf16_f32 v22, v22, v22
v_cvt_pk_bf16_f32 v23, v23, v23
v_cvt_pk_bf16_f32 v24, v24, v24
v_and_b32 v16, s62, v16
v_and_b32 v17, s62, v17
v_and_b32 v18, s62, v18
v_and_b32 v19, s62, v19
v_and_b32 v20, s62, v20
v_and_b32 v21, s62, v21
v_and_b32 v22, s62, v22
v_and_b32 v23, s62, v23
v_and_b32 v24, s62, v24
v_mul_f32 v16, 0x3d800000, v16
v_mul_f32 v17, 0x3d800000, v17
v_mul_f32 v18, 0x3d800000, v18
v_mul_f32 v19, 0x3d800000, v19
v_mul_f32 v20, 0x3d800000, v20
v_mul_f32 v21, 0x3d800000, v21
v_mul_f32 v22, 0x3d800000, v22
v_mul_f32 v23, 0x3d800000, v23
v_mul_f32 v24, 0x3d800000, v24
v_max_f32 v26, v16, v17
v_max_f32 v26, v26, v18
v_max_f32 v26, v26, v19
v_max_f32 v26, v26, v20
v_max_f32 v26, v26, v21
v_max_f32 v26, v26, v22
v_max_f32 v26, v26, v23
v_max_f32 v26, v26, v24
s_nop 1
v_max_f32_dpp v26, v26, v26 row_ror:8
v_mov_b32 v28, v26
s_nop 1
v_permlane16_swap_b32 v26, v28
v_max_f32 v26, v26, v28
v_mov_b32 v28, v26
s_nop 1
v_permlane32_swap_b32 v26, v28
v_max_f32 v26, v26, v28
v_sub_f32 v16, v16, v26
v_sub_f32 v17, v17, v26
v_sub_f32 v18, v18, v26
v_sub_f32 v19, v19, v26
v_sub_f32 v20, v20, v26
v_sub_f32 v21, v21, v26
v_sub_f32 v22, v22, v26
v_sub_f32 v23, v23, v26
v_sub_f32 v24, v24, v26
v_mul_f32 v16, 0x3fb8aa3b, v16
v_mul_f32 v17, 0x3fb8aa3b, v17
v_mul_f32 v18, 0x3fb8aa3b, v18
v_mul_f32 v19, 0x3fb8aa3b, v19
v_mul_f32 v20, 0x3fb8aa3b, v20
v_mul_f32 v21, 0x3fb8aa3b, v21
v_mul_f32 v22, 0x3fb8aa3b, v22
v_mul_f32 v23, 0x3fb8aa3b, v23
v_mul_f32 v24, 0x3fb8aa3b, v24
v_exp_f32 v16, v16
v_exp_f32 v17, v17
v_exp_f32 v18, v18
v_exp_f32 v19, v19
v_exp_f32 v20, v20
v_exp_f32 v21, v21
v_exp_f32 v22, v22
v_exp_f32 v23, v23
v_exp_f32 v24, v24
v_add_f32 v27, v16, v17
v_add_f32 v27, v27, v18
v_add_f32 v27, v27, v19
v_add_f32 v27, v27, v20
v_add_f32 v27, v27, v21
v_add_f32 v27, v27, v22
v_add_f32 v27, v27, v23
v_add_f32 v27, v27, v24
s_nop 1
v_add_f32_dpp v27, v27, v27 row_ror:8
v_mov_b32 v28, v27
s_nop 1
v_permlane16_swap_b32 v27, v28
v_add_f32 v27, v27, v28
v_mov_b32 v28, v27
s_nop 1
v_permlane32_swap_b32 v27, v28
v_add_f32 v27, v27, v28
v_mov_b32 v36, v16
v_mov_b32 v37, v17
v_mov_b32 v38, v18
v_mov_b32 v39, v19
v_mov_b32 v40, v20
v_mov_b32 v41, v21
v_mov_b32 v42, v22
v_mov_b32 v43, v23
v_mov_b32 v44, v24
v_permlane16_swap_b32 v16, v36
v_permlane16_swap_b32 v17, v37
v_permlane16_swap_b32 v18, v38
v_permlane16_swap_b32 v19, v39
v_permlane16_swap_b32 v20, v40
v_permlane16_swap_b32 v21, v41
v_permlane16_swap_b32 v22, v42
v_permlane16_swap_b32 v23, v43
v_permlane16_swap_b32 v24, v44
v_cvt_pk_bf16_f32 v16, v16, v36
v_cvt_pk_bf16_f32 v17, v17, v37
v_cvt_pk_bf16_f32 v18, v18, v38
v_cvt_pk_bf16_f32 v19, v19, v39
v_cvt_pk_bf16_f32 v20, v20, v40
v_cvt_pk_bf16_f32 v21, v21, v41
v_cvt_pk_bf16_f32 v22, v22, v42
v_cvt_pk_bf16_f32 v23, v23, v43
v_cvt_pk_bf16_f32 v24, v24, v44
v_mov_b32 v8, 0
v_mov_b32 v9, 0
v_mov_b32 v10, 0
v_mov_b32 v11, 0
v_mov_b32 v12, 0
v_mov_b32 v13, 0
v_mov_b32 v14, 0
v_mov_b32 v15, 0
v_perm_b32 v28, v164, v160, s80
v_perm_b32 v29, v164, v160, s81
v_perm_b32 v30, v165, v161, s80
v_perm_b32 v31, v165, v161, s81
v_perm_b32 v32, v166, v162, s80
v_perm_b32 v33, v166, v162, s81
v_perm_b32 v34, v167, v163, s80
v_perm_b32 v35, v167, v163, s81
v_dot2c_f32_bf16_dpp v8, v16, v28 row_newbcast:0
v_dot2c_f32_bf16_dpp v9, v16, v29 row_newbcast:0
v_dot2c_f32_bf16_dpp v10, v16, v30 row_newbcast:0
v_dot2c_f32_bf16_dpp v11, v16, v31 row_newbcast:0
v_dot2c_f32_bf16_dpp v12, v16, v32 row_newbcast:0
v_dot2c_f32_bf16_dpp v13, v16, v33 row_newbcast:0
v_dot2c_f32_bf16_dpp v14, v16, v34 row_newbcast:0
v_dot2c_f32_bf16_dpp v15, v16, v35 row_newbcast:0
v_perm_b32 v28, v172, v168, s80
v_perm_b32 v29, v172, v168, s81
v_perm_b32 v30, v173, v169, s80
v_perm_b32 v31, v173, v169, s81
v_perm_b32 v32, v174, v170, s80
v_perm_b32 v33, v174, v170, s81
v_perm_b32 v34, v175, v171, s80
v_perm_b32 v35, v175, v171, s81
v_dot2c_f32_bf16_dpp v8, v16, v28 row_newbcast:8
v_dot2c_f32_bf16_dpp v9, v16, v29 row_newbcast:8
v_dot2c_f32_bf16_dpp v10, v16, v30 row_newbcast:8
v_dot2c_f32_bf16_dpp v11, v16, v31 row_newbcast:8
v_dot2c_f32_bf16_dpp v12, v16, v32 row_newbcast:8
v_dot2c_f32_bf16_dpp v13, v16, v33 row_newbcast:8
v_dot2c_f32_bf16_dpp v14, v16, v34 row_newbcast:8
v_dot2c_f32_bf16_dpp v15, v16, v35 row_newbcast:8
v_perm_b32 v28, v180, v176, s80
v_perm_b32 v29, v180, v176, s81
v_perm_b32 v30, v181, v177, s80
v_perm_b32 v31, v181, v177, s81
v_perm_b32 v32, v182, v178, s80
v_perm_b32 v33, v182, v178, s81
v_perm_b32 v34, v183, v179, s80
v_perm_b32 v35, v183, v179, s81
v_dot2c_f32_bf16_dpp v8, v17, v28 row_newbcast:0
v_dot2c_f32_bf16_dpp v9, v17, v29 row_newbcast:0
v_dot2c_f32_bf16_dpp v10, v17, v30 row_newbcast:0
v_dot2c_f32_bf16_dpp v11, v17, v31 row_newbcast:0
v_dot2c_f32_bf16_dpp v12, v17, v32 row_newbcast:0
v_dot2c_f32_bf16_dpp v13, v17, v33 row_newbcast:0
v_dot2c_f32_bf16_dpp v14, v17, v34 row_newbcast:0
v_dot2c_f32_bf16_dpp v15, v17, v35 row_newbcast:0
v_perm_b32 v28, v188, v184, s80
v_perm_b32 v29, v188, v184, s81
v_perm_b32 v30, v189, v185, s80
v_perm_b32 v31, v189, v185, s81
v_perm_b32 v32, v190, v186, s80
v_perm_b32 v33, v190, v186, s81
v_perm_b32 v34, v191, v187, s80
v_perm_b32 v35, v191, v187, s81
v_dot2c_f32_bf16_dpp v8, v17, v28 row_newbcast:8
v_dot2c_f32_bf16_dpp v9, v17, v29 row_newbcast:8
v_dot2c_f32_bf16_dpp v10, v17, v30 row_newbcast:8
v_dot2c_f32_bf16_dpp v11, v17, v31 row_newbcast:8
v_dot2c_f32_bf16_dpp v12, v17, v32 row_newbcast:8
v_dot2c_f32_bf16_dpp v13, v17, v33 row_newbcast:8
v_dot2c_f32_bf16_dpp v14, v17, v34 row_newbcast:8
v_dot2c_f32_bf16_dpp v15, v17, v35 row_newbcast:8
v_perm_b32 v28, v196, v192, s80
v_perm_b32 v29, v196, v192, s81
v_perm_b32 v30, v197, v193, s80
v_perm_b32 v31, v197, v193, s81
v_perm_b32 v32, v198, v194, s80
v_perm_b32 v33, v198, v194, s81
v_perm_b32 v34, v199, v195, s80
v_perm_b32 v35, v199, v195, s81
v_dot2c_f32_bf16_dpp v8, v18, v28 row_newbcast:0
v_dot2c_f32_bf16_dpp v9, v18, v29 row_newbcast:0
v_dot2c_f32_bf16_dpp v10, v18, v30 row_newbcast:0
v_dot2c_f32_bf16_dpp v11, v18, v31 row_newbcast:0
v_dot2c_f32_bf16_dpp v12, v18, v32 row_newbcast:0
v_dot2c_f32_bf16_dpp v13, v18, v33 row_newbcast:0
v_dot2c_f32_bf16_dpp v14, v18, v34 row_newbcast:0
v_dot2c_f32_bf16_dpp v15, v18, v35 row_newbcast:0
v_perm_b32 v28, v204, v200, s80
v_perm_b32 v29, v204, v200, s81
v_perm_b32 v30, v205, v201, s80
v_perm_b32 v31, v205, v201, s81
v_perm_b32 v32, v206, v202, s80
v_perm_b32 v33, v206, v202, s81
v_perm_b32 v34, v207, v203, s80
v_perm_b32 v35, v207, v203, s81
v_dot2c_f32_bf16_dpp v8, v18, v28 row_newbcast:8
v_dot2c_f32_bf16_dpp v9, v18, v29 row_newbcast:8
v_dot2c_f32_bf16_dpp v10, v18, v30 row_newbcast:8
v_dot2c_f32_bf16_dpp v11, v18, v31 row_newbcast:8
v_dot2c_f32_bf16_dpp v12, v18, v32 row_newbcast:8
v_dot2c_f32_bf16_dpp v13, v18, v33 row_newbcast:8
v_dot2c_f32_bf16_dpp v14, v18, v34 row_newbcast:8
v_dot2c_f32_bf16_dpp v15, v18, v35 row_newbcast:8
v_perm_b32 v28, v212, v208, s80
v_perm_b32 v29, v212, v208, s81
v_perm_b32 v30, v213, v209, s80
v_perm_b32 v31, v213, v209, s81
v_perm_b32 v32, v214, v210, s80
v_perm_b32 v33, v214, v210, s81
v_perm_b32 v34, v215, v211, s80
v_perm_b32 v35, v215, v211, s81
v_dot2c_f32_bf16_dpp v8, v19, v28 row_newbcast:0
v_dot2c_f32_bf16_dpp v9, v19, v29 row_newbcast:0
v_dot2c_f32_bf16_dpp v10, v19, v30 row_newbcast:0
v_dot2c_f32_bf16_dpp v11, v19, v31 row_newbcast:0
v_dot2c_f32_bf16_dpp v12, v19, v32 row_newbcast:0
v_dot2c_f32_bf16_dpp v13, v19, v33 row_newbcast:0
v_dot2c_f32_bf16_dpp v14, v19, v34 row_newbcast:0
v_dot2c_f32_bf16_dpp v15, v19, v35 row_newbcast:0
v_perm_b32 v28, v220, v216, s80
v_perm_b32 v29, v220, v216, s81
v_perm_b32 v30, v221, v217, s80
v_perm_b32 v31, v221, v217, s81
v_perm_b32 v32, v222, v218, s80
v_perm_b32 v33, v222, v218, s81
v_perm_b32 v34, v223, v219, s80
v_perm_b32 v35, v223, v219, s81
v_dot2c_f32_bf16_dpp v8, v19, v28 row_newbcast:8
v_dot2c_f32_bf16_dpp v9, v19, v29 row_newbcast:8
v_dot2c_f32_bf16_dpp v10, v19, v30 row_newbcast:8
v_dot2c_f32_bf16_dpp v11, v19, v31 row_newbcast:8
v_dot2c_f32_bf16_dpp v12, v19, v32 row_newbcast:8
v_dot2c_f32_bf16_dpp v13, v19, v33 row_newbcast:8
v_dot2c_f32_bf16_dpp v14, v19, v34 row_newbcast:8
v_dot2c_f32_bf16_dpp v15, v19, v35 row_newbcast:8
v_perm_b32 v28, v228, v224, s80
v_perm_b32 v29, v228, v224, s81
v_perm_b32 v30, v229, v225, s80
v_perm_b32 v31, v229, v225, s81
v_perm_b32 v32, v230, v226, s80
v_perm_b32 v33, v230, v226, s81
v_perm_b32 v34, v231, v227, s80
v_perm_b32 v35, v231, v227, s81
v_dot2c_f32_bf16_dpp v8, v20, v28 row_newbcast:0
v_dot2c_f32_bf16_dpp v9, v20, v29 row_newbcast:0
v_dot2c_f32_bf16_dpp v10, v20, v30 row_newbcast:0
v_dot2c_f32_bf16_dpp v11, v20, v31 row_newbcast:0
v_dot2c_f32_bf16_dpp v12, v20, v32 row_newbcast:0
v_dot2c_f32_bf16_dpp v13, v20, v33 row_newbcast:0
v_dot2c_f32_bf16_dpp v14, v20, v34 row_newbcast:0
v_dot2c_f32_bf16_dpp v15, v20, v35 row_newbcast:0
v_perm_b32 v28, v236, v232, s80
v_perm_b32 v29, v236, v232, s81
v_perm_b32 v30, v237, v233, s80
v_perm_b32 v31, v237, v233, s81
v_perm_b32 v32, v238, v234, s80
v_perm_b32 v33, v238, v234, s81
v_perm_b32 v34, v239, v235, s80
v_perm_b32 v35, v239, v235, s81
v_dot2c_f32_bf16_dpp v8, v20, v28 row_newbcast:8
v_dot2c_f32_bf16_dpp v9, v20, v29 row_newbcast:8
v_dot2c_f32_bf16_dpp v10, v20, v30 row_newbcast:8
v_dot2c_f32_bf16_dpp v11, v20, v31 row_newbcast:8
v_dot2c_f32_bf16_dpp v12, v20, v32 row_newbcast:8
v_dot2c_f32_bf16_dpp v13, v20, v33 row_newbcast:8
v_dot2c_f32_bf16_dpp v14, v20, v34 row_newbcast:8
v_dot2c_f32_bf16_dpp v15, v20, v35 row_newbcast:8
s_add_u32 s56, s51, 196608
buffer_load_dwordx4 v[232:235], v1, s[8:11], s56 offen offset:0 nt
s_waitcnt vmcnt(3)
s_add_u32 s56, s51, 196608
buffer_load_dwordx4 v[236:239], v1, s[8:11], s56 offen offset:1024 nt
s_waitcnt vmcnt(3)
v_perm_b32 v28, v244, v240, s80
v_perm_b32 v29, v244, v240, s81
v_perm_b32 v30, v245, v241, s80
v_perm_b32 v31, v245, v241, s81
v_perm_b32 v32, v246, v242, s80
v_perm_b32 v33, v246, v242, s81
v_perm_b32 v34, v247, v243, s80
v_perm_b32 v35, v247, v243, s81
v_dot2c_f32_bf16_dpp v8, v21, v28 row_newbcast:0
v_dot2c_f32_bf16_dpp v9, v21, v29 row_newbcast:0
v_dot2c_f32_bf16_dpp v10, v21, v30 row_newbcast:0
v_dot2c_f32_bf16_dpp v11, v21, v31 row_newbcast:0
v_dot2c_f32_bf16_dpp v12, v21, v32 row_newbcast:0
v_dot2c_f32_bf16_dpp v13, v21, v33 row_newbcast:0
v_dot2c_f32_bf16_dpp v14, v21, v34 row_newbcast:0
v_dot2c_f32_bf16_dpp v15, v21, v35 row_newbcast:0
s_add_u32 s56, s51, 196608
buffer_load_dwordx4 v[240:243], v1, s[8:11], s56 offen offset:2048 nt
s_waitcnt vmcnt(3)
s_add_u32 s56, s51, 196608
buffer_load_dwordx4 v[244:247], v1, s[8:11], s56 offen offset:3072 nt
s_waitcnt vmcnt(3)
v_perm_b32 v28, v252, v248, s80
v_perm_b32 v29, v252, v248, s81
v_perm_b32 v30, v253, v249, s80
v_perm_b32 v31, v253, v249, s81
v_perm_b32 v32, v254, v250, s80
v_perm_b32 v33, v254, v250, s81
v_perm_b32 v34, v255, v251, s80
v_perm_b32 v35, v255, v251, s81
v_dot2c_f32_bf16_dpp v8, v21, v28 row_newbcast:8
v_dot2c_f32_bf16_dpp v9, v21, v29 row_newbcast:8
v_dot2c_f32_bf16_dpp v10, v21, v30 row_newbcast:8
v_dot2c_f32_bf16_dpp v11, v21, v31 row_newbcast:8
v_dot2c_f32_bf16_dpp v12, v21, v32 row_newbcast:8
v_dot2c_f32_bf16_dpp v13, v21, v33 row_newbcast:8
v_dot2c_f32_bf16_dpp v14, v21, v34 row_newbcast:8
v_dot2c_f32_bf16_dpp v15, v21, v35 row_newbcast:8
s_add_u32 s56, s51, 229376
buffer_load_dwordx4 v[248:251], v1, s[8:11], s56 offen offset:0 nt
s_waitcnt vmcnt(3)
s_add_u32 s56, s51, 229376
buffer_load_dwordx4 v[252:255], v1, s[8:11], s56 offen offset:1024 nt
s_waitcnt vmcnt(3)
v_perm_b32 v28, v236, v232, s80
v_perm_b32 v29, v236, v232, s81
v_perm_b32 v30, v237, v233, s80
v_perm_b32 v31, v237, v233, s81
v_perm_b32 v32, v238, v234, s80
v_perm_b32 v33, v238, v234, s81
v_perm_b32 v34, v239, v235, s80
v_perm_b32 v35, v239, v235, s81
v_dot2c_f32_bf16_dpp v8, v22, v28 row_newbcast:0
v_dot2c_f32_bf16_dpp v9, v22, v29 row_newbcast:0
v_dot2c_f32_bf16_dpp v10, v22, v30 row_newbcast:0
v_dot2c_f32_bf16_dpp v11, v22, v31 row_newbcast:0
v_dot2c_f32_bf16_dpp v12, v22, v32 row_newbcast:0
v_dot2c_f32_bf16_dpp v13, v22, v33 row_newbcast:0
v_dot2c_f32_bf16_dpp v14, v22, v34 row_newbcast:0
v_dot2c_f32_bf16_dpp v15, v22, v35 row_newbcast:0
s_add_u32 s56, s51, 229376
buffer_load_dwordx4 v[232:235], v1, s[8:11], s56 offen offset:2048 nt
s_waitcnt vmcnt(3)
s_add_u32 s56, s51, 229376
buffer_load_dwordx4 v[236:239], v1, s[8:11], s56 offen offset:3072 nt
s_waitcnt vmcnt(3)
v_perm_b32 v28, v244, v240, s80
v_perm_b32 v29, v244, v240, s81
v_perm_b32 v30, v245, v241, s80
v_perm_b32 v31, v245, v241, s81
v_perm_b32 v32, v246, v242, s80
v_perm_b32 v33, v246, v242, s81
v_perm_b32 v34, v247, v243, s80
v_perm_b32 v35, v247, v243, s81
v_dot2c_f32_bf16_dpp v8, v22, v28 row_newbcast:8
v_dot2c_f32_bf16_dpp v9, v22, v29 row_newbcast:8
v_dot2c_f32_bf16_dpp v10, v22, v30 row_newbcast:8
v_dot2c_f32_bf16_dpp v11, v22, v31 row_newbcast:8
v_dot2c_f32_bf16_dpp v12, v22, v32 row_newbcast:8
v_dot2c_f32_bf16_dpp v13, v22, v33 row_newbcast:8
v_dot2c_f32_bf16_dpp v14, v22, v34 row_newbcast:8
v_dot2c_f32_bf16_dpp v15, v22, v35 row_newbcast:8
s_add_u32 s56, s51, 262144
buffer_load_dwordx4 v[240:243], v1, s[8:11], s56 offen offset:0 nt
s_waitcnt vmcnt(3)
s_add_u32 s56, s51, 262144
buffer_load_dwordx4 v[244:247], v1, s[8:11], s56 offen offset:1024 nt
s_waitcnt vmcnt(3)
v_perm_b32 v28, v252, v248, s80
v_perm_b32 v29, v252, v248, s81
v_perm_b32 v30, v253, v249, s80
v_perm_b32 v31, v253, v249, s81
v_perm_b32 v32, v254, v250, s80
v_perm_b32 v33, v254, v250, s81
v_perm_b32 v34, v255, v251, s80
v_perm_b32 v35, v255, v251, s81
v_dot2c_f32_bf16_dpp v8, v23, v28 row_newbcast:0
v_dot2c_f32_bf16_dpp v9, v23, v29 row_newbcast:0
v_dot2c_f32_bf16_dpp v10, v23, v30 row_newbcast:0
v_dot2c_f32_bf16_dpp v11, v23, v31 row_newbcast:0
v_dot2c_f32_bf16_dpp v12, v23, v32 row_newbcast:0
v_dot2c_f32_bf16_dpp v13, v23, v33 row_newbcast:0
v_dot2c_f32_bf16_dpp v14, v23, v34 row_newbcast:0
v_dot2c_f32_bf16_dpp v15, v23, v35 row_newbcast:0
s_add_u32 s56, s51, 262144
buffer_load_dwordx4 v[248:251], v1, s[8:11], s56 offen offset:2048 nt
s_waitcnt vmcnt(3)
s_add_u32 s56, s51, 262144
buffer_load_dwordx4 v[252:255], v1, s[8:11], s56 offen offset:3072 nt
s_waitcnt vmcnt(3)
v_and_b32 v32, 31, v3
v_lshlrev_b32 v32, 5, v32
s_lshl_b32 s56, s49, 10
s_add_u32 s56, s56, 0x408000
buffer_load_dwordx4 v[56:59], v32, s[44:47], s56 offen offset:0 sc1
buffer_load_dwordx4 v[60:63], v32, s[44:47], s56 offen offset:16 sc1
v_perm_b32 v28, v236, v232, s80
v_perm_b32 v29, v236, v232, s81
v_perm_b32 v30, v237, v233, s80
v_perm_b32 v31, v237, v233, s81
v_perm_b32 v32, v238, v234, s80
v_perm_b32 v33, v238, v234, s81
v_perm_b32 v34, v239, v235, s80
v_perm_b32 v35, v239, v235, s81
v_dot2c_f32_bf16_dpp v8, v23, v28 row_newbcast:8
v_dot2c_f32_bf16_dpp v9, v23, v29 row_newbcast:8
v_dot2c_f32_bf16_dpp v10, v23, v30 row_newbcast:8
v_dot2c_f32_bf16_dpp v11, v23, v31 row_newbcast:8
v_dot2c_f32_bf16_dpp v12, v23, v32 row_newbcast:8
v_dot2c_f32_bf16_dpp v13, v23, v33 row_newbcast:8
v_dot2c_f32_bf16_dpp v14, v23, v34 row_newbcast:8
v_dot2c_f32_bf16_dpp v15, v23, v35 row_newbcast:8
s_waitcnt vmcnt(3)
buffer_load_dwordx4 v[232:235], v1, s[4:7], s52 offen offset:0 nt
s_waitcnt vmcnt(3)
buffer_load_dwordx4 v[236:239], v1, s[4:7], s52 offen offset:1024 nt
v_perm_b32 v28, v244, v240, s80
v_perm_b32 v29, v244, v240, s81
v_perm_b32 v30, v245, v241, s80
v_perm_b32 v31, v245, v241, s81
v_perm_b32 v32, v246, v242, s80
v_perm_b32 v33, v246, v242, s81
v_perm_b32 v34, v247, v243, s80
v_perm_b32 v35, v247, v243, s81
v_dot2c_f32_bf16_dpp v8, v24, v28 row_newbcast:0
v_dot2c_f32_bf16_dpp v9, v24, v29 row_newbcast:0
v_dot2c_f32_bf16_dpp v10, v24, v30 row_newbcast:0
v_dot2c_f32_bf16_dpp v11, v24, v31 row_newbcast:0
v_dot2c_f32_bf16_dpp v12, v24, v32 row_newbcast:0
v_dot2c_f32_bf16_dpp v13, v24, v33 row_newbcast:0
v_dot2c_f32_bf16_dpp v14, v24, v34 row_newbcast:0
v_dot2c_f32_bf16_dpp v15, v24, v35 row_newbcast:0
s_waitcnt vmcnt(3)
buffer_load_dwordx4 v[240:243], v1, s[4:7], s52 offen offset:2048 nt
s_waitcnt vmcnt(3)
buffer_load_dwordx4 v[244:247], v1, s[4:7], s52 offen offset:3072 nt
v_perm_b32 v28, v252, v248, s80
v_perm_b32 v29, v252, v248, s81
v_perm_b32 v30, v253, v249, s80
v_perm_b32 v31, v253, v249, s81
v_perm_b32 v32, v254, v250, s80
v_perm_b32 v33, v254, v250, s81
v_perm_b32 v34, v255, v251, s80
v_perm_b32 v35, v255, v251, s81
v_dot2c_f32_bf16_dpp v8, v24, v28 row_newbcast:8
v_dot2c_f32_bf16_dpp v9, v24, v29 row_newbcast:8
v_dot2c_f32_bf16_dpp v10, v24, v30 row_newbcast:8
v_dot2c_f32_bf16_dpp v11, v24, v31 row_newbcast:8
v_dot2c_f32_bf16_dpp v12, v24, v32 row_newbcast:8
v_dot2c_f32_bf16_dpp v13, v24, v33 row_newbcast:8
v_dot2c_f32_bf16_dpp v14, v24, v34 row_newbcast:8
v_dot2c_f32_bf16_dpp v15, v24, v35 row_newbcast:8
s_waitcnt vmcnt(3)
s_add_u32 s56, s52, 32768
buffer_load_dwordx4 v[248:251], v1, s[4:7], s56 offen offset:0 nt
s_waitcnt vmcnt(3)
s_add_u32 s56, s52, 32768
buffer_load_dwordx4 v[252:255], v1, s[4:7], s56 offen offset:1024 nt
v_mov_b32 v36, v8
v_mov_b32 v37, v9
v_mov_b32 v38, v10
v_mov_b32 v39, v11
v_mov_b32 v40, v12
v_mov_b32 v41, v13
v_mov_b32 v42, v14
v_mov_b32 v43, v15
v_permlane32_swap_b32 v8, v36
v_permlane32_swap_b32 v9, v37
v_permlane32_swap_b32 v10, v38
v_permlane32_swap_b32 v11, v39
v_permlane32_swap_b32 v12, v40
v_permlane32_swap_b32 v13, v41
v_permlane32_swap_b32 v14, v42
v_permlane32_swap_b32 v15, v43
v_add_f32 v8, v8, v36
v_add_f32 v9, v9, v37
v_add_f32 v10, v10, v38
v_add_f32 v11, v11, v39
v_add_f32 v12, v12, v40
v_add_f32 v13, v13, v41
v_add_f32 v14, v14, v42
v_add_f32 v15, v15, v43
v_and_b32 v28, 31, v3
v_lshlrev_b32 v28, 5, v28
s_lshl_b32 s56, s48, 10
s_add_u32 s56, s56, 0x0
v_add_u32 v28, s56, v28
ds_write_b128 v28, v[8:11]
ds_write_b128 v28, v[12:15] offset:16
s_lshl_b32 s56, s48, 3
s_add_u32 s56, s56, 0x4000
v_mov_b32 v29, s56
ds_write_b64 v29, v[26:27]
v_mov_b32 v30, 0x4080
v_mov_b32 v31, 1
s_waitcnt lgkmcnt(0)
s_mov_b64 exec, 1
ds_add_rtn_u32 v28, v30, v31
s_mov_b64 exec, -1
s_waitcnt lgkmcnt(0)
v_readfirstlane_b32 s59, v28
s_nop 0
s_cmp_lg_u32 s59, 7
s_cbranch_scc1 L_nos1_34
s_setprio 3
v_add_u32 v24, 0x0, v1
v_mov_b32 v25, 0x4000
ds_read_b128 v[8:11], v25 offset:0
ds_read_b128 v[12:15], v25 offset:16
ds_read_b128 v[16:19], v25 offset:32
ds_read_b128 v[20:23], v25 offset:48
ds_read_b128 v[36:39], v24 offset:0
ds_read_b128 v[40:43], v24 offset:1024
ds_read_b128 v[44:47], v24 offset:2048
ds_read_b128 v[48:51], v24 offset:3072
s_waitcnt lgkmcnt(0)
v_max_f32 v26, v8, v10
v_max_f32 v26, v26, v12
v_max_f32 v26, v26, v14
v_max_f32 v26, v26, v16
v_max_f32 v26, v26, v18
v_max_f32 v26, v26, v20
v_max_f32 v26, v26, v22
v_sub_f32 v8, v8, v26
v_sub_f32 v10, v10, v26
v_sub_f32 v12, v12, v26
v_sub_f32 v14, v14, v26
v_sub_f32 v16, v16, v26
v_sub_f32 v18, v18, v26
v_sub_f32 v20, v20, v26
v_sub_f32 v22, v22, v26
v_mul_f32 v8, 0x3fb8aa3b, v8
v_mul_f32 v10, 0x3fb8aa3b, v10
v_mul_f32 v12, 0x3fb8aa3b, v12
v_mul_f32 v14, 0x3fb8aa3b, v14
v_mul_f32 v16, 0x3fb8aa3b, v16
v_mul_f32 v18, 0x3fb8aa3b, v18
v_mul_f32 v20, 0x3fb8aa3b, v20
v_mul_f32 v22, 0x3fb8aa3b, v22
v_exp_f32 v8, v8
v_exp_f32 v10, v10
v_exp_f32 v12, v12
v_exp_f32 v14, v14
v_exp_f32 v16, v16
v_exp_f32 v18, v18
v_exp_f32 v20, v20
v_exp_f32 v22, v22
v_mul_f32 v27, v8, v9
v_fmac_f32 v27, v10, v11
v_fmac_f32 v27, v12, v13
v_fmac_f32 v27, v14, v15
v_fmac_f32 v27, v16, v17
v_fmac_f32 v27, v18, v19
v_fmac_f32 v27, v20, v21
v_fmac_f32 v27, v22, v23
v_mul_f32 v28, v8, v36
v_mul_f32 v29, v8, v37
v_mul_f32 v30, v8, v38
v_mul_f32 v31, v8, v39
v_fmac_f32 v28, v10, v40
v_fmac_f32 v29, v10, v41
v_fmac_f32 v30, v10, v42
v_fmac_f32 v31, v10, v43
v_fmac_f32 v28, v12, v44
v_fmac_f32 v29, v12, v45
v_fmac_f32 v30, v12, v46
v_fmac_f32 v31, v12, v47
v_fmac_f32 v28, v14, v48
v_fmac_f32 v29, v14, v49
v_fmac_f32 v30, v14, v50
v_fmac_f32 v31, v14, v51
ds_read_b128 v[36:39], v24 offset:4096
ds_read_b128 v[40:43], v24 offset:5120
ds_read_b128 v[44:47], v24 offset:6144
ds_read_b128 v[48:51], v24 offset:7168
s_waitcnt lgkmcnt(0)
v_fmac_f32 v28, v16, v36
v_fmac_f32 v29, v16, v37
v_fmac_f32 v30, v16, v38
v_fmac_f32 v31, v16, v39
v_fmac_f32 v28, v18, v40
v_fmac_f32 v29, v18, v41
v_fmac_f32 v30, v18, v42
v_fmac_f32 v31, v18, v43
v_fmac_f32 v28, v20, v44
v_fmac_f32 v29, v20, v45
v_fmac_f32 v30, v20, v46
v_fmac_f32 v31, v20, v47
v_fmac_f32 v28, v22, v48
v_fmac_f32 v29, v22, v49
v_fmac_f32 v30, v22, v50
v_fmac_f32 v31, v22, v51
v_or_b32 v28, 1, v28
v_or_b32 v29, 1, v29
v_or_b32 v30, 1, v30
v_or_b32 v31, 1, v31
v_or_b32 v26, 1, v26
v_or_b32 v27, 1, v27
s_mul_i32 s56, s49, 14
s_add_u32 s56, s56, s50
s_mul_i32 s56, s56, 1088
s_add_u32 s56, s56, 0x100000
buffer_store_dwordx4 v[28:31], v1, s[44:47], s56 offen sc1
s_mov_b64 exec, 1
buffer_store_dwordx2 v[26:27], v1, s[44:47], s56 offen offset:1024 sc1
s_mov_b64 exec, -1
L_nos1_34:
s_nop 4
v_mov_b32 v28, 0x4080
s_mov_b32 s60, 0
L_p_wgw_49:
s_nop 4
ds_read_b32 v29, v28
s_waitcnt lgkmcnt(0)
v_cmp_ne_u32 vcc, 8, v29
s_cbranch_vccz L_d_wgw_50
s_sleep 1
s_add_u32 s60, s60, 1
s_cmp_lt_u32 s60, 400000
s_cbranch_scc1 L_p_wgw_49
s_endpgm
L_d_wgw_50:
s_nop 4
s_setprio 2
v_mov_b32 v28, 0
v_xor_b32 v29, v52, v56
v_or_b32 v28, v29, v28
v_xor_b32 v29, v52, v58
v_or_b32 v28, v29, v28
v_xor_b32 v29, v52, v60
v_or_b32 v28, v29, v28
v_xor_b32 v29, v52, v62
v_or_b32 v28, v29, v28
v_cmp_ne_u32 vcc, 0, v28
s_cbranch_vccz L_qburst_52
s_mov_b32 s60, 0
L_p_q_54:
s_nop 4
v_and_b32 v32, 31, v3
v_lshlrev_b32 v32, 5, v32
s_lshl_b32 s56, s49, 10
s_add_u32 s56, s56, 0x408000
buffer_load_dwordx4 v[56:59], v32, s[44:47], s56 offen offset:0 sc1
buffer_load_dwordx4 v[60:63], v32, s[44:47], s56 offen offset:16 sc1
s_waitcnt vmcnt(0)
v_mov_b32 v28, 0
v_xor_b32 v29, v52, v56
v_or_b32 v28, v29, v28
v_xor_b32 v29, v52, v58
v_or_b32 v28, v29, v28
v_xor_b32 v29, v52, v60
v_or_b32 v28, v29, v28
v_xor_b32 v29, v52, v62
v_or_b32 v28, v29, v28
v_cmp_ne_u32 vcc, 0, v28
s_cbranch_vccz L_d_q_55
s_sleep 1
s_add_u32 s60, s60, 1
s_cmp_lt_u32 s60, 400000
s_cbranch_scc1 L_p_q_54
s_endpgm
L_d_q_55:
s_nop 4
s_branch L_qjoin_53
L_qburst_52:
s_nop 4
L_qjoin_53:
s_nop 4
v_mov_b32 v4, v57
v_mov_b32 v5, v59
v_mov_b32 v6, v61
v_mov_b32 v7, v63
s_waitcnt vmcnt(3)
s_waitcnt vmcnt(2)
v_dot2_f32_bf16 v28, v232, v4, 0
v_dot2_f32_bf16 v29, v236, v4, 0
v_dot2_f32_bf16 v30, v240, v4, 0
v_dot2_f32_bf16 v31, v244, v4, 0
v_dot2_f32_bf16 v28, v233, v5, v28
v_dot2_f32_bf16 v29, v237, v5, v29
v_dot2_f32_bf16 v30, v241, v5, v30
v_dot2_f32_bf16 v31, v245, v5, v31
v_dot2_f32_bf16 v28, v234, v6, v28
v_dot2_f32_bf16 v29, v238, v6, v29
v_dot2_f32_bf16 v30, v242, v6, v30
v_dot2_f32_bf16 v31, v246, v6, v31
v_dot2_f32_bf16 v28, v235, v7, v28
v_dot2_f32_bf16 v29, v239, v7, v29
v_dot2_f32_bf16 v30, v243, v7, v30
v_dot2_f32_bf16 v31, v247, v7, v31
s_nop 0
v_permlane16_swap_b32 v28, v29
s_nop 0
v_permlane16_swap_b32 v30, v31
v_add_f32 v28, v28, v29
v_add_f32 v30, v30, v31
s_nop 0
v_add_f32_dpp v16, v28, v28 row_ror:8 row_mask:0xf bank_mask:0x3
v_add_f32_dpp v16, v30, v30 row_ror:8 row_mask:0xf bank_mask:0xc
s_add_u32 s56, s52, 32768
buffer_load_dwordx4 v[232:235], v1, s[4:7], s56 offen offset:2048 nt
s_add_u32 s56, s52, 32768
buffer_load_dwordx4 v[236:239], v1, s[4:7], s56 offen offset:3072 nt
s_waitcnt vmcnt(3)
s_add_u32 s56, s52, 65536
buffer_load_dwordx4 v[240:243], v1, s[4:7], s56 offen offset:0 nt
s_waitcnt vmcnt(3)
s_add_u32 s56, s52, 65536
buffer_load_dwordx4 v[244:247], v1, s[4:7], s56 offen offset:1024 nt
s_waitcnt vmcnt(3)
s_waitcnt vmcnt(2)
v_dot2_f32_bf16 v28, v248, v4, 0
v_dot2_f32_bf16 v29, v252, v4, 0
v_dot2_f32_bf16 v30, v232, v4, 0
v_dot2_f32_bf16 v31, v236, v4, 0
v_dot2_f32_bf16 v28, v249, v5, v28
v_dot2_f32_bf16 v29, v253, v5, v29
v_dot2_f32_bf16 v30, v233, v5, v30
v_dot2_f32_bf16 v31, v237, v5, v31
v_dot2_f32_bf16 v28, v250, v6, v28
v_dot2_f32_bf16 v29, v254, v6, v29
v_dot2_f32_bf16 v30, v234, v6, v30
v_dot2_f32_bf16 v31, v238, v6, v31
v_dot2_f32_bf16 v28, v251, v7, v28
v_dot2_f32_bf16 v29, v255, v7, v29
v_dot2_f32_bf16 v30, v235, v7, v30
v_dot2_f32_bf16 v31, v239, v7, v31
s_nop 0
v_permlane16_swap_b32 v28, v29
s_nop 0
v_permlane16_swap_b32 v30, v31
v_add_f32 v28, v28, v29
v_add_f32 v30, v30, v31
s_nop 0
v_add_f32_dpp v17, v28, v28 row_ror:8 row_mask:0xf bank_mask:0x3
v_add_f32_dpp v17, v30, v30 row_ror:8 row_mask:0xf bank_mask:0xc
s_add_u32 s56, s52, 65536
buffer_load_dwordx4 v[248:251], v1, s[4:7], s56 offen offset:2048 nt
s_add_u32 s56, s52, 65536
buffer_load_dwordx4 v[252:255], v1, s[4:7], s56 offen offset:3072 nt
s_waitcnt vmcnt(3)
s_add_u32 s56, s52, 98304
buffer_load_dwordx4 v[232:235], v1, s[4:7], s56 offen offset:0 nt
s_waitcnt vmcnt(3)
s_add_u32 s56, s52, 98304
buffer_load_dwordx4 v[236:239], v1, s[4:7], s56 offen offset:1024 nt
s_waitcnt vmcnt(3)
s_waitcnt vmcnt(2)
v_dot2_f32_bf16 v28, v240, v4, 0
v_dot2_f32_bf16 v29, v244, v4, 0
v_dot2_f32_bf16 v30, v248, v4, 0
v_dot2_f32_bf16 v31, v252, v4, 0
v_dot2_f32_bf16 v28, v241, v5, v28
v_dot2_f32_bf16 v29, v245, v5, v29
v_dot2_f32_bf16 v30, v249, v5, v30
v_dot2_f32_bf16 v31, v253, v5, v31
v_dot2_f32_bf16 v28, v242, v6, v28
v_dot2_f32_bf16 v29, v246, v6, v29
v_dot2_f32_bf16 v30, v250, v6, v30
v_dot2_f32_bf16 v31, v254, v6, v31
v_dot2_f32_bf16 v28, v243, v7, v28
v_dot2_f32_bf16 v29, v247, v7, v29
v_dot2_f32_bf16 v30, v251, v7, v30
v_dot2_f32_bf16 v31, v255, v7, v31
s_nop 0
v_permlane16_swap_b32 v28, v29
s_nop 0
v_permlane16_swap_b32 v30, v31
v_add_f32 v28, v28, v29
v_add_f32 v30, v30, v31
s_nop 0
v_add_f32_dpp v18, v28, v28 row_ror:8 row_mask:0xf bank_mask:0x3
v_add_f32_dpp v18, v30, v30 row_ror:8 row_mask:0xf bank_mask:0xc
s_add_u32 s56, s52, 98304
buffer_load_dwordx4 v[240:243], v1, s[4:7], s56 offen offset:2048 nt
s_add_u32 s56, s52, 98304
buffer_load_dwordx4 v[244:247], v1, s[4:7], s56 offen offset:3072 nt
s_waitcnt vmcnt(3)
s_add_u32 s56, s52, 131072
buffer_load_dwordx4 v[248:251], v1, s[4:7], s56 offen offset:0 nt
s_waitcnt vmcnt(3)
s_add_u32 s56, s52, 131072
buffer_load_dwordx4 v[252:255], v1, s[4:7], s56 offen offset:1024 nt
s_waitcnt vmcnt(3)
s_waitcnt vmcnt(2)
v_dot2_f32_bf16 v28, v232, v4, 0
v_dot2_f32_bf16 v29, v236, v4, 0
v_dot2_f32_bf16 v30, v240, v4, 0
v_dot2_f32_bf16 v31, v244, v4, 0
v_dot2_f32_bf16 v28, v233, v5, v28
v_dot2_f32_bf16 v29, v237, v5, v29
v_dot2_f32_bf16 v30, v241, v5, v30
v_dot2_f32_bf16 v31, v245, v5, v31
v_dot2_f32_bf16 v28, v234, v6, v28
v_dot2_f32_bf16 v29, v238, v6, v29
v_dot2_f32_bf16 v30, v242, v6, v30
v_dot2_f32_bf16 v31, v246, v6, v31
v_dot2_f32_bf16 v28, v235, v7, v28
v_dot2_f32_bf16 v29, v239, v7, v29
v_dot2_f32_bf16 v30, v243, v7, v30
v_dot2_f32_bf16 v31, v247, v7, v31
s_nop 0
v_permlane16_swap_b32 v28, v29
s_nop 0
v_permlane16_swap_b32 v30, v31
v_add_f32 v28, v28, v29
v_add_f32 v30, v30, v31
s_nop 0
v_add_f32_dpp v19, v28, v28 row_ror:8 row_mask:0xf bank_mask:0x3
v_add_f32_dpp v19, v30, v30 row_ror:8 row_mask:0xf bank_mask:0xc
s_add_u32 s56, s52, 131072
buffer_load_dwordx4 v[232:235], v1, s[4:7], s56 offen offset:2048 nt
s_add_u32 s56, s52, 131072
buffer_load_dwordx4 v[236:239], v1, s[4:7], s56 offen offset:3072 nt
s_waitcnt vmcnt(3)
s_add_u32 s56, s52, 163840
buffer_load_dwordx4 v[240:243], v1, s[4:7], s56 offen offset:0 nt
s_waitcnt vmcnt(3)
s_add_u32 s56, s52, 163840
buffer_load_dwordx4 v[244:247], v1, s[4:7], s56 offen offset:1024 nt
s_waitcnt vmcnt(3)
s_waitcnt vmcnt(2)
v_dot2_f32_bf16 v28, v248, v4, 0
v_dot2_f32_bf16 v29, v252, v4, 0
v_dot2_f32_bf16 v30, v232, v4, 0
v_dot2_f32_bf16 v31, v236, v4, 0
v_dot2_f32_bf16 v28, v249, v5, v28
v_dot2_f32_bf16 v29, v253, v5, v29
v_dot2_f32_bf16 v30, v233, v5, v30
v_dot2_f32_bf16 v31, v237, v5, v31
v_dot2_f32_bf16 v28, v250, v6, v28
v_dot2_f32_bf16 v29, v254, v6, v29
v_dot2_f32_bf16 v30, v234, v6, v30
v_dot2_f32_bf16 v31, v238, v6, v31
v_dot2_f32_bf16 v28, v251, v7, v28
v_dot2_f32_bf16 v29, v255, v7, v29
v_dot2_f32_bf16 v30, v235, v7, v30
v_dot2_f32_bf16 v31, v239, v7, v31
s_nop 0
v_permlane16_swap_b32 v28, v29
s_nop 0
v_permlane16_swap_b32 v30, v31
v_add_f32 v28, v28, v29
v_add_f32 v30, v30, v31
s_nop 0
v_add_f32_dpp v20, v28, v28 row_ror:8 row_mask:0xf bank_mask:0x3
v_add_f32_dpp v20, v30, v30 row_ror:8 row_mask:0xf bank_mask:0xc
s_add_u32 s56, s52, 163840
buffer_load_dwordx4 v[248:251], v1, s[4:7], s56 offen offset:2048 nt
s_add_u32 s56, s52, 163840
buffer_load_dwordx4 v[252:255], v1, s[4:7], s56 offen offset:3072 nt
s_waitcnt vmcnt(3)
s_add_u32 s56, s52, 196608
buffer_load_dwordx4 v[232:235], v1, s[4:7], s56 offen offset:0 nt
s_waitcnt vmcnt(3)
s_add_u32 s56, s52, 196608
buffer_load_dwordx4 v[236:239], v1, s[4:7], s56 offen offset:1024 nt
s_waitcnt vmcnt(3)
s_waitcnt vmcnt(2)
v_dot2_f32_bf16 v28, v240, v4, 0
v_dot2_f32_bf16 v29, v244, v4, 0
v_dot2_f32_bf16 v30, v248, v4, 0
v_dot2_f32_bf16 v31, v252, v4, 0
v_dot2_f32_bf16 v28, v241, v5, v28
v_dot2_f32_bf16 v29, v245, v5, v29
v_dot2_f32_bf16 v30, v249, v5, v30
v_dot2_f32_bf16 v31, v253, v5, v31
v_dot2_f32_bf16 v28, v242, v6, v28
v_dot2_f32_bf16 v29, v246, v6, v29
v_dot2_f32_bf16 v30, v250, v6, v30
v_dot2_f32_bf16 v31, v254, v6, v31
v_dot2_f32_bf16 v28, v243, v7, v28
v_dot2_f32_bf16 v29, v247, v7, v29
v_dot2_f32_bf16 v30, v251, v7, v30
v_dot2_f32_bf16 v31, v255, v7, v31
s_nop 0
v_permlane16_swap_b32 v28, v29
s_nop 0
v_permlane16_swap_b32 v30, v31
v_add_f32 v28, v28, v29
v_add_f32 v30, v30, v31
s_nop 0
v_add_f32_dpp v21, v28, v28 row_ror:8 row_mask:0xf bank_mask:0x3
v_add_f32_dpp v21, v30, v30 row_ror:8 row_mask:0xf bank_mask:0xc
s_add_u32 s56, s52, 196608
buffer_load_dwordx4 v[240:243], v1, s[4:7], s56 offen offset:2048 nt
s_add_u32 s56, s52, 196608
buffer_load_dwordx4 v[244:247], v1, s[4:7], s56 offen offset:3072 nt
s_waitcnt vmcnt(3)
s_add_u32 s56, s52, 229376
buffer_load_dwordx4 v[248:251], v1, s[4:7], s56 offen offset:0 nt
s_waitcnt vmcnt(3)
s_add_u32 s56, s52, 229376
buffer_load_dwordx4 v[252:255], v1, s[4:7], s56 offen offset:1024 nt
s_waitcnt vmcnt(3)
s_waitcnt vmcnt(2)
v_dot2_f32_bf16 v28, v232, v4, 0
v_dot2_f32_bf16 v29, v236, v4, 0
v_dot2_f32_bf16 v30, v240, v4, 0
v_dot2_f32_bf16 v31, v244, v4, 0
v_dot2_f32_bf16 v28, v233, v5, v28
v_dot2_f32_bf16 v29, v237, v5, v29
v_dot2_f32_bf16 v30, v241, v5, v30
v_dot2_f32_bf16 v31, v245, v5, v31
v_dot2_f32_bf16 v28, v234, v6, v28
v_dot2_f32_bf16 v29, v238, v6, v29
v_dot2_f32_bf16 v30, v242, v6, v30
v_dot2_f32_bf16 v31, v246, v6, v31
v_dot2_f32_bf16 v28, v235, v7, v28
v_dot2_f32_bf16 v29, v239, v7, v29
v_dot2_f32_bf16 v30, v243, v7, v30
v_dot2_f32_bf16 v31, v247, v7, v31
s_nop 0
v_permlane16_swap_b32 v28, v29
s_nop 0
v_permlane16_swap_b32 v30, v31
v_add_f32 v28, v28, v29
v_add_f32 v30, v30, v31
s_nop 0
v_add_f32_dpp v22, v28, v28 row_ror:8 row_mask:0xf bank_mask:0x3
v_add_f32_dpp v22, v30, v30 row_ror:8 row_mask:0xf bank_mask:0xc
s_add_u32 s56, s52, 229376
buffer_load_dwordx4 v[232:235], v1, s[4:7], s56 offen offset:2048 nt
s_add_u32 s56, s52, 229376
buffer_load_dwordx4 v[236:239], v1, s[4:7], s56 offen offset:3072 nt
s_waitcnt vmcnt(3)
s_add_u32 s56, s52, 262144
buffer_load_dwordx4 v[240:243], v1, s[4:7], s56 offen offset:0 nt
s_waitcnt vmcnt(3)
s_add_u32 s56, s52, 262144
buffer_load_dwordx4 v[244:247], v1, s[4:7], s56 offen offset:1024 nt
s_waitcnt vmcnt(3)
s_waitcnt vmcnt(2)
v_dot2_f32_bf16 v28, v248, v4, 0
v_dot2_f32_bf16 v29, v252, v4, 0
v_dot2_f32_bf16 v30, v232, v4, 0
v_dot2_f32_bf16 v31, v236, v4, 0
v_dot2_f32_bf16 v28, v249, v5, v28
v_dot2_f32_bf16 v29, v253, v5, v29
v_dot2_f32_bf16 v30, v233, v5, v30
v_dot2_f32_bf16 v31, v237, v5, v31
v_dot2_f32_bf16 v28, v250, v6, v28
v_dot2_f32_bf16 v29, v254, v6, v29
v_dot2_f32_bf16 v30, v234, v6, v30
v_dot2_f32_bf16 v31, v238, v6, v31
v_dot2_f32_bf16 v28, v251, v7, v28
v_dot2_f32_bf16 v29, v255, v7, v29
v_dot2_f32_bf16 v30, v235, v7, v30
v_dot2_f32_bf16 v31, v239, v7, v31
s_nop 0
v_permlane16_swap_b32 v28, v29
s_nop 0
v_permlane16_swap_b32 v30, v31
v_add_f32 v28, v28, v29
v_add_f32 v30, v30, v31
s_nop 0
v_add_f32_dpp v23, v28, v28 row_ror:8 row_mask:0xf bank_mask:0x3
v_add_f32_dpp v23, v30, v30 row_ror:8 row_mask:0xf bank_mask:0xc
s_add_u32 s56, s52, 262144
buffer_load_dwordx4 v[248:251], v1, s[4:7], s56 offen offset:2048 nt
s_add_u32 s56, s52, 262144
buffer_load_dwordx4 v[252:255], v1, s[4:7], s56 offen offset:3072 nt
s_waitcnt vmcnt(3)
buffer_load_dwordx4 v[232:235], v1, s[8:11], s52 offen offset:0 nt
s_waitcnt vmcnt(3)
buffer_load_dwordx4 v[236:239], v1, s[8:11], s52 offen offset:1024 nt
s_waitcnt vmcnt(3)
s_waitcnt vmcnt(2)
v_dot2_f32_bf16 v28, v240, v4, 0
v_dot2_f32_bf16 v29, v244, v4, 0
v_dot2_f32_bf16 v30, v248, v4, 0
v_dot2_f32_bf16 v31, v252, v4, 0
v_dot2_f32_bf16 v28, v241, v5, v28
v_dot2_f32_bf16 v29, v245, v5, v29
v_dot2_f32_bf16 v30, v249, v5, v30
v_dot2_f32_bf16 v31, v253, v5, v31
v_dot2_f32_bf16 v28, v242, v6, v28
v_dot2_f32_bf16 v29, v246, v6, v29
v_dot2_f32_bf16 v30, v250, v6, v30
v_dot2_f32_bf16 v31, v254, v6, v31
v_dot2_f32_bf16 v28, v243, v7, v28
v_dot2_f32_bf16 v29, v247, v7, v29
v_dot2_f32_bf16 v30, v251, v7, v30
v_dot2_f32_bf16 v31, v255, v7, v31
s_nop 0
v_permlane16_swap_b32 v28, v29
s_nop 0
v_permlane16_swap_b32 v30, v31
v_add_f32 v28, v28, v29
v_add_f32 v30, v30, v31
s_nop 0
v_add_f32_dpp v24, v28, v28 row_ror:8 row_mask:0xf bank_mask:0x3
v_add_f32_dpp v24, v30, v30 row_ror:8 row_mask:0xf bank_mask:0xc
buffer_load_dwordx4 v[240:243], v1, s[8:11], s52 offen offset:2048 nt
buffer_load_dwordx4 v[244:247], v1, s[8:11], s52 offen offset:3072 nt
s_waitcnt vmcnt(3)
s_add_u32 s56, s52, 32768
buffer_load_dwordx4 v[248:251], v1, s[8:11], s56 offen offset:0 nt
s_waitcnt vmcnt(3)
s_add_u32 s56, s52, 32768
buffer_load_dwordx4 v[252:255], v1, s[8:11], s56 offen offset:1024 nt
s_waitcnt vmcnt(3)
v_add_f32_dpp v16, v16, v16 quad_perm:[1,0,3,2]
v_add_f32_dpp v17, v17, v17 quad_perm:[1,0,3,2]
v_add_f32_dpp v18, v18, v18 quad_perm:[1,0,3,2]
v_add_f32_dpp v19, v19, v19 quad_perm:[1,0,3,2]
v_add_f32_dpp v20, v20, v20 quad_perm:[1,0,3,2]
v_add_f32_dpp v21, v21, v21 quad_perm:[1,0,3,2]
v_add_f32_dpp v22, v22, v22 quad_perm:[1,0,3,2]
v_add_f32_dpp v23, v23, v23 quad_perm:[1,0,3,2]
v_add_f32_dpp v24, v24, v24 quad_perm:[1,0,3,2]
v_add_f32_dpp v16, v16, v16 quad_perm:[2,3,0,1]
v_add_f32_dpp v17, v17, v17 quad_perm:[2,3,0,1]
v_add_f32_dpp v18, v18, v18 quad_perm:[2,3,0,1]
v_add_f32_dpp v19, v19, v19 quad_perm:[2,3,0,1]
v_add_f32_dpp v20, v20, v20 quad_perm:[2,3,0,1]
v_add_f32_dpp v21, v21, v21 quad_perm:[2,3,0,1]
v_add_f32_dpp v22, v22, v22 quad_perm:[2,3,0,1]
v_add_f32_dpp v23, v23, v23 quad_perm:[2,3,0,1]
v_add_f32_dpp v24, v24, v24 quad_perm:[2,3,0,1]
v_add_f32_dpp v16, v16, v16 row_half_mirror
v_add_f32_dpp v17, v17, v17 row_half_mirror
v_add_f32_dpp v18, v18, v18 row_half_mirror
v_add_f32_dpp v19, v19, v19 row_half_mirror
v_add_f32_dpp v20, v20, v20 row_half_mirror
v_add_f32_dpp v21, v21, v21 row_half_mirror
v_add_f32_dpp v22, v22, v22 row_half_mirror
v_add_f32_dpp v23, v23, v23 row_half_mirror
v_add_f32_dpp v24, v24, v24 row_half_mirror
v_cvt_pk_bf16_f32 v16, v16, v16
v_cvt_pk_bf16_f32 v17, v17, v17
v_cvt_pk_bf16_f32 v18, v18, v18
v_cvt_pk_bf16_f32 v19, v19, v19
v_cvt_pk_bf16_f32 v20, v20, v20
v_cvt_pk_bf16_f32 v21, v21, v21
v_cvt_pk_bf16_f32 v22, v22, v22
v_cvt_pk_bf16_f32 v23, v23, v23
v_cvt_pk_bf16_f32 v24, v24, v24
v_and_b32 v16, s62, v16
v_and_b32 v17, s62, v17
v_and_b32 v18, s62, v18
v_and_b32 v19, s62, v19
v_and_b32 v20, s62, v20
v_and_b32 v21, s62, v21
v_and_b32 v22, s62, v22
v_and_b32 v23, s62, v23
v_and_b32 v24, s62, v24
v_mul_f32 v16, 0x3d800000, v16
v_mul_f32 v17, 0x3d800000, v17
v_mul_f32 v18, 0x3d800000, v18
v_mul_f32 v19, 0x3d800000, v19
v_mul_f32 v20, 0x3d800000, v20
v_mul_f32 v21, 0x3d800000, v21
v_mul_f32 v22, 0x3d800000, v22
v_mul_f32 v23, 0x3d800000, v23
v_mul_f32 v24, 0x3d800000, v24
v_max_f32 v26, v16, v17
v_max_f32 v26, v26, v18
v_max_f32 v26, v26, v19
v_max_f32 v26, v26, v20
v_max_f32 v26, v26, v21
v_max_f32 v26, v26, v22
v_max_f32 v26, v26, v23
v_max_f32 v26, v26, v24
s_nop 1
v_max_f32_dpp v26, v26, v26 row_ror:8
v_mov_b32 v28, v26
s_nop 1
v_permlane16_swap_b32 v26, v28
v_max_f32 v26, v26, v28
v_mov_b32 v28, v26
s_nop 1
v_permlane32_swap_b32 v26, v28
v_max_f32 v26, v26, v28
v_sub_f32 v16, v16, v26
v_sub_f32 v17, v17, v26
v_sub_f32 v18, v18, v26
v_sub_f32 v19, v19, v26
v_sub_f32 v20, v20, v26
v_sub_f32 v21, v21, v26
v_sub_f32 v22, v22, v26
v_sub_f32 v23, v23, v26
v_sub_f32 v24, v24, v26
v_mul_f32 v16, 0x3fb8aa3b, v16
v_mul_f32 v17, 0x3fb8aa3b, v17
v_mul_f32 v18, 0x3fb8aa3b, v18
v_mul_f32 v19, 0x3fb8aa3b, v19
v_mul_f32 v20, 0x3fb8aa3b, v20
v_mul_f32 v21, 0x3fb8aa3b, v21
v_mul_f32 v22, 0x3fb8aa3b, v22
v_mul_f32 v23, 0x3fb8aa3b, v23
v_mul_f32 v24, 0x3fb8aa3b, v24
v_exp_f32 v16, v16
v_exp_f32 v17, v17
v_exp_f32 v18, v18
v_exp_f32 v19, v19
v_exp_f32 v20, v20
v_exp_f32 v21, v21
v_exp_f32 v22, v22
v_exp_f32 v23, v23
v_exp_f32 v24, v24
v_add_f32 v27, v16, v17
v_add_f32 v27, v27, v18
v_add_f32 v27, v27, v19
v_add_f32 v27, v27, v20
v_add_f32 v27, v27, v21
v_add_f32 v27, v27, v22
v_add_f32 v27, v27, v23
v_add_f32 v27, v27, v24
s_nop 1
v_add_f32_dpp v27, v27, v27 row_ror:8
v_mov_b32 v28, v27
s_nop 1
v_permlane16_swap_b32 v27, v28
v_add_f32 v27, v27, v28
v_mov_b32 v28, v27
s_nop 1
v_permlane32_swap_b32 v27, v28
v_add_f32 v27, v27, v28
v_mov_b32 v36, v16
v_mov_b32 v37, v17
v_mov_b32 v38, v18
v_mov_b32 v39, v19
v_mov_b32 v40, v20
v_mov_b32 v41, v21
v_mov_b32 v42, v22
v_mov_b32 v43, v23
v_mov_b32 v44, v24
v_permlane16_swap_b32 v16, v36
v_permlane16_swap_b32 v17, v37
v_permlane16_swap_b32 v18, v38
v_permlane16_swap_b32 v19, v39
v_permlane16_swap_b32 v20, v40
v_permlane16_swap_b32 v21, v41
v_permlane16_swap_b32 v22, v42
v_permlane16_swap_b32 v23, v43
v_permlane16_swap_b32 v24, v44
v_cvt_pk_bf16_f32 v16, v16, v36
v_cvt_pk_bf16_f32 v17, v17, v37
v_cvt_pk_bf16_f32 v18, v18, v38
v_cvt_pk_bf16_f32 v19, v19, v39
v_cvt_pk_bf16_f32 v20, v20, v40
v_cvt_pk_bf16_f32 v21, v21, v41
v_cvt_pk_bf16_f32 v22, v22, v42
v_cvt_pk_bf16_f32 v23, v23, v43
v_cvt_pk_bf16_f32 v24, v24, v44
v_mov_b32 v8, 0
v_mov_b32 v9, 0
v_mov_b32 v10, 0
v_mov_b32 v11, 0
v_mov_b32 v12, 0
v_mov_b32 v13, 0
v_mov_b32 v14, 0
v_mov_b32 v15, 0
v_perm_b32 v28, v236, v232, s80
v_perm_b32 v29, v236, v232, s81
v_perm_b32 v30, v237, v233, s80
v_perm_b32 v31, v237, v233, s81
v_perm_b32 v32, v238, v234, s80
v_perm_b32 v33, v238, v234, s81
v_perm_b32 v34, v239, v235, s80
v_perm_b32 v35, v239, v235, s81
v_dot2c_f32_bf16_dpp v8, v16, v28 row_newbcast:0
v_dot2c_f32_bf16_dpp v9, v16, v29 row_newbcast:0
v_dot2c_f32_bf16_dpp v10, v16, v30 row_newbcast:0
v_dot2c_f32_bf16_dpp v11, v16, v31 row_newbcast:0
v_dot2c_f32_bf16_dpp v12, v16, v32 row_newbcast:0
v_dot2c_f32_bf16_dpp v13, v16, v33 row_newbcast:0
v_dot2c_f32_bf16_dpp v14, v16, v34 row_newbcast:0
v_dot2c_f32_bf16_dpp v15, v16, v35 row_newbcast:0
s_add_u32 s56, s52, 32768
buffer_load_dwordx4 v[232:235], v1, s[8:11], s56 offen offset:2048
s_waitcnt vmcnt(3)
s_add_u32 s56, s52, 32768
buffer_load_dwordx4 v[236:239], v1, s[8:11], s56 offen offset:3072
s_waitcnt vmcnt(3)
v_perm_b32 v28, v244, v240, s80
v_perm_b32 v29, v244, v240, s81
v_perm_b32 v30, v245, v241, s80
v_perm_b32 v31, v245, v241, s81
v_perm_b32 v32, v246, v242, s80
v_perm_b32 v33, v246, v242, s81
v_perm_b32 v34, v247, v243, s80
v_perm_b32 v35, v247, v243, s81
v_dot2c_f32_bf16_dpp v8, v16, v28 row_newbcast:8
v_dot2c_f32_bf16_dpp v9, v16, v29 row_newbcast:8
v_dot2c_f32_bf16_dpp v10, v16, v30 row_newbcast:8
v_dot2c_f32_bf16_dpp v11, v16, v31 row_newbcast:8
v_dot2c_f32_bf16_dpp v12, v16, v32 row_newbcast:8
v_dot2c_f32_bf16_dpp v13, v16, v33 row_newbcast:8
v_dot2c_f32_bf16_dpp v14, v16, v34 row_newbcast:8
v_dot2c_f32_bf16_dpp v15, v16, v35 row_newbcast:8
s_add_u32 s56, s52, 65536
buffer_load_dwordx4 v[240:243], v1, s[8:11], s56 offen offset:0
s_waitcnt vmcnt(3)
s_add_u32 s56, s52, 65536
buffer_load_dwordx4 v[244:247], v1, s[8:11], s56 offen offset:1024
s_waitcnt vmcnt(3)
v_perm_b32 v28, v252, v248, s80
v_perm_b32 v29, v252, v248, s81
v_perm_b32 v30, v253, v249, s80
v_perm_b32 v31, v253, v249, s81
v_perm_b32 v32, v254, v250, s80
v_perm_b32 v33, v254, v250, s81
v_perm_b32 v34, v255, v251, s80
v_perm_b32 v35, v255, v251, s81
v_dot2c_f32_bf16_dpp v8, v17, v28 row_newbcast:0
v_dot2c_f32_bf16_dpp v9, v17, v29 row_newbcast:0
v_dot2c_f32_bf16_dpp v10, v17, v30 row_newbcast:0
v_dot2c_f32_bf16_dpp v11, v17, v31 row_newbcast:0
v_dot2c_f32_bf16_dpp v12, v17, v32 row_newbcast:0
v_dot2c_f32_bf16_dpp v13, v17, v33 row_newbcast:0
v_dot2c_f32_bf16_dpp v14, v17, v34 row_newbcast:0
v_dot2c_f32_bf16_dpp v15, v17, v35 row_newbcast:0
s_add_u32 s56, s52, 65536
buffer_load_dwordx4 v[248:251], v1, s[8:11], s56 offen offset:2048
s_waitcnt vmcnt(3)
s_add_u32 s56, s52, 65536
buffer_load_dwordx4 v[252:255], v1, s[8:11], s56 offen offset:3072
s_waitcnt vmcnt(3)
v_perm_b32 v28, v236, v232, s80
v_perm_b32 v29, v236, v232, s81
v_perm_b32 v30, v237, v233, s80
v_perm_b32 v31, v237, v233, s81
v_perm_b32 v32, v238, v234, s80
v_perm_b32 v33, v238, v234, s81
v_perm_b32 v34, v239, v235, s80
v_perm_b32 v35, v239, v235, s81
v_dot2c_f32_bf16_dpp v8, v17, v28 row_newbcast:8
v_dot2c_f32_bf16_dpp v9, v17, v29 row_newbcast:8
v_dot2c_f32_bf16_dpp v10, v17, v30 row_newbcast:8
v_dot2c_f32_bf16_dpp v11, v17, v31 row_newbcast:8
v_dot2c_f32_bf16_dpp v12, v17, v32 row_newbcast:8
v_dot2c_f32_bf16_dpp v13, v17, v33 row_newbcast:8
v_dot2c_f32_bf16_dpp v14, v17, v34 row_newbcast:8
v_dot2c_f32_bf16_dpp v15, v17, v35 row_newbcast:8
s_add_u32 s56, s52, 98304
buffer_load_dwordx4 v[232:235], v1, s[8:11], s56 offen offset:0
s_waitcnt vmcnt(3)
s_add_u32 s56, s52, 98304
buffer_load_dwordx4 v[236:239], v1, s[8:11], s56 offen offset:1024
s_waitcnt vmcnt(3)
v_perm_b32 v28, v244, v240, s80
v_perm_b32 v29, v244, v240, s81
v_perm_b32 v30, v245, v241, s80
v_perm_b32 v31, v245, v241, s81
v_perm_b32 v32, v246, v242, s80
v_perm_b32 v33, v246, v242, s81
v_perm_b32 v34, v247, v243, s80
v_perm_b32 v35, v247, v243, s81
v_dot2c_f32_bf16_dpp v8, v18, v28 row_newbcast:0
v_dot2c_f32_bf16_dpp v9, v18, v29 row_newbcast:0
v_dot2c_f32_bf16_dpp v10, v18, v30 row_newbcast:0
v_dot2c_f32_bf16_dpp v11, v18, v31 row_newbcast:0
v_dot2c_f32_bf16_dpp v12, v18, v32 row_newbcast:0
v_dot2c_f32_bf16_dpp v13, v18, v33 row_newbcast:0
v_dot2c_f32_bf16_dpp v14, v18, v34 row_newbcast:0
v_dot2c_f32_bf16_dpp v15, v18, v35 row_newbcast:0
s_add_u32 s56, s52, 98304
buffer_load_dwordx4 v[240:243], v1, s[8:11], s56 offen offset:2048
s_waitcnt vmcnt(3)
s_add_u32 s56, s52, 98304
buffer_load_dwordx4 v[244:247], v1, s[8:11], s56 offen offset:3072
s_waitcnt vmcnt(3)
v_perm_b32 v28, v252, v248, s80
v_perm_b32 v29, v252, v248, s81
v_perm_b32 v30, v253, v249, s80
v_perm_b32 v31, v253, v249, s81
v_perm_b32 v32, v254, v250, s80
v_perm_b32 v33, v254, v250, s81
v_perm_b32 v34, v255, v251, s80
v_perm_b32 v35, v255, v251, s81
v_dot2c_f32_bf16_dpp v8, v18, v28 row_newbcast:8
v_dot2c_f32_bf16_dpp v9, v18, v29 row_newbcast:8
v_dot2c_f32_bf16_dpp v10, v18, v30 row_newbcast:8
v_dot2c_f32_bf16_dpp v11, v18, v31 row_newbcast:8
v_dot2c_f32_bf16_dpp v12, v18, v32 row_newbcast:8
v_dot2c_f32_bf16_dpp v13, v18, v33 row_newbcast:8
v_dot2c_f32_bf16_dpp v14, v18, v34 row_newbcast:8
v_dot2c_f32_bf16_dpp v15, v18, v35 row_newbcast:8
s_add_u32 s56, s52, 131072
buffer_load_dwordx4 v[248:251], v1, s[8:11], s56 offen offset:0
s_waitcnt vmcnt(3)
s_add_u32 s56, s52, 131072
buffer_load_dwordx4 v[252:255], v1, s[8:11], s56 offen offset:1024
s_waitcnt vmcnt(3)
v_perm_b32 v28, v236, v232, s80
v_perm_b32 v29, v236, v232, s81
v_perm_b32 v30, v237, v233, s80
v_perm_b32 v31, v237, v233, s81
v_perm_b32 v32, v238, v234, s80
v_perm_b32 v33, v238, v234, s81
v_perm_b32 v34, v239, v235, s80
v_perm_b32 v35, v239, v235, s81
v_dot2c_f32_bf16_dpp v8, v19, v28 row_newbcast:0
v_dot2c_f32_bf16_dpp v9, v19, v29 row_newbcast:0
v_dot2c_f32_bf16_dpp v10, v19, v30 row_newbcast:0
v_dot2c_f32_bf16_dpp v11, v19, v31 row_newbcast:0
v_dot2c_f32_bf16_dpp v12, v19, v32 row_newbcast:0
v_dot2c_f32_bf16_dpp v13, v19, v33 row_newbcast:0
v_dot2c_f32_bf16_dpp v14, v19, v34 row_newbcast:0
v_dot2c_f32_bf16_dpp v15, v19, v35 row_newbcast:0
s_add_u32 s56, s52, 131072
buffer_load_dwordx4 v[232:235], v1, s[8:11], s56 offen offset:2048
s_waitcnt vmcnt(3)
s_add_u32 s56, s52, 131072
buffer_load_dwordx4 v[236:239], v1, s[8:11], s56 offen offset:3072
s_waitcnt vmcnt(3)
v_perm_b32 v28, v244, v240, s80
v_perm_b32 v29, v244, v240, s81
v_perm_b32 v30, v245, v241, s80
v_perm_b32 v31, v245, v241, s81
v_perm_b32 v32, v246, v242, s80
v_perm_b32 v33, v246, v242, s81
v_perm_b32 v34, v247, v243, s80
v_perm_b32 v35, v247, v243, s81
v_dot2c_f32_bf16_dpp v8, v19, v28 row_newbcast:8
v_dot2c_f32_bf16_dpp v9, v19, v29 row_newbcast:8
v_dot2c_f32_bf16_dpp v10, v19, v30 row_newbcast:8
v_dot2c_f32_bf16_dpp v11, v19, v31 row_newbcast:8
v_dot2c_f32_bf16_dpp v12, v19, v32 row_newbcast:8
v_dot2c_f32_bf16_dpp v13, v19, v33 row_newbcast:8
v_dot2c_f32_bf16_dpp v14, v19, v34 row_newbcast:8
v_dot2c_f32_bf16_dpp v15, v19, v35 row_newbcast:8
s_add_u32 s56, s52, 163840
buffer_load_dwordx4 v[240:243], v1, s[8:11], s56 offen offset:0 nt
s_waitcnt vmcnt(3)
s_add_u32 s56, s52, 163840
buffer_load_dwordx4 v[244:247], v1, s[8:11], s56 offen offset:1024 nt
s_waitcnt vmcnt(3)
v_and_b32 v32, 31, v3
v_lshlrev_b32 v32, 5, v32
s_lshl_b32 s56, s49, 10
s_add_u32 s56, s56, 0x410000
buffer_load_dwordx4 v[56:59], v32, s[44:47], s56 offen offset:0 sc1
buffer_load_dwordx4 v[60:63], v32, s[44:47], s56 offen offset:16 sc1
v_perm_b32 v28, v252, v248, s80
v_perm_b32 v29, v252, v248, s81
v_perm_b32 v30, v253, v249, s80
v_perm_b32 v31, v253, v249, s81
v_perm_b32 v32, v254, v250, s80
v_perm_b32 v33, v254, v250, s81
v_perm_b32 v34, v255, v251, s80
v_perm_b32 v35, v255, v251, s81
v_dot2c_f32_bf16_dpp v8, v20, v28 row_newbcast:0
v_dot2c_f32_bf16_dpp v9, v20, v29 row_newbcast:0
v_dot2c_f32_bf16_dpp v10, v20, v30 row_newbcast:0
v_dot2c_f32_bf16_dpp v11, v20, v31 row_newbcast:0
v_dot2c_f32_bf16_dpp v12, v20, v32 row_newbcast:0
v_dot2c_f32_bf16_dpp v13, v20, v33 row_newbcast:0
v_dot2c_f32_bf16_dpp v14, v20, v34 row_newbcast:0
v_dot2c_f32_bf16_dpp v15, v20, v35 row_newbcast:0
s_waitcnt vmcnt(3)
s_add_u32 s56, s52, 163840
buffer_load_dwordx4 v[248:251], v1, s[8:11], s56 offen offset:2048 nt
s_waitcnt vmcnt(3)
s_add_u32 s56, s52, 163840
buffer_load_dwordx4 v[252:255], v1, s[8:11], s56 offen offset:3072 nt
v_perm_b32 v28, v236, v232, s80
v_perm_b32 v29, v236, v232, s81
v_perm_b32 v30, v237, v233, s80
v_perm_b32 v31, v237, v233, s81
v_perm_b32 v32, v238, v234, s80
v_perm_b32 v33, v238, v234, s81
v_perm_b32 v34, v239, v235, s80
v_perm_b32 v35, v239, v235, s81
v_dot2c_f32_bf16_dpp v8, v20, v28 row_newbcast:8
v_dot2c_f32_bf16_dpp v9, v20, v29 row_newbcast:8
v_dot2c_f32_bf16_dpp v10, v20, v30 row_newbcast:8
v_dot2c_f32_bf16_dpp v11, v20, v31 row_newbcast:8
v_dot2c_f32_bf16_dpp v12, v20, v32 row_newbcast:8
v_dot2c_f32_bf16_dpp v13, v20, v33 row_newbcast:8
v_dot2c_f32_bf16_dpp v14, v20, v34 row_newbcast:8
v_dot2c_f32_bf16_dpp v15, v20, v35 row_newbcast:8
s_waitcnt vmcnt(3)
s_add_u32 s56, s52, 196608
buffer_load_dwordx4 v[232:235], v1, s[8:11], s56 offen offset:0 nt
s_waitcnt vmcnt(3)
s_add_u32 s56, s52, 196608
buffer_load_dwordx4 v[236:239], v1, s[8:11], s56 offen offset:1024 nt
v_mov_b32 v76, v8
v_mov_b32 v77, v9
v_mov_b32 v78, v10
v_mov_b32 v79, v11
v_mov_b32 v80, v12
v_mov_b32 v81, v13
v_mov_b32 v82, v14
v_mov_b32 v83, v15
v_mov_b32 v64, v16
v_mov_b32 v65, v17
v_mov_b32 v66, v18
v_mov_b32 v67, v19
v_mov_b32 v68, v20
v_mov_b32 v69, v21
v_mov_b32 v70, v22
v_mov_b32 v71, v23
v_mov_b32 v72, v24
v_mov_b32 v74, v26
v_mov_b32 v75, v27
v_and_b32 v28, v56, v57
v_and_b32 v28, v28, v58
v_and_b32 v28, v28, v59
v_and_b32 v28, v28, v60
v_and_b32 v28, v28, v61
v_and_b32 v28, v28, v62
v_and_b32 v28, v28, v63
v_and_b32 v28, 1, v28
v_cmp_ne_u32 vcc, 1, v28
s_cbranch_vccz L_qburst_60
s_mov_b32 s60, 0
L_p_q_62:
s_nop 4
v_and_b32 v32, 31, v3
v_lshlrev_b32 v32, 5, v32
s_lshl_b32 s56, s49, 10
s_add_u32 s56, s56, 0x410000
buffer_load_dwordx4 v[56:59], v32, s[44:47], s56 offen offset:0 sc1
buffer_load_dwordx4 v[60:63], v32, s[44:47], s56 offen offset:16 sc1
s_waitcnt vmcnt(0)
v_and_b32 v28, v56, v57
v_and_b32 v28, v28, v58
v_and_b32 v28, v28, v59
v_and_b32 v28, v28, v60
v_and_b32 v28, v28, v61
v_and_b32 v28, v28, v62
v_and_b32 v28, v28, v63
v_and_b32 v28, 1, v28
v_cmp_ne_u32 vcc, 1, v28
s_cbranch_vccz L_d_q_63
s_sleep 1
s_add_u32 s60, s60, 1
s_cmp_lt_u32 s60, 400000
s_cbranch_scc1 L_p_q_62
s_endpgm
L_d_q_63:
s_nop 4
s_branch L_qjoin_61
L_qburst_60:
s_nop 4
L_qjoin_61:
s_nop 4
s_mov_b32 s56, 0x07060302
v_perm_b32 v4, v57, v56, s56
v_perm_b32 v5, v59, v58, s56
v_perm_b32 v6, v61, v60, s56
v_perm_b32 v7, v63, v62, s56
ds_read_b128 v[36:39], v2 offset:0
ds_read_b128 v[40:43], v2 offset:1024
ds_read_b128 v[44:47], v2 offset:2048
ds_read_b128 v[48:51], v2 offset:3072
s_waitcnt lgkmcnt(0)
v_dot2_f32_bf16 v28, v36, v4, 0
v_dot2_f32_bf16 v29, v40, v4, 0
v_dot2_f32_bf16 v30, v44, v4, 0
v_dot2_f32_bf16 v31, v48, v4, 0
v_dot2_f32_bf16 v28, v37, v5, v28
v_dot2_f32_bf16 v29, v41, v5, v29
v_dot2_f32_bf16 v30, v45, v5, v30
v_dot2_f32_bf16 v31, v49, v5, v31
v_dot2_f32_bf16 v28, v38, v6, v28
v_dot2_f32_bf16 v29, v42, v6, v29
v_dot2_f32_bf16 v30, v46, v6, v30
v_dot2_f32_bf16 v31, v50, v6, v31
v_dot2_f32_bf16 v28, v39, v7, v28
v_dot2_f32_bf16 v29, v43, v7, v29
v_dot2_f32_bf16 v30, v47, v7, v30
v_dot2_f32_bf16 v31, v51, v7, v31
s_nop 0
v_permlane16_swap_b32 v28, v29
s_nop 0
v_permlane16_swap_b32 v30, v31
v_add_f32 v28, v28, v29
v_add_f32 v30, v30, v31
s_nop 0
v_add_f32_dpp v16, v28, v28 row_ror:8 row_mask:0xf bank_mask:0x3
v_add_f32_dpp v16, v30, v30 row_ror:8 row_mask:0xf bank_mask:0xc
s_add_u32 m0, s53, 0
s_add_u32 s56, s52, 198656
buffer_load_dwordx4 v1, s[8:11], s56 offen nt lds
s_add_u32 m0, s53, 1024
s_add_u32 s56, s52, 199680
buffer_load_dwordx4 v1, s[8:11], s56 offen nt lds
s_add_u32 m0, s53, 2048
s_add_u32 s56, s52, 229376
buffer_load_dwordx4 v1, s[8:11], s56 offen nt lds
s_add_u32 m0, s53, 3072
s_add_u32 s56, s52, 230400
buffer_load_dwordx4 v1, s[8:11], s56 offen nt lds
ds_read_b128 v[36:39], v2 offset:4096
ds_read_b128 v[40:43], v2 offset:5120
ds_read_b128 v[44:47], v2 offset:6144
ds_read_b128 v[48:51], v2 offset:7168
s_waitcnt lgkmcnt(0)
v_dot2_f32_bf16 v28, v36, v4, 0
v_dot2_f32_bf16 v29, v40, v4, 0
v_dot2_f32_bf16 v30, v44, v4, 0
v_dot2_f32_bf16 v31, v48, v4, 0
v_dot2_f32_bf16 v28, v37, v5, v28
v_dot2_f32_bf16 v29, v41, v5, v29
v_dot2_f32_bf16 v30, v45, v5, v30
v_dot2_f32_bf16 v31, v49, v5, v31
v_dot2_f32_bf16 v28, v38, v6, v28
v_dot2_f32_bf16 v29, v42, v6, v29
v_dot2_f32_bf16 v30, v46, v6, v30
v_dot2_f32_bf16 v31, v50, v6, v31
v_dot2_f32_bf16 v28, v39, v7, v28
v_dot2_f32_bf16 v29, v43, v7, v29
v_dot2_f32_bf16 v30, v47, v7, v30
v_dot2_f32_bf16 v31, v51, v7, v31
s_nop 0
v_permlane16_swap_b32 v28, v29
s_nop 0
v_permlane16_swap_b32 v30, v31
v_add_f32 v28, v28, v29
v_add_f32 v30, v30, v31
s_nop 0
v_add_f32_dpp v17, v28, v28 row_ror:8 row_mask:0xf bank_mask:0x3
v_add_f32_dpp v17, v30, v30 row_ror:8 row_mask:0xf bank_mask:0xc
s_add_u32 m0, s53, 4096
s_add_u32 s56, s52, 231424
buffer_load_dwordx4 v1, s[8:11], s56 offen nt lds
s_add_u32 m0, s53, 5120
s_add_u32 s56, s52, 232448
buffer_load_dwordx4 v1, s[8:11], s56 offen nt lds
s_add_u32 m0, s53, 6144
s_add_u32 s56, s52, 262144
buffer_load_dwordx4 v1, s[8:11], s56 offen nt lds
s_add_u32 m0, s53, 7168
s_add_u32 s56, s52, 263168
buffer_load_dwordx4 v1, s[8:11], s56 offen nt lds
ds_read_b128 v[36:39], v2 offset:8192
ds_read_b128 v[40:43], v2 offset:9216
ds_read_b128 v[44:47], v2 offset:10240
ds_read_b128 v[48:51], v2 offset:11264
s_waitcnt lgkmcnt(0)
v_dot2_f32_bf16 v28, v36, v4, 0
v_dot2_f32_bf16 v29, v40, v4, 0
v_dot2_f32_bf16 v30, v44, v4, 0
v_dot2_f32_bf16 v31, v48, v4, 0
v_dot2_f32_bf16 v28, v37, v5, v28
v_dot2_f32_bf16 v29, v41, v5, v29
v_dot2_f32_bf16 v30, v45, v5, v30
v_dot2_f32_bf16 v31, v49, v5, v31
v_dot2_f32_bf16 v28, v38, v6, v28
v_dot2_f32_bf16 v29, v42, v6, v29
v_dot2_f32_bf16 v30, v46, v6, v30
v_dot2_f32_bf16 v31, v50, v6, v31
v_dot2_f32_bf16 v28, v39, v7, v28
v_dot2_f32_bf16 v29, v43, v7, v29
v_dot2_f32_bf16 v30, v47, v7, v30
v_dot2_f32_bf16 v31, v51, v7, v31
s_nop 0
v_permlane16_swap_b32 v28, v29
s_nop 0
v_permlane16_swap_b32 v30, v31
v_add_f32 v28, v28, v29
v_add_f32 v30, v30, v31
s_nop 0
v_add_f32_dpp v18, v28, v28 row_ror:8 row_mask:0xf bank_mask:0x3
v_add_f32_dpp v18, v30, v30 row_ror:8 row_mask:0xf bank_mask:0xc
ds_read_b128 v[36:39], v2 offset:12288
ds_read_b128 v[40:43], v2 offset:13312
ds_read_b128 v[44:47], v2 offset:14336
ds_read_b128 v[48:51], v2 offset:15360
s_waitcnt lgkmcnt(0)
v_dot2_f32_bf16 v28, v36, v4, 0
v_dot2_f32_bf16 v29, v40, v4, 0
v_dot2_f32_bf16 v30, v44, v4, 0
v_dot2_f32_bf16 v31, v48, v4, 0
v_dot2_f32_bf16 v28, v37, v5, v28
v_dot2_f32_bf16 v29, v41, v5, v29
v_dot2_f32_bf16 v30, v45, v5, v30
v_dot2_f32_bf16 v31, v49, v5, v31
v_dot2_f32_bf16 v28, v38, v6, v28
v_dot2_f32_bf16 v29, v42, v6, v29
v_dot2_f32_bf16 v30, v46, v6, v30
v_dot2_f32_bf16 v31, v50, v6, v31
v_dot2_f32_bf16 v28, v39, v7, v28
v_dot2_f32_bf16 v29, v43, v7, v29
v_dot2_f32_bf16 v30, v47, v7, v30
v_dot2_f32_bf16 v31, v51, v7, v31
s_nop 0
v_permlane16_swap_b32 v28, v29
s_nop 0
v_permlane16_swap_b32 v30, v31
v_add_f32 v28, v28, v29
v_add_f32 v30, v30, v31
s_nop 0
v_add_f32_dpp v19, v28, v28 row_ror:8 row_mask:0xf bank_mask:0x3
v_add_f32_dpp v19, v30, v30 row_ror:8 row_mask:0xf bank_mask:0xc
ds_read_b128 v[36:39], v2 offset:16384
s_waitcnt lgkmcnt(0)
v_dot2_f32_bf16 v28, v36, v4, 0
v_dot2_f32_bf16 v29, v84, v4, 0
v_dot2_f32_bf16 v30, v88, v4, 0
v_dot2_f32_bf16 v31, v92, v4, 0
v_dot2_f32_bf16 v28, v37, v5, v28
v_dot2_f32_bf16 v29, v85, v5, v29
v_dot2_f32_bf16 v30, v89, v5, v30
v_dot2_f32_bf16 v31, v93, v5, v31
v_dot2_f32_bf16 v28, v38, v6, v28
v_dot2_f32_bf16 v29, v86, v6, v29
v_dot2_f32_bf16 v30, v90, v6, v30
v_dot2_f32_bf16 v31, v94, v6, v31
v_dot2_f32_bf16 v28, v39, v7, v28
v_dot2_f32_bf16 v29, v87, v7, v29
v_dot2_f32_bf16 v30, v91, v7, v30
v_dot2_f32_bf16 v31, v95, v7, v31
s_nop 0
v_permlane16_swap_b32 v28, v29
s_nop 0
v_permlane16_swap_b32 v30, v31
v_add_f32 v28, v28, v29
v_add_f32 v30, v30, v31
s_nop 0
v_add_f32_dpp v20, v28, v28 row_ror:8 row_mask:0xf bank_mask:0x3
v_add_f32_dpp v20, v30, v30 row_ror:8 row_mask:0xf bank_mask:0xc
v_dot2_f32_bf16 v28, v96, v4, 0
v_dot2_f32_bf16 v29, v100, v4, 0
v_dot2_f32_bf16 v30, v104, v4, 0
v_dot2_f32_bf16 v31, v108, v4, 0
v_dot2_f32_bf16 v28, v97, v5, v28
v_dot2_f32_bf16 v29, v101, v5, v29
v_dot2_f32_bf16 v30, v105, v5, v30
v_dot2_f32_bf16 v31, v109, v5, v31
v_dot2_f32_bf16 v28, v98, v6, v28
v_dot2_f32_bf16 v29, v102, v6, v29
v_dot2_f32_bf16 v30, v106, v6, v30
v_dot2_f32_bf16 v31, v110, v6, v31
v_dot2_f32_bf16 v28, v99, v7, v28
v_dot2_f32_bf16 v29, v103, v7, v29
v_dot2_f32_bf16 v30, v107, v7, v30
v_dot2_f32_bf16 v31, v111, v7, v31
s_nop 0
v_permlane16_swap_b32 v28, v29
s_nop 0
v_permlane16_swap_b32 v30, v31
v_add_f32 v28, v28, v29
v_add_f32 v30, v30, v31
s_nop 0
v_add_f32_dpp v21, v28, v28 row_ror:8 row_mask:0xf bank_mask:0x3
v_add_f32_dpp v21, v30, v30 row_ror:8 row_mask:0xf bank_mask:0xc
v_dot2_f32_bf16 v28, v112, v4, 0
v_dot2_f32_bf16 v29, v116, v4, 0
v_dot2_f32_bf16 v30, v120, v4, 0
v_dot2_f32_bf16 v31, v124, v4, 0
v_dot2_f32_bf16 v28, v113, v5, v28
v_dot2_f32_bf16 v29, v117, v5, v29
v_dot2_f32_bf16 v30, v121, v5, v30
v_dot2_f32_bf16 v31, v125, v5, v31
v_dot2_f32_bf16 v28, v114, v6, v28
v_dot2_f32_bf16 v29, v118, v6, v29
v_dot2_f32_bf16 v30, v122, v6, v30
v_dot2_f32_bf16 v31, v126, v6, v31
v_dot2_f32_bf16 v28, v115, v7, v28
v_dot2_f32_bf16 v29, v119, v7, v29
v_dot2_f32_bf16 v30, v123, v7, v30
v_dot2_f32_bf16 v31, v127, v7, v31
s_nop 0
v_permlane16_swap_b32 v28, v29
s_nop 0
v_permlane16_swap_b32 v30, v31
v_add_f32 v28, v28, v29
v_add_f32 v30, v30, v31
s_nop 0
v_add_f32_dpp v22, v28, v28 row_ror:8 row_mask:0xf bank_mask:0x3
v_add_f32_dpp v22, v30, v30 row_ror:8 row_mask:0xf bank_mask:0xc
v_dot2_f32_bf16 v28, v128, v4, 0
v_dot2_f32_bf16 v29, v132, v4, 0
v_dot2_f32_bf16 v30, v136, v4, 0
v_dot2_f32_bf16 v31, v140, v4, 0
v_dot2_f32_bf16 v28, v129, v5, v28
v_dot2_f32_bf16 v29, v133, v5, v29
v_dot2_f32_bf16 v30, v137, v5, v30
v_dot2_f32_bf16 v31, v141, v5, v31
v_dot2_f32_bf16 v28, v130, v6, v28
v_dot2_f32_bf16 v29, v134, v6, v29
v_dot2_f32_bf16 v30, v138, v6, v30
v_dot2_f32_bf16 v31, v142, v6, v31
v_dot2_f32_bf16 v28, v131, v7, v28
v_dot2_f32_bf16 v29, v135, v7, v29
v_dot2_f32_bf16 v30, v139, v7, v30
v_dot2_f32_bf16 v31, v143, v7, v31
s_nop 0
v_permlane16_swap_b32 v28, v29
s_nop 0
v_permlane16_swap_b32 v30, v31
v_add_f32 v28, v28, v29
v_add_f32 v30, v30, v31
s_nop 0
v_add_f32_dpp v23, v28, v28 row_ror:8 row_mask:0xf bank_mask:0x3
v_add_f32_dpp v23, v30, v30 row_ror:8 row_mask:0xf bank_mask:0xc
v_dot2_f32_bf16 v28, v144, v4, 0
v_dot2_f32_bf16 v29, v148, v4, 0
v_dot2_f32_bf16 v30, v152, v4, 0
v_dot2_f32_bf16 v31, v156, v4, 0
v_dot2_f32_bf16 v28, v145, v5, v28
v_dot2_f32_bf16 v29, v149, v5, v29
v_dot2_f32_bf16 v30, v153, v5, v30
v_dot2_f32_bf16 v31, v157, v5, v31
v_dot2_f32_bf16 v28, v146, v6, v28
v_dot2_f32_bf16 v29, v150, v6, v29
v_dot2_f32_bf16 v30, v154, v6, v30
v_dot2_f32_bf16 v31, v158, v6, v31
v_dot2_f32_bf16 v28, v147, v7, v28
v_dot2_f32_bf16 v29, v151, v7, v29
v_dot2_f32_bf16 v30, v155, v7, v30
v_dot2_f32_bf16 v31, v159, v7, v31
s_nop 0
v_permlane16_swap_b32 v28, v29
s_nop 0
v_permlane16_swap_b32 v30, v31
v_add_f32 v28, v28, v29
v_add_f32 v30, v30, v31
s_nop 0
v_add_f32_dpp v24, v28, v28 row_ror:8 row_mask:0xf bank_mask:0x3
v_add_f32_dpp v24, v30, v30 row_ror:8 row_mask:0xf bank_mask:0xc
v_add_f32_dpp v16, v16, v16 quad_perm:[1,0,3,2]
v_add_f32_dpp v17, v17, v17 quad_perm:[1,0,3,2]
v_add_f32_dpp v18, v18, v18 quad_perm:[1,0,3,2]
v_add_f32_dpp v19, v19, v19 quad_perm:[1,0,3,2]
v_add_f32_dpp v20, v20, v20 quad_perm:[1,0,3,2]
v_add_f32_dpp v21, v21, v21 quad_perm:[1,0,3,2]
v_add_f32_dpp v22, v22, v22 quad_perm:[1,0,3,2]
v_add_f32_dpp v23, v23, v23 quad_perm:[1,0,3,2]
v_add_f32_dpp v24, v24, v24 quad_perm:[1,0,3,2]
v_add_f32_dpp v16, v16, v16 quad_perm:[2,3,0,1]
v_add_f32_dpp v17, v17, v17 quad_perm:[2,3,0,1]
v_add_f32_dpp v18, v18, v18 quad_perm:[2,3,0,1]
v_add_f32_dpp v19, v19, v19 quad_perm:[2,3,0,1]
v_add_f32_dpp v20, v20, v20 quad_perm:[2,3,0,1]
v_add_f32_dpp v21, v21, v21 quad_perm:[2,3,0,1]
v_add_f32_dpp v22, v22, v22 quad_perm:[2,3,0,1]
v_add_f32_dpp v23, v23, v23 quad_perm:[2,3,0,1]
v_add_f32_dpp v24, v24, v24 quad_perm:[2,3,0,1]
v_add_f32_dpp v16, v16, v16 row_half_mirror
v_add_f32_dpp v17, v17, v17 row_half_mirror
v_add_f32_dpp v18, v18, v18 row_half_mirror
v_add_f32_dpp v19, v19, v19 row_half_mirror
v_add_f32_dpp v20, v20, v20 row_half_mirror
v_add_f32_dpp v21, v21, v21 row_half_mirror
v_add_f32_dpp v22, v22, v22 row_half_mirror
v_add_f32_dpp v23, v23, v23 row_half_mirror
v_add_f32_dpp v24, v24, v24 row_half_mirror
v_cvt_pk_bf16_f32 v16, v16, v16
v_cvt_pk_bf16_f32 v17, v17, v17
v_cvt_pk_bf16_f32 v18, v18, v18
v_cvt_pk_bf16_f32 v19, v19, v19
v_cvt_pk_bf16_f32 v20, v20, v20
v_cvt_pk_bf16_f32 v21, v21, v21
v_cvt_pk_bf16_f32 v22, v22, v22
v_cvt_pk_bf16_f32 v23, v23, v23
v_cvt_pk_bf16_f32 v24, v24, v24
v_and_b32 v16, s62, v16
v_and_b32 v17, s62, v17
v_and_b32 v18, s62, v18
v_and_b32 v19, s62, v19
v_and_b32 v20, s62, v20
v_and_b32 v21, s62, v21
v_and_b32 v22, s62, v22
v_and_b32 v23, s62, v23
v_and_b32 v24, s62, v24
v_mul_f32 v16, 0x3d800000, v16
v_mul_f32 v17, 0x3d800000, v17
v_mul_f32 v18, 0x3d800000, v18
v_mul_f32 v19, 0x3d800000, v19
v_mul_f32 v20, 0x3d800000, v20
v_mul_f32 v21, 0x3d800000, v21
v_mul_f32 v22, 0x3d800000, v22
v_mul_f32 v23, 0x3d800000, v23
v_mul_f32 v24, 0x3d800000, v24
v_max_f32 v26, v16, v17
v_max_f32 v26, v26, v18
v_max_f32 v26, v26, v19
v_max_f32 v26, v26, v20
v_max_f32 v26, v26, v21
v_max_f32 v26, v26, v22
v_max_f32 v26, v26, v23
v_max_f32 v26, v26, v24
s_nop 1
v_max_f32_dpp v26, v26, v26 row_ror:8
v_mov_b32 v28, v26
s_nop 1
v_permlane16_swap_b32 v26, v28
v_max_f32 v26, v26, v28
v_mov_b32 v28, v26
s_nop 1
v_permlane32_swap_b32 v26, v28
v_max_f32 v26, v26, v28
v_sub_f32 v16, v16, v26
v_sub_f32 v17, v17, v26
v_sub_f32 v18, v18, v26
v_sub_f32 v19, v19, v26
v_sub_f32 v20, v20, v26
v_sub_f32 v21, v21, v26
v_sub_f32 v22, v22, v26
v_sub_f32 v23, v23, v26
v_sub_f32 v24, v24, v26
v_mul_f32 v16, 0x3fb8aa3b, v16
v_mul_f32 v17, 0x3fb8aa3b, v17
v_mul_f32 v18, 0x3fb8aa3b, v18
v_mul_f32 v19, 0x3fb8aa3b, v19
v_mul_f32 v20, 0x3fb8aa3b, v20
v_mul_f32 v21, 0x3fb8aa3b, v21
v_mul_f32 v22, 0x3fb8aa3b, v22
v_mul_f32 v23, 0x3fb8aa3b, v23
v_mul_f32 v24, 0x3fb8aa3b, v24
v_exp_f32 v16, v16
v_exp_f32 v17, v17
v_exp_f32 v18, v18
v_exp_f32 v19, v19
v_exp_f32 v20, v20
v_exp_f32 v21, v21
v_exp_f32 v22, v22
v_exp_f32 v23, v23
v_exp_f32 v24, v24
v_add_f32 v27, v16, v17
v_add_f32 v27, v27, v18
v_add_f32 v27, v27, v19
v_add_f32 v27, v27, v20
v_add_f32 v27, v27, v21
v_add_f32 v27, v27, v22
v_add_f32 v27, v27, v23
v_add_f32 v27, v27, v24
s_nop 1
v_add_f32_dpp v27, v27, v27 row_ror:8
v_mov_b32 v28, v27
s_nop 1
v_permlane16_swap_b32 v27, v28
v_add_f32 v27, v27, v28
v_mov_b32 v28, v27
s_nop 1
v_permlane32_swap_b32 v27, v28
v_add_f32 v27, v27, v28
v_mov_b32 v36, v16
v_mov_b32 v37, v17
v_mov_b32 v38, v18
v_mov_b32 v39, v19
v_mov_b32 v40, v20
v_mov_b32 v41, v21
v_mov_b32 v42, v22
v_mov_b32 v43, v23
v_mov_b32 v44, v24
v_permlane16_swap_b32 v16, v36
v_permlane16_swap_b32 v17, v37
v_permlane16_swap_b32 v18, v38
v_permlane16_swap_b32 v19, v39
v_permlane16_swap_b32 v20, v40
v_permlane16_swap_b32 v21, v41
v_permlane16_swap_b32 v22, v42
v_permlane16_swap_b32 v23, v43
v_permlane16_swap_b32 v24, v44
v_cvt_pk_bf16_f32 v16, v16, v36
v_cvt_pk_bf16_f32 v17, v17, v37
v_cvt_pk_bf16_f32 v18, v18, v38
v_cvt_pk_bf16_f32 v19, v19, v39
v_cvt_pk_bf16_f32 v20, v20, v40
v_cvt_pk_bf16_f32 v21, v21, v41
v_cvt_pk_bf16_f32 v22, v22, v42
v_cvt_pk_bf16_f32 v23, v23, v43
v_cvt_pk_bf16_f32 v24, v24, v44
v_mov_b32 v8, 0
v_mov_b32 v9, 0
v_mov_b32 v10, 0
v_mov_b32 v11, 0
v_mov_b32 v12, 0
v_mov_b32 v13, 0
v_mov_b32 v14, 0
v_mov_b32 v15, 0
v_perm_b32 v28, v164, v160, s80
v_perm_b32 v29, v164, v160, s81
v_perm_b32 v30, v165, v161, s80
v_perm_b32 v31, v165, v161, s81
v_perm_b32 v32, v166, v162, s80
v_perm_b32 v33, v166, v162, s81
v_perm_b32 v34, v167, v163, s80
v_perm_b32 v35, v167, v163, s81
v_dot2c_f32_bf16_dpp v8, v16, v28 row_newbcast:0
v_dot2c_f32_bf16_dpp v9, v16, v29 row_newbcast:0
v_dot2c_f32_bf16_dpp v10, v16, v30 row_newbcast:0
v_dot2c_f32_bf16_dpp v11, v16, v31 row_newbcast:0
v_dot2c_f32_bf16_dpp v12, v16, v32 row_newbcast:0
v_dot2c_f32_bf16_dpp v13, v16, v33 row_newbcast:0
v_dot2c_f32_bf16_dpp v14, v16, v34 row_newbcast:0
v_dot2c_f32_bf16_dpp v15, v16, v35 row_newbcast:0
v_perm_b32 v28, v172, v168, s80
v_perm_b32 v29, v172, v168, s81
v_perm_b32 v30, v173, v169, s80
v_perm_b32 v31, v173, v169, s81
v_perm_b32 v32, v174, v170, s80
v_perm_b32 v33, v174, v170, s81
v_perm_b32 v34, v175, v171, s80
v_perm_b32 v35, v175, v171, s81
v_dot2c_f32_bf16_dpp v8, v16, v28 row_newbcast:8
v_dot2c_f32_bf16_dpp v9, v16, v29 row_newbcast:8
v_dot2c_f32_bf16_dpp v10, v16, v30 row_newbcast:8
v_dot2c_f32_bf16_dpp v11, v16, v31 row_newbcast:8
v_dot2c_f32_bf16_dpp v12, v16, v32 row_newbcast:8
v_dot2c_f32_bf16_dpp v13, v16, v33 row_newbcast:8
v_dot2c_f32_bf16_dpp v14, v16, v34 row_newbcast:8
v_dot2c_f32_bf16_dpp v15, v16, v35 row_newbcast:8
v_perm_b32 v28, v180, v176, s80
v_perm_b32 v29, v180, v176, s81
v_perm_b32 v30, v181, v177, s80
v_perm_b32 v31, v181, v177, s81
v_perm_b32 v32, v182, v178, s80
v_perm_b32 v33, v182, v178, s81
v_perm_b32 v34, v183, v179, s80
v_perm_b32 v35, v183, v179, s81
v_dot2c_f32_bf16_dpp v8, v17, v28 row_newbcast:0
v_dot2c_f32_bf16_dpp v9, v17, v29 row_newbcast:0
v_dot2c_f32_bf16_dpp v10, v17, v30 row_newbcast:0
v_dot2c_f32_bf16_dpp v11, v17, v31 row_newbcast:0
v_dot2c_f32_bf16_dpp v12, v17, v32 row_newbcast:0
v_dot2c_f32_bf16_dpp v13, v17, v33 row_newbcast:0
v_dot2c_f32_bf16_dpp v14, v17, v34 row_newbcast:0
v_dot2c_f32_bf16_dpp v15, v17, v35 row_newbcast:0
v_perm_b32 v28, v188, v184, s80
v_perm_b32 v29, v188, v184, s81
v_perm_b32 v30, v189, v185, s80
v_perm_b32 v31, v189, v185, s81
v_perm_b32 v32, v190, v186, s80
v_perm_b32 v33, v190, v186, s81
v_perm_b32 v34, v191, v187, s80
v_perm_b32 v35, v191, v187, s81
v_dot2c_f32_bf16_dpp v8, v17, v28 row_newbcast:8
v_dot2c_f32_bf16_dpp v9, v17, v29 row_newbcast:8
v_dot2c_f32_bf16_dpp v10, v17, v30 row_newbcast:8
v_dot2c_f32_bf16_dpp v11, v17, v31 row_newbcast:8
v_dot2c_f32_bf16_dpp v12, v17, v32 row_newbcast:8
v_dot2c_f32_bf16_dpp v13, v17, v33 row_newbcast:8
v_dot2c_f32_bf16_dpp v14, v17, v34 row_newbcast:8
v_dot2c_f32_bf16_dpp v15, v17, v35 row_newbcast:8
v_perm_b32 v28, v196, v192, s80
v_perm_b32 v29, v196, v192, s81
v_perm_b32 v30, v197, v193, s80
v_perm_b32 v31, v197, v193, s81
v_perm_b32 v32, v198, v194, s80
v_perm_b32 v33, v198, v194, s81
v_perm_b32 v34, v199, v195, s80
v_perm_b32 v35, v199, v195, s81
v_dot2c_f32_bf16_dpp v8, v18, v28 row_newbcast:0
v_dot2c_f32_bf16_dpp v9, v18, v29 row_newbcast:0
v_dot2c_f32_bf16_dpp v10, v18, v30 row_newbcast:0
v_dot2c_f32_bf16_dpp v11, v18, v31 row_newbcast:0
v_dot2c_f32_bf16_dpp v12, v18, v32 row_newbcast:0
v_dot2c_f32_bf16_dpp v13, v18, v33 row_newbcast:0
v_dot2c_f32_bf16_dpp v14, v18, v34 row_newbcast:0
v_dot2c_f32_bf16_dpp v15, v18, v35 row_newbcast:0
v_perm_b32 v28, v204, v200, s80
v_perm_b32 v29, v204, v200, s81
v_perm_b32 v30, v205, v201, s80
v_perm_b32 v31, v205, v201, s81
v_perm_b32 v32, v206, v202, s80
v_perm_b32 v33, v206, v202, s81
v_perm_b32 v34, v207, v203, s80
v_perm_b32 v35, v207, v203, s81
v_dot2c_f32_bf16_dpp v8, v18, v28 row_newbcast:8
v_dot2c_f32_bf16_dpp v9, v18, v29 row_newbcast:8
v_dot2c_f32_bf16_dpp v10, v18, v30 row_newbcast:8
v_dot2c_f32_bf16_dpp v11, v18, v31 row_newbcast:8
v_dot2c_f32_bf16_dpp v12, v18, v32 row_newbcast:8
v_dot2c_f32_bf16_dpp v13, v18, v33 row_newbcast:8
v_dot2c_f32_bf16_dpp v14, v18, v34 row_newbcast:8
v_dot2c_f32_bf16_dpp v15, v18, v35 row_newbcast:8
v_perm_b32 v28, v212, v208, s80
v_perm_b32 v29, v212, v208, s81
v_perm_b32 v30, v213, v209, s80
v_perm_b32 v31, v213, v209, s81
v_perm_b32 v32, v214, v210, s80
v_perm_b32 v33, v214, v210, s81
v_perm_b32 v34, v215, v211, s80
v_perm_b32 v35, v215, v211, s81
v_dot2c_f32_bf16_dpp v8, v19, v28 row_newbcast:0
v_dot2c_f32_bf16_dpp v9, v19, v29 row_newbcast:0
v_dot2c_f32_bf16_dpp v10, v19, v30 row_newbcast:0
v_dot2c_f32_bf16_dpp v11, v19, v31 row_newbcast:0
v_dot2c_f32_bf16_dpp v12, v19, v32 row_newbcast:0
v_dot2c_f32_bf16_dpp v13, v19, v33 row_newbcast:0
v_dot2c_f32_bf16_dpp v14, v19, v34 row_newbcast:0
v_dot2c_f32_bf16_dpp v15, v19, v35 row_newbcast:0
v_perm_b32 v28, v220, v216, s80
v_perm_b32 v29, v220, v216, s81
v_perm_b32 v30, v221, v217, s80
v_perm_b32 v31, v221, v217, s81
v_perm_b32 v32, v222, v218, s80
v_perm_b32 v33, v222, v218, s81
v_perm_b32 v34, v223, v219, s80
v_perm_b32 v35, v223, v219, s81
v_dot2c_f32_bf16_dpp v8, v19, v28 row_newbcast:8
v_dot2c_f32_bf16_dpp v9, v19, v29 row_newbcast:8
v_dot2c_f32_bf16_dpp v10, v19, v30 row_newbcast:8
v_dot2c_f32_bf16_dpp v11, v19, v31 row_newbcast:8
v_dot2c_f32_bf16_dpp v12, v19, v32 row_newbcast:8
v_dot2c_f32_bf16_dpp v13, v19, v33 row_newbcast:8
v_dot2c_f32_bf16_dpp v14, v19, v34 row_newbcast:8
v_dot2c_f32_bf16_dpp v15, v19, v35 row_newbcast:8
v_perm_b32 v28, v228, v224, s80
v_perm_b32 v29, v228, v224, s81
v_perm_b32 v30, v229, v225, s80
v_perm_b32 v31, v229, v225, s81
v_perm_b32 v32, v230, v226, s80
v_perm_b32 v33, v230, v226, s81
v_perm_b32 v34, v231, v227, s80
v_perm_b32 v35, v231, v227, s81
v_dot2c_f32_bf16_dpp v8, v20, v28 row_newbcast:0
v_dot2c_f32_bf16_dpp v9, v20, v29 row_newbcast:0
v_dot2c_f32_bf16_dpp v10, v20, v30 row_newbcast:0
v_dot2c_f32_bf16_dpp v11, v20, v31 row_newbcast:0
v_dot2c_f32_bf16_dpp v12, v20, v32 row_newbcast:0
v_dot2c_f32_bf16_dpp v13, v20, v33 row_newbcast:0
v_dot2c_f32_bf16_dpp v14, v20, v34 row_newbcast:0
v_dot2c_f32_bf16_dpp v15, v20, v35 row_newbcast:0
v_swap_b32 v16, v64
v_swap_b32 v17, v65
v_swap_b32 v18, v66
v_swap_b32 v19, v67
v_swap_b32 v20, v68
v_swap_b32 v21, v69
v_swap_b32 v22, v70
v_swap_b32 v23, v71
v_swap_b32 v24, v72
v_swap_b32 v26, v74
v_swap_b32 v27, v75
v_swap_b32 v8, v76
v_swap_b32 v9, v77
v_swap_b32 v10, v78
v_swap_b32 v11, v79
v_swap_b32 v12, v80
v_swap_b32 v13, v81
v_swap_b32 v14, v82
v_swap_b32 v15, v83
v_perm_b32 v28, v244, v240, s80
v_perm_b32 v29, v244, v240, s81
v_perm_b32 v30, v245, v241, s80
v_perm_b32 v31, v245, v241, s81
v_perm_b32 v32, v246, v242, s80
v_perm_b32 v33, v246, v242, s81
v_perm_b32 v34, v247, v243, s80
v_perm_b32 v35, v247, v243, s81
v_dot2c_f32_bf16_dpp v8, v21, v28 row_newbcast:0
v_dot2c_f32_bf16_dpp v9, v21, v29 row_newbcast:0
v_dot2c_f32_bf16_dpp v10, v21, v30 row_newbcast:0
v_dot2c_f32_bf16_dpp v11, v21, v31 row_newbcast:0
v_dot2c_f32_bf16_dpp v12, v21, v32 row_newbcast:0
v_dot2c_f32_bf16_dpp v13, v21, v33 row_newbcast:0
v_dot2c_f32_bf16_dpp v14, v21, v34 row_newbcast:0
v_dot2c_f32_bf16_dpp v15, v21, v35 row_newbcast:0
s_waitcnt vmcnt(11)
s_add_u32 m0, s53, 8192
s_add_u32 s56, s52, 264192
buffer_load_dwordx4 v1, s[8:11], s56 offen nt lds
s_waitcnt vmcnt(11)
s_add_u32 m0, s53, 9216
s_add_u32 s56, s52, 265216
buffer_load_dwordx4 v1, s[8:11], s56 offen nt lds
v_perm_b32 v28, v252, v248, s80
v_perm_b32 v29, v252, v248, s81
v_perm_b32 v30, v253, v249, s80
v_perm_b32 v31, v253, v249, s81
v_perm_b32 v32, v254, v250, s80
v_perm_b32 v33, v254, v250, s81
v_perm_b32 v34, v255, v251, s80
v_perm_b32 v35, v255, v251, s81
v_dot2c_f32_bf16_dpp v8, v21, v28 row_newbcast:8
v_dot2c_f32_bf16_dpp v9, v21, v29 row_newbcast:8
v_dot2c_f32_bf16_dpp v10, v21, v30 row_newbcast:8
v_dot2c_f32_bf16_dpp v11, v21, v31 row_newbcast:8
v_dot2c_f32_bf16_dpp v12, v21, v32 row_newbcast:8
v_dot2c_f32_bf16_dpp v13, v21, v33 row_newbcast:8
v_dot2c_f32_bf16_dpp v14, v21, v34 row_newbcast:8
v_dot2c_f32_bf16_dpp v15, v21, v35 row_newbcast:8
s_waitcnt vmcnt(11)
s_add_u32 s56, s51, 131072
buffer_load_dwordx4 v[84:87], v1, s[8:11], s56 offen offset:2048 nt
s_waitcnt vmcnt(11)
s_add_u32 s56, s51, 131072
buffer_load_dwordx4 v[88:91], v1, s[8:11], s56 offen offset:3072 nt
v_perm_b32 v28, v236, v232, s80
v_perm_b32 v29, v236, v232, s81
v_perm_b32 v30, v237, v233, s80
v_perm_b32 v31, v237, v233, s81
v_perm_b32 v32, v238, v234, s80
v_perm_b32 v33, v238, v234, s81
v_perm_b32 v34, v239, v235, s80
v_perm_b32 v35, v239, v235, s81
v_dot2c_f32_bf16_dpp v8, v22, v28 row_newbcast:0
v_dot2c_f32_bf16_dpp v9, v22, v29 row_newbcast:0
v_dot2c_f32_bf16_dpp v10, v22, v30 row_newbcast:0
v_dot2c_f32_bf16_dpp v11, v22, v31 row_newbcast:0
v_dot2c_f32_bf16_dpp v12, v22, v32 row_newbcast:0
v_dot2c_f32_bf16_dpp v13, v22, v33 row_newbcast:0
v_dot2c_f32_bf16_dpp v14, v22, v34 row_newbcast:0
v_dot2c_f32_bf16_dpp v15, v22, v35 row_newbcast:0
s_waitcnt vmcnt(11)
s_add_u32 s56, s51, 163840
buffer_load_dwordx4 v[92:95], v1, s[8:11], s56 offen offset:0 nt
s_waitcnt vmcnt(11)
s_add_u32 s56, s51, 163840
buffer_load_dwordx4 v[96:99], v1, s[8:11], s56 offen offset:1024 nt
ds_read_b128 v[36:39], v2 offset:0
ds_read_b128 v[40:43], v2 offset:1024
s_waitcnt lgkmcnt(0)
v_perm_b32 v28, v40, v36, s80
v_perm_b32 v29, v40, v36, s81
v_perm_b32 v30, v41, v37, s80
v_perm_b32 v31, v41, v37, s81
v_perm_b32 v32, v42, v38, s80
v_perm_b32 v33, v42, v38, s81
v_perm_b32 v34, v43, v39, s80
v_perm_b32 v35, v43, v39, s81
v_dot2c_f32_bf16_dpp v8, v22, v28 row_newbcast:8
v_dot2c_f32_bf16_dpp v9, v22, v29 row_newbcast:8
v_dot2c_f32_bf16_dpp v10, v22, v30 row_newbcast:8
v_dot2c_f32_bf16_dpp v11, v22, v31 row_newbcast:8
v_dot2c_f32_bf16_dpp v12, v22, v32 row_newbcast:8
v_dot2c_f32_bf16_dpp v13, v22, v33 row_newbcast:8
v_dot2c_f32_bf16_dpp v14, v22, v34 row_newbcast:8
v_dot2c_f32_bf16_dpp v15, v22, v35 row_newbcast:8
s_waitcnt vmcnt(11)
s_add_u32 s56, s51, 163840
buffer_load_dwordx4 v[100:103], v1, s[8:11], s56 offen offset:2048 nt
s_waitcnt vmcnt(11)
s_add_u32 s56, s51, 163840
buffer_load_dwordx4 v[104:107], v1, s[8:11], s56 offen offset:3072 nt
ds_read_b128 v[36:39], v2 offset:2048
ds_read_b128 v[40:43], v2 offset:3072
s_waitcnt lgkmcnt(0)
v_perm_b32 v28, v40, v36, s80
v_perm_b32 v29, v40, v36, s81
v_perm_b32 v30, v41, v37, s80
v_perm_b32 v31, v41, v37, s81
v_perm_b32 v32, v42, v38, s80
v_perm_b32 v33, v42, v38, s81
v_perm_b32 v34, v43, v39, s80
v_perm_b32 v35, v43, v39, s81
v_dot2c_f32_bf16_dpp v8, v23, v28 row_newbcast:0
v_dot2c_f32_bf16_dpp v9, v23, v29 row_newbcast:0
v_dot2c_f32_bf16_dpp v10, v23, v30 row_newbcast:0
v_dot2c_f32_bf16_dpp v11, v23, v31 row_newbcast:0
v_dot2c_f32_bf16_dpp v12, v23, v32 row_newbcast:0
v_dot2c_f32_bf16_dpp v13, v23, v33 row_newbcast:0
v_dot2c_f32_bf16_dpp v14, v23, v34 row_newbcast:0
v_dot2c_f32_bf16_dpp v15, v23, v35 row_newbcast:0
s_waitcnt vmcnt(11)
s_add_u32 s56, s51, 196608
buffer_load_dwordx4 v[108:111], v1, s[8:11], s56 offen offset:0 nt
s_waitcnt vmcnt(11)
s_add_u32 s56, s51, 196608
buffer_load_dwordx4 v[112:115], v1, s[8:11], s56 offen offset:1024 nt
ds_read_b128 v[36:39], v2 offset:4096
ds_read_b128 v[40:43], v2 offset:5120
s_waitcnt lgkmcnt(0)
v_perm_b32 v28, v40, v36, s80
v_perm_b32 v29, v40, v36, s81
v_perm_b32 v30, v41, v37, s80
v_perm_b32 v31, v41, v37, s81
v_perm_b32 v32, v42, v38, s80
v_perm_b32 v33, v42, v38, s81
v_perm_b32 v34, v43, v39, s80
v_perm_b32 v35, v43, v39, s81
v_dot2c_f32_bf16_dpp v8, v23, v28 row_newbcast:8
v_dot2c_f32_bf16_dpp v9, v23, v29 row_newbcast:8
v_dot2c_f32_bf16_dpp v10, v23, v30 row_newbcast:8
v_dot2c_f32_bf16_dpp v11, v23, v31 row_newbcast:8
v_dot2c_f32_bf16_dpp v12, v23, v32 row_newbcast:8
v_dot2c_f32_bf16_dpp v13, v23, v33 row_newbcast:8
v_dot2c_f32_bf16_dpp v14, v23, v34 row_newbcast:8
v_dot2c_f32_bf16_dpp v15, v23, v35 row_newbcast:8
s_waitcnt vmcnt(11)
s_add_u32 s56, s51, 196608
buffer_load_dwordx4 v[116:119], v1, s[8:11], s56 offen offset:2048 nt
s_waitcnt vmcnt(11)
s_add_u32 s56, s51, 196608
buffer_load_dwordx4 v[120:123], v1, s[8:11], s56 offen offset:3072 nt
ds_read_b128 v[36:39], v2 offset:6144
ds_read_b128 v[40:43], v2 offset:7168
s_waitcnt lgkmcnt(0)
v_perm_b32 v28, v40, v36, s80
v_perm_b32 v29, v40, v36, s81
v_perm_b32 v30, v41, v37, s80
v_perm_b32 v31, v41, v37, s81
v_perm_b32 v32, v42, v38, s80
v_perm_b32 v33, v42, v38, s81
v_perm_b32 v34, v43, v39, s80
v_perm_b32 v35, v43, v39, s81
v_dot2c_f32_bf16_dpp v8, v24, v28 row_newbcast:0
v_dot2c_f32_bf16_dpp v9, v24, v29 row_newbcast:0
v_dot2c_f32_bf16_dpp v10, v24, v30 row_newbcast:0
v_dot2c_f32_bf16_dpp v11, v24, v31 row_newbcast:0
v_dot2c_f32_bf16_dpp v12, v24, v32 row_newbcast:0
v_dot2c_f32_bf16_dpp v13, v24, v33 row_newbcast:0
v_dot2c_f32_bf16_dpp v14, v24, v34 row_newbcast:0
v_dot2c_f32_bf16_dpp v15, v24, v35 row_newbcast:0
s_waitcnt vmcnt(11)
s_add_u32 s56, s51, 229376
buffer_load_dwordx4 v[124:127], v1, s[8:11], s56 offen offset:0 nt
s_waitcnt vmcnt(11)
s_add_u32 s56, s51, 229376
buffer_load_dwordx4 v[128:131], v1, s[8:11], s56 offen offset:1024 nt
ds_read_b128 v[36:39], v2 offset:8192
ds_read_b128 v[40:43], v2 offset:9216
s_waitcnt lgkmcnt(0)
v_perm_b32 v28, v40, v36, s80
v_perm_b32 v29, v40, v36, s81
v_perm_b32 v30, v41, v37, s80
v_perm_b32 v31, v41, v37, s81
v_perm_b32 v32, v42, v38, s80
v_perm_b32 v33, v42, v38, s81
v_perm_b32 v34, v43, v39, s80
v_perm_b32 v35, v43, v39, s81
v_dot2c_f32_bf16_dpp v8, v24, v28 row_newbcast:8
v_dot2c_f32_bf16_dpp v9, v24, v29 row_newbcast:8
v_dot2c_f32_bf16_dpp v10, v24, v30 row_newbcast:8
v_dot2c_f32_bf16_dpp v11, v24, v31 row_newbcast:8
v_dot2c_f32_bf16_dpp v12, v24, v32 row_newbcast:8
v_dot2c_f32_bf16_dpp v13, v24, v33 row_newbcast:8
v_dot2c_f32_bf16_dpp v14, v24, v34 row_newbcast:8
v_dot2c_f32_bf16_dpp v15, v24, v35 row_newbcast:8
s_waitcnt vmcnt(11)
s_add_u32 s56, s51, 229376
buffer_load_dwordx4 v[132:135], v1, s[8:11], s56 offen offset:2048 nt
s_waitcnt vmcnt(11)
s_add_u32 s56, s51, 229376
buffer_load_dwordx4 v[136:139], v1, s[8:11], s56 offen offset:3072 nt
v_mov_b32 v36, v8
v_mov_b32 v37, v9
v_mov_b32 v38, v10
v_mov_b32 v39, v11
v_mov_b32 v40, v12
v_mov_b32 v41, v13
v_mov_b32 v42, v14
v_mov_b32 v43, v15
v_permlane32_swap_b32 v8, v36
v_permlane32_swap_b32 v9, v37
v_permlane32_swap_b32 v10, v38
v_permlane32_swap_b32 v11, v39
v_permlane32_swap_b32 v12, v40
v_permlane32_swap_b32 v13, v41
v_permlane32_swap_b32 v14, v42
v_permlane32_swap_b32 v15, v43
v_add_f32 v8, v8, v36
v_add_f32 v9, v9, v37
v_add_f32 v10, v10, v38
v_add_f32 v11, v11, v39
v_add_f32 v12, v12, v40
v_add_f32 v13, v13, v41
v_add_f32 v14, v14, v42
v_add_f32 v15, v15, v43
v_and_b32 v28, 31, v3
v_lshlrev_b32 v28, 5, v28
s_lshl_b32 s56, s48, 10
s_add_u32 s56, s56, 0x2000
v_add_u32 v28, s56, v28
ds_write_b128 v28, v[8:11]
ds_write_b128 v28, v[12:15] offset:16
s_lshl_b32 s56, s48, 3
s_add_u32 s56, s56, 0x4040
v_mov_b32 v29, s56
ds_write_b64 v29, v[26:27]
v_mov_b32 v30, 0x4084
v_mov_b32 v31, 1
s_waitcnt lgkmcnt(0)
s_mov_b64 exec, 1
ds_add_rtn_u32 v28, v30, v31
s_mov_b64 exec, -1
s_waitcnt lgkmcnt(0)
v_readfirstlane_b32 s59, v28
s_nop 0
s_cmp_lg_u32 s59, 7
s_cbranch_scc1 L_nos1_97
s_setprio 3
v_add_u32 v24, 0x2000, v1
v_mov_b32 v25, 0x4040
ds_read_b128 v[8:11], v25 offset:0
ds_read_b128 v[12:15], v25 offset:16
ds_read_b128 v[16:19], v25 offset:32
ds_read_b128 v[20:23], v25 offset:48
ds_read_b128 v[36:39], v24 offset:0
ds_read_b128 v[40:43], v24 offset:1024
ds_read_b128 v[44:47], v24 offset:2048
ds_read_b128 v[48:51], v24 offset:3072
s_waitcnt lgkmcnt(0)
v_max_f32 v26, v8, v10
v_max_f32 v26, v26, v12
v_max_f32 v26, v26, v14
v_max_f32 v26, v26, v16
v_max_f32 v26, v26, v18
v_max_f32 v26, v26, v20
v_max_f32 v26, v26, v22
v_sub_f32 v8, v8, v26
v_sub_f32 v10, v10, v26
v_sub_f32 v12, v12, v26
v_sub_f32 v14, v14, v26
v_sub_f32 v16, v16, v26
v_sub_f32 v18, v18, v26
v_sub_f32 v20, v20, v26
v_sub_f32 v22, v22, v26
v_mul_f32 v8, 0x3fb8aa3b, v8
v_mul_f32 v10, 0x3fb8aa3b, v10
v_mul_f32 v12, 0x3fb8aa3b, v12
v_mul_f32 v14, 0x3fb8aa3b, v14
v_mul_f32 v16, 0x3fb8aa3b, v16
v_mul_f32 v18, 0x3fb8aa3b, v18
v_mul_f32 v20, 0x3fb8aa3b, v20
v_mul_f32 v22, 0x3fb8aa3b, v22
v_exp_f32 v8, v8
v_exp_f32 v10, v10
v_exp_f32 v12, v12
v_exp_f32 v14, v14
v_exp_f32 v16, v16
v_exp_f32 v18, v18
v_exp_f32 v20, v20
v_exp_f32 v22, v22
v_mul_f32 v27, v8, v9
v_fmac_f32 v27, v10, v11
v_fmac_f32 v27, v12, v13
v_fmac_f32 v27, v14, v15
v_fmac_f32 v27, v16, v17
v_fmac_f32 v27, v18, v19
v_fmac_f32 v27, v20, v21
v_fmac_f32 v27, v22, v23
v_mul_f32 v28, v8, v36
v_mul_f32 v29, v8, v37
v_mul_f32 v30, v8, v38
v_mul_f32 v31, v8, v39
v_fmac_f32 v28, v10, v40
v_fmac_f32 v29, v10, v41
v_fmac_f32 v30, v10, v42
v_fmac_f32 v31, v10, v43
v_fmac_f32 v28, v12, v44
v_fmac_f32 v29, v12, v45
v_fmac_f32 v30, v12, v46
v_fmac_f32 v31, v12, v47
v_fmac_f32 v28, v14, v48
v_fmac_f32 v29, v14, v49
v_fmac_f32 v30, v14, v50
v_fmac_f32 v31, v14, v51
ds_read_b128 v[36:39], v24 offset:4096
ds_read_b128 v[40:43], v24 offset:5120
ds_read_b128 v[44:47], v24 offset:6144
ds_read_b128 v[48:51], v24 offset:7168
s_waitcnt lgkmcnt(0)
v_fmac_f32 v28, v16, v36
v_fmac_f32 v29, v16, v37
v_fmac_f32 v30, v16, v38
v_fmac_f32 v31, v16, v39
v_fmac_f32 v28, v18, v40
v_fmac_f32 v29, v18, v41
v_fmac_f32 v30, v18, v42
v_fmac_f32 v31, v18, v43
v_fmac_f32 v28, v20, v44
v_fmac_f32 v29, v20, v45
v_fmac_f32 v30, v20, v46
v_fmac_f32 v31, v20, v47
v_fmac_f32 v28, v22, v48
v_fmac_f32 v29, v22, v49
v_fmac_f32 v30, v22, v50
v_fmac_f32 v31, v22, v51
v_or_b32 v28, 1, v28
v_or_b32 v29, 1, v29
v_or_b32 v30, 1, v30
v_or_b32 v31, 1, v31
v_or_b32 v26, 1, v26
v_or_b32 v27, 1, v27
s_mul_i32 s56, s49, 14
s_add_u32 s56, s56, s50
s_mul_i32 s56, s56, 1088
s_add_u32 s56, s56, 0x13b800
buffer_store_dwordx4 v[28:31], v1, s[44:47], s56 offen sc1
s_mov_b64 exec, 1
buffer_store_dwordx2 v[26:27], v1, s[44:47], s56 offen offset:1024 sc1
s_mov_b64 exec, -1
L_nos1_97:
s_nop 4
v_mov_b32 v28, 0x4084
s_mov_b32 s60, 0
L_p_wgw_112:
s_nop 4
ds_read_b32 v29, v28
s_waitcnt lgkmcnt(0)
v_cmp_ne_u32 vcc, 8, v29
s_cbranch_vccz L_d_wgw_113
s_sleep 1
s_add_u32 s60, s60, 1
s_cmp_lt_u32 s60, 400000
s_cbranch_scc1 L_p_wgw_112
s_endpgm
L_d_wgw_113:
s_nop 4
s_setprio 1
v_mov_b32 v16, v64
v_mov_b32 v17, v65
v_mov_b32 v18, v66
v_mov_b32 v19, v67
v_mov_b32 v20, v68
v_mov_b32 v21, v69
v_mov_b32 v22, v70
v_mov_b32 v23, v71
v_mov_b32 v24, v72
v_mov_b32 v26, v74
v_mov_b32 v27, v75
v_mov_b32 v8, v76
v_mov_b32 v9, v77
v_mov_b32 v10, v78
v_mov_b32 v11, v79
v_mov_b32 v12, v80
v_mov_b32 v13, v81
v_mov_b32 v14, v82
v_mov_b32 v15, v83
v_perm_b32 v28, v88, v84, s80
v_perm_b32 v29, v88, v84, s81
v_perm_b32 v30, v89, v85, s80
v_perm_b32 v31, v89, v85, s81
v_perm_b32 v32, v90, v86, s80
v_perm_b32 v33, v90, v86, s81
v_perm_b32 v34, v91, v87, s80
v_perm_b32 v35, v91, v87, s81
v_dot2c_f32_bf16_dpp v8, v20, v28 row_newbcast:8
v_dot2c_f32_bf16_dpp v9, v20, v29 row_newbcast:8
v_dot2c_f32_bf16_dpp v10, v20, v30 row_newbcast:8
v_dot2c_f32_bf16_dpp v11, v20, v31 row_newbcast:8
v_dot2c_f32_bf16_dpp v12, v20, v32 row_newbcast:8
v_dot2c_f32_bf16_dpp v13, v20, v33 row_newbcast:8
v_dot2c_f32_bf16_dpp v14, v20, v34 row_newbcast:8
v_dot2c_f32_bf16_dpp v15, v20, v35 row_newbcast:8
s_waitcnt vmcnt(5)
s_add_u32 s56, s51, 262144
buffer_load_dwordx4 v[140:143], v1, s[8:11], s56 offen offset:0 nt
s_waitcnt vmcnt(5)
s_add_u32 s56, s51, 262144
buffer_load_dwordx4 v[144:147], v1, s[8:11], s56 offen offset:1024 nt
v_perm_b32 v28, v96, v92, s80
v_perm_b32 v29, v96, v92, s81
v_perm_b32 v30, v97, v93, s80
v_perm_b32 v31, v97, v93, s81
v_perm_b32 v32, v98, v94, s80
v_perm_b32 v33, v98, v94, s81
v_perm_b32 v34, v99, v95, s80
v_perm_b32 v35, v99, v95, s81
v_dot2c_f32_bf16_dpp v8, v21, v28 row_newbcast:0
v_dot2c_f32_bf16_dpp v9, v21, v29 row_newbcast:0
v_dot2c_f32_bf16_dpp v10, v21, v30 row_newbcast:0
v_dot2c_f32_bf16_dpp v11, v21, v31 row_newbcast:0
v_dot2c_f32_bf16_dpp v12, v21, v32 row_newbcast:0
v_dot2c_f32_bf16_dpp v13, v21, v33 row_newbcast:0
v_dot2c_f32_bf16_dpp v14, v21, v34 row_newbcast:0
v_dot2c_f32_bf16_dpp v15, v21, v35 row_newbcast:0
s_waitcnt vmcnt(5)
s_add_u32 s56, s51, 262144
buffer_load_dwordx4 v[148:151], v1, s[8:11], s56 offen offset:2048 nt
s_waitcnt vmcnt(5)
s_add_u32 s56, s51, 262144
buffer_load_dwordx4 v[152:155], v1, s[8:11], s56 offen offset:3072 nt
v_perm_b32 v28, v104, v100, s80
v_perm_b32 v29, v104, v100, s81
v_perm_b32 v30, v105, v101, s80
v_perm_b32 v31, v105, v101, s81
v_perm_b32 v32, v106, v102, s80
v_perm_b32 v33, v106, v102, s81
v_perm_b32 v34, v107, v103, s80
v_perm_b32 v35, v107, v103, s81
v_dot2c_f32_bf16_dpp v8, v21, v28 row_newbcast:8
v_dot2c_f32_bf16_dpp v9, v21, v29 row_newbcast:8
v_dot2c_f32_bf16_dpp v10, v21, v30 row_newbcast:8
v_dot2c_f32_bf16_dpp v11, v21, v31 row_newbcast:8
v_dot2c_f32_bf16_dpp v12, v21, v32 row_newbcast:8
v_dot2c_f32_bf16_dpp v13, v21, v33 row_newbcast:8
v_dot2c_f32_bf16_dpp v14, v21, v34 row_newbcast:8
v_dot2c_f32_bf16_dpp v15, v21, v35 row_newbcast:8
s_waitcnt vmcnt(5)
buffer_load_dwordx4 v[156:159], v1, s[4:7], s52 offen offset:0 nt
s_waitcnt vmcnt(5)
buffer_load_dwordx4 v[160:163], v1, s[4:7], s52 offen offset:1024 nt
v_perm_b32 v28, v112, v108, s80
v_perm_b32 v29, v112, v108, s81
v_perm_b32 v30, v113, v109, s80
v_perm_b32 v31, v113, v109, s81
v_perm_b32 v32, v114, v110, s80
v_perm_b32 v33, v114, v110, s81
v_perm_b32 v34, v115, v111, s80
v_perm_b32 v35, v115, v111, s81
v_dot2c_f32_bf16_dpp v8, v22, v28 row_newbcast:0
v_dot2c_f32_bf16_dpp v9, v22, v29 row_newbcast:0
v_dot2c_f32_bf16_dpp v10, v22, v30 row_newbcast:0
v_dot2c_f32_bf16_dpp v11, v22, v31 row_newbcast:0
v_dot2c_f32_bf16_dpp v12, v22, v32 row_newbcast:0
v_dot2c_f32_bf16_dpp v13, v22, v33 row_newbcast:0
v_dot2c_f32_bf16_dpp v14, v22, v34 row_newbcast:0
v_dot2c_f32_bf16_dpp v15, v22, v35 row_newbcast:0
s_waitcnt vmcnt(5)
buffer_load_dwordx4 v[164:167], v1, s[4:7], s52 offen offset:2048 nt
s_waitcnt vmcnt(5)
buffer_load_dwordx4 v[168:171], v1, s[4:7], s52 offen offset:3072 nt
v_perm_b32 v28, v120, v116, s80
v_perm_b32 v29, v120, v116, s81
v_perm_b32 v30, v121, v117, s80
v_perm_b32 v31, v121, v117, s81
v_perm_b32 v32, v122, v118, s80
v_perm_b32 v33, v122, v118, s81
v_perm_b32 v34, v123, v119, s80
v_perm_b32 v35, v123, v119, s81
v_dot2c_f32_bf16_dpp v8, v22, v28 row_newbcast:8
v_dot2c_f32_bf16_dpp v9, v22, v29 row_newbcast:8
v_dot2c_f32_bf16_dpp v10, v22, v30 row_newbcast:8
v_dot2c_f32_bf16_dpp v11, v22, v31 row_newbcast:8
v_dot2c_f32_bf16_dpp v12, v22, v32 row_newbcast:8
v_dot2c_f32_bf16_dpp v13, v22, v33 row_newbcast:8
v_dot2c_f32_bf16_dpp v14, v22, v34 row_newbcast:8
v_dot2c_f32_bf16_dpp v15, v22, v35 row_newbcast:8
s_waitcnt vmcnt(5)
s_add_u32 s56, s52, 32768
buffer_load_dwordx4 v[172:175], v1, s[4:7], s56 offen offset:0 nt
s_waitcnt vmcnt(5)
s_add_u32 s56, s52, 32768
buffer_load_dwordx4 v[176:179], v1, s[4:7], s56 offen offset:1024 nt
v_perm_b32 v28, v128, v124, s80
v_perm_b32 v29, v128, v124, s81
v_perm_b32 v30, v129, v125, s80
v_perm_b32 v31, v129, v125, s81
v_perm_b32 v32, v130, v126, s80
v_perm_b32 v33, v130, v126, s81
v_perm_b32 v34, v131, v127, s80
v_perm_b32 v35, v131, v127, s81
v_dot2c_f32_bf16_dpp v8, v23, v28 row_newbcast:0
v_dot2c_f32_bf16_dpp v9, v23, v29 row_newbcast:0
v_dot2c_f32_bf16_dpp v10, v23, v30 row_newbcast:0
v_dot2c_f32_bf16_dpp v11, v23, v31 row_newbcast:0
v_dot2c_f32_bf16_dpp v12, v23, v32 row_newbcast:0
v_dot2c_f32_bf16_dpp v13, v23, v33 row_newbcast:0
v_dot2c_f32_bf16_dpp v14, v23, v34 row_newbcast:0
v_dot2c_f32_bf16_dpp v15, v23, v35 row_newbcast:0
s_waitcnt vmcnt(5)
s_add_u32 s56, s52, 32768
buffer_load_dwordx4 v[180:183], v1, s[4:7], s56 offen offset:2048 nt
s_waitcnt vmcnt(5)
s_add_u32 s56, s52, 32768
buffer_load_dwordx4 v[184:187], v1, s[4:7], s56 offen offset:3072 nt
v_perm_b32 v28, v136, v132, s80
v_perm_b32 v29, v136, v132, s81
v_perm_b32 v30, v137, v133, s80
v_perm_b32 v31, v137, v133, s81
v_perm_b32 v32, v138, v134, s80
v_perm_b32 v33, v138, v134, s81
v_perm_b32 v34, v139, v135, s80
v_perm_b32 v35, v139, v135, s81
v_dot2c_f32_bf16_dpp v8, v23, v28 row_newbcast:8
v_dot2c_f32_bf16_dpp v9, v23, v29 row_newbcast:8
v_dot2c_f32_bf16_dpp v10, v23, v30 row_newbcast:8
v_dot2c_f32_bf16_dpp v11, v23, v31 row_newbcast:8
v_dot2c_f32_bf16_dpp v12, v23, v32 row_newbcast:8
v_dot2c_f32_bf16_dpp v13, v23, v33 row_newbcast:8
v_dot2c_f32_bf16_dpp v14, v23, v34 row_newbcast:8
v_dot2c_f32_bf16_dpp v15, v23, v35 row_newbcast:8
s_waitcnt vmcnt(5)
s_add_u32 s56, s52, 65536
buffer_load_dwordx4 v[188:191], v1, s[4:7], s56 offen offset:0 nt
s_waitcnt vmcnt(5)
s_add_u32 s56, s52, 65536
buffer_load_dwordx4 v[192:195], v1, s[4:7], s56 offen offset:1024 nt
v_perm_b32 v28, v144, v140, s80
v_perm_b32 v29, v144, v140, s81
v_perm_b32 v30, v145, v141, s80
v_perm_b32 v31, v145, v141, s81
v_perm_b32 v32, v146, v142, s80
v_perm_b32 v33, v146, v142, s81
v_perm_b32 v34, v147, v143, s80
v_perm_b32 v35, v147, v143, s81
v_dot2c_f32_bf16_dpp v8, v24, v28 row_newbcast:0
v_dot2c_f32_bf16_dpp v9, v24, v29 row_newbcast:0
v_dot2c_f32_bf16_dpp v10, v24, v30 row_newbcast:0
v_dot2c_f32_bf16_dpp v11, v24, v31 row_newbcast:0
v_dot2c_f32_bf16_dpp v12, v24, v32 row_newbcast:0
v_dot2c_f32_bf16_dpp v13, v24, v33 row_newbcast:0
v_dot2c_f32_bf16_dpp v14, v24, v34 row_newbcast:0
v_dot2c_f32_bf16_dpp v15, v24, v35 row_newbcast:0
s_waitcnt vmcnt(5)
s_add_u32 s56, s52, 65536
buffer_load_dwordx4 v[196:199], v1, s[4:7], s56 offen offset:2048 nt
s_waitcnt vmcnt(5)
s_add_u32 s56, s52, 65536
buffer_load_dwordx4 v[200:203], v1, s[4:7], s56 offen offset:3072 nt
v_perm_b32 v28, v152, v148, s80
v_perm_b32 v29, v152, v148, s81
v_perm_b32 v30, v153, v149, s80
v_perm_b32 v31, v153, v149, s81
v_perm_b32 v32, v154, v150, s80
v_perm_b32 v33, v154, v150, s81
v_perm_b32 v34, v155, v151, s80
v_perm_b32 v35, v155, v151, s81
v_dot2c_f32_bf16_dpp v8, v24, v28 row_newbcast:8
v_dot2c_f32_bf16_dpp v9, v24, v29 row_newbcast:8
v_dot2c_f32_bf16_dpp v10, v24, v30 row_newbcast:8
v_dot2c_f32_bf16_dpp v11, v24, v31 row_newbcast:8
v_dot2c_f32_bf16_dpp v12, v24, v32 row_newbcast:8
v_dot2c_f32_bf16_dpp v13, v24, v33 row_newbcast:8
v_dot2c_f32_bf16_dpp v14, v24, v34 row_newbcast:8
v_dot2c_f32_bf16_dpp v15, v24, v35 row_newbcast:8
s_waitcnt vmcnt(5)
s_add_u32 s56, s52, 98304
buffer_load_dwordx4 v[204:207], v1, s[4:7], s56 offen offset:0 nt
s_waitcnt vmcnt(5)
s_add_u32 s56, s52, 98304
buffer_load_dwordx4 v[208:211], v1, s[4:7], s56 offen offset:1024 nt
v_mov_b32 v36, v8
v_mov_b32 v37, v9
v_mov_b32 v38, v10
v_mov_b32 v39, v11
v_mov_b32 v40, v12
v_mov_b32 v41, v13
v_mov_b32 v42, v14
v_mov_b32 v43, v15
v_permlane32_swap_b32 v8, v36
v_permlane32_swap_b32 v9, v37
v_permlane32_swap_b32 v10, v38
v_permlane32_swap_b32 v11, v39
v_permlane32_swap_b32 v12, v40
v_permlane32_swap_b32 v13, v41
v_permlane32_swap_b32 v14, v42
v_permlane32_swap_b32 v15, v43
v_add_f32 v8, v8, v36
v_add_f32 v9, v9, v37
v_add_f32 v10, v10, v38
v_add_f32 v11, v11, v39
v_add_f32 v12, v12, v40
v_add_f32 v13, v13, v41
v_add_f32 v14, v14, v42
v_add_f32 v15, v15, v43
v_and_b32 v28, 31, v3
v_lshlrev_b32 v28, 5, v28
s_lshl_b32 s56, s48, 10
s_add_u32 s56, s56, 0x0
v_add_u32 v28, s56, v28
ds_write_b128 v28, v[8:11]
ds_write_b128 v28, v[12:15] offset:16
s_lshl_b32 s56, s48, 3
s_add_u32 s56, s56, 0x4000
v_mov_b32 v29, s56
ds_write_b64 v29, v[26:27]
v_mov_b32 v30, 0x4088
v_mov_b32 v31, 1
s_waitcnt lgkmcnt(0)
s_mov_b64 exec, 1
ds_add_rtn_u32 v28, v30, v31
s_mov_b64 exec, -1
s_waitcnt lgkmcnt(0)
v_readfirstlane_b32 s59, v28
s_nop 0
s_cmp_lg_u32 s59, 7
s_cbranch_scc1 L_nos1_119
s_setprio 3
v_add_u32 v24, 0x0, v1
v_mov_b32 v25, 0x4000
ds_read_b128 v[8:11], v25 offset:0
ds_read_b128 v[12:15], v25 offset:16
ds_read_b128 v[16:19], v25 offset:32
ds_read_b128 v[20:23], v25 offset:48
ds_read_b128 v[36:39], v24 offset:0
ds_read_b128 v[40:43], v24 offset:1024
ds_read_b128 v[44:47], v24 offset:2048
ds_read_b128 v[48:51], v24 offset:3072
s_waitcnt lgkmcnt(0)
v_max_f32 v26, v8, v10
v_max_f32 v26, v26, v12
v_max_f32 v26, v26, v14
v_max_f32 v26, v26, v16
v_max_f32 v26, v26, v18
v_max_f32 v26, v26, v20
v_max_f32 v26, v26, v22
v_sub_f32 v8, v8, v26
v_sub_f32 v10, v10, v26
v_sub_f32 v12, v12, v26
v_sub_f32 v14, v14, v26
v_sub_f32 v16, v16, v26
v_sub_f32 v18, v18, v26
v_sub_f32 v20, v20, v26
v_sub_f32 v22, v22, v26
v_mul_f32 v8, 0x3fb8aa3b, v8
v_mul_f32 v10, 0x3fb8aa3b, v10
v_mul_f32 v12, 0x3fb8aa3b, v12
v_mul_f32 v14, 0x3fb8aa3b, v14
v_mul_f32 v16, 0x3fb8aa3b, v16
v_mul_f32 v18, 0x3fb8aa3b, v18
v_mul_f32 v20, 0x3fb8aa3b, v20
v_mul_f32 v22, 0x3fb8aa3b, v22
v_exp_f32 v8, v8
v_exp_f32 v10, v10
v_exp_f32 v12, v12
v_exp_f32 v14, v14
v_exp_f32 v16, v16
v_exp_f32 v18, v18
v_exp_f32 v20, v20
v_exp_f32 v22, v22
v_mul_f32 v27, v8, v9
v_fmac_f32 v27, v10, v11
v_fmac_f32 v27, v12, v13
v_fmac_f32 v27, v14, v15
v_fmac_f32 v27, v16, v17
v_fmac_f32 v27, v18, v19
v_fmac_f32 v27, v20, v21
v_fmac_f32 v27, v22, v23
v_mul_f32 v28, v8, v36
v_mul_f32 v29, v8, v37
v_mul_f32 v30, v8, v38
v_mul_f32 v31, v8, v39
v_fmac_f32 v28, v10, v40
v_fmac_f32 v29, v10, v41
v_fmac_f32 v30, v10, v42
v_fmac_f32 v31, v10, v43
v_fmac_f32 v28, v12, v44
v_fmac_f32 v29, v12, v45
v_fmac_f32 v30, v12, v46
v_fmac_f32 v31, v12, v47
v_fmac_f32 v28, v14, v48
v_fmac_f32 v29, v14, v49
v_fmac_f32 v30, v14, v50
v_fmac_f32 v31, v14, v51
ds_read_b128 v[36:39], v24 offset:4096
ds_read_b128 v[40:43], v24 offset:5120
ds_read_b128 v[44:47], v24 offset:6144
ds_read_b128 v[48:51], v24 offset:7168
s_waitcnt lgkmcnt(0)
v_fmac_f32 v28, v16, v36
v_fmac_f32 v29, v16, v37
v_fmac_f32 v30, v16, v38
v_fmac_f32 v31, v16, v39
v_fmac_f32 v28, v18, v40
v_fmac_f32 v29, v18, v41
v_fmac_f32 v30, v18, v42
v_fmac_f32 v31, v18, v43
v_fmac_f32 v28, v20, v44
v_fmac_f32 v29, v20, v45
v_fmac_f32 v30, v20, v46
v_fmac_f32 v31, v20, v47
v_fmac_f32 v28, v22, v48
v_fmac_f32 v29, v22, v49
v_fmac_f32 v30, v22, v50
v_fmac_f32 v31, v22, v51
v_or_b32 v28, 1, v28
v_or_b32 v29, 1, v29
v_or_b32 v30, 1, v30
v_or_b32 v31, 1, v31
v_or_b32 v26, 1, v26
v_or_b32 v27, 1, v27
s_mul_i32 s56, s49, 14
s_add_u32 s56, s56, s50
s_mul_i32 s56, s56, 1088
s_add_u32 s56, s56, 0x177000
buffer_store_dwordx4 v[28:31], v1, s[44:47], s56 offen sc1
s_mov_b64 exec, 1
buffer_store_dwordx2 v[26:27], v1, s[44:47], s56 offen offset:1024 sc1
s_mov_b64 exec, -1
L_nos1_119:
s_nop 4
s_setprio 0
s_waitcnt vmcnt(5)
s_add_u32 s56, s52, 98304
buffer_load_dwordx4 v[212:215], v1, s[4:7], s56 offen offset:2048 nt
s_waitcnt vmcnt(5)
s_add_u32 s56, s52, 98304
buffer_load_dwordx4 v[216:219], v1, s[4:7], s56 offen offset:3072 nt
s_waitcnt vmcnt(5)
s_add_u32 s56, s52, 131072
buffer_load_dwordx4 v[220:223], v1, s[4:7], s56 offen offset:0 nt
s_waitcnt vmcnt(5)
s_add_u32 s56, s52, 131072
buffer_load_dwordx4 v[224:227], v1, s[4:7], s56 offen offset:1024 nt
s_waitcnt vmcnt(5)
s_add_u32 s56, s52, 131072
buffer_load_dwordx4 v[228:231], v1, s[4:7], s56 offen offset:2048 nt
s_waitcnt vmcnt(5)
s_add_u32 s56, s52, 131072
buffer_load_dwordx4 v[84:87], v1, s[4:7], s56 offen offset:3072 nt
s_waitcnt vmcnt(5)
s_add_u32 s56, s52, 163840
buffer_load_dwordx4 v[88:91], v1, s[4:7], s56 offen offset:0 nt
s_waitcnt vmcnt(5)
s_add_u32 s56, s52, 163840
buffer_load_dwordx4 v[92:95], v1, s[4:7], s56 offen offset:1024 nt
s_waitcnt vmcnt(5)
s_add_u32 s56, s52, 163840
buffer_load_dwordx4 v[96:99], v1, s[4:7], s56 offen offset:2048 nt
s_waitcnt vmcnt(5)
s_add_u32 s56, s52, 163840
buffer_load_dwordx4 v[100:103], v1, s[4:7], s56 offen offset:3072 nt
s_waitcnt vmcnt(5)
s_add_u32 s56, s52, 196608
buffer_load_dwordx4 v[104:107], v1, s[4:7], s56 offen offset:0 nt
s_waitcnt vmcnt(5)
s_add_u32 s56, s52, 196608
buffer_load_dwordx4 v[108:111], v1, s[4:7], s56 offen offset:1024 nt
s_waitcnt vmcnt(5)
s_add_u32 s56, s52, 196608
buffer_load_dwordx4 v[112:115], v1, s[4:7], s56 offen offset:2048 nt
s_waitcnt vmcnt(5)
s_add_u32 s56, s52, 196608
buffer_load_dwordx4 v[116:119], v1, s[4:7], s56 offen offset:3072 nt
s_waitcnt vmcnt(5)
s_add_u32 s56, s52, 229376
buffer_load_dwordx4 v[120:123], v1, s[4:7], s56 offen offset:0 nt
s_waitcnt vmcnt(5)
s_add_u32 s56, s52, 229376
buffer_load_dwordx4 v[124:127], v1, s[4:7], s56 offen offset:1024 nt
s_waitcnt vmcnt(5)
s_add_u32 s56, s52, 229376
buffer_load_dwordx4 v[128:131], v1, s[4:7], s56 offen offset:2048 nt
s_waitcnt vmcnt(5)
s_add_u32 s56, s52, 229376
buffer_load_dwordx4 v[132:135], v1, s[4:7], s56 offen offset:3072 nt
s_waitcnt vmcnt(5)
s_add_u32 s56, s52, 262144
buffer_load_dwordx4 v[136:139], v1, s[4:7], s56 offen offset:0 nt
s_waitcnt vmcnt(5)
s_add_u32 s56, s52, 262144
buffer_load_dwordx4 v[140:143], v1, s[4:7], s56 offen offset:1024 nt
v_and_b32 v32, 31, v3
v_lshlrev_b32 v32, 5, v32
s_lshl_b32 s56, s49, 10
s_add_u32 s56, s56, 0x414000
buffer_load_dwordx4 v[56:59], v32, s[44:47], s56 offen offset:0 sc1
buffer_load_dwordx4 v[60:63], v32, s[44:47], s56 offen offset:16 sc1
s_waitcnt vmcnt(5)
s_add_u32 s56, s52, 262144
buffer_load_dwordx4 v[144:147], v1, s[4:7], s56 offen offset:2048 nt
s_waitcnt vmcnt(5)
s_add_u32 s56, s52, 262144
buffer_load_dwordx4 v[148:151], v1, s[4:7], s56 offen offset:3072 nt
s_waitcnt vmcnt(5)
buffer_load_dwordx4 v[152:155], v1, s[8:11], s52 offen offset:0 nt
s_waitcnt vmcnt(5)
s_add_u32 m0, s53, 10240
s_add_u32 s56, s52, 1024
buffer_load_dwordx4 v1, s[8:11], s56 offen nt lds
s_waitcnt vmcnt(5)
s_add_u32 m0, s53, 11264
s_add_u32 s56, s52, 2048
buffer_load_dwordx4 v1, s[8:11], s56 offen nt lds
s_waitcnt vmcnt(5)
s_add_u32 m0, s53, 12288
s_add_u32 s56, s52, 3072
buffer_load_dwordx4 v1, s[8:11], s56 offen nt lds
v_and_b32 v28, v56, v57
v_and_b32 v28, v28, v58
v_and_b32 v28, v28, v59
v_and_b32 v28, v28, v60
v_and_b32 v28, v28, v61
v_and_b32 v28, v28, v62
v_and_b32 v28, v28, v63
v_and_b32 v28, 1, v28
v_cmp_ne_u32 vcc, 1, v28
s_cbranch_vccz L_qburst_136
s_waitcnt vmcnt(5)
s_add_u32 m0, s53, 13312
s_add_u32 s56, s52, 32768
buffer_load_dwordx4 v1, s[8:11], s56 offen nt lds
s_waitcnt vmcnt(5)
s_add_u32 m0, s53, 14336
s_add_u32 s56, s52, 33792
buffer_load_dwordx4 v1, s[8:11], s56 offen nt lds
s_waitcnt vmcnt(5)
s_add_u32 m0, s53, 15360
s_add_u32 s56, s52, 34816
buffer_load_dwordx4 v1, s[8:11], s56 offen lds
s_waitcnt vmcnt(5)
s_add_u32 m0, s53, 16384
s_add_u32 s56, s52, 35840
buffer_load_dwordx4 v1, s[8:11], s56 offen lds
s_mov_b32 s60, 0
L_p_q_138:
s_nop 4
v_and_b32 v32, 31, v3
v_lshlrev_b32 v32, 5, v32
s_lshl_b32 s56, s49, 10
s_add_u32 s56, s56, 0x414000
buffer_load_dwordx4 v[56:59], v32, s[44:47], s56 offen offset:0 sc1
buffer_load_dwordx4 v[60:63], v32, s[44:47], s56 offen offset:16 sc1
s_waitcnt vmcnt(0)
v_and_b32 v28, v56, v57
v_and_b32 v28, v28, v58
v_and_b32 v28, v28, v59
v_and_b32 v28, v28, v60
v_and_b32 v28, v28, v61
v_and_b32 v28, v28, v62
v_and_b32 v28, v28, v63
v_and_b32 v28, 1, v28
v_cmp_ne_u32 vcc, 1, v28
s_cbranch_vccz L_d_q_139
s_sleep 1
s_add_u32 s60, s60, 1
s_cmp_lt_u32 s60, 400000
s_cbranch_scc1 L_p_q_138
s_endpgm
L_d_q_139:
s_nop 4
s_branch L_qjoin_137
L_qburst_136:
s_nop 4
s_add_u32 m0, s53, 13312
s_add_u32 s56, s52, 32768
buffer_load_dwordx4 v1, s[8:11], s56 offen nt lds
s_add_u32 m0, s53, 14336
s_add_u32 s56, s52, 33792
buffer_load_dwordx4 v1, s[8:11], s56 offen nt lds
s_add_u32 m0, s53, 15360
s_add_u32 s56, s52, 34816
buffer_load_dwordx4 v1, s[8:11], s56 offen lds
s_add_u32 m0, s53, 16384
s_add_u32 s56, s52, 35840
buffer_load_dwordx4 v1, s[8:11], s56 offen lds
L_qjoin_137:
s_nop 4
s_mov_b32 s56, 0x07060302
v_perm_b32 v4, v57, v56, s56
v_perm_b32 v5, v59, v58, s56
v_perm_b32 v6, v61, v60, s56
v_perm_b32 v7, v63, v62, s56
v_dot2_f32_bf16 v28, v156, v4, 0
v_dot2_f32_bf16 v29, v160, v4, 0
v_dot2_f32_bf16 v30, v164, v4, 0
v_dot2_f32_bf16 v31, v168, v4, 0
v_dot2_f32_bf16 v28, v157, v5, v28
v_dot2_f32_bf16 v29, v161, v5, v29
v_dot2_f32_bf16 v30, v165, v5, v30
v_dot2_f32_bf16 v31, v169, v5, v31
v_dot2_f32_bf16 v28, v158, v6, v28
v_dot2_f32_bf16 v29, v162, v6, v29
v_dot2_f32_bf16 v30, v166, v6, v30
v_dot2_f32_bf16 v31, v170, v6, v31
v_dot2_f32_bf16 v28, v159, v7, v28
v_dot2_f32_bf16 v29, v163, v7, v29
v_dot2_f32_bf16 v30, v167, v7, v30
v_dot2_f32_bf16 v31, v171, v7, v31
s_nop 0
v_permlane16_swap_b32 v28, v29
s_nop 0
v_permlane16_swap_b32 v30, v31
v_add_f32 v28, v28, v29
v_add_f32 v30, v30, v31
s_nop 0
v_add_f32_dpp v16, v28, v28 row_ror:8 row_mask:0xf bank_mask:0x3
v_add_f32_dpp v16, v30, v30 row_ror:8 row_mask:0xf bank_mask:0xc
s_add_u32 s56, s52, 65536
buffer_load_dwordx4 v[156:159], v1, s[8:11], s56 offen offset:0
s_add_u32 s56, s52, 65536
buffer_load_dwordx4 v[160:163], v1, s[8:11], s56 offen offset:1024
s_waitcnt vmcnt(11)
s_add_u32 s56, s52, 65536
buffer_load_dwordx4 v[164:167], v1, s[8:11], s56 offen offset:2048
s_waitcnt vmcnt(11)
s_add_u32 s56, s52, 65536
buffer_load_dwordx4 v[168:171], v1, s[8:11], s56 offen offset:3072
s_waitcnt vmcnt(11)
v_dot2_f32_bf16 v28, v172, v4, 0
v_dot2_f32_bf16 v29, v176, v4, 0
v_dot2_f32_bf16 v30, v180, v4, 0
v_dot2_f32_bf16 v31, v184, v4, 0
v_dot2_f32_bf16 v28, v173, v5, v28
v_dot2_f32_bf16 v29, v177, v5, v29
v_dot2_f32_bf16 v30, v181, v5, v30
v_dot2_f32_bf16 v31, v185, v5, v31
v_dot2_f32_bf16 v28, v174, v6, v28
v_dot2_f32_bf16 v29, v178, v6, v29
v_dot2_f32_bf16 v30, v182, v6, v30
v_dot2_f32_bf16 v31, v186, v6, v31
v_dot2_f32_bf16 v28, v175, v7, v28
v_dot2_f32_bf16 v29, v179, v7, v29
v_dot2_f32_bf16 v30, v183, v7, v30
v_dot2_f32_bf16 v31, v187, v7, v31
s_nop 0
v_permlane16_swap_b32 v28, v29
s_nop 0
v_permlane16_swap_b32 v30, v31
v_add_f32 v28, v28, v29
v_add_f32 v30, v30, v31
s_nop 0
v_add_f32_dpp v17, v28, v28 row_ror:8 row_mask:0xf bank_mask:0x3
v_add_f32_dpp v17, v30, v30 row_ror:8 row_mask:0xf bank_mask:0xc
s_add_u32 s56, s52, 98304
buffer_load_dwordx4 v[172:175], v1, s[8:11], s56 offen offset:0
s_waitcnt vmcnt(11)
s_add_u32 s56, s52, 98304
buffer_load_dwordx4 v[176:179], v1, s[8:11], s56 offen offset:1024
s_waitcnt vmcnt(11)
s_add_u32 s56, s52, 98304
buffer_load_dwordx4 v[180:183], v1, s[8:11], s56 offen offset:2048
s_waitcnt vmcnt(11)
s_add_u32 s56, s52, 98304
buffer_load_dwordx4 v[184:187], v1, s[8:11], s56 offen offset:3072
s_waitcnt vmcnt(11)
v_dot2_f32_bf16 v28, v188, v4, 0
v_dot2_f32_bf16 v29, v192, v4, 0
v_dot2_f32_bf16 v30, v196, v4, 0
v_dot2_f32_bf16 v31, v200, v4, 0
v_dot2_f32_bf16 v28, v189, v5, v28
v_dot2_f32_bf16 v29, v193, v5, v29
v_dot2_f32_bf16 v30, v197, v5, v30
v_dot2_f32_bf16 v31, v201, v5, v31
v_dot2_f32_bf16 v28, v190, v6, v28
v_dot2_f32_bf16 v29, v194, v6, v29
v_dot2_f32_bf16 v30, v198, v6, v30
v_dot2_f32_bf16 v31, v202, v6, v31
v_dot2_f32_bf16 v28, v191, v7, v28
v_dot2_f32_bf16 v29, v195, v7, v29
v_dot2_f32_bf16 v30, v199, v7, v30
v_dot2_f32_bf16 v31, v203, v7, v31
s_nop 0
v_permlane16_swap_b32 v28, v29
s_nop 0
v_permlane16_swap_b32 v30, v31
v_add_f32 v28, v28, v29
v_add_f32 v30, v30, v31
s_nop 0
v_add_f32_dpp v18, v28, v28 row_ror:8 row_mask:0xf bank_mask:0x3
v_add_f32_dpp v18, v30, v30 row_ror:8 row_mask:0xf bank_mask:0xc
s_add_u32 s56, s52, 131072
buffer_load_dwordx4 v[188:191], v1, s[8:11], s56 offen offset:0
s_waitcnt vmcnt(11)
s_add_u32 s56, s52, 131072
buffer_load_dwordx4 v[192:195], v1, s[8:11], s56 offen offset:1024
s_waitcnt vmcnt(11)
s_add_u32 s56, s52, 131072
buffer_load_dwordx4 v[196:199], v1, s[8:11], s56 offen offset:2048
s_waitcnt vmcnt(11)
s_add_u32 s56, s52, 131072
buffer_load_dwordx4 v[200:203], v1, s[8:11], s56 offen offset:3072
s_waitcnt vmcnt(11)
v_dot2_f32_bf16 v28, v204, v4, 0
v_dot2_f32_bf16 v29, v208, v4, 0
v_dot2_f32_bf16 v30, v212, v4, 0
v_dot2_f32_bf16 v31, v216, v4, 0
v_dot2_f32_bf16 v28, v205, v5, v28
v_dot2_f32_bf16 v29, v209, v5, v29
v_dot2_f32_bf16 v30, v213, v5, v30
v_dot2_f32_bf16 v31, v217, v5, v31
v_dot2_f32_bf16 v28, v206, v6, v28
v_dot2_f32_bf16 v29, v210, v6, v29
v_dot2_f32_bf16 v30, v214, v6, v30
v_dot2_f32_bf16 v31, v218, v6, v31
v_dot2_f32_bf16 v28, v207, v7, v28
v_dot2_f32_bf16 v29, v211, v7, v29
v_dot2_f32_bf16 v30, v215, v7, v30
v_dot2_f32_bf16 v31, v219, v7, v31
s_nop 0
v_permlane16_swap_b32 v28, v29
s_nop 0
v_permlane16_swap_b32 v30, v31
v_add_f32 v28, v28, v29
v_add_f32 v30, v30, v31
s_nop 0
v_add_f32_dpp v19, v28, v28 row_ror:8 row_mask:0xf bank_mask:0x3
v_add_f32_dpp v19, v30, v30 row_ror:8 row_mask:0xf bank_mask:0xc
v_dot2_f32_bf16 v28, v220, v4, 0
v_dot2_f32_bf16 v29, v224, v4, 0
v_dot2_f32_bf16 v30, v228, v4, 0
v_dot2_f32_bf16 v31, v84, v4, 0
v_dot2_f32_bf16 v28, v221, v5, v28
v_dot2_f32_bf16 v29, v225, v5, v29
v_dot2_f32_bf16 v30, v229, v5, v30
v_dot2_f32_bf16 v31, v85, v5, v31
v_dot2_f32_bf16 v28, v222, v6, v28
v_dot2_f32_bf16 v29, v226, v6, v29
v_dot2_f32_bf16 v30, v230, v6, v30
v_dot2_f32_bf16 v31, v86, v6, v31
v_dot2_f32_bf16 v28, v223, v7, v28
v_dot2_f32_bf16 v29, v227, v7, v29
v_dot2_f32_bf16 v30, v231, v7, v30
v_dot2_f32_bf16 v31, v87, v7, v31
s_nop 0
v_permlane16_swap_b32 v28, v29
s_nop 0
v_permlane16_swap_b32 v30, v31
v_add_f32 v28, v28, v29
v_add_f32 v30, v30, v31
s_nop 0
v_add_f32_dpp v20, v28, v28 row_ror:8 row_mask:0xf bank_mask:0x3
v_add_f32_dpp v20, v30, v30 row_ror:8 row_mask:0xf bank_mask:0xc
v_dot2_f32_bf16 v28, v88, v4, 0
v_dot2_f32_bf16 v29, v92, v4, 0
v_dot2_f32_bf16 v30, v96, v4, 0
v_dot2_f32_bf16 v31, v100, v4, 0
v_dot2_f32_bf16 v28, v89, v5, v28
v_dot2_f32_bf16 v29, v93, v5, v29
v_dot2_f32_bf16 v30, v97, v5, v30
v_dot2_f32_bf16 v31, v101, v5, v31
v_dot2_f32_bf16 v28, v90, v6, v28
v_dot2_f32_bf16 v29, v94, v6, v29
v_dot2_f32_bf16 v30, v98, v6, v30
v_dot2_f32_bf16 v31, v102, v6, v31
v_dot2_f32_bf16 v28, v91, v7, v28
v_dot2_f32_bf16 v29, v95, v7, v29
v_dot2_f32_bf16 v30, v99, v7, v30
v_dot2_f32_bf16 v31, v103, v7, v31
s_nop 0
v_permlane16_swap_b32 v28, v29
s_nop 0
v_permlane16_swap_b32 v30, v31
v_add_f32 v28, v28, v29
v_add_f32 v30, v30, v31
s_nop 0
v_add_f32_dpp v21, v28, v28 row_ror:8 row_mask:0xf bank_mask:0x3
v_add_f32_dpp v21, v30, v30 row_ror:8 row_mask:0xf bank_mask:0xc
v_dot2_f32_bf16 v28, v104, v4, 0
v_dot2_f32_bf16 v29, v108, v4, 0
v_dot2_f32_bf16 v30, v112, v4, 0
v_dot2_f32_bf16 v31, v116, v4, 0
v_dot2_f32_bf16 v28, v105, v5, v28
v_dot2_f32_bf16 v29, v109, v5, v29
v_dot2_f32_bf16 v30, v113, v5, v30
v_dot2_f32_bf16 v31, v117, v5, v31
v_dot2_f32_bf16 v28, v106, v6, v28
v_dot2_f32_bf16 v29, v110, v6, v29
v_dot2_f32_bf16 v30, v114, v6, v30
v_dot2_f32_bf16 v31, v118, v6, v31
v_dot2_f32_bf16 v28, v107, v7, v28
v_dot2_f32_bf16 v29, v111, v7, v29
v_dot2_f32_bf16 v30, v115, v7, v30
v_dot2_f32_bf16 v31, v119, v7, v31
s_nop 0
v_permlane16_swap_b32 v28, v29
s_nop 0
v_permlane16_swap_b32 v30, v31
v_add_f32 v28, v28, v29
v_add_f32 v30, v30, v31
s_nop 0
v_add_f32_dpp v22, v28, v28 row_ror:8 row_mask:0xf bank_mask:0x3
v_add_f32_dpp v22, v30, v30 row_ror:8 row_mask:0xf bank_mask:0xc
v_dot2_f32_bf16 v28, v120, v4, 0
v_dot2_f32_bf16 v29, v124, v4, 0
v_dot2_f32_bf16 v30, v128, v4, 0
v_dot2_f32_bf16 v31, v132, v4, 0
v_dot2_f32_bf16 v28, v121, v5, v28
v_dot2_f32_bf16 v29, v125, v5, v29
v_dot2_f32_bf16 v30, v129, v5, v30
v_dot2_f32_bf16 v31, v133, v5, v31
v_dot2_f32_bf16 v28, v122, v6, v28
v_dot2_f32_bf16 v29, v126, v6, v29
v_dot2_f32_bf16 v30, v130, v6, v30
v_dot2_f32_bf16 v31, v134, v6, v31
v_dot2_f32_bf16 v28, v123, v7, v28
v_dot2_f32_bf16 v29, v127, v7, v29
v_dot2_f32_bf16 v30, v131, v7, v30
v_dot2_f32_bf16 v31, v135, v7, v31
s_nop 0
v_permlane16_swap_b32 v28, v29
s_nop 0
v_permlane16_swap_b32 v30, v31
v_add_f32 v28, v28, v29
v_add_f32 v30, v30, v31
s_nop 0
v_add_f32_dpp v23, v28, v28 row_ror:8 row_mask:0xf bank_mask:0x3
v_add_f32_dpp v23, v30, v30 row_ror:8 row_mask:0xf bank_mask:0xc
v_dot2_f32_bf16 v28, v136, v4, 0
v_dot2_f32_bf16 v29, v140, v4, 0
v_dot2_f32_bf16 v30, v144, v4, 0
v_dot2_f32_bf16 v31, v148, v4, 0
v_dot2_f32_bf16 v28, v137, v5, v28
v_dot2_f32_bf16 v29, v141, v5, v29
v_dot2_f32_bf16 v30, v145, v5, v30
v_dot2_f32_bf16 v31, v149, v5, v31
v_dot2_f32_bf16 v28, v138, v6, v28
v_dot2_f32_bf16 v29, v142, v6, v29
v_dot2_f32_bf16 v30, v146, v6, v30
v_dot2_f32_bf16 v31, v150, v6, v31
v_dot2_f32_bf16 v28, v139, v7, v28
v_dot2_f32_bf16 v29, v143, v7, v29
v_dot2_f32_bf16 v30, v147, v7, v30
v_dot2_f32_bf16 v31, v151, v7, v31
s_nop 0
v_permlane16_swap_b32 v28, v29
s_nop 0
v_permlane16_swap_b32 v30, v31
v_add_f32 v28, v28, v29
v_add_f32 v30, v30, v31
s_nop 0
v_add_f32_dpp v24, v28, v28 row_ror:8 row_mask:0xf bank_mask:0x3
v_add_f32_dpp v24, v30, v30 row_ror:8 row_mask:0xf bank_mask:0xc
v_add_f32_dpp v16, v16, v16 quad_perm:[1,0,3,2]
v_add_f32_dpp v17, v17, v17 quad_perm:[1,0,3,2]
v_add_f32_dpp v18, v18, v18 quad_perm:[1,0,3,2]
v_add_f32_dpp v19, v19, v19 quad_perm:[1,0,3,2]
v_add_f32_dpp v20, v20, v20 quad_perm:[1,0,3,2]
v_add_f32_dpp v21, v21, v21 quad_perm:[1,0,3,2]
v_add_f32_dpp v22, v22, v22 quad_perm:[1,0,3,2]
v_add_f32_dpp v23, v23, v23 quad_perm:[1,0,3,2]
v_add_f32_dpp v24, v24, v24 quad_perm:[1,0,3,2]
v_add_f32_dpp v16, v16, v16 quad_perm:[2,3,0,1]
v_add_f32_dpp v17, v17, v17 quad_perm:[2,3,0,1]
v_add_f32_dpp v18, v18, v18 quad_perm:[2,3,0,1]
v_add_f32_dpp v19, v19, v19 quad_perm:[2,3,0,1]
v_add_f32_dpp v20, v20, v20 quad_perm:[2,3,0,1]
v_add_f32_dpp v21, v21, v21 quad_perm:[2,3,0,1]
v_add_f32_dpp v22, v22, v22 quad_perm:[2,3,0,1]
v_add_f32_dpp v23, v23, v23 quad_perm:[2,3,0,1]
v_add_f32_dpp v24, v24, v24 quad_perm:[2,3,0,1]
v_add_f32_dpp v16, v16, v16 row_half_mirror
v_add_f32_dpp v17, v17, v17 row_half_mirror
v_add_f32_dpp v18, v18, v18 row_half_mirror
v_add_f32_dpp v19, v19, v19 row_half_mirror
v_add_f32_dpp v20, v20, v20 row_half_mirror
v_add_f32_dpp v21, v21, v21 row_half_mirror
v_add_f32_dpp v22, v22, v22 row_half_mirror
v_add_f32_dpp v23, v23, v23 row_half_mirror
v_add_f32_dpp v24, v24, v24 row_half_mirror
v_cvt_pk_bf16_f32 v16, v16, v16
v_cvt_pk_bf16_f32 v17, v17, v17
v_cvt_pk_bf16_f32 v18, v18, v18
v_cvt_pk_bf16_f32 v19, v19, v19
v_cvt_pk_bf16_f32 v20, v20, v20
v_cvt_pk_bf16_f32 v21, v21, v21
v_cvt_pk_bf16_f32 v22, v22, v22
v_cvt_pk_bf16_f32 v23, v23, v23
v_cvt_pk_bf16_f32 v24, v24, v24
v_and_b32 v16, s62, v16
v_and_b32 v17, s62, v17
v_and_b32 v18, s62, v18
v_and_b32 v19, s62, v19
v_and_b32 v20, s62, v20
v_and_b32 v21, s62, v21
v_and_b32 v22, s62, v22
v_and_b32 v23, s62, v23
v_and_b32 v24, s62, v24
v_mul_f32 v16, 0x3d800000, v16
v_mul_f32 v17, 0x3d800000, v17
v_mul_f32 v18, 0x3d800000, v18
v_mul_f32 v19, 0x3d800000, v19
v_mul_f32 v20, 0x3d800000, v20
v_mul_f32 v21, 0x3d800000, v21
v_mul_f32 v22, 0x3d800000, v22
v_mul_f32 v23, 0x3d800000, v23
v_mul_f32 v24, 0x3d800000, v24
v_max_f32 v26, v16, v17
v_max_f32 v26, v26, v18
v_max_f32 v26, v26, v19
v_max_f32 v26, v26, v20
v_max_f32 v26, v26, v21
v_max_f32 v26, v26, v22
v_max_f32 v26, v26, v23
v_max_f32 v26, v26, v24
s_nop 1
v_max_f32_dpp v26, v26, v26 row_ror:8
v_mov_b32 v28, v26
s_nop 1
v_permlane16_swap_b32 v26, v28
v_max_f32 v26, v26, v28
v_mov_b32 v28, v26
s_nop 1
v_permlane32_swap_b32 v26, v28
v_max_f32 v26, v26, v28
v_sub_f32 v16, v16, v26
v_sub_f32 v17, v17, v26
v_sub_f32 v18, v18, v26
v_sub_f32 v19, v19, v26
v_sub_f32 v20, v20, v26
v_sub_f32 v21, v21, v26
v_sub_f32 v22, v22, v26
v_sub_f32 v23, v23, v26
v_sub_f32 v24, v24, v26
v_mul_f32 v16, 0x3fb8aa3b, v16
v_mul_f32 v17, 0x3fb8aa3b, v17
v_mul_f32 v18, 0x3fb8aa3b, v18
v_mul_f32 v19, 0x3fb8aa3b, v19
v_mul_f32 v20, 0x3fb8aa3b, v20
v_mul_f32 v21, 0x3fb8aa3b, v21
v_mul_f32 v22, 0x3fb8aa3b, v22
v_mul_f32 v23, 0x3fb8aa3b, v23
v_mul_f32 v24, 0x3fb8aa3b, v24
v_exp_f32 v16, v16
v_exp_f32 v17, v17
v_exp_f32 v18, v18
v_exp_f32 v19, v19
v_exp_f32 v20, v20
v_exp_f32 v21, v21
v_exp_f32 v22, v22
v_exp_f32 v23, v23
v_exp_f32 v24, v24
v_add_f32 v27, v16, v17
v_add_f32 v27, v27, v18
v_add_f32 v27, v27, v19
v_add_f32 v27, v27, v20
v_add_f32 v27, v27, v21
v_add_f32 v27, v27, v22
v_add_f32 v27, v27, v23
v_add_f32 v27, v27, v24
s_nop 1
v_add_f32_dpp v27, v27, v27 row_ror:8
v_mov_b32 v28, v27
s_nop 1
v_permlane16_swap_b32 v27, v28
v_add_f32 v27, v27, v28
v_mov_b32 v28, v27
s_nop 1
v_permlane32_swap_b32 v27, v28
v_add_f32 v27, v27, v28
v_mov_b32 v36, v16
v_mov_b32 v37, v17
v_mov_b32 v38, v18
v_mov_b32 v39, v19
v_mov_b32 v40, v20
v_mov_b32 v41, v21
v_mov_b32 v42, v22
v_mov_b32 v43, v23
v_mov_b32 v44, v24
v_permlane16_swap_b32 v16, v36
v_permlane16_swap_b32 v17, v37
v_permlane16_swap_b32 v18, v38
v_permlane16_swap_b32 v19, v39
v_permlane16_swap_b32 v20, v40
v_permlane16_swap_b32 v21, v41
v_permlane16_swap_b32 v22, v42
v_permlane16_swap_b32 v23, v43
v_permlane16_swap_b32 v24, v44
v_cvt_pk_bf16_f32 v16, v16, v36
v_cvt_pk_bf16_f32 v17, v17, v37
v_cvt_pk_bf16_f32 v18, v18, v38
v_cvt_pk_bf16_f32 v19, v19, v39
v_cvt_pk_bf16_f32 v20, v20, v40
v_cvt_pk_bf16_f32 v21, v21, v41
v_cvt_pk_bf16_f32 v22, v22, v42
v_cvt_pk_bf16_f32 v23, v23, v43
v_cvt_pk_bf16_f32 v24, v24, v44
v_mov_b32 v8, 0
v_mov_b32 v9, 0
v_mov_b32 v10, 0
v_mov_b32 v11, 0
v_mov_b32 v12, 0
v_mov_b32 v13, 0
v_mov_b32 v14, 0
v_mov_b32 v15, 0
ds_read_b128 v[36:39], v2 offset:10240
s_waitcnt lgkmcnt(0)
v_perm_b32 v28, v36, v152, s80
v_perm_b32 v29, v36, v152, s81
v_perm_b32 v30, v37, v153, s80
v_perm_b32 v31, v37, v153, s81
v_perm_b32 v32, v38, v154, s80
v_perm_b32 v33, v38, v154, s81
v_perm_b32 v34, v39, v155, s80
v_perm_b32 v35, v39, v155, s81
v_dot2c_f32_bf16_dpp v8, v16, v28 row_newbcast:0
v_dot2c_f32_bf16_dpp v9, v16, v29 row_newbcast:0
v_dot2c_f32_bf16_dpp v10, v16, v30 row_newbcast:0
v_dot2c_f32_bf16_dpp v11, v16, v31 row_newbcast:0
v_dot2c_f32_bf16_dpp v12, v16, v32 row_newbcast:0
v_dot2c_f32_bf16_dpp v13, v16, v33 row_newbcast:0
v_dot2c_f32_bf16_dpp v14, v16, v34 row_newbcast:0
v_dot2c_f32_bf16_dpp v15, v16, v35 row_newbcast:0
ds_read_b128 v[36:39], v2 offset:11264
ds_read_b128 v[40:43], v2 offset:12288
s_waitcnt lgkmcnt(0)
v_perm_b32 v28, v40, v36, s80
v_perm_b32 v29, v40, v36, s81
v_perm_b32 v30, v41, v37, s80
v_perm_b32 v31, v41, v37, s81
v_perm_b32 v32, v42, v38, s80
v_perm_b32 v33, v42, v38, s81
v_perm_b32 v34, v43, v39, s80
v_perm_b32 v35, v43, v39, s81
v_dot2c_f32_bf16_dpp v8, v16, v28 row_newbcast:8
v_dot2c_f32_bf16_dpp v9, v16, v29 row_newbcast:8
v_dot2c_f32_bf16_dpp v10, v16, v30 row_newbcast:8
v_dot2c_f32_bf16_dpp v11, v16, v31 row_newbcast:8
v_dot2c_f32_bf16_dpp v12, v16, v32 row_newbcast:8
v_dot2c_f32_bf16_dpp v13, v16, v33 row_newbcast:8
v_dot2c_f32_bf16_dpp v14, v16, v34 row_newbcast:8
v_dot2c_f32_bf16_dpp v15, v16, v35 row_newbcast:8
ds_read_b128 v[36:39], v2 offset:13312
ds_read_b128 v[40:43], v2 offset:14336
s_waitcnt lgkmcnt(0)
v_perm_b32 v28, v40, v36, s80
v_perm_b32 v29, v40, v36, s81
v_perm_b32 v30, v41, v37, s80
v_perm_b32 v31, v41, v37, s81
v_perm_b32 v32, v42, v38, s80
v_perm_b32 v33, v42, v38, s81
v_perm_b32 v34, v43, v39, s80
v_perm_b32 v35, v43, v39, s81
v_dot2c_f32_bf16_dpp v8, v17, v28 row_newbcast:0
v_dot2c_f32_bf16_dpp v9, v17, v29 row_newbcast:0
v_dot2c_f32_bf16_dpp v10, v17, v30 row_newbcast:0
v_dot2c_f32_bf16_dpp v11, v17, v31 row_newbcast:0
v_dot2c_f32_bf16_dpp v12, v17, v32 row_newbcast:0
v_dot2c_f32_bf16_dpp v13, v17, v33 row_newbcast:0
v_dot2c_f32_bf16_dpp v14, v17, v34 row_newbcast:0
v_dot2c_f32_bf16_dpp v15, v17, v35 row_newbcast:0
ds_read_b128 v[36:39], v2 offset:15360
ds_read_b128 v[40:43], v2 offset:16384
s_waitcnt lgkmcnt(0)
v_perm_b32 v28, v40, v36, s80
v_perm_b32 v29, v40, v36, s81
v_perm_b32 v30, v41, v37, s80
v_perm_b32 v31, v41, v37, s81
v_perm_b32 v32, v42, v38, s80
v_perm_b32 v33, v42, v38, s81
v_perm_b32 v34, v43, v39, s80
v_perm_b32 v35, v43, v39, s81
v_dot2c_f32_bf16_dpp v8, v17, v28 row_newbcast:8
v_dot2c_f32_bf16_dpp v9, v17, v29 row_newbcast:8
v_dot2c_f32_bf16_dpp v10, v17, v30 row_newbcast:8
v_dot2c_f32_bf16_dpp v11, v17, v31 row_newbcast:8
v_dot2c_f32_bf16_dpp v12, v17, v32 row_newbcast:8
v_dot2c_f32_bf16_dpp v13, v17, v33 row_newbcast:8
v_dot2c_f32_bf16_dpp v14, v17, v34 row_newbcast:8
v_dot2c_f32_bf16_dpp v15, v17, v35 row_newbcast:8
s_waitcnt vmcnt(10)
v_perm_b32 v28, v160, v156, s80
v_perm_b32 v29, v160, v156, s81
v_perm_b32 v30, v161, v157, s80
v_perm_b32 v31, v161, v157, s81
v_perm_b32 v32, v162, v158, s80
v_perm_b32 v33, v162, v158, s81
v_perm_b32 v34, v163, v159, s80
v_perm_b32 v35, v163, v159, s81
v_dot2c_f32_bf16_dpp v8, v18, v28 row_newbcast:0
v_dot2c_f32_bf16_dpp v9, v18, v29 row_newbcast:0
v_dot2c_f32_bf16_dpp v10, v18, v30 row_newbcast:0
v_dot2c_f32_bf16_dpp v11, v18, v31 row_newbcast:0
v_dot2c_f32_bf16_dpp v12, v18, v32 row_newbcast:0
v_dot2c_f32_bf16_dpp v13, v18, v33 row_newbcast:0
v_dot2c_f32_bf16_dpp v14, v18, v34 row_newbcast:0
v_dot2c_f32_bf16_dpp v15, v18, v35 row_newbcast:0
s_waitcnt vmcnt(9)
s_waitcnt vmcnt(8)
v_perm_b32 v28, v168, v164, s80
v_perm_b32 v29, v168, v164, s81
v_perm_b32 v30, v169, v165, s80
v_perm_b32 v31, v169, v165, s81
v_perm_b32 v32, v170, v166, s80
v_perm_b32 v33, v170, v166, s81
v_perm_b32 v34, v171, v167, s80
v_perm_b32 v35, v171, v167, s81
v_dot2c_f32_bf16_dpp v8, v18, v28 row_newbcast:8
v_dot2c_f32_bf16_dpp v9, v18, v29 row_newbcast:8
v_dot2c_f32_bf16_dpp v10, v18, v30 row_newbcast:8
v_dot2c_f32_bf16_dpp v11, v18, v31 row_newbcast:8
v_dot2c_f32_bf16_dpp v12, v18, v32 row_newbcast:8
v_dot2c_f32_bf16_dpp v13, v18, v33 row_newbcast:8
v_dot2c_f32_bf16_dpp v14, v18, v34 row_newbcast:8
v_dot2c_f32_bf16_dpp v15, v18, v35 row_newbcast:8
s_waitcnt vmcnt(7)
s_waitcnt vmcnt(6)
v_perm_b32 v28, v176, v172, s80
v_perm_b32 v29, v176, v172, s81
v_perm_b32 v30, v177, v173, s80
v_perm_b32 v31, v177, v173, s81
v_perm_b32 v32, v178, v174, s80
v_perm_b32 v33, v178, v174, s81
v_perm_b32 v34, v179, v175, s80
v_perm_b32 v35, v179, v175, s81
v_dot2c_f32_bf16_dpp v8, v19, v28 row_newbcast:0
v_dot2c_f32_bf16_dpp v9, v19, v29 row_newbcast:0
v_dot2c_f32_bf16_dpp v10, v19, v30 row_newbcast:0
v_dot2c_f32_bf16_dpp v11, v19, v31 row_newbcast:0
v_dot2c_f32_bf16_dpp v12, v19, v32 row_newbcast:0
v_dot2c_f32_bf16_dpp v13, v19, v33 row_newbcast:0
v_dot2c_f32_bf16_dpp v14, v19, v34 row_newbcast:0
v_dot2c_f32_bf16_dpp v15, v19, v35 row_newbcast:0
s_waitcnt vmcnt(5)
s_waitcnt vmcnt(4)
v_perm_b32 v28, v184, v180, s80
v_perm_b32 v29, v184, v180, s81
v_perm_b32 v30, v185, v181, s80
v_perm_b32 v31, v185, v181, s81
v_perm_b32 v32, v186, v182, s80
v_perm_b32 v33, v186, v182, s81
v_perm_b32 v34, v187, v183, s80
v_perm_b32 v35, v187, v183, s81
v_dot2c_f32_bf16_dpp v8, v19, v28 row_newbcast:8
v_dot2c_f32_bf16_dpp v9, v19, v29 row_newbcast:8
v_dot2c_f32_bf16_dpp v10, v19, v30 row_newbcast:8
v_dot2c_f32_bf16_dpp v11, v19, v31 row_newbcast:8
v_dot2c_f32_bf16_dpp v12, v19, v32 row_newbcast:8
v_dot2c_f32_bf16_dpp v13, v19, v33 row_newbcast:8
v_dot2c_f32_bf16_dpp v14, v19, v34 row_newbcast:8
v_dot2c_f32_bf16_dpp v15, v19, v35 row_newbcast:8
s_waitcnt vmcnt(3)
s_waitcnt vmcnt(2)
v_perm_b32 v28, v192, v188, s80
v_perm_b32 v29, v192, v188, s81
v_perm_b32 v30, v193, v189, s80
v_perm_b32 v31, v193, v189, s81
v_perm_b32 v32, v194, v190, s80
v_perm_b32 v33, v194, v190, s81
v_perm_b32 v34, v195, v191, s80
v_perm_b32 v35, v195, v191, s81
v_dot2c_f32_bf16_dpp v8, v20, v28 row_newbcast:0
v_dot2c_f32_bf16_dpp v9, v20, v29 row_newbcast:0
v_dot2c_f32_bf16_dpp v10, v20, v30 row_newbcast:0
v_dot2c_f32_bf16_dpp v11, v20, v31 row_newbcast:0
v_dot2c_f32_bf16_dpp v12, v20, v32 row_newbcast:0
v_dot2c_f32_bf16_dpp v13, v20, v33 row_newbcast:0
v_dot2c_f32_bf16_dpp v14, v20, v34 row_newbcast:0
v_dot2c_f32_bf16_dpp v15, v20, v35 row_newbcast:0
s_waitcnt vmcnt(1)
s_waitcnt vmcnt(0)
v_perm_b32 v28, v200, v196, s80
v_perm_b32 v29, v200, v196, s81
v_perm_b32 v30, v201, v197, s80
v_perm_b32 v31, v201, v197, s81
v_perm_b32 v32, v202, v198, s80
v_perm_b32 v33, v202, v198, s81
v_perm_b32 v34, v203, v199, s80
v_perm_b32 v35, v203, v199, s81
v_dot2c_f32_bf16_dpp v8, v20, v28 row_newbcast:8
v_dot2c_f32_bf16_dpp v9, v20, v29 row_newbcast:8
v_dot2c_f32_bf16_dpp v10, v20, v30 row_newbcast:8
v_dot2c_f32_bf16_dpp v11, v20, v31 row_newbcast:8
v_dot2c_f32_bf16_dpp v12, v20, v32 row_newbcast:8
v_dot2c_f32_bf16_dpp v13, v20, v33 row_newbcast:8
v_dot2c_f32_bf16_dpp v14, v20, v34 row_newbcast:8
v_dot2c_f32_bf16_dpp v15, v20, v35 row_newbcast:8
v_perm_b32 v28, v244, v240, s80
v_perm_b32 v29, v244, v240, s81
v_perm_b32 v30, v245, v241, s80
v_perm_b32 v31, v245, v241, s81
v_perm_b32 v32, v246, v242, s80
v_perm_b32 v33, v246, v242, s81
v_perm_b32 v34, v247, v243, s80
v_perm_b32 v35, v247, v243, s81
v_dot2c_f32_bf16_dpp v8, v21, v28 row_newbcast:0
v_dot2c_f32_bf16_dpp v9, v21, v29 row_newbcast:0
v_dot2c_f32_bf16_dpp v10, v21, v30 row_newbcast:0
v_dot2c_f32_bf16_dpp v11, v21, v31 row_newbcast:0
v_dot2c_f32_bf16_dpp v12, v21, v32 row_newbcast:0
v_dot2c_f32_bf16_dpp v13, v21, v33 row_newbcast:0
v_dot2c_f32_bf16_dpp v14, v21, v34 row_newbcast:0
v_dot2c_f32_bf16_dpp v15, v21, v35 row_newbcast:0
v_perm_b32 v28, v252, v248, s80
v_perm_b32 v29, v252, v248, s81
v_perm_b32 v30, v253, v249, s80
v_perm_b32 v31, v253, v249, s81
v_perm_b32 v32, v254, v250, s80
v_perm_b32 v33, v254, v250, s81
v_perm_b32 v34, v255, v251, s80
v_perm_b32 v35, v255, v251, s81
v_dot2c_f32_bf16_dpp v8, v21, v28 row_newbcast:8
v_dot2c_f32_bf16_dpp v9, v21, v29 row_newbcast:8
v_dot2c_f32_bf16_dpp v10, v21, v30 row_newbcast:8
v_dot2c_f32_bf16_dpp v11, v21, v31 row_newbcast:8
v_dot2c_f32_bf16_dpp v12, v21, v32 row_newbcast:8
v_dot2c_f32_bf16_dpp v13, v21, v33 row_newbcast:8
v_dot2c_f32_bf16_dpp v14, v21, v34 row_newbcast:8
v_dot2c_f32_bf16_dpp v15, v21, v35 row_newbcast:8
v_perm_b32 v28, v236, v232, s80
v_perm_b32 v29, v236, v232, s81
v_perm_b32 v30, v237, v233, s80
v_perm_b32 v31, v237, v233, s81
v_perm_b32 v32, v238, v234, s80
v_perm_b32 v33, v238, v234, s81
v_perm_b32 v34, v239, v235, s80
v_perm_b32 v35, v239, v235, s81
v_dot2c_f32_bf16_dpp v8, v22, v28 row_newbcast:0
v_dot2c_f32_bf16_dpp v9, v22, v29 row_newbcast:0
v_dot2c_f32_bf16_dpp v10, v22, v30 row_newbcast:0
v_dot2c_f32_bf16_dpp v11, v22, v31 row_newbcast:0
v_dot2c_f32_bf16_dpp v12, v22, v32 row_newbcast:0
v_dot2c_f32_bf16_dpp v13, v22, v33 row_newbcast:0
v_dot2c_f32_bf16_dpp v14, v22, v34 row_newbcast:0
v_dot2c_f32_bf16_dpp v15, v22, v35 row_newbcast:0
ds_read_b128 v[36:39], v2 offset:0
ds_read_b128 v[40:43], v2 offset:1024
s_waitcnt lgkmcnt(0)
v_perm_b32 v28, v40, v36, s80
v_perm_b32 v29, v40, v36, s81
v_perm_b32 v30, v41, v37, s80
v_perm_b32 v31, v41, v37, s81
v_perm_b32 v32, v42, v38, s80
v_perm_b32 v33, v42, v38, s81
v_perm_b32 v34, v43, v39, s80
v_perm_b32 v35, v43, v39, s81
v_dot2c_f32_bf16_dpp v8, v22, v28 row_newbcast:8
v_dot2c_f32_bf16_dpp v9, v22, v29 row_newbcast:8
v_dot2c_f32_bf16_dpp v10, v22, v30 row_newbcast:8
v_dot2c_f32_bf16_dpp v11, v22, v31 row_newbcast:8
v_dot2c_f32_bf16_dpp v12, v22, v32 row_newbcast:8
v_dot2c_f32_bf16_dpp v13, v22, v33 row_newbcast:8
v_dot2c_f32_bf16_dpp v14, v22, v34 row_newbcast:8
v_dot2c_f32_bf16_dpp v15, v22, v35 row_newbcast:8
ds_read_b128 v[36:39], v2 offset:2048
ds_read_b128 v[40:43], v2 offset:3072
s_waitcnt lgkmcnt(0)
v_perm_b32 v28, v40, v36, s80
v_perm_b32 v29, v40, v36, s81
v_perm_b32 v30, v41, v37, s80
v_perm_b32 v31, v41, v37, s81
v_perm_b32 v32, v42, v38, s80
v_perm_b32 v33, v42, v38, s81
v_perm_b32 v34, v43, v39, s80
v_perm_b32 v35, v43, v39, s81
v_dot2c_f32_bf16_dpp v8, v23, v28 row_newbcast:0
v_dot2c_f32_bf16_dpp v9, v23, v29 row_newbcast:0
v_dot2c_f32_bf16_dpp v10, v23, v30 row_newbcast:0
v_dot2c_f32_bf16_dpp v11, v23, v31 row_newbcast:0
v_dot2c_f32_bf16_dpp v12, v23, v32 row_newbcast:0
v_dot2c_f32_bf16_dpp v13, v23, v33 row_newbcast:0
v_dot2c_f32_bf16_dpp v14, v23, v34 row_newbcast:0
v_dot2c_f32_bf16_dpp v15, v23, v35 row_newbcast:0
ds_read_b128 v[36:39], v2 offset:4096
ds_read_b128 v[40:43], v2 offset:5120
s_waitcnt lgkmcnt(0)
v_perm_b32 v28, v40, v36, s80
v_perm_b32 v29, v40, v36, s81
v_perm_b32 v30, v41, v37, s80
v_perm_b32 v31, v41, v37, s81
v_perm_b32 v32, v42, v38, s80
v_perm_b32 v33, v42, v38, s81
v_perm_b32 v34, v43, v39, s80
v_perm_b32 v35, v43, v39, s81
v_dot2c_f32_bf16_dpp v8, v23, v28 row_newbcast:8
v_dot2c_f32_bf16_dpp v9, v23, v29 row_newbcast:8
v_dot2c_f32_bf16_dpp v10, v23, v30 row_newbcast:8
v_dot2c_f32_bf16_dpp v11, v23, v31 row_newbcast:8
v_dot2c_f32_bf16_dpp v12, v23, v32 row_newbcast:8
v_dot2c_f32_bf16_dpp v13, v23, v33 row_newbcast:8
v_dot2c_f32_bf16_dpp v14, v23, v34 row_newbcast:8
v_dot2c_f32_bf16_dpp v15, v23, v35 row_newbcast:8
ds_read_b128 v[36:39], v2 offset:6144
ds_read_b128 v[40:43], v2 offset:7168
s_waitcnt lgkmcnt(0)
v_perm_b32 v28, v40, v36, s80
v_perm_b32 v29, v40, v36, s81
v_perm_b32 v30, v41, v37, s80
v_perm_b32 v31, v41, v37, s81
v_perm_b32 v32, v42, v38, s80
v_perm_b32 v33, v42, v38, s81
v_perm_b32 v34, v43, v39, s80
v_perm_b32 v35, v43, v39, s81
v_dot2c_f32_bf16_dpp v8, v24, v28 row_newbcast:0
v_dot2c_f32_bf16_dpp v9, v24, v29 row_newbcast:0
v_dot2c_f32_bf16_dpp v10, v24, v30 row_newbcast:0
v_dot2c_f32_bf16_dpp v11, v24, v31 row_newbcast:0
v_dot2c_f32_bf16_dpp v12, v24, v32 row_newbcast:0
v_dot2c_f32_bf16_dpp v13, v24, v33 row_newbcast:0
v_dot2c_f32_bf16_dpp v14, v24, v34 row_newbcast:0
v_dot2c_f32_bf16_dpp v15, v24, v35 row_newbcast:0
ds_read_b128 v[36:39], v2 offset:8192
ds_read_b128 v[40:43], v2 offset:9216
s_waitcnt lgkmcnt(0)
v_perm_b32 v28, v40, v36, s80
v_perm_b32 v29, v40, v36, s81
v_perm_b32 v30, v41, v37, s80
v_perm_b32 v31, v41, v37, s81
v_perm_b32 v32, v42, v38, s80
v_perm_b32 v33, v42, v38, s81
v_perm_b32 v34, v43, v39, s80
v_perm_b32 v35, v43, v39, s81
v_dot2c_f32_bf16_dpp v8, v24, v28 row_newbcast:8
v_dot2c_f32_bf16_dpp v9, v24, v29 row_newbcast:8
v_dot2c_f32_bf16_dpp v10, v24, v30 row_newbcast:8
v_dot2c_f32_bf16_dpp v11, v24, v31 row_newbcast:8
v_dot2c_f32_bf16_dpp v12, v24, v32 row_newbcast:8
v_dot2c_f32_bf16_dpp v13, v24, v33 row_newbcast:8
v_dot2c_f32_bf16_dpp v14, v24, v34 row_newbcast:8
v_dot2c_f32_bf16_dpp v15, v24, v35 row_newbcast:8
v_mov_b32 v36, v8
v_mov_b32 v37, v9
v_mov_b32 v38, v10
v_mov_b32 v39, v11
v_mov_b32 v40, v12
v_mov_b32 v41, v13
v_mov_b32 v42, v14
v_mov_b32 v43, v15
v_permlane32_swap_b32 v8, v36
v_permlane32_swap_b32 v9, v37
v_permlane32_swap_b32 v10, v38
v_permlane32_swap_b32 v11, v39
v_permlane32_swap_b32 v12, v40
v_permlane32_swap_b32 v13, v41
v_permlane32_swap_b32 v14, v42
v_permlane32_swap_b32 v15, v43
v_add_f32 v8, v8, v36
v_add_f32 v9, v9, v37
v_add_f32 v10, v10, v38
v_add_f32 v11, v11, v39
v_add_f32 v12, v12, v40
v_add_f32 v13, v13, v41
v_add_f32 v14, v14, v42
v_add_f32 v15, v15, v43
v_and_b32 v28, 31, v3
v_lshlrev_b32 v28, 5, v28
s_lshl_b32 s56, s48, 10
s_add_u32 s56, s56, 0x2000
v_add_u32 v28, s56, v28
ds_write_b128 v28, v[8:11]
ds_write_b128 v28, v[12:15] offset:16
s_lshl_b32 s56, s48, 3
s_add_u32 s56, s56, 0x4040
v_mov_b32 v29, s56
ds_write_b64 v29, v[26:27]
v_mov_b32 v30, 0x408c
v_mov_b32 v31, 1
s_waitcnt lgkmcnt(0)
s_mov_b64 exec, 1
ds_add_rtn_u32 v28, v30, v31
s_mov_b64 exec, -1
s_waitcnt lgkmcnt(0)
v_readfirstlane_b32 s59, v28
s_nop 0
s_cmp_lg_u32 s59, 7
s_cbranch_scc1 L_nos1_163
s_setprio 3
v_add_u32 v24, 0x2000, v1
v_mov_b32 v25, 0x4040
ds_read_b128 v[8:11], v25 offset:0
ds_read_b128 v[12:15], v25 offset:16
ds_read_b128 v[16:19], v25 offset:32
ds_read_b128 v[20:23], v25 offset:48
ds_read_b128 v[36:39], v24 offset:0
ds_read_b128 v[40:43], v24 offset:1024
ds_read_b128 v[44:47], v24 offset:2048
ds_read_b128 v[48:51], v24 offset:3072
s_waitcnt lgkmcnt(0)
v_max_f32 v26, v8, v10
v_max_f32 v26, v26, v12
v_max_f32 v26, v26, v14
v_max_f32 v26, v26, v16
v_max_f32 v26, v26, v18
v_max_f32 v26, v26, v20
v_max_f32 v26, v26, v22
v_sub_f32 v8, v8, v26
v_sub_f32 v10, v10, v26
v_sub_f32 v12, v12, v26
v_sub_f32 v14, v14, v26
v_sub_f32 v16, v16, v26
v_sub_f32 v18, v18, v26
v_sub_f32 v20, v20, v26
v_sub_f32 v22, v22, v26
v_mul_f32 v8, 0x3fb8aa3b, v8
v_mul_f32 v10, 0x3fb8aa3b, v10
v_mul_f32 v12, 0x3fb8aa3b, v12
v_mul_f32 v14, 0x3fb8aa3b, v14
v_mul_f32 v16, 0x3fb8aa3b, v16
v_mul_f32 v18, 0x3fb8aa3b, v18
v_mul_f32 v20, 0x3fb8aa3b, v20
v_mul_f32 v22, 0x3fb8aa3b, v22
v_exp_f32 v8, v8
v_exp_f32 v10, v10
v_exp_f32 v12, v12
v_exp_f32 v14, v14
v_exp_f32 v16, v16
v_exp_f32 v18, v18
v_exp_f32 v20, v20
v_exp_f32 v22, v22
v_mul_f32 v27, v8, v9
v_fmac_f32 v27, v10, v11
v_fmac_f32 v27, v12, v13
v_fmac_f32 v27, v14, v15
v_fmac_f32 v27, v16, v17
v_fmac_f32 v27, v18, v19
v_fmac_f32 v27, v20, v21
v_fmac_f32 v27, v22, v23
v_mul_f32 v28, v8, v36
v_mul_f32 v29, v8, v37
v_mul_f32 v30, v8, v38
v_mul_f32 v31, v8, v39
v_fmac_f32 v28, v10, v40
v_fmac_f32 v29, v10, v41
v_fmac_f32 v30, v10, v42
v_fmac_f32 v31, v10, v43
v_fmac_f32 v28, v12, v44
v_fmac_f32 v29, v12, v45
v_fmac_f32 v30, v12, v46
v_fmac_f32 v31, v12, v47
v_fmac_f32 v28, v14, v48
v_fmac_f32 v29, v14, v49
v_fmac_f32 v30, v14, v50
v_fmac_f32 v31, v14, v51
ds_read_b128 v[36:39], v24 offset:4096
ds_read_b128 v[40:43], v24 offset:5120
ds_read_b128 v[44:47], v24 offset:6144
ds_read_b128 v[48:51], v24 offset:7168
s_waitcnt lgkmcnt(0)
v_fmac_f32 v28, v16, v36
v_fmac_f32 v29, v16, v37
v_fmac_f32 v30, v16, v38
v_fmac_f32 v31, v16, v39
v_fmac_f32 v28, v18, v40
v_fmac_f32 v29, v18, v41
v_fmac_f32 v30, v18, v42
v_fmac_f32 v31, v18, v43
v_fmac_f32 v28, v20, v44
v_fmac_f32 v29, v20, v45
v_fmac_f32 v30, v20, v46
v_fmac_f32 v31, v20, v47
v_fmac_f32 v28, v22, v48
v_fmac_f32 v29, v22, v49
v_fmac_f32 v30, v22, v50
v_fmac_f32 v31, v22, v51
v_or_b32 v28, 1, v28
v_or_b32 v29, 1, v29
v_or_b32 v30, 1, v30
v_or_b32 v31, 1, v31
v_or_b32 v26, 1, v26
v_or_b32 v27, 1, v27
s_mul_i32 s56, s49, 14
s_add_u32 s56, s56, s50
s_mul_i32 s56, s56, 1088
s_add_u32 s56, s56, 0x1b2800
buffer_store_dwordx4 v[28:31], v1, s[44:47], s56 offen sc1
s_mov_b64 exec, 1
buffer_store_dwordx2 v[26:27], v1, s[44:47], s56 offen offset:1024 sc1
s_mov_b64 exec, -1
L_nos1_163:
s_nop 4
s_endpgm
L_typeB:
s_nop 4
s_setprio 3
s_add_u32 m0, s53, 0
s_add_u32 s56, s51, 0
buffer_load_dwordx4 v1, s[4:7], s56 offen nt lds
s_add_u32 m0, s53, 1024
s_add_u32 s56, s51, 1024
buffer_load_dwordx4 v1, s[4:7], s56 offen nt lds
s_add_u32 m0, s53, 2048
s_add_u32 s56, s51, 2048
buffer_load_dwordx4 v1, s[4:7], s56 offen nt lds
s_add_u32 m0, s53, 3072
s_add_u32 s56, s51, 3072
buffer_load_dwordx4 v1, s[4:7], s56 offen nt lds
s_waitcnt vmcnt(3)
s_add_u32 m0, s53, 4096
s_add_u32 s56, s51, 32768
buffer_load_dwordx4 v1, s[4:7], s56 offen nt lds
s_waitcnt vmcnt(3)
s_add_u32 m0, s53, 5120
s_add_u32 s56, s51, 33792
buffer_load_dwordx4 v1, s[4:7], s56 offen nt lds
s_waitcnt vmcnt(3)
s_add_u32 m0, s53, 6144
s_add_u32 s56, s51, 34816
buffer_load_dwordx4 v1, s[4:7], s56 offen nt lds
s_waitcnt vmcnt(3)
s_add_u32 m0, s53, 7168
s_add_u32 s56, s51, 35840
buffer_load_dwordx4 v1, s[4:7], s56 offen nt lds
s_waitcnt vmcnt(3)
s_add_u32 m0, s53, 8192
s_add_u32 s56, s51, 65536
buffer_load_dwordx4 v1, s[4:7], s56 offen nt lds
s_waitcnt vmcnt(3)
s_add_u32 m0, s53, 9216
s_add_u32 s56, s51, 66560
buffer_load_dwordx4 v1, s[4:7], s56 offen nt lds
s_waitcnt vmcnt(3)
s_add_u32 m0, s53, 10240
s_add_u32 s56, s51, 67584
buffer_load_dwordx4 v1, s[4:7], s56 offen nt lds
s_waitcnt vmcnt(3)
s_add_u32 m0, s53, 11264
s_add_u32 s56, s51, 68608
buffer_load_dwordx4 v1, s[4:7], s56 offen nt lds
s_waitcnt vmcnt(3)
s_add_u32 m0, s53, 12288
s_add_u32 s56, s51, 98304
buffer_load_dwordx4 v1, s[4:7], s56 offen nt lds
s_waitcnt vmcnt(3)
s_add_u32 m0, s53, 13312
s_add_u32 s56, s51, 99328
buffer_load_dwordx4 v1, s[4:7], s56 offen nt lds
s_waitcnt vmcnt(3)
s_add_u32 m0, s53, 14336
s_add_u32 s56, s51, 100352
buffer_load_dwordx4 v1, s[4:7], s56 offen nt lds
s_waitcnt vmcnt(3)
s_add_u32 m0, s53, 15360
s_add_u32 s56, s51, 101376
buffer_load_dwordx4 v1, s[4:7], s56 offen nt lds
s_waitcnt vmcnt(3)
s_add_u32 m0, s53, 16384
s_add_u32 s56, s51, 131072
buffer_load_dwordx4 v1, s[4:7], s56 offen nt lds
s_waitcnt vmcnt(3)
s_add_u32 s56, s51, 131072
buffer_load_dwordx4 v[84:87], v1, s[4:7], s56 offen offset:1024 nt
s_waitcnt vmcnt(3)
s_add_u32 s56, s51, 131072
buffer_load_dwordx4 v[88:91], v1, s[4:7], s56 offen offset:2048 nt
s_waitcnt vmcnt(3)
s_add_u32 s56, s51, 131072
buffer_load_dwordx4 v[92:95], v1, s[4:7], s56 offen offset:3072 nt
s_waitcnt vmcnt(3)
s_add_u32 s56, s51, 163840
buffer_load_dwordx4 v[96:99], v1, s[4:7], s56 offen offset:0 nt
s_waitcnt vmcnt(3)
s_add_u32 s56, s51, 163840
buffer_load_dwordx4 v[100:103], v1, s[4:7], s56 offen offset:1024 nt
s_waitcnt vmcnt(3)
s_add_u32 s56, s51, 163840
buffer_load_dwordx4 v[104:107], v1, s[4:7], s56 offen offset:2048 nt
s_waitcnt vmcnt(3)
s_add_u32 s56, s51, 163840
buffer_load_dwordx4 v[108:111], v1, s[4:7], s56 offen offset:3072 nt
s_waitcnt vmcnt(3)
s_add_u32 s56, s51, 196608
buffer_load_dwordx4 v[112:115], v1, s[4:7], s56 offen offset:0 nt
s_waitcnt vmcnt(3)
s_add_u32 s56, s51, 196608
buffer_load_dwordx4 v[116:119], v1, s[4:7], s56 offen offset:1024 nt
s_waitcnt vmcnt(3)
s_add_u32 s56, s51, 196608
buffer_load_dwordx4 v[120:123], v1, s[4:7], s56 offen offset:2048 nt
s_waitcnt vmcnt(3)
s_add_u32 s56, s51, 196608
buffer_load_dwordx4 v[124:127], v1, s[4:7], s56 offen offset:3072 nt
s_waitcnt vmcnt(3)
s_add_u32 s56, s51, 229376
buffer_load_dwordx4 v[128:131], v1, s[4:7], s56 offen offset:0 nt
s_waitcnt vmcnt(3)
s_add_u32 s56, s51, 229376
buffer_load_dwordx4 v[132:135], v1, s[4:7], s56 offen offset:1024 nt
s_waitcnt vmcnt(3)
s_add_u32 s56, s51, 229376
buffer_load_dwordx4 v[136:139], v1, s[4:7], s56 offen offset:2048 nt
s_waitcnt vmcnt(3)
s_add_u32 s56, s51, 229376
buffer_load_dwordx4 v[140:143], v1, s[4:7], s56 offen offset:3072 nt
s_waitcnt vmcnt(3)
s_add_u32 s56, s51, 262144
buffer_load_dwordx4 v[144:147], v1, s[4:7], s56 offen offset:0 nt
s_waitcnt vmcnt(3)
s_add_u32 s56, s51, 262144
buffer_load_dwordx4 v[148:151], v1, s[4:7], s56 offen offset:1024 nt
s_waitcnt vmcnt(3)
s_add_u32 s56, s51, 262144
buffer_load_dwordx4 v[152:155], v1, s[4:7], s56 offen offset:2048 nt
s_waitcnt vmcnt(3)
s_add_u32 s56, s51, 262144
buffer_load_dwordx4 v[156:159], v1, s[4:7], s56 offen offset:3072 nt
s_waitcnt vmcnt(3)
s_add_u32 s56, s51, 294912
buffer_load_dwordx4 v[160:163], v1, s[4:7], s56 offen offset:0 nt
s_waitcnt vmcnt(3)
s_add_u32 s56, s51, 294912
buffer_load_dwordx4 v[164:167], v1, s[4:7], s56 offen offset:1024 nt
s_waitcnt vmcnt(3)
s_add_u32 s56, s51, 294912
buffer_load_dwordx4 v[168:171], v1, s[4:7], s56 offen offset:2048 nt
s_waitcnt vmcnt(3)
s_add_u32 s56, s51, 294912
buffer_load_dwordx4 v[172:175], v1, s[4:7], s56 offen offset:3072 nt
s_waitcnt vmcnt(3)
buffer_load_dwordx4 v[176:179], v1, s[8:11], s51 offen offset:0 nt
s_waitcnt vmcnt(3)
buffer_load_dwordx4 v[180:183], v1, s[8:11], s51 offen offset:1024 nt
s_waitcnt vmcnt(3)
buffer_load_dwordx4 v[184:187], v1, s[8:11], s51 offen offset:2048 nt
s_waitcnt vmcnt(3)
buffer_load_dwordx4 v[188:191], v1, s[8:11], s51 offen offset:3072 nt
s_waitcnt vmcnt(3)
s_add_u32 s56, s51, 32768
buffer_load_dwordx4 v[192:195], v1, s[8:11], s56 offen offset:0 nt
s_waitcnt vmcnt(3)
s_add_u32 s56, s51, 32768
buffer_load_dwordx4 v[196:199], v1, s[8:11], s56 offen offset:1024 nt
v_and_b32 v32, 31, v3
v_lshlrev_b32 v32, 5, v32
s_lshl_b32 s56, s49, 10
s_add_u32 s56, s56, 0x400000
v_mov_b32 v33, 0
buffer_load_dwordx4 v[36:39], v33, s[40:43], 0 offen sc1
buffer_load_dwordx4 v[56:59], v32, s[44:47], s56 offen offset:0 sc1
buffer_load_dwordx4 v[60:63], v32, s[44:47], s56 offen offset:16 sc1
s_waitcnt vmcnt(3)
s_add_u32 s56, s51, 32768
buffer_load_dwordx4 v[200:203], v1, s[8:11], s56 offen offset:2048 nt
s_waitcnt vmcnt(3)
s_add_u32 s56, s51, 32768
buffer_load_dwordx4 v[204:207], v1, s[8:11], s56 offen offset:3072 nt
s_waitcnt vmcnt(3)
s_add_u32 s56, s51, 65536
buffer_load_dwordx4 v[208:211], v1, s[8:11], s56 offen offset:0 nt
s_waitcnt vmcnt(3)
s_add_u32 s56, s51, 65536
buffer_load_dwordx4 v[212:215], v1, s[8:11], s56 offen offset:1024 nt
s_waitcnt vmcnt(3)
s_add_u32 s56, s51, 65536
buffer_load_dwordx4 v[216:219], v1, s[8:11], s56 offen offset:2048 nt
s_waitcnt vmcnt(3)
s_add_u32 s56, s51, 65536
buffer_load_dwordx4 v[220:223], v1, s[8:11], s56 offen offset:3072 nt
v_mov_b32 v52, v36
v_and_b32 v28, v37, v39
v_xor_b32 v28, 1, v28
v_xor_b32 v29, v52, v56
v_or_b32 v28, v29, v28
v_xor_b32 v29, v52, v58
v_or_b32 v28, v29, v28
v_xor_b32 v29, v52, v60
v_or_b32 v28, v29, v28
v_xor_b32 v29, v52, v62
v_or_b32 v28, v29, v28
v_cmp_ne_u32 vcc, 0, v28
s_cbranch_vccz L_qburst_181
s_waitcnt vmcnt(3)
s_add_u32 s56, s51, 98304
buffer_load_dwordx4 v[224:227], v1, s[8:11], s56 offen offset:0 nt
s_waitcnt vmcnt(3)
s_add_u32 s56, s51, 98304
buffer_load_dwordx4 v[228:231], v1, s[8:11], s56 offen offset:1024 nt
s_waitcnt vmcnt(3)
s_add_u32 s56, s51, 98304
buffer_load_dwordx4 v[232:235], v1, s[8:11], s56 offen offset:2048 nt
s_waitcnt vmcnt(3)
s_add_u32 s56, s51, 98304
buffer_load_dwordx4 v[236:239], v1, s[8:11], s56 offen offset:3072 nt
s_waitcnt vmcnt(3)
s_add_u32 s56, s51, 131072
buffer_load_dwordx4 v[240:243], v1, s[8:11], s56 offen offset:0 nt
s_waitcnt vmcnt(3)
s_add_u32 s56, s51, 131072
buffer_load_dwordx4 v[244:247], v1, s[8:11], s56 offen offset:1024 nt
s_waitcnt vmcnt(3)
s_add_u32 s56, s51, 131072
buffer_load_dwordx4 v[248:251], v1, s[8:11], s56 offen offset:2048 nt
s_waitcnt vmcnt(3)
s_add_u32 s56, s51, 131072
buffer_load_dwordx4 v[252:255], v1, s[8:11], s56 offen offset:3072 nt
s_mov_b32 s60, 0
L_p_q_183:
s_nop 4
v_and_b32 v32, 31, v3
v_lshlrev_b32 v32, 5, v32
s_lshl_b32 s56, s49, 10
s_add_u32 s56, s56, 0x400000
v_mov_b32 v33, 0
buffer_load_dwordx4 v[36:39], v33, s[40:43], 0 offen sc1
buffer_load_dwordx4 v[56:59], v32, s[44:47], s56 offen offset:0 sc1
buffer_load_dwordx4 v[60:63], v32, s[44:47], s56 offen offset:16 sc1
s_waitcnt vmcnt(0)
v_mov_b32 v52, v36
v_and_b32 v28, v37, v39
v_xor_b32 v28, 1, v28
v_xor_b32 v29, v52, v56
v_or_b32 v28, v29, v28
v_xor_b32 v29, v52, v58
v_or_b32 v28, v29, v28
v_xor_b32 v29, v52, v60
v_or_b32 v28, v29, v28
v_xor_b32 v29, v52, v62
v_or_b32 v28, v29, v28
v_cmp_ne_u32 vcc, 0, v28
s_cbranch_vccz L_d_q_184
s_sleep 1
s_add_u32 s60, s60, 1
s_cmp_lt_u32 s60, 400000
s_cbranch_scc1 L_p_q_183
s_endpgm
L_d_q_184:
s_nop 4
s_branch L_qjoin_182
L_qburst_181:
s_nop 4
s_add_u32 s56, s51, 98304
buffer_load_dwordx4 v[224:227], v1, s[8:11], s56 offen offset:0 nt
s_add_u32 s56, s51, 98304
buffer_load_dwordx4 v[228:231], v1, s[8:11], s56 offen offset:1024 nt
s_add_u32 s56, s51, 98304
buffer_load_dwordx4 v[232:235], v1, s[8:11], s56 offen offset:2048 nt
s_add_u32 s56, s51, 98304
buffer_load_dwordx4 v[236:239], v1, s[8:11], s56 offen offset:3072 nt
s_add_u32 s56, s51, 131072
buffer_load_dwordx4 v[240:243], v1, s[8:11], s56 offen offset:0 nt
s_add_u32 s56, s51, 131072
buffer_load_dwordx4 v[244:247], v1, s[8:11], s56 offen offset:1024 nt
s_add_u32 s56, s51, 131072
buffer_load_dwordx4 v[248:251], v1, s[8:11], s56 offen offset:2048 nt
s_add_u32 s56, s51, 131072
buffer_load_dwordx4 v[252:255], v1, s[8:11], s56 offen offset:3072 nt
L_qjoin_182:
s_nop 4
v_mov_b32 v4, v57
v_mov_b32 v5, v59
v_mov_b32 v6, v61
v_mov_b32 v7, v63
ds_read_b128 v[36:39], v2 offset:0
ds_read_b128 v[40:43], v2 offset:1024
ds_read_b128 v[44:47], v2 offset:2048
ds_read_b128 v[48:51], v2 offset:3072
s_waitcnt lgkmcnt(0)
v_dot2_f32_bf16 v28, v36, v4, 0
v_dot2_f32_bf16 v29, v40, v4, 0
v_dot2_f32_bf16 v30, v44, v4, 0
v_dot2_f32_bf16 v31, v48, v4, 0
v_dot2_f32_bf16 v28, v37, v5, v28
v_dot2_f32_bf16 v29, v41, v5, v29
v_dot2_f32_bf16 v30, v45, v5, v30
v_dot2_f32_bf16 v31, v49, v5, v31
v_dot2_f32_bf16 v28, v38, v6, v28
v_dot2_f32_bf16 v29, v42, v6, v29
v_dot2_f32_bf16 v30, v46, v6, v30
v_dot2_f32_bf16 v31, v50, v6, v31
v_dot2_f32_bf16 v28, v39, v7, v28
v_dot2_f32_bf16 v29, v43, v7, v29
v_dot2_f32_bf16 v30, v47, v7, v30
v_dot2_f32_bf16 v31, v51, v7, v31
s_nop 0
v_permlane16_swap_b32 v28, v29
s_nop 0
v_permlane16_swap_b32 v30, v31
v_add_f32 v28, v28, v29
v_add_f32 v30, v30, v31
s_nop 0
v_add_f32_dpp v16, v28, v28 row_ror:8 row_mask:0xf bank_mask:0x3
v_add_f32_dpp v16, v30, v30 row_ror:8 row_mask:0xf bank_mask:0xc
s_waitcnt vmcnt(3)
ds_read_b128 v[36:39], v2 offset:4096
ds_read_b128 v[40:43], v2 offset:5120
ds_read_b128 v[44:47], v2 offset:6144
ds_read_b128 v[48:51], v2 offset:7168
s_waitcnt lgkmcnt(0)
v_dot2_f32_bf16 v28, v36, v4, 0
v_dot2_f32_bf16 v29, v40, v4, 0
v_dot2_f32_bf16 v30, v44, v4, 0
v_dot2_f32_bf16 v31, v48, v4, 0
v_dot2_f32_bf16 v28, v37, v5, v28
v_dot2_f32_bf16 v29, v41, v5, v29
v_dot2_f32_bf16 v30, v45, v5, v30
v_dot2_f32_bf16 v31, v49, v5, v31
v_dot2_f32_bf16 v28, v38, v6, v28
v_dot2_f32_bf16 v29, v42, v6, v29
v_dot2_f32_bf16 v30, v46, v6, v30
v_dot2_f32_bf16 v31, v50, v6, v31
v_dot2_f32_bf16 v28, v39, v7, v28
v_dot2_f32_bf16 v29, v43, v7, v29
v_dot2_f32_bf16 v30, v47, v7, v30
v_dot2_f32_bf16 v31, v51, v7, v31
s_nop 0
v_permlane16_swap_b32 v28, v29
s_nop 0
v_permlane16_swap_b32 v30, v31
v_add_f32 v28, v28, v29
v_add_f32 v30, v30, v31
s_nop 0
v_add_f32_dpp v17, v28, v28 row_ror:8 row_mask:0xf bank_mask:0x3
v_add_f32_dpp v17, v30, v30 row_ror:8 row_mask:0xf bank_mask:0xc
ds_read_b128 v[36:39], v2 offset:8192
ds_read_b128 v[40:43], v2 offset:9216
ds_read_b128 v[44:47], v2 offset:10240
ds_read_b128 v[48:51], v2 offset:11264
s_waitcnt lgkmcnt(0)
v_dot2_f32_bf16 v28, v36, v4, 0
v_dot2_f32_bf16 v29, v40, v4, 0
v_dot2_f32_bf16 v30, v44, v4, 0
v_dot2_f32_bf16 v31, v48, v4, 0
v_dot2_f32_bf16 v28, v37, v5, v28
v_dot2_f32_bf16 v29, v41, v5, v29
v_dot2_f32_bf16 v30, v45, v5, v30
v_dot2_f32_bf16 v31, v49, v5, v31
v_dot2_f32_bf16 v28, v38, v6, v28
v_dot2_f32_bf16 v29, v42, v6, v29
v_dot2_f32_bf16 v30, v46, v6, v30
v_dot2_f32_bf16 v31, v50, v6, v31
v_dot2_f32_bf16 v28, v39, v7, v28
v_dot2_f32_bf16 v29, v43, v7, v29
v_dot2_f32_bf16 v30, v47, v7, v30
v_dot2_f32_bf16 v31, v51, v7, v31
s_nop 0
v_permlane16_swap_b32 v28, v29
s_nop 0
v_permlane16_swap_b32 v30, v31
v_add_f32 v28, v28, v29
v_add_f32 v30, v30, v31
s_nop 0
v_add_f32_dpp v18, v28, v28 row_ror:8 row_mask:0xf bank_mask:0x3
v_add_f32_dpp v18, v30, v30 row_ror:8 row_mask:0xf bank_mask:0xc
ds_read_b128 v[36:39], v2 offset:12288
ds_read_b128 v[40:43], v2 offset:13312
ds_read_b128 v[44:47], v2 offset:14336
ds_read_b128 v[48:51], v2 offset:15360
s_waitcnt lgkmcnt(0)
v_dot2_f32_bf16 v28, v36, v4, 0
v_dot2_f32_bf16 v29, v40, v4, 0
v_dot2_f32_bf16 v30, v44, v4, 0
v_dot2_f32_bf16 v31, v48, v4, 0
v_dot2_f32_bf16 v28, v37, v5, v28
v_dot2_f32_bf16 v29, v41, v5, v29
v_dot2_f32_bf16 v30, v45, v5, v30
v_dot2_f32_bf16 v31, v49, v5, v31
v_dot2_f32_bf16 v28, v38, v6, v28
v_dot2_f32_bf16 v29, v42, v6, v29
v_dot2_f32_bf16 v30, v46, v6, v30
v_dot2_f32_bf16 v31, v50, v6, v31
v_dot2_f32_bf16 v28, v39, v7, v28
v_dot2_f32_bf16 v29, v43, v7, v29
v_dot2_f32_bf16 v30, v47, v7, v30
v_dot2_f32_bf16 v31, v51, v7, v31
s_nop 0
v_permlane16_swap_b32 v28, v29
s_nop 0
v_permlane16_swap_b32 v30, v31
v_add_f32 v28, v28, v29
v_add_f32 v30, v30, v31
s_nop 0
v_add_f32_dpp v19, v28, v28 row_ror:8 row_mask:0xf bank_mask:0x3
v_add_f32_dpp v19, v30, v30 row_ror:8 row_mask:0xf bank_mask:0xc
ds_read_b128 v[36:39], v2 offset:16384
s_waitcnt lgkmcnt(0)
v_dot2_f32_bf16 v28, v36, v4, 0
v_dot2_f32_bf16 v29, v84, v4, 0
v_dot2_f32_bf16 v30, v88, v4, 0
v_dot2_f32_bf16 v31, v92, v4, 0
v_dot2_f32_bf16 v28, v37, v5, v28
v_dot2_f32_bf16 v29, v85, v5, v29
v_dot2_f32_bf16 v30, v89, v5, v30
v_dot2_f32_bf16 v31, v93, v5, v31
v_dot2_f32_bf16 v28, v38, v6, v28
v_dot2_f32_bf16 v29, v86, v6, v29
v_dot2_f32_bf16 v30, v90, v6, v30
v_dot2_f32_bf16 v31, v94, v6, v31
v_dot2_f32_bf16 v28, v39, v7, v28
v_dot2_f32_bf16 v29, v87, v7, v29
v_dot2_f32_bf16 v30, v91, v7, v30
v_dot2_f32_bf16 v31, v95, v7, v31
s_nop 0
v_permlane16_swap_b32 v28, v29
s_nop 0
v_permlane16_swap_b32 v30, v31
v_add_f32 v28, v28, v29
v_add_f32 v30, v30, v31
s_nop 0
v_add_f32_dpp v20, v28, v28 row_ror:8 row_mask:0xf bank_mask:0x3
v_add_f32_dpp v20, v30, v30 row_ror:8 row_mask:0xf bank_mask:0xc
v_dot2_f32_bf16 v28, v96, v4, 0
v_dot2_f32_bf16 v29, v100, v4, 0
v_dot2_f32_bf16 v30, v104, v4, 0
v_dot2_f32_bf16 v31, v108, v4, 0
v_dot2_f32_bf16 v28, v97, v5, v28
v_dot2_f32_bf16 v29, v101, v5, v29
v_dot2_f32_bf16 v30, v105, v5, v30
v_dot2_f32_bf16 v31, v109, v5, v31
v_dot2_f32_bf16 v28, v98, v6, v28
v_dot2_f32_bf16 v29, v102, v6, v29
v_dot2_f32_bf16 v30, v106, v6, v30
v_dot2_f32_bf16 v31, v110, v6, v31
v_dot2_f32_bf16 v28, v99, v7, v28
v_dot2_f32_bf16 v29, v103, v7, v29
v_dot2_f32_bf16 v30, v107, v7, v30
v_dot2_f32_bf16 v31, v111, v7, v31
s_nop 0
v_permlane16_swap_b32 v28, v29
s_nop 0
v_permlane16_swap_b32 v30, v31
v_add_f32 v28, v28, v29
v_add_f32 v30, v30, v31
s_nop 0
v_add_f32_dpp v21, v28, v28 row_ror:8 row_mask:0xf bank_mask:0x3
v_add_f32_dpp v21, v30, v30 row_ror:8 row_mask:0xf bank_mask:0xc
v_dot2_f32_bf16 v28, v112, v4, 0
v_dot2_f32_bf16 v29, v116, v4, 0
v_dot2_f32_bf16 v30, v120, v4, 0
v_dot2_f32_bf16 v31, v124, v4, 0
v_dot2_f32_bf16 v28, v113, v5, v28
v_dot2_f32_bf16 v29, v117, v5, v29
v_dot2_f32_bf16 v30, v121, v5, v30
v_dot2_f32_bf16 v31, v125, v5, v31
v_dot2_f32_bf16 v28, v114, v6, v28
v_dot2_f32_bf16 v29, v118, v6, v29
v_dot2_f32_bf16 v30, v122, v6, v30
v_dot2_f32_bf16 v31, v126, v6, v31
v_dot2_f32_bf16 v28, v115, v7, v28
v_dot2_f32_bf16 v29, v119, v7, v29
v_dot2_f32_bf16 v30, v123, v7, v30
v_dot2_f32_bf16 v31, v127, v7, v31
s_nop 0
v_permlane16_swap_b32 v28, v29
s_nop 0
v_permlane16_swap_b32 v30, v31
v_add_f32 v28, v28, v29
v_add_f32 v30, v30, v31
s_nop 0
v_add_f32_dpp v22, v28, v28 row_ror:8 row_mask:0xf bank_mask:0x3
v_add_f32_dpp v22, v30, v30 row_ror:8 row_mask:0xf bank_mask:0xc
v_dot2_f32_bf16 v28, v128, v4, 0
v_dot2_f32_bf16 v29, v132, v4, 0
v_dot2_f32_bf16 v30, v136, v4, 0
v_dot2_f32_bf16 v31, v140, v4, 0
v_dot2_f32_bf16 v28, v129, v5, v28
v_dot2_f32_bf16 v29, v133, v5, v29
v_dot2_f32_bf16 v30, v137, v5, v30
v_dot2_f32_bf16 v31, v141, v5, v31
v_dot2_f32_bf16 v28, v130, v6, v28
v_dot2_f32_bf16 v29, v134, v6, v29
v_dot2_f32_bf16 v30, v138, v6, v30
v_dot2_f32_bf16 v31, v142, v6, v31
v_dot2_f32_bf16 v28, v131, v7, v28
v_dot2_f32_bf16 v29, v135, v7, v29
v_dot2_f32_bf16 v30, v139, v7, v30
v_dot2_f32_bf16 v31, v143, v7, v31
s_nop 0
v_permlane16_swap_b32 v28, v29
s_nop 0
v_permlane16_swap_b32 v30, v31
v_add_f32 v28, v28, v29
v_add_f32 v30, v30, v31
s_nop 0
v_add_f32_dpp v23, v28, v28 row_ror:8 row_mask:0xf bank_mask:0x3
v_add_f32_dpp v23, v30, v30 row_ror:8 row_mask:0xf bank_mask:0xc
v_dot2_f32_bf16 v28, v144, v4, 0
v_dot2_f32_bf16 v29, v148, v4, 0
v_dot2_f32_bf16 v30, v152, v4, 0
v_dot2_f32_bf16 v31, v156, v4, 0
v_dot2_f32_bf16 v28, v145, v5, v28
v_dot2_f32_bf16 v29, v149, v5, v29
v_dot2_f32_bf16 v30, v153, v5, v30
v_dot2_f32_bf16 v31, v157, v5, v31
v_dot2_f32_bf16 v28, v146, v6, v28
v_dot2_f32_bf16 v29, v150, v6, v29
v_dot2_f32_bf16 v30, v154, v6, v30
v_dot2_f32_bf16 v31, v158, v6, v31
v_dot2_f32_bf16 v28, v147, v7, v28
v_dot2_f32_bf16 v29, v151, v7, v29
v_dot2_f32_bf16 v30, v155, v7, v30
v_dot2_f32_bf16 v31, v159, v7, v31
s_nop 0
v_permlane16_swap_b32 v28, v29
s_nop 0
v_permlane16_swap_b32 v30, v31
v_add_f32 v28, v28, v29
v_add_f32 v30, v30, v31
s_nop 0
v_add_f32_dpp v24, v28, v28 row_ror:8 row_mask:0xf bank_mask:0x3
v_add_f32_dpp v24, v30, v30 row_ror:8 row_mask:0xf bank_mask:0xc
v_dot2_f32_bf16 v28, v160, v4, 0
v_dot2_f32_bf16 v29, v164, v4, 0
v_dot2_f32_bf16 v30, v168, v4, 0
v_dot2_f32_bf16 v31, v172, v4, 0
v_dot2_f32_bf16 v28, v161, v5, v28
v_dot2_f32_bf16 v29, v165, v5, v29
v_dot2_f32_bf16 v30, v169, v5, v30
v_dot2_f32_bf16 v31, v173, v5, v31
v_dot2_f32_bf16 v28, v162, v6, v28
v_dot2_f32_bf16 v29, v166, v6, v29
v_dot2_f32_bf16 v30, v170, v6, v30
v_dot2_f32_bf16 v31, v174, v6, v31
v_dot2_f32_bf16 v28, v163, v7, v28
v_dot2_f32_bf16 v29, v167, v7, v29
v_dot2_f32_bf16 v30, v171, v7, v30
v_dot2_f32_bf16 v31, v175, v7, v31
s_nop 0
v_permlane16_swap_b32 v28, v29
s_nop 0
v_permlane16_swap_b32 v30, v31
v_add_f32 v28, v28, v29
v_add_f32 v30, v30, v31
s_nop 0
v_add_f32_dpp v25, v28, v28 row_ror:8 row_mask:0xf bank_mask:0x3
v_add_f32_dpp v25, v30, v30 row_ror:8 row_mask:0xf bank_mask:0xc
v_add_f32_dpp v16, v16, v16 quad_perm:[1,0,3,2]
v_add_f32_dpp v17, v17, v17 quad_perm:[1,0,3,2]
v_add_f32_dpp v18, v18, v18 quad_perm:[1,0,3,2]
v_add_f32_dpp v19, v19, v19 quad_perm:[1,0,3,2]
v_add_f32_dpp v20, v20, v20 quad_perm:[1,0,3,2]
v_add_f32_dpp v21, v21, v21 quad_perm:[1,0,3,2]
v_add_f32_dpp v22, v22, v22 quad_perm:[1,0,3,2]
v_add_f32_dpp v23, v23, v23 quad_perm:[1,0,3,2]
v_add_f32_dpp v24, v24, v24 quad_perm:[1,0,3,2]
v_add_f32_dpp v25, v25, v25 quad_perm:[1,0,3,2]
v_add_f32_dpp v16, v16, v16 quad_perm:[2,3,0,1]
v_add_f32_dpp v17, v17, v17 quad_perm:[2,3,0,1]
v_add_f32_dpp v18, v18, v18 quad_perm:[2,3,0,1]
v_add_f32_dpp v19, v19, v19 quad_perm:[2,3,0,1]
v_add_f32_dpp v20, v20, v20 quad_perm:[2,3,0,1]
v_add_f32_dpp v21, v21, v21 quad_perm:[2,3,0,1]
v_add_f32_dpp v22, v22, v22 quad_perm:[2,3,0,1]
v_add_f32_dpp v23, v23, v23 quad_perm:[2,3,0,1]
v_add_f32_dpp v24, v24, v24 quad_perm:[2,3,0,1]
v_add_f32_dpp v25, v25, v25 quad_perm:[2,3,0,1]
v_add_f32_dpp v16, v16, v16 row_half_mirror
v_add_f32_dpp v17, v17, v17 row_half_mirror
v_add_f32_dpp v18, v18, v18 row_half_mirror
v_add_f32_dpp v19, v19, v19 row_half_mirror
v_add_f32_dpp v20, v20, v20 row_half_mirror
v_add_f32_dpp v21, v21, v21 row_half_mirror
v_add_f32_dpp v22, v22, v22 row_half_mirror
v_add_f32_dpp v23, v23, v23 row_half_mirror
v_add_f32_dpp v24, v24, v24 row_half_mirror
v_add_f32_dpp v25, v25, v25 row_half_mirror
v_cvt_pk_bf16_f32 v16, v16, v16
v_cvt_pk_bf16_f32 v17, v17, v17
v_cvt_pk_bf16_f32 v18, v18, v18
v_cvt_pk_bf16_f32 v19, v19, v19
v_cvt_pk_bf16_f32 v20, v20, v20
v_cvt_pk_bf16_f32 v21, v21, v21
v_cvt_pk_bf16_f32 v22, v22, v22
v_cvt_pk_bf16_f32 v23, v23, v23
v_cvt_pk_bf16_f32 v24, v24, v24
v_cvt_pk_bf16_f32 v25, v25, v25
v_and_b32 v16, s62, v16
v_and_b32 v17, s62, v17
v_and_b32 v18, s62, v18
v_and_b32 v19, s62, v19
v_and_b32 v20, s62, v20
v_and_b32 v21, s62, v21
v_and_b32 v22, s62, v22
v_and_b32 v23, s62, v23
v_and_b32 v24, s62, v24
v_and_b32 v25, s62, v25
v_mul_f32 v16, 0x3d800000, v16
v_mul_f32 v17, 0x3d800000, v17
v_mul_f32 v18, 0x3d800000, v18
v_mul_f32 v19, 0x3d800000, v19
v_mul_f32 v20, 0x3d800000, v20
v_mul_f32 v21, 0x3d800000, v21
v_mul_f32 v22, 0x3d800000, v22
v_mul_f32 v23, 0x3d800000, v23
v_mul_f32 v24, 0x3d800000, v24
v_mul_f32 v25, 0x3d800000, v25
v_max_f32 v26, v16, v17
v_max_f32 v26, v26, v18
v_max_f32 v26, v26, v19
v_max_f32 v26, v26, v20
v_max_f32 v26, v26, v21
v_max_f32 v26, v26, v22
v_max_f32 v26, v26, v23
v_max_f32 v26, v26, v24
v_max_f32 v26, v26, v25
s_nop 1
v_max_f32_dpp v26, v26, v26 row_ror:8
v_mov_b32 v28, v26
s_nop 1
v_permlane16_swap_b32 v26, v28
v_max_f32 v26, v26, v28
v_mov_b32 v28, v26
s_nop 1
v_permlane32_swap_b32 v26, v28
v_max_f32 v26, v26, v28
v_sub_f32 v16, v16, v26
v_sub_f32 v17, v17, v26
v_sub_f32 v18, v18, v26
v_sub_f32 v19, v19, v26
v_sub_f32 v20, v20, v26
v_sub_f32 v21, v21, v26
v_sub_f32 v22, v22, v26
v_sub_f32 v23, v23, v26
v_sub_f32 v24, v24, v26
v_sub_f32 v25, v25, v26
v_mul_f32 v16, 0x3fb8aa3b, v16
v_mul_f32 v17, 0x3fb8aa3b, v17
v_mul_f32 v18, 0x3fb8aa3b, v18
v_mul_f32 v19, 0x3fb8aa3b, v19
v_mul_f32 v20, 0x3fb8aa3b, v20
v_mul_f32 v21, 0x3fb8aa3b, v21
v_mul_f32 v22, 0x3fb8aa3b, v22
v_mul_f32 v23, 0x3fb8aa3b, v23
v_mul_f32 v24, 0x3fb8aa3b, v24
v_mul_f32 v25, 0x3fb8aa3b, v25
v_exp_f32 v16, v16
v_exp_f32 v17, v17
v_exp_f32 v18, v18
v_exp_f32 v19, v19
v_exp_f32 v20, v20
v_exp_f32 v21, v21
v_exp_f32 v22, v22
v_exp_f32 v23, v23
v_exp_f32 v24, v24
v_exp_f32 v25, v25
v_add_f32 v27, v16, v17
v_add_f32 v27, v27, v18
v_add_f32 v27, v27, v19
v_add_f32 v27, v27, v20
v_add_f32 v27, v27, v21
v_add_f32 v27, v27, v22
v_add_f32 v27, v27, v23
v_add_f32 v27, v27, v24
v_add_f32 v27, v27, v25
s_nop 1
v_add_f32_dpp v27, v27, v27 row_ror:8
v_mov_b32 v28, v27
s_nop 1
v_permlane16_swap_b32 v27, v28
v_add_f32 v27, v27, v28
v_mov_b32 v28, v27
s_nop 1
v_permlane32_swap_b32 v27, v28
v_add_f32 v27, v27, v28
v_mov_b32 v36, v16
v_mov_b32 v37, v17
v_mov_b32 v38, v18
v_mov_b32 v39, v19
v_mov_b32 v40, v20
v_mov_b32 v41, v21
v_mov_b32 v42, v22
v_mov_b32 v43, v23
v_mov_b32 v44, v24
v_mov_b32 v45, v25
v_permlane16_swap_b32 v16, v36
v_permlane16_swap_b32 v17, v37
v_permlane16_swap_b32 v18, v38
v_permlane16_swap_b32 v19, v39
v_permlane16_swap_b32 v20, v40
v_permlane16_swap_b32 v21, v41
v_permlane16_swap_b32 v22, v42
v_permlane16_swap_b32 v23, v43
v_permlane16_swap_b32 v24, v44
v_permlane16_swap_b32 v25, v45
v_cvt_pk_bf16_f32 v16, v16, v36
v_cvt_pk_bf16_f32 v17, v17, v37
v_cvt_pk_bf16_f32 v18, v18, v38
v_cvt_pk_bf16_f32 v19, v19, v39
v_cvt_pk_bf16_f32 v20, v20, v40
v_cvt_pk_bf16_f32 v21, v21, v41
v_cvt_pk_bf16_f32 v22, v22, v42
v_cvt_pk_bf16_f32 v23, v23, v43
v_cvt_pk_bf16_f32 v24, v24, v44
v_cvt_pk_bf16_f32 v25, v25, v45
v_mov_b32 v8, 0
v_mov_b32 v9, 0
v_mov_b32 v10, 0
v_mov_b32 v11, 0
v_mov_b32 v12, 0
v_mov_b32 v13, 0
v_mov_b32 v14, 0
v_mov_b32 v15, 0
v_perm_b32 v28, v180, v176, s80
v_perm_b32 v29, v180, v176, s81
v_perm_b32 v30, v181, v177, s80
v_perm_b32 v31, v181, v177, s81
v_perm_b32 v32, v182, v178, s80
v_perm_b32 v33, v182, v178, s81
v_perm_b32 v34, v183, v179, s80
v_perm_b32 v35, v183, v179, s81
v_dot2c_f32_bf16_dpp v8, v16, v28 row_newbcast:0
v_dot2c_f32_bf16_dpp v9, v16, v29 row_newbcast:0
v_dot2c_f32_bf16_dpp v10, v16, v30 row_newbcast:0
v_dot2c_f32_bf16_dpp v11, v16, v31 row_newbcast:0
v_dot2c_f32_bf16_dpp v12, v16, v32 row_newbcast:0
v_dot2c_f32_bf16_dpp v13, v16, v33 row_newbcast:0
v_dot2c_f32_bf16_dpp v14, v16, v34 row_newbcast:0
v_dot2c_f32_bf16_dpp v15, v16, v35 row_newbcast:0
v_perm_b32 v28, v188, v184, s80
v_perm_b32 v29, v188, v184, s81
v_perm_b32 v30, v189, v185, s80
v_perm_b32 v31, v189, v185, s81
v_perm_b32 v32, v190, v186, s80
v_perm_b32 v33, v190, v186, s81
v_perm_b32 v34, v191, v187, s80
v_perm_b32 v35, v191, v187, s81
v_dot2c_f32_bf16_dpp v8, v16, v28 row_newbcast:8
v_dot2c_f32_bf16_dpp v9, v16, v29 row_newbcast:8
v_dot2c_f32_bf16_dpp v10, v16, v30 row_newbcast:8
v_dot2c_f32_bf16_dpp v11, v16, v31 row_newbcast:8
v_dot2c_f32_bf16_dpp v12, v16, v32 row_newbcast:8
v_dot2c_f32_bf16_dpp v13, v16, v33 row_newbcast:8
v_dot2c_f32_bf16_dpp v14, v16, v34 row_newbcast:8
v_dot2c_f32_bf16_dpp v15, v16, v35 row_newbcast:8
v_perm_b32 v28, v196, v192, s80
v_perm_b32 v29, v196, v192, s81
v_perm_b32 v30, v197, v193, s80
v_perm_b32 v31, v197, v193, s81
v_perm_b32 v32, v198, v194, s80
v_perm_b32 v33, v198, v194, s81
v_perm_b32 v34, v199, v195, s80
v_perm_b32 v35, v199, v195, s81
v_dot2c_f32_bf16_dpp v8, v17, v28 row_newbcast:0
v_dot2c_f32_bf16_dpp v9, v17, v29 row_newbcast:0
v_dot2c_f32_bf16_dpp v10, v17, v30 row_newbcast:0
v_dot2c_f32_bf16_dpp v11, v17, v31 row_newbcast:0
v_dot2c_f32_bf16_dpp v12, v17, v32 row_newbcast:0
v_dot2c_f32_bf16_dpp v13, v17, v33 row_newbcast:0
v_dot2c_f32_bf16_dpp v14, v17, v34 row_newbcast:0
v_dot2c_f32_bf16_dpp v15, v17, v35 row_newbcast:0
v_perm_b32 v28, v204, v200, s80
v_perm_b32 v29, v204, v200, s81
v_perm_b32 v30, v205, v201, s80
v_perm_b32 v31, v205, v201, s81
v_perm_b32 v32, v206, v202, s80
v_perm_b32 v33, v206, v202, s81
v_perm_b32 v34, v207, v203, s80
v_perm_b32 v35, v207, v203, s81
v_dot2c_f32_bf16_dpp v8, v17, v28 row_newbcast:8
v_dot2c_f32_bf16_dpp v9, v17, v29 row_newbcast:8
v_dot2c_f32_bf16_dpp v10, v17, v30 row_newbcast:8
v_dot2c_f32_bf16_dpp v11, v17, v31 row_newbcast:8
v_dot2c_f32_bf16_dpp v12, v17, v32 row_newbcast:8
v_dot2c_f32_bf16_dpp v13, v17, v33 row_newbcast:8
v_dot2c_f32_bf16_dpp v14, v17, v34 row_newbcast:8
v_dot2c_f32_bf16_dpp v15, v17, v35 row_newbcast:8
v_perm_b32 v28, v212, v208, s80
v_perm_b32 v29, v212, v208, s81
v_perm_b32 v30, v213, v209, s80
v_perm_b32 v31, v213, v209, s81
v_perm_b32 v32, v214, v210, s80
v_perm_b32 v33, v214, v210, s81
v_perm_b32 v34, v215, v211, s80
v_perm_b32 v35, v215, v211, s81
v_dot2c_f32_bf16_dpp v8, v18, v28 row_newbcast:0
v_dot2c_f32_bf16_dpp v9, v18, v29 row_newbcast:0
v_dot2c_f32_bf16_dpp v10, v18, v30 row_newbcast:0
v_dot2c_f32_bf16_dpp v11, v18, v31 row_newbcast:0
v_dot2c_f32_bf16_dpp v12, v18, v32 row_newbcast:0
v_dot2c_f32_bf16_dpp v13, v18, v33 row_newbcast:0
v_dot2c_f32_bf16_dpp v14, v18, v34 row_newbcast:0
v_dot2c_f32_bf16_dpp v15, v18, v35 row_newbcast:0
v_perm_b32 v28, v220, v216, s80
v_perm_b32 v29, v220, v216, s81
v_perm_b32 v30, v221, v217, s80
v_perm_b32 v31, v221, v217, s81
v_perm_b32 v32, v222, v218, s80
v_perm_b32 v33, v222, v218, s81
v_perm_b32 v34, v223, v219, s80
v_perm_b32 v35, v223, v219, s81
v_dot2c_f32_bf16_dpp v8, v18, v28 row_newbcast:8
v_dot2c_f32_bf16_dpp v9, v18, v29 row_newbcast:8
v_dot2c_f32_bf16_dpp v10, v18, v30 row_newbcast:8
v_dot2c_f32_bf16_dpp v11, v18, v31 row_newbcast:8
v_dot2c_f32_bf16_dpp v12, v18, v32 row_newbcast:8
v_dot2c_f32_bf16_dpp v13, v18, v33 row_newbcast:8
v_dot2c_f32_bf16_dpp v14, v18, v34 row_newbcast:8
v_dot2c_f32_bf16_dpp v15, v18, v35 row_newbcast:8
v_perm_b32 v28, v228, v224, s80
v_perm_b32 v29, v228, v224, s81
v_perm_b32 v30, v229, v225, s80
v_perm_b32 v31, v229, v225, s81
v_perm_b32 v32, v230, v226, s80
v_perm_b32 v33, v230, v226, s81
v_perm_b32 v34, v231, v227, s80
v_perm_b32 v35, v231, v227, s81
v_dot2c_f32_bf16_dpp v8, v19, v28 row_newbcast:0
v_dot2c_f32_bf16_dpp v9, v19, v29 row_newbcast:0
v_dot2c_f32_bf16_dpp v10, v19, v30 row_newbcast:0
v_dot2c_f32_bf16_dpp v11, v19, v31 row_newbcast:0
v_dot2c_f32_bf16_dpp v12, v19, v32 row_newbcast:0
v_dot2c_f32_bf16_dpp v13, v19, v33 row_newbcast:0
v_dot2c_f32_bf16_dpp v14, v19, v34 row_newbcast:0
v_dot2c_f32_bf16_dpp v15, v19, v35 row_newbcast:0
v_perm_b32 v28, v236, v232, s80
v_perm_b32 v29, v236, v232, s81
v_perm_b32 v30, v237, v233, s80
v_perm_b32 v31, v237, v233, s81
v_perm_b32 v32, v238, v234, s80
v_perm_b32 v33, v238, v234, s81
v_perm_b32 v34, v239, v235, s80
v_perm_b32 v35, v239, v235, s81
v_dot2c_f32_bf16_dpp v8, v19, v28 row_newbcast:8
v_dot2c_f32_bf16_dpp v9, v19, v29 row_newbcast:8
v_dot2c_f32_bf16_dpp v10, v19, v30 row_newbcast:8
v_dot2c_f32_bf16_dpp v11, v19, v31 row_newbcast:8
v_dot2c_f32_bf16_dpp v12, v19, v32 row_newbcast:8
v_dot2c_f32_bf16_dpp v13, v19, v33 row_newbcast:8
v_dot2c_f32_bf16_dpp v14, v19, v34 row_newbcast:8
v_dot2c_f32_bf16_dpp v15, v19, v35 row_newbcast:8
s_add_u32 s56, s51, 163840
buffer_load_dwordx4 v[232:235], v1, s[8:11], s56 offen offset:0 nt
s_waitcnt vmcnt(3)
s_add_u32 s56, s51, 163840
buffer_load_dwordx4 v[236:239], v1, s[8:11], s56 offen offset:1024 nt
s_waitcnt vmcnt(3)
v_perm_b32 v28, v244, v240, s80
v_perm_b32 v29, v244, v240, s81
v_perm_b32 v30, v245, v241, s80
v_perm_b32 v31, v245, v241, s81
v_perm_b32 v32, v246, v242, s80
v_perm_b32 v33, v246, v242, s81
v_perm_b32 v34, v247, v243, s80
v_perm_b32 v35, v247, v243, s81
v_dot2c_f32_bf16_dpp v8, v20, v28 row_newbcast:0
v_dot2c_f32_bf16_dpp v9, v20, v29 row_newbcast:0
v_dot2c_f32_bf16_dpp v10, v20, v30 row_newbcast:0
v_dot2c_f32_bf16_dpp v11, v20, v31 row_newbcast:0
v_dot2c_f32_bf16_dpp v12, v20, v32 row_newbcast:0
v_dot2c_f32_bf16_dpp v13, v20, v33 row_newbcast:0
v_dot2c_f32_bf16_dpp v14, v20, v34 row_newbcast:0
v_dot2c_f32_bf16_dpp v15, v20, v35 row_newbcast:0
s_add_u32 s56, s51, 163840
buffer_load_dwordx4 v[240:243], v1, s[8:11], s56 offen offset:2048 nt
s_waitcnt vmcnt(3)
s_add_u32 s56, s51, 163840
buffer_load_dwordx4 v[244:247], v1, s[8:11], s56 offen offset:3072 nt
s_waitcnt vmcnt(3)
v_perm_b32 v28, v252, v248, s80
v_perm_b32 v29, v252, v248, s81
v_perm_b32 v30, v253, v249, s80
v_perm_b32 v31, v253, v249, s81
v_perm_b32 v32, v254, v250, s80
v_perm_b32 v33, v254, v250, s81
v_perm_b32 v34, v255, v251, s80
v_perm_b32 v35, v255, v251, s81
v_dot2c_f32_bf16_dpp v8, v20, v28 row_newbcast:8
v_dot2c_f32_bf16_dpp v9, v20, v29 row_newbcast:8
v_dot2c_f32_bf16_dpp v10, v20, v30 row_newbcast:8
v_dot2c_f32_bf16_dpp v11, v20, v31 row_newbcast:8
v_dot2c_f32_bf16_dpp v12, v20, v32 row_newbcast:8
v_dot2c_f32_bf16_dpp v13, v20, v33 row_newbcast:8
v_dot2c_f32_bf16_dpp v14, v20, v34 row_newbcast:8
v_dot2c_f32_bf16_dpp v15, v20, v35 row_newbcast:8
s_add_u32 s56, s51, 196608
buffer_load_dwordx4 v[248:251], v1, s[8:11], s56 offen offset:0 nt
s_waitcnt vmcnt(3)
s_add_u32 s56, s51, 196608
buffer_load_dwordx4 v[252:255], v1, s[8:11], s56 offen offset:1024 nt
s_waitcnt vmcnt(3)
v_perm_b32 v28, v236, v232, s80
v_perm_b32 v29, v236, v232, s81
v_perm_b32 v30, v237, v233, s80
v_perm_b32 v31, v237, v233, s81
v_perm_b32 v32, v238, v234, s80
v_perm_b32 v33, v238, v234, s81
v_perm_b32 v34, v239, v235, s80
v_perm_b32 v35, v239, v235, s81
v_dot2c_f32_bf16_dpp v8, v21, v28 row_newbcast:0
v_dot2c_f32_bf16_dpp v9, v21, v29 row_newbcast:0
v_dot2c_f32_bf16_dpp v10, v21, v30 row_newbcast:0
v_dot2c_f32_bf16_dpp v11, v21, v31 row_newbcast:0
v_dot2c_f32_bf16_dpp v12, v21, v32 row_newbcast:0
v_dot2c_f32_bf16_dpp v13, v21, v33 row_newbcast:0
v_dot2c_f32_bf16_dpp v14, v21, v34 row_newbcast:0
v_dot2c_f32_bf16_dpp v15, v21, v35 row_newbcast:0
s_add_u32 s56, s51, 196608
buffer_load_dwordx4 v[232:235], v1, s[8:11], s56 offen offset:2048 nt
s_waitcnt vmcnt(3)
s_add_u32 s56, s51, 196608
buffer_load_dwordx4 v[236:239], v1, s[8:11], s56 offen offset:3072 nt
s_waitcnt vmcnt(3)
v_perm_b32 v28, v244, v240, s80
v_perm_b32 v29, v244, v240, s81
v_perm_b32 v30, v245, v241, s80
v_perm_b32 v31, v245, v241, s81
v_perm_b32 v32, v246, v242, s80
v_perm_b32 v33, v246, v242, s81
v_perm_b32 v34, v247, v243, s80
v_perm_b32 v35, v247, v243, s81
v_dot2c_f32_bf16_dpp v8, v21, v28 row_newbcast:8
v_dot2c_f32_bf16_dpp v9, v21, v29 row_newbcast:8
v_dot2c_f32_bf16_dpp v10, v21, v30 row_newbcast:8
v_dot2c_f32_bf16_dpp v11, v21, v31 row_newbcast:8
v_dot2c_f32_bf16_dpp v12, v21, v32 row_newbcast:8
v_dot2c_f32_bf16_dpp v13, v21, v33 row_newbcast:8
v_dot2c_f32_bf16_dpp v14, v21, v34 row_newbcast:8
v_dot2c_f32_bf16_dpp v15, v21, v35 row_newbcast:8
s_add_u32 s56, s51, 229376
buffer_load_dwordx4 v[240:243], v1, s[8:11], s56 offen offset:0 nt
s_waitcnt vmcnt(3)
s_add_u32 s56, s51, 229376
buffer_load_dwordx4 v[244:247], v1, s[8:11], s56 offen offset:1024 nt
s_waitcnt vmcnt(3)
v_perm_b32 v28, v252, v248, s80
v_perm_b32 v29, v252, v248, s81
v_perm_b32 v30, v253, v249, s80
v_perm_b32 v31, v253, v249, s81
v_perm_b32 v32, v254, v250, s80
v_perm_b32 v33, v254, v250, s81
v_perm_b32 v34, v255, v251, s80
v_perm_b32 v35, v255, v251, s81
v_dot2c_f32_bf16_dpp v8, v22, v28 row_newbcast:0
v_dot2c_f32_bf16_dpp v9, v22, v29 row_newbcast:0
v_dot2c_f32_bf16_dpp v10, v22, v30 row_newbcast:0
v_dot2c_f32_bf16_dpp v11, v22, v31 row_newbcast:0
v_dot2c_f32_bf16_dpp v12, v22, v32 row_newbcast:0
v_dot2c_f32_bf16_dpp v13, v22, v33 row_newbcast:0
v_dot2c_f32_bf16_dpp v14, v22, v34 row_newbcast:0
v_dot2c_f32_bf16_dpp v15, v22, v35 row_newbcast:0
s_add_u32 s56, s51, 229376
buffer_load_dwordx4 v[248:251], v1, s[8:11], s56 offen offset:2048 nt
s_waitcnt vmcnt(3)
s_add_u32 s56, s51, 229376
buffer_load_dwordx4 v[252:255], v1, s[8:11], s56 offen offset:3072 nt
s_waitcnt vmcnt(3)
v_perm_b32 v28, v236, v232, s80
v_perm_b32 v29, v236, v232, s81
v_perm_b32 v30, v237, v233, s80
v_perm_b32 v31, v237, v233, s81
v_perm_b32 v32, v238, v234, s80
v_perm_b32 v33, v238, v234, s81
v_perm_b32 v34, v239, v235, s80
v_perm_b32 v35, v239, v235, s81
v_dot2c_f32_bf16_dpp v8, v22, v28 row_newbcast:8
v_dot2c_f32_bf16_dpp v9, v22, v29 row_newbcast:8
v_dot2c_f32_bf16_dpp v10, v22, v30 row_newbcast:8
v_dot2c_f32_bf16_dpp v11, v22, v31 row_newbcast:8
v_dot2c_f32_bf16_dpp v12, v22, v32 row_newbcast:8
v_dot2c_f32_bf16_dpp v13, v22, v33 row_newbcast:8
v_dot2c_f32_bf16_dpp v14, v22, v34 row_newbcast:8
v_dot2c_f32_bf16_dpp v15, v22, v35 row_newbcast:8
s_add_u32 s56, s51, 262144
buffer_load_dwordx4 v[232:235], v1, s[8:11], s56 offen offset:0 nt
s_waitcnt vmcnt(3)
s_add_u32 s56, s51, 262144
buffer_load_dwordx4 v[236:239], v1, s[8:11], s56 offen offset:1024 nt
s_waitcnt vmcnt(3)
v_perm_b32 v28, v244, v240, s80
v_perm_b32 v29, v244, v240, s81
v_perm_b32 v30, v245, v241, s80
v_perm_b32 v31, v245, v241, s81
v_perm_b32 v32, v246, v242, s80
v_perm_b32 v33, v246, v242, s81
v_perm_b32 v34, v247, v243, s80
v_perm_b32 v35, v247, v243, s81
v_dot2c_f32_bf16_dpp v8, v23, v28 row_newbcast:0
v_dot2c_f32_bf16_dpp v9, v23, v29 row_newbcast:0
v_dot2c_f32_bf16_dpp v10, v23, v30 row_newbcast:0
v_dot2c_f32_bf16_dpp v11, v23, v31 row_newbcast:0
v_dot2c_f32_bf16_dpp v12, v23, v32 row_newbcast:0
v_dot2c_f32_bf16_dpp v13, v23, v33 row_newbcast:0
v_dot2c_f32_bf16_dpp v14, v23, v34 row_newbcast:0
v_dot2c_f32_bf16_dpp v15, v23, v35 row_newbcast:0
s_add_u32 s56, s51, 262144
buffer_load_dwordx4 v[240:243], v1, s[8:11], s56 offen offset:2048 nt
s_waitcnt vmcnt(3)
s_add_u32 s56, s51, 262144
buffer_load_dwordx4 v[244:247], v1, s[8:11], s56 offen offset:3072 nt
s_waitcnt vmcnt(3)
v_perm_b32 v28, v252, v248, s80
v_perm_b32 v29, v252, v248, s81
v_perm_b32 v30, v253, v249, s80
v_perm_b32 v31, v253, v249, s81
v_perm_b32 v32, v254, v250, s80
v_perm_b32 v33, v254, v250, s81
v_perm_b32 v34, v255, v251, s80
v_perm_b32 v35, v255, v251, s81
v_dot2c_f32_bf16_dpp v8, v23, v28 row_newbcast:8
v_dot2c_f32_bf16_dpp v9, v23, v29 row_newbcast:8
v_dot2c_f32_bf16_dpp v10, v23, v30 row_newbcast:8
v_dot2c_f32_bf16_dpp v11, v23, v31 row_newbcast:8
v_dot2c_f32_bf16_dpp v12, v23, v32 row_newbcast:8
v_dot2c_f32_bf16_dpp v13, v23, v33 row_newbcast:8
v_dot2c_f32_bf16_dpp v14, v23, v34 row_newbcast:8
v_dot2c_f32_bf16_dpp v15, v23, v35 row_newbcast:8
s_add_u32 s56, s51, 294912
buffer_load_dwordx4 v[248:251], v1, s[8:11], s56 offen offset:0 nt
s_waitcnt vmcnt(3)
s_add_u32 s56, s51, 294912
buffer_load_dwordx4 v[252:255], v1, s[8:11], s56 offen offset:1024 nt
s_waitcnt vmcnt(3)
v_perm_b32 v28, v236, v232, s80
v_perm_b32 v29, v236, v232, s81
v_perm_b32 v30, v237, v233, s80
v_perm_b32 v31, v237, v233, s81
v_perm_b32 v32, v238, v234, s80
v_perm_b32 v33, v238, v234, s81
v_perm_b32 v34, v239, v235, s80
v_perm_b32 v35, v239, v235, s81
v_dot2c_f32_bf16_dpp v8, v24, v28 row_newbcast:0
v_dot2c_f32_bf16_dpp v9, v24, v29 row_newbcast:0
v_dot2c_f32_bf16_dpp v10, v24, v30 row_newbcast:0
v_dot2c_f32_bf16_dpp v11, v24, v31 row_newbcast:0
v_dot2c_f32_bf16_dpp v12, v24, v32 row_newbcast:0
v_dot2c_f32_bf16_dpp v13, v24, v33 row_newbcast:0
v_dot2c_f32_bf16_dpp v14, v24, v34 row_newbcast:0
v_dot2c_f32_bf16_dpp v15, v24, v35 row_newbcast:0
s_add_u32 s56, s51, 294912
buffer_load_dwordx4 v[232:235], v1, s[8:11], s56 offen offset:2048 nt
s_waitcnt vmcnt(3)
s_add_u32 s56, s51, 294912
buffer_load_dwordx4 v[236:239], v1, s[8:11], s56 offen offset:3072 nt
s_waitcnt vmcnt(3)
v_and_b32 v32, 31, v3
v_lshlrev_b32 v32, 5, v32
s_lshl_b32 s56, s49, 10
s_add_u32 s56, s56, 0x408000
buffer_load_dwordx4 v[56:59], v32, s[44:47], s56 offen offset:0 sc1
buffer_load_dwordx4 v[60:63], v32, s[44:47], s56 offen offset:16 sc1
v_perm_b32 v28, v244, v240, s80
v_perm_b32 v29, v244, v240, s81
v_perm_b32 v30, v245, v241, s80
v_perm_b32 v31, v245, v241, s81
v_perm_b32 v32, v246, v242, s80
v_perm_b32 v33, v246, v242, s81
v_perm_b32 v34, v247, v243, s80
v_perm_b32 v35, v247, v243, s81
v_dot2c_f32_bf16_dpp v8, v24, v28 row_newbcast:8
v_dot2c_f32_bf16_dpp v9, v24, v29 row_newbcast:8
v_dot2c_f32_bf16_dpp v10, v24, v30 row_newbcast:8
v_dot2c_f32_bf16_dpp v11, v24, v31 row_newbcast:8
v_dot2c_f32_bf16_dpp v12, v24, v32 row_newbcast:8
v_dot2c_f32_bf16_dpp v13, v24, v33 row_newbcast:8
v_dot2c_f32_bf16_dpp v14, v24, v34 row_newbcast:8
v_dot2c_f32_bf16_dpp v15, v24, v35 row_newbcast:8
s_waitcnt vmcnt(3)
buffer_load_dwordx4 v[240:243], v1, s[4:7], s52 offen offset:0 nt
s_waitcnt vmcnt(3)
buffer_load_dwordx4 v[244:247], v1, s[4:7], s52 offen offset:1024 nt
v_perm_b32 v28, v252, v248, s80
v_perm_b32 v29, v252, v248, s81
v_perm_b32 v30, v253, v249, s80
v_perm_b32 v31, v253, v249, s81
v_perm_b32 v32, v254, v250, s80
v_perm_b32 v33, v254, v250, s81
v_perm_b32 v34, v255, v251, s80
v_perm_b32 v35, v255, v251, s81
v_dot2c_f32_bf16_dpp v8, v25, v28 row_newbcast:0
v_dot2c_f32_bf16_dpp v9, v25, v29 row_newbcast:0
v_dot2c_f32_bf16_dpp v10, v25, v30 row_newbcast:0
v_dot2c_f32_bf16_dpp v11, v25, v31 row_newbcast:0
v_dot2c_f32_bf16_dpp v12, v25, v32 row_newbcast:0
v_dot2c_f32_bf16_dpp v13, v25, v33 row_newbcast:0
v_dot2c_f32_bf16_dpp v14, v25, v34 row_newbcast:0
v_dot2c_f32_bf16_dpp v15, v25, v35 row_newbcast:0
s_waitcnt vmcnt(3)
buffer_load_dwordx4 v[248:251], v1, s[4:7], s52 offen offset:2048 nt
s_waitcnt vmcnt(3)
buffer_load_dwordx4 v[252:255], v1, s[4:7], s52 offen offset:3072 nt
v_perm_b32 v28, v236, v232, s80
v_perm_b32 v29, v236, v232, s81
v_perm_b32 v30, v237, v233, s80
v_perm_b32 v31, v237, v233, s81
v_perm_b32 v32, v238, v234, s80
v_perm_b32 v33, v238, v234, s81
v_perm_b32 v34, v239, v235, s80
v_perm_b32 v35, v239, v235, s81
v_dot2c_f32_bf16_dpp v8, v25, v28 row_newbcast:8
v_dot2c_f32_bf16_dpp v9, v25, v29 row_newbcast:8
v_dot2c_f32_bf16_dpp v10, v25, v30 row_newbcast:8
v_dot2c_f32_bf16_dpp v11, v25, v31 row_newbcast:8
v_dot2c_f32_bf16_dpp v12, v25, v32 row_newbcast:8
v_dot2c_f32_bf16_dpp v13, v25, v33 row_newbcast:8
v_dot2c_f32_bf16_dpp v14, v25, v34 row_newbcast:8
v_dot2c_f32_bf16_dpp v15, v25, v35 row_newbcast:8
s_waitcnt vmcnt(3)
s_add_u32 s56, s52, 32768
buffer_load_dwordx4 v[232:235], v1, s[4:7], s56 offen offset:0 nt
s_waitcnt vmcnt(3)
s_add_u32 s56, s52, 32768
buffer_load_dwordx4 v[236:239], v1, s[4:7], s56 offen offset:1024 nt
v_mov_b32 v36, v8
v_mov_b32 v37, v9
v_mov_b32 v38, v10
v_mov_b32 v39, v11
v_mov_b32 v40, v12
v_mov_b32 v41, v13
v_mov_b32 v42, v14
v_mov_b32 v43, v15
v_permlane32_swap_b32 v8, v36
v_permlane32_swap_b32 v9, v37
v_permlane32_swap_b32 v10, v38
v_permlane32_swap_b32 v11, v39
v_permlane32_swap_b32 v12, v40
v_permlane32_swap_b32 v13, v41
v_permlane32_swap_b32 v14, v42
v_permlane32_swap_b32 v15, v43
v_add_f32 v8, v8, v36
v_add_f32 v9, v9, v37
v_add_f32 v10, v10, v38
v_add_f32 v11, v11, v39
v_add_f32 v12, v12, v40
v_add_f32 v13, v13, v41
v_add_f32 v14, v14, v42
v_add_f32 v15, v15, v43
v_and_b32 v28, 31, v3
v_lshlrev_b32 v28, 5, v28
s_lshl_b32 s56, s48, 10
s_add_u32 s56, s56, 0x0
v_add_u32 v28, s56, v28
ds_write_b128 v28, v[8:11]
ds_write_b128 v28, v[12:15] offset:16
s_lshl_b32 s56, s48, 3
s_add_u32 s56, s56, 0x4000
v_mov_b32 v29, s56
ds_write_b64 v29, v[26:27]
v_mov_b32 v30, 0x4080
v_mov_b32 v31, 1
s_waitcnt lgkmcnt(0)
s_mov_b64 exec, 1
ds_add_rtn_u32 v28, v30, v31
s_mov_b64 exec, -1
s_waitcnt lgkmcnt(0)
v_readfirstlane_b32 s59, v28
s_nop 0
s_cmp_lg_u32 s59, 7
s_cbranch_scc1 L_nos1_211
s_setprio 3
v_add_u32 v24, 0x0, v1
v_mov_b32 v25, 0x4000
ds_read_b128 v[8:11], v25 offset:0
ds_read_b128 v[12:15], v25 offset:16
ds_read_b128 v[16:19], v25 offset:32
ds_read_b128 v[20:23], v25 offset:48
ds_read_b128 v[36:39], v24 offset:0
ds_read_b128 v[40:43], v24 offset:1024
ds_read_b128 v[44:47], v24 offset:2048
ds_read_b128 v[48:51], v24 offset:3072
s_waitcnt lgkmcnt(0)
v_max_f32 v26, v8, v10
v_max_f32 v26, v26, v12
v_max_f32 v26, v26, v14
v_max_f32 v26, v26, v16
v_max_f32 v26, v26, v18
v_max_f32 v26, v26, v20
v_max_f32 v26, v26, v22
v_sub_f32 v8, v8, v26
v_sub_f32 v10, v10, v26
v_sub_f32 v12, v12, v26
v_sub_f32 v14, v14, v26
v_sub_f32 v16, v16, v26
v_sub_f32 v18, v18, v26
v_sub_f32 v20, v20, v26
v_sub_f32 v22, v22, v26
v_mul_f32 v8, 0x3fb8aa3b, v8
v_mul_f32 v10, 0x3fb8aa3b, v10
v_mul_f32 v12, 0x3fb8aa3b, v12
v_mul_f32 v14, 0x3fb8aa3b, v14
v_mul_f32 v16, 0x3fb8aa3b, v16
v_mul_f32 v18, 0x3fb8aa3b, v18
v_mul_f32 v20, 0x3fb8aa3b, v20
v_mul_f32 v22, 0x3fb8aa3b, v22
v_exp_f32 v8, v8
v_exp_f32 v10, v10
v_exp_f32 v12, v12
v_exp_f32 v14, v14
v_exp_f32 v16, v16
v_exp_f32 v18, v18
v_exp_f32 v20, v20
v_exp_f32 v22, v22
v_mul_f32 v27, v8, v9
v_fmac_f32 v27, v10, v11
v_fmac_f32 v27, v12, v13
v_fmac_f32 v27, v14, v15
v_fmac_f32 v27, v16, v17
v_fmac_f32 v27, v18, v19
v_fmac_f32 v27, v20, v21
v_fmac_f32 v27, v22, v23
v_mul_f32 v28, v8, v36
v_mul_f32 v29, v8, v37
v_mul_f32 v30, v8, v38
v_mul_f32 v31, v8, v39
v_fmac_f32 v28, v10, v40
v_fmac_f32 v29, v10, v41
v_fmac_f32 v30, v10, v42
v_fmac_f32 v31, v10, v43
v_fmac_f32 v28, v12, v44
v_fmac_f32 v29, v12, v45
v_fmac_f32 v30, v12, v46
v_fmac_f32 v31, v12, v47
v_fmac_f32 v28, v14, v48
v_fmac_f32 v29, v14, v49
v_fmac_f32 v30, v14, v50
v_fmac_f32 v31, v14, v51
ds_read_b128 v[36:39], v24 offset:4096
ds_read_b128 v[40:43], v24 offset:5120
ds_read_b128 v[44:47], v24 offset:6144
ds_read_b128 v[48:51], v24 offset:7168
s_waitcnt lgkmcnt(0)
v_fmac_f32 v28, v16, v36
v_fmac_f32 v29, v16, v37
v_fmac_f32 v30, v16, v38
v_fmac_f32 v31, v16, v39
v_fmac_f32 v28, v18, v40
v_fmac_f32 v29, v18, v41
v_fmac_f32 v30, v18, v42
v_fmac_f32 v31, v18, v43
v_fmac_f32 v28, v20, v44
v_fmac_f32 v29, v20, v45
v_fmac_f32 v30, v20, v46
v_fmac_f32 v31, v20, v47
v_fmac_f32 v28, v22, v48
v_fmac_f32 v29, v22, v49
v_fmac_f32 v30, v22, v50
v_fmac_f32 v31, v22, v51
v_or_b32 v28, 1, v28
v_or_b32 v29, 1, v29
v_or_b32 v30, 1, v30
v_or_b32 v31, 1, v31
v_or_b32 v26, 1, v26
v_or_b32 v27, 1, v27
s_mul_i32 s56, s49, 14
s_add_u32 s56, s56, s50
s_mul_i32 s56, s56, 1088
s_add_u32 s56, s56, 0x100000
buffer_store_dwordx4 v[28:31], v1, s[44:47], s56 offen sc1
s_mov_b64 exec, 1
buffer_store_dwordx2 v[26:27], v1, s[44:47], s56 offen offset:1024 sc1
s_mov_b64 exec, -1
L_nos1_211:
s_nop 4
v_mov_b32 v28, 0x4080
s_mov_b32 s60, 0
L_p_wgw_226:
s_nop 4
ds_read_b32 v29, v28
s_waitcnt lgkmcnt(0)
v_cmp_ne_u32 vcc, 8, v29
s_cbranch_vccz L_d_wgw_227
s_sleep 1
s_add_u32 s60, s60, 1
s_cmp_lt_u32 s60, 400000
s_cbranch_scc1 L_p_wgw_226
s_endpgm
L_d_wgw_227:
s_nop 4
s_setprio 2
v_mov_b32 v28, 0
v_xor_b32 v29, v52, v56
v_or_b32 v28, v29, v28
v_xor_b32 v29, v52, v58
v_or_b32 v28, v29, v28
v_xor_b32 v29, v52, v60
v_or_b32 v28, v29, v28
v_xor_b32 v29, v52, v62
v_or_b32 v28, v29, v28
v_cmp_ne_u32 vcc, 0, v28
s_cbranch_vccz L_qburst_229
s_mov_b32 s60, 0
L_p_q_231:
s_nop 4
v_and_b32 v32, 31, v3
v_lshlrev_b32 v32, 5, v32
s_lshl_b32 s56, s49, 10
s_add_u32 s56, s56, 0x408000
buffer_load_dwordx4 v[56:59], v32, s[44:47], s56 offen offset:0 sc1
buffer_load_dwordx4 v[60:63], v32, s[44:47], s56 offen offset:16 sc1
s_waitcnt vmcnt(0)
v_mov_b32 v28, 0
v_xor_b32 v29, v52, v56
v_or_b32 v28, v29, v28
v_xor_b32 v29, v52, v58
v_or_b32 v28, v29, v28
v_xor_b32 v29, v52, v60
v_or_b32 v28, v29, v28
v_xor_b32 v29, v52, v62
v_or_b32 v28, v29, v28
v_cmp_ne_u32 vcc, 0, v28
s_cbranch_vccz L_d_q_232
s_sleep 1
s_add_u32 s60, s60, 1
s_cmp_lt_u32 s60, 400000
s_cbranch_scc1 L_p_q_231
s_endpgm
L_d_q_232:
s_nop 4
s_branch L_qjoin_230
L_qburst_229:
s_nop 4
L_qjoin_230:
s_nop 4
v_mov_b32 v4, v57
v_mov_b32 v5, v59
v_mov_b32 v6, v61
v_mov_b32 v7, v63
s_waitcnt vmcnt(3)
s_waitcnt vmcnt(2)
v_dot2_f32_bf16 v28, v240, v4, 0
v_dot2_f32_bf16 v29, v244, v4, 0
v_dot2_f32_bf16 v30, v248, v4, 0
v_dot2_f32_bf16 v31, v252, v4, 0
v_dot2_f32_bf16 v28, v241, v5, v28
v_dot2_f32_bf16 v29, v245, v5, v29
v_dot2_f32_bf16 v30, v249, v5, v30
v_dot2_f32_bf16 v31, v253, v5, v31
v_dot2_f32_bf16 v28, v242, v6, v28
v_dot2_f32_bf16 v29, v246, v6, v29
v_dot2_f32_bf16 v30, v250, v6, v30
v_dot2_f32_bf16 v31, v254, v6, v31
v_dot2_f32_bf16 v28, v243, v7, v28
v_dot2_f32_bf16 v29, v247, v7, v29
v_dot2_f32_bf16 v30, v251, v7, v30
v_dot2_f32_bf16 v31, v255, v7, v31
s_nop 0
v_permlane16_swap_b32 v28, v29
s_nop 0
v_permlane16_swap_b32 v30, v31
v_add_f32 v28, v28, v29
v_add_f32 v30, v30, v31
s_nop 0
v_add_f32_dpp v16, v28, v28 row_ror:8 row_mask:0xf bank_mask:0x3
v_add_f32_dpp v16, v30, v30 row_ror:8 row_mask:0xf bank_mask:0xc
s_add_u32 s56, s52, 32768
buffer_load_dwordx4 v[240:243], v1, s[4:7], s56 offen offset:2048 nt
s_add_u32 s56, s52, 32768
buffer_load_dwordx4 v[244:247], v1, s[4:7], s56 offen offset:3072 nt
s_waitcnt vmcnt(3)
s_add_u32 s56, s52, 65536
buffer_load_dwordx4 v[248:251], v1, s[4:7], s56 offen offset:0 nt
s_waitcnt vmcnt(3)
s_add_u32 s56, s52, 65536
buffer_load_dwordx4 v[252:255], v1, s[4:7], s56 offen offset:1024 nt
s_waitcnt vmcnt(3)
s_waitcnt vmcnt(2)
v_dot2_f32_bf16 v28, v232, v4, 0
v_dot2_f32_bf16 v29, v236, v4, 0
v_dot2_f32_bf16 v30, v240, v4, 0
v_dot2_f32_bf16 v31, v244, v4, 0
v_dot2_f32_bf16 v28, v233, v5, v28
v_dot2_f32_bf16 v29, v237, v5, v29
v_dot2_f32_bf16 v30, v241, v5, v30
v_dot2_f32_bf16 v31, v245, v5, v31
v_dot2_f32_bf16 v28, v234, v6, v28
v_dot2_f32_bf16 v29, v238, v6, v29
v_dot2_f32_bf16 v30, v242, v6, v30
v_dot2_f32_bf16 v31, v246, v6, v31
v_dot2_f32_bf16 v28, v235, v7, v28
v_dot2_f32_bf16 v29, v239, v7, v29
v_dot2_f32_bf16 v30, v243, v7, v30
v_dot2_f32_bf16 v31, v247, v7, v31
s_nop 0
v_permlane16_swap_b32 v28, v29
s_nop 0
v_permlane16_swap_b32 v30, v31
v_add_f32 v28, v28, v29
v_add_f32 v30, v30, v31
s_nop 0
v_add_f32_dpp v17, v28, v28 row_ror:8 row_mask:0xf bank_mask:0x3
v_add_f32_dpp v17, v30, v30 row_ror:8 row_mask:0xf bank_mask:0xc
s_add_u32 s56, s52, 65536
buffer_load_dwordx4 v[232:235], v1, s[4:7], s56 offen offset:2048 nt
s_add_u32 s56, s52, 65536
buffer_load_dwordx4 v[236:239], v1, s[4:7], s56 offen offset:3072 nt
s_waitcnt vmcnt(3)
s_add_u32 s56, s52, 98304
buffer_load_dwordx4 v[240:243], v1, s[4:7], s56 offen offset:0 nt
s_waitcnt vmcnt(3)
s_add_u32 s56, s52, 98304
buffer_load_dwordx4 v[244:247], v1, s[4:7], s56 offen offset:1024 nt
s_waitcnt vmcnt(3)
s_waitcnt vmcnt(2)
v_dot2_f32_bf16 v28, v248, v4, 0
v_dot2_f32_bf16 v29, v252, v4, 0
v_dot2_f32_bf16 v30, v232, v4, 0
v_dot2_f32_bf16 v31, v236, v4, 0
v_dot2_f32_bf16 v28, v249, v5, v28
v_dot2_f32_bf16 v29, v253, v5, v29
v_dot2_f32_bf16 v30, v233, v5, v30
v_dot2_f32_bf16 v31, v237, v5, v31
v_dot2_f32_bf16 v28, v250, v6, v28
v_dot2_f32_bf16 v29, v254, v6, v29
v_dot2_f32_bf16 v30, v234, v6, v30
v_dot2_f32_bf16 v31, v238, v6, v31
v_dot2_f32_bf16 v28, v251, v7, v28
v_dot2_f32_bf16 v29, v255, v7, v29
v_dot2_f32_bf16 v30, v235, v7, v30
v_dot2_f32_bf16 v31, v239, v7, v31
s_nop 0
v_permlane16_swap_b32 v28, v29
s_nop 0
v_permlane16_swap_b32 v30, v31
v_add_f32 v28, v28, v29
v_add_f32 v30, v30, v31
s_nop 0
v_add_f32_dpp v18, v28, v28 row_ror:8 row_mask:0xf bank_mask:0x3
v_add_f32_dpp v18, v30, v30 row_ror:8 row_mask:0xf bank_mask:0xc
s_add_u32 s56, s52, 98304
buffer_load_dwordx4 v[248:251], v1, s[4:7], s56 offen offset:2048 nt
s_add_u32 s56, s52, 98304
buffer_load_dwordx4 v[252:255], v1, s[4:7], s56 offen offset:3072 nt
s_waitcnt vmcnt(3)
s_add_u32 s56, s52, 131072
buffer_load_dwordx4 v[232:235], v1, s[4:7], s56 offen offset:0 nt
s_waitcnt vmcnt(3)
s_add_u32 s56, s52, 131072
buffer_load_dwordx4 v[236:239], v1, s[4:7], s56 offen offset:1024 nt
s_waitcnt vmcnt(3)
s_waitcnt vmcnt(2)
v_dot2_f32_bf16 v28, v240, v4, 0
v_dot2_f32_bf16 v29, v244, v4, 0
v_dot2_f32_bf16 v30, v248, v4, 0
v_dot2_f32_bf16 v31, v252, v4, 0
v_dot2_f32_bf16 v28, v241, v5, v28
v_dot2_f32_bf16 v29, v245, v5, v29
v_dot2_f32_bf16 v30, v249, v5, v30
v_dot2_f32_bf16 v31, v253, v5, v31
v_dot2_f32_bf16 v28, v242, v6, v28
v_dot2_f32_bf16 v29, v246, v6, v29
v_dot2_f32_bf16 v30, v250, v6, v30
v_dot2_f32_bf16 v31, v254, v6, v31
v_dot2_f32_bf16 v28, v243, v7, v28
v_dot2_f32_bf16 v29, v247, v7, v29
v_dot2_f32_bf16 v30, v251, v7, v30
v_dot2_f32_bf16 v31, v255, v7, v31
s_nop 0
v_permlane16_swap_b32 v28, v29
s_nop 0
v_permlane16_swap_b32 v30, v31
v_add_f32 v28, v28, v29
v_add_f32 v30, v30, v31
s_nop 0
v_add_f32_dpp v19, v28, v28 row_ror:8 row_mask:0xf bank_mask:0x3
v_add_f32_dpp v19, v30, v30 row_ror:8 row_mask:0xf bank_mask:0xc
s_add_u32 s56, s52, 131072
buffer_load_dwordx4 v[240:243], v1, s[4:7], s56 offen offset:2048 nt
s_add_u32 s56, s52, 131072
buffer_load_dwordx4 v[244:247], v1, s[4:7], s56 offen offset:3072 nt
s_waitcnt vmcnt(3)
s_add_u32 s56, s52, 163840
buffer_load_dwordx4 v[248:251], v1, s[4:7], s56 offen offset:0 nt
s_waitcnt vmcnt(3)
s_add_u32 s56, s52, 163840
buffer_load_dwordx4 v[252:255], v1, s[4:7], s56 offen offset:1024 nt
s_waitcnt vmcnt(3)
s_waitcnt vmcnt(2)
v_dot2_f32_bf16 v28, v232, v4, 0
v_dot2_f32_bf16 v29, v236, v4, 0
v_dot2_f32_bf16 v30, v240, v4, 0
v_dot2_f32_bf16 v31, v244, v4, 0
v_dot2_f32_bf16 v28, v233, v5, v28
v_dot2_f32_bf16 v29, v237, v5, v29
v_dot2_f32_bf16 v30, v241, v5, v30
v_dot2_f32_bf16 v31, v245, v5, v31
v_dot2_f32_bf16 v28, v234, v6, v28
v_dot2_f32_bf16 v29, v238, v6, v29
v_dot2_f32_bf16 v30, v242, v6, v30
v_dot2_f32_bf16 v31, v246, v6, v31
v_dot2_f32_bf16 v28, v235, v7, v28
v_dot2_f32_bf16 v29, v239, v7, v29
v_dot2_f32_bf16 v30, v243, v7, v30
v_dot2_f32_bf16 v31, v247, v7, v31
s_nop 0
v_permlane16_swap_b32 v28, v29
s_nop 0
v_permlane16_swap_b32 v30, v31
v_add_f32 v28, v28, v29
v_add_f32 v30, v30, v31
s_nop 0
v_add_f32_dpp v20, v28, v28 row_ror:8 row_mask:0xf bank_mask:0x3
v_add_f32_dpp v20, v30, v30 row_ror:8 row_mask:0xf bank_mask:0xc
s_add_u32 s56, s52, 163840
buffer_load_dwordx4 v[232:235], v1, s[4:7], s56 offen offset:2048 nt
s_add_u32 s56, s52, 163840
buffer_load_dwordx4 v[236:239], v1, s[4:7], s56 offen offset:3072 nt
s_waitcnt vmcnt(3)
s_add_u32 s56, s52, 196608
buffer_load_dwordx4 v[240:243], v1, s[4:7], s56 offen offset:0 nt
s_waitcnt vmcnt(3)
s_add_u32 s56, s52, 196608
buffer_load_dwordx4 v[244:247], v1, s[4:7], s56 offen offset:1024 nt
s_waitcnt vmcnt(3)
s_waitcnt vmcnt(2)
v_dot2_f32_bf16 v28, v248, v4, 0
v_dot2_f32_bf16 v29, v252, v4, 0
v_dot2_f32_bf16 v30, v232, v4, 0
v_dot2_f32_bf16 v31, v236, v4, 0
v_dot2_f32_bf16 v28, v249, v5, v28
v_dot2_f32_bf16 v29, v253, v5, v29
v_dot2_f32_bf16 v30, v233, v5, v30
v_dot2_f32_bf16 v31, v237, v5, v31
v_dot2_f32_bf16 v28, v250, v6, v28
v_dot2_f32_bf16 v29, v254, v6, v29
v_dot2_f32_bf16 v30, v234, v6, v30
v_dot2_f32_bf16 v31, v238, v6, v31
v_dot2_f32_bf16 v28, v251, v7, v28
v_dot2_f32_bf16 v29, v255, v7, v29
v_dot2_f32_bf16 v30, v235, v7, v30
v_dot2_f32_bf16 v31, v239, v7, v31
s_nop 0
v_permlane16_swap_b32 v28, v29
s_nop 0
v_permlane16_swap_b32 v30, v31
v_add_f32 v28, v28, v29
v_add_f32 v30, v30, v31
s_nop 0
v_add_f32_dpp v21, v28, v28 row_ror:8 row_mask:0xf bank_mask:0x3
v_add_f32_dpp v21, v30, v30 row_ror:8 row_mask:0xf bank_mask:0xc
s_add_u32 s56, s52, 196608
buffer_load_dwordx4 v[248:251], v1, s[4:7], s56 offen offset:2048 nt
s_add_u32 s56, s52, 196608
buffer_load_dwordx4 v[252:255], v1, s[4:7], s56 offen offset:3072 nt
s_waitcnt vmcnt(3)
s_add_u32 s56, s52, 229376
buffer_load_dwordx4 v[232:235], v1, s[4:7], s56 offen offset:0 nt
s_waitcnt vmcnt(3)
s_add_u32 s56, s52, 229376
buffer_load_dwordx4 v[236:239], v1, s[4:7], s56 offen offset:1024 nt
s_waitcnt vmcnt(3)
s_waitcnt vmcnt(2)
v_dot2_f32_bf16 v28, v240, v4, 0
v_dot2_f32_bf16 v29, v244, v4, 0
v_dot2_f32_bf16 v30, v248, v4, 0
v_dot2_f32_bf16 v31, v252, v4, 0
v_dot2_f32_bf16 v28, v241, v5, v28
v_dot2_f32_bf16 v29, v245, v5, v29
v_dot2_f32_bf16 v30, v249, v5, v30
v_dot2_f32_bf16 v31, v253, v5, v31
v_dot2_f32_bf16 v28, v242, v6, v28
v_dot2_f32_bf16 v29, v246, v6, v29
v_dot2_f32_bf16 v30, v250, v6, v30
v_dot2_f32_bf16 v31, v254, v6, v31
v_dot2_f32_bf16 v28, v243, v7, v28
v_dot2_f32_bf16 v29, v247, v7, v29
v_dot2_f32_bf16 v30, v251, v7, v30
v_dot2_f32_bf16 v31, v255, v7, v31
s_nop 0
v_permlane16_swap_b32 v28, v29
s_nop 0
v_permlane16_swap_b32 v30, v31
v_add_f32 v28, v28, v29
v_add_f32 v30, v30, v31
s_nop 0
v_add_f32_dpp v22, v28, v28 row_ror:8 row_mask:0xf bank_mask:0x3
v_add_f32_dpp v22, v30, v30 row_ror:8 row_mask:0xf bank_mask:0xc
s_add_u32 s56, s52, 229376
buffer_load_dwordx4 v[240:243], v1, s[4:7], s56 offen offset:2048 nt
s_add_u32 s56, s52, 229376
buffer_load_dwordx4 v[244:247], v1, s[4:7], s56 offen offset:3072 nt
s_waitcnt vmcnt(3)
s_add_u32 s56, s52, 262144
buffer_load_dwordx4 v[248:251], v1, s[4:7], s56 offen offset:0 nt
s_waitcnt vmcnt(3)
s_add_u32 s56, s52, 262144
buffer_load_dwordx4 v[252:255], v1, s[4:7], s56 offen offset:1024 nt
s_waitcnt vmcnt(3)
s_waitcnt vmcnt(2)
v_dot2_f32_bf16 v28, v232, v4, 0
v_dot2_f32_bf16 v29, v236, v4, 0
v_dot2_f32_bf16 v30, v240, v4, 0
v_dot2_f32_bf16 v31, v244, v4, 0
v_dot2_f32_bf16 v28, v233, v5, v28
v_dot2_f32_bf16 v29, v237, v5, v29
v_dot2_f32_bf16 v30, v241, v5, v30
v_dot2_f32_bf16 v31, v245, v5, v31
v_dot2_f32_bf16 v28, v234, v6, v28
v_dot2_f32_bf16 v29, v238, v6, v29
v_dot2_f32_bf16 v30, v242, v6, v30
v_dot2_f32_bf16 v31, v246, v6, v31
v_dot2_f32_bf16 v28, v235, v7, v28
v_dot2_f32_bf16 v29, v239, v7, v29
v_dot2_f32_bf16 v30, v243, v7, v30
v_dot2_f32_bf16 v31, v247, v7, v31
s_nop 0
v_permlane16_swap_b32 v28, v29
s_nop 0
v_permlane16_swap_b32 v30, v31
v_add_f32 v28, v28, v29
v_add_f32 v30, v30, v31
s_nop 0
v_add_f32_dpp v23, v28, v28 row_ror:8 row_mask:0xf bank_mask:0x3
v_add_f32_dpp v23, v30, v30 row_ror:8 row_mask:0xf bank_mask:0xc
s_add_u32 s56, s52, 262144
buffer_load_dwordx4 v[232:235], v1, s[4:7], s56 offen offset:2048 nt
s_add_u32 s56, s52, 262144
buffer_load_dwordx4 v[236:239], v1, s[4:7], s56 offen offset:3072 nt
s_waitcnt vmcnt(3)
s_add_u32 s56, s52, 294912
buffer_load_dwordx4 v[240:243], v1, s[4:7], s56 offen offset:0 nt
s_waitcnt vmcnt(3)
s_add_u32 s56, s52, 294912
buffer_load_dwordx4 v[244:247], v1, s[4:7], s56 offen offset:1024 nt
s_waitcnt vmcnt(3)
s_waitcnt vmcnt(2)
v_dot2_f32_bf16 v28, v248, v4, 0
v_dot2_f32_bf16 v29, v252, v4, 0
v_dot2_f32_bf16 v30, v232, v4, 0
v_dot2_f32_bf16 v31, v236, v4, 0
v_dot2_f32_bf16 v28, v249, v5, v28
v_dot2_f32_bf16 v29, v253, v5, v29
v_dot2_f32_bf16 v30, v233, v5, v30
v_dot2_f32_bf16 v31, v237, v5, v31
v_dot2_f32_bf16 v28, v250, v6, v28
v_dot2_f32_bf16 v29, v254, v6, v29
v_dot2_f32_bf16 v30, v234, v6, v30
v_dot2_f32_bf16 v31, v238, v6, v31
v_dot2_f32_bf16 v28, v251, v7, v28
v_dot2_f32_bf16 v29, v255, v7, v29
v_dot2_f32_bf16 v30, v235, v7, v30
v_dot2_f32_bf16 v31, v239, v7, v31
s_nop 0
v_permlane16_swap_b32 v28, v29
s_nop 0
v_permlane16_swap_b32 v30, v31
v_add_f32 v28, v28, v29
v_add_f32 v30, v30, v31
s_nop 0
v_add_f32_dpp v24, v28, v28 row_ror:8 row_mask:0xf bank_mask:0x3
v_add_f32_dpp v24, v30, v30 row_ror:8 row_mask:0xf bank_mask:0xc
s_add_u32 s56, s52, 294912
buffer_load_dwordx4 v[248:251], v1, s[4:7], s56 offen offset:2048
s_add_u32 s56, s52, 294912
buffer_load_dwordx4 v[252:255], v1, s[4:7], s56 offen offset:3072
s_waitcnt vmcnt(3)
buffer_load_dwordx4 v[232:235], v1, s[8:11], s52 offen offset:0
s_waitcnt vmcnt(3)
buffer_load_dwordx4 v[236:239], v1, s[8:11], s52 offen offset:1024
s_waitcnt vmcnt(3)
s_waitcnt vmcnt(2)
v_dot2_f32_bf16 v28, v240, v4, 0
v_dot2_f32_bf16 v29, v244, v4, 0
v_dot2_f32_bf16 v30, v248, v4, 0
v_dot2_f32_bf16 v31, v252, v4, 0
v_dot2_f32_bf16 v28, v241, v5, v28
v_dot2_f32_bf16 v29, v245, v5, v29
v_dot2_f32_bf16 v30, v249, v5, v30
v_dot2_f32_bf16 v31, v253, v5, v31
v_dot2_f32_bf16 v28, v242, v6, v28
v_dot2_f32_bf16 v29, v246, v6, v29
v_dot2_f32_bf16 v30, v250, v6, v30
v_dot2_f32_bf16 v31, v254, v6, v31
v_dot2_f32_bf16 v28, v243, v7, v28
v_dot2_f32_bf16 v29, v247, v7, v29
v_dot2_f32_bf16 v30, v251, v7, v30
v_dot2_f32_bf16 v31, v255, v7, v31
s_nop 0
v_permlane16_swap_b32 v28, v29
s_nop 0
v_permlane16_swap_b32 v30, v31
v_add_f32 v28, v28, v29
v_add_f32 v30, v30, v31
s_nop 0
v_add_f32_dpp v25, v28, v28 row_ror:8 row_mask:0xf bank_mask:0x3
v_add_f32_dpp v25, v30, v30 row_ror:8 row_mask:0xf bank_mask:0xc
buffer_load_dwordx4 v[240:243], v1, s[8:11], s52 offen offset:2048
buffer_load_dwordx4 v[244:247], v1, s[8:11], s52 offen offset:3072
s_waitcnt vmcnt(3)
s_add_u32 s56, s52, 32768
buffer_load_dwordx4 v[248:251], v1, s[8:11], s56 offen offset:0
s_waitcnt vmcnt(3)
s_add_u32 s56, s52, 32768
buffer_load_dwordx4 v[252:255], v1, s[8:11], s56 offen offset:1024
s_waitcnt vmcnt(3)
v_add_f32_dpp v16, v16, v16 quad_perm:[1,0,3,2]
v_add_f32_dpp v17, v17, v17 quad_perm:[1,0,3,2]
v_add_f32_dpp v18, v18, v18 quad_perm:[1,0,3,2]
v_add_f32_dpp v19, v19, v19 quad_perm:[1,0,3,2]
v_add_f32_dpp v20, v20, v20 quad_perm:[1,0,3,2]
v_add_f32_dpp v21, v21, v21 quad_perm:[1,0,3,2]
v_add_f32_dpp v22, v22, v22 quad_perm:[1,0,3,2]
v_add_f32_dpp v23, v23, v23 quad_perm:[1,0,3,2]
v_add_f32_dpp v24, v24, v24 quad_perm:[1,0,3,2]
v_add_f32_dpp v25, v25, v25 quad_perm:[1,0,3,2]
v_add_f32_dpp v16, v16, v16 quad_perm:[2,3,0,1]
v_add_f32_dpp v17, v17, v17 quad_perm:[2,3,0,1]
v_add_f32_dpp v18, v18, v18 quad_perm:[2,3,0,1]
v_add_f32_dpp v19, v19, v19 quad_perm:[2,3,0,1]
v_add_f32_dpp v20, v20, v20 quad_perm:[2,3,0,1]
v_add_f32_dpp v21, v21, v21 quad_perm:[2,3,0,1]
v_add_f32_dpp v22, v22, v22 quad_perm:[2,3,0,1]
v_add_f32_dpp v23, v23, v23 quad_perm:[2,3,0,1]
v_add_f32_dpp v24, v24, v24 quad_perm:[2,3,0,1]
v_add_f32_dpp v25, v25, v25 quad_perm:[2,3,0,1]
v_add_f32_dpp v16, v16, v16 row_half_mirror
v_add_f32_dpp v17, v17, v17 row_half_mirror
v_add_f32_dpp v18, v18, v18 row_half_mirror
v_add_f32_dpp v19, v19, v19 row_half_mirror
v_add_f32_dpp v20, v20, v20 row_half_mirror
v_add_f32_dpp v21, v21, v21 row_half_mirror
v_add_f32_dpp v22, v22, v22 row_half_mirror
v_add_f32_dpp v23, v23, v23 row_half_mirror
v_add_f32_dpp v24, v24, v24 row_half_mirror
v_add_f32_dpp v25, v25, v25 row_half_mirror
v_cvt_pk_bf16_f32 v16, v16, v16
v_cvt_pk_bf16_f32 v17, v17, v17
v_cvt_pk_bf16_f32 v18, v18, v18
v_cvt_pk_bf16_f32 v19, v19, v19
v_cvt_pk_bf16_f32 v20, v20, v20
v_cvt_pk_bf16_f32 v21, v21, v21
v_cvt_pk_bf16_f32 v22, v22, v22
v_cvt_pk_bf16_f32 v23, v23, v23
v_cvt_pk_bf16_f32 v24, v24, v24
v_cvt_pk_bf16_f32 v25, v25, v25
v_and_b32 v16, s62, v16
v_and_b32 v17, s62, v17
v_and_b32 v18, s62, v18
v_and_b32 v19, s62, v19
v_and_b32 v20, s62, v20
v_and_b32 v21, s62, v21
v_and_b32 v22, s62, v22
v_and_b32 v23, s62, v23
v_and_b32 v24, s62, v24
v_and_b32 v25, s62, v25
v_mul_f32 v16, 0x3d800000, v16
v_mul_f32 v17, 0x3d800000, v17
v_mul_f32 v18, 0x3d800000, v18
v_mul_f32 v19, 0x3d800000, v19
v_mul_f32 v20, 0x3d800000, v20
v_mul_f32 v21, 0x3d800000, v21
v_mul_f32 v22, 0x3d800000, v22
v_mul_f32 v23, 0x3d800000, v23
v_mul_f32 v24, 0x3d800000, v24
v_mul_f32 v25, 0x3d800000, v25
v_max_f32 v26, v16, v17
v_max_f32 v26, v26, v18
v_max_f32 v26, v26, v19
v_max_f32 v26, v26, v20
v_max_f32 v26, v26, v21
v_max_f32 v26, v26, v22
v_max_f32 v26, v26, v23
v_max_f32 v26, v26, v24
v_max_f32 v26, v26, v25
s_nop 1
v_max_f32_dpp v26, v26, v26 row_ror:8
v_mov_b32 v28, v26
s_nop 1
v_permlane16_swap_b32 v26, v28
v_max_f32 v26, v26, v28
v_mov_b32 v28, v26
s_nop 1
v_permlane32_swap_b32 v26, v28
v_max_f32 v26, v26, v28
v_sub_f32 v16, v16, v26
v_sub_f32 v17, v17, v26
v_sub_f32 v18, v18, v26
v_sub_f32 v19, v19, v26
v_sub_f32 v20, v20, v26
v_sub_f32 v21, v21, v26
v_sub_f32 v22, v22, v26
v_sub_f32 v23, v23, v26
v_sub_f32 v24, v24, v26
v_sub_f32 v25, v25, v26
v_mul_f32 v16, 0x3fb8aa3b, v16
v_mul_f32 v17, 0x3fb8aa3b, v17
v_mul_f32 v18, 0x3fb8aa3b, v18
v_mul_f32 v19, 0x3fb8aa3b, v19
v_mul_f32 v20, 0x3fb8aa3b, v20
v_mul_f32 v21, 0x3fb8aa3b, v21
v_mul_f32 v22, 0x3fb8aa3b, v22
v_mul_f32 v23, 0x3fb8aa3b, v23
v_mul_f32 v24, 0x3fb8aa3b, v24
v_mul_f32 v25, 0x3fb8aa3b, v25
v_exp_f32 v16, v16
v_exp_f32 v17, v17
v_exp_f32 v18, v18
v_exp_f32 v19, v19
v_exp_f32 v20, v20
v_exp_f32 v21, v21
v_exp_f32 v22, v22
v_exp_f32 v23, v23
v_exp_f32 v24, v24
v_exp_f32 v25, v25
v_add_f32 v27, v16, v17
v_add_f32 v27, v27, v18
v_add_f32 v27, v27, v19
v_add_f32 v27, v27, v20
v_add_f32 v27, v27, v21
v_add_f32 v27, v27, v22
v_add_f32 v27, v27, v23
v_add_f32 v27, v27, v24
v_add_f32 v27, v27, v25
s_nop 1
v_add_f32_dpp v27, v27, v27 row_ror:8
v_mov_b32 v28, v27
s_nop 1
v_permlane16_swap_b32 v27, v28
v_add_f32 v27, v27, v28
v_mov_b32 v28, v27
s_nop 1
v_permlane32_swap_b32 v27, v28
v_add_f32 v27, v27, v28
v_mov_b32 v36, v16
v_mov_b32 v37, v17
v_mov_b32 v38, v18
v_mov_b32 v39, v19
v_mov_b32 v40, v20
v_mov_b32 v41, v21
v_mov_b32 v42, v22
v_mov_b32 v43, v23
v_mov_b32 v44, v24
v_mov_b32 v45, v25
v_permlane16_swap_b32 v16, v36
v_permlane16_swap_b32 v17, v37
v_permlane16_swap_b32 v18, v38
v_permlane16_swap_b32 v19, v39
v_permlane16_swap_b32 v20, v40
v_permlane16_swap_b32 v21, v41
v_permlane16_swap_b32 v22, v42
v_permlane16_swap_b32 v23, v43
v_permlane16_swap_b32 v24, v44
v_permlane16_swap_b32 v25, v45
v_cvt_pk_bf16_f32 v16, v16, v36
v_cvt_pk_bf16_f32 v17, v17, v37
v_cvt_pk_bf16_f32 v18, v18, v38
v_cvt_pk_bf16_f32 v19, v19, v39
v_cvt_pk_bf16_f32 v20, v20, v40
v_cvt_pk_bf16_f32 v21, v21, v41
v_cvt_pk_bf16_f32 v22, v22, v42
v_cvt_pk_bf16_f32 v23, v23, v43
v_cvt_pk_bf16_f32 v24, v24, v44
v_cvt_pk_bf16_f32 v25, v25, v45
v_mov_b32 v8, 0
v_mov_b32 v9, 0
v_mov_b32 v10, 0
v_mov_b32 v11, 0
v_mov_b32 v12, 0
v_mov_b32 v13, 0
v_mov_b32 v14, 0
v_mov_b32 v15, 0
v_perm_b32 v28, v236, v232, s80
v_perm_b32 v29, v236, v232, s81
v_perm_b32 v30, v237, v233, s80
v_perm_b32 v31, v237, v233, s81
v_perm_b32 v32, v238, v234, s80
v_perm_b32 v33, v238, v234, s81
v_perm_b32 v34, v239, v235, s80
v_perm_b32 v35, v239, v235, s81
v_dot2c_f32_bf16_dpp v8, v16, v28 row_newbcast:0
v_dot2c_f32_bf16_dpp v9, v16, v29 row_newbcast:0
v_dot2c_f32_bf16_dpp v10, v16, v30 row_newbcast:0
v_dot2c_f32_bf16_dpp v11, v16, v31 row_newbcast:0
v_dot2c_f32_bf16_dpp v12, v16, v32 row_newbcast:0
v_dot2c_f32_bf16_dpp v13, v16, v33 row_newbcast:0
v_dot2c_f32_bf16_dpp v14, v16, v34 row_newbcast:0
v_dot2c_f32_bf16_dpp v15, v16, v35 row_newbcast:0
s_add_u32 s56, s52, 32768
buffer_load_dwordx4 v[232:235], v1, s[8:11], s56 offen offset:2048
s_waitcnt vmcnt(3)
s_add_u32 s56, s52, 32768
buffer_load_dwordx4 v[236:239], v1, s[8:11], s56 offen offset:3072
s_waitcnt vmcnt(3)
v_perm_b32 v28, v244, v240, s80
v_perm_b32 v29, v244, v240, s81
v_perm_b32 v30, v245, v241, s80
v_perm_b32 v31, v245, v241, s81
v_perm_b32 v32, v246, v242, s80
v_perm_b32 v33, v246, v242, s81
v_perm_b32 v34, v247, v243, s80
v_perm_b32 v35, v247, v243, s81
v_dot2c_f32_bf16_dpp v8, v16, v28 row_newbcast:8
v_dot2c_f32_bf16_dpp v9, v16, v29 row_newbcast:8
v_dot2c_f32_bf16_dpp v10, v16, v30 row_newbcast:8
v_dot2c_f32_bf16_dpp v11, v16, v31 row_newbcast:8
v_dot2c_f32_bf16_dpp v12, v16, v32 row_newbcast:8
v_dot2c_f32_bf16_dpp v13, v16, v33 row_newbcast:8
v_dot2c_f32_bf16_dpp v14, v16, v34 row_newbcast:8
v_dot2c_f32_bf16_dpp v15, v16, v35 row_newbcast:8
s_add_u32 s56, s52, 65536
buffer_load_dwordx4 v[240:243], v1, s[8:11], s56 offen offset:0
s_waitcnt vmcnt(3)
s_add_u32 s56, s52, 65536
buffer_load_dwordx4 v[244:247], v1, s[8:11], s56 offen offset:1024
s_waitcnt vmcnt(3)
v_perm_b32 v28, v252, v248, s80
v_perm_b32 v29, v252, v248, s81
v_perm_b32 v30, v253, v249, s80
v_perm_b32 v31, v253, v249, s81
v_perm_b32 v32, v254, v250, s80
v_perm_b32 v33, v254, v250, s81
v_perm_b32 v34, v255, v251, s80
v_perm_b32 v35, v255, v251, s81
v_dot2c_f32_bf16_dpp v8, v17, v28 row_newbcast:0
v_dot2c_f32_bf16_dpp v9, v17, v29 row_newbcast:0
v_dot2c_f32_bf16_dpp v10, v17, v30 row_newbcast:0
v_dot2c_f32_bf16_dpp v11, v17, v31 row_newbcast:0
v_dot2c_f32_bf16_dpp v12, v17, v32 row_newbcast:0
v_dot2c_f32_bf16_dpp v13, v17, v33 row_newbcast:0
v_dot2c_f32_bf16_dpp v14, v17, v34 row_newbcast:0
v_dot2c_f32_bf16_dpp v15, v17, v35 row_newbcast:0
s_add_u32 s56, s52, 65536
buffer_load_dwordx4 v[248:251], v1, s[8:11], s56 offen offset:2048
s_waitcnt vmcnt(3)
s_add_u32 s56, s52, 65536
buffer_load_dwordx4 v[252:255], v1, s[8:11], s56 offen offset:3072
s_waitcnt vmcnt(3)
v_perm_b32 v28, v236, v232, s80
v_perm_b32 v29, v236, v232, s81
v_perm_b32 v30, v237, v233, s80
v_perm_b32 v31, v237, v233, s81
v_perm_b32 v32, v238, v234, s80
v_perm_b32 v33, v238, v234, s81
v_perm_b32 v34, v239, v235, s80
v_perm_b32 v35, v239, v235, s81
v_dot2c_f32_bf16_dpp v8, v17, v28 row_newbcast:8
v_dot2c_f32_bf16_dpp v9, v17, v29 row_newbcast:8
v_dot2c_f32_bf16_dpp v10, v17, v30 row_newbcast:8
v_dot2c_f32_bf16_dpp v11, v17, v31 row_newbcast:8
v_dot2c_f32_bf16_dpp v12, v17, v32 row_newbcast:8
v_dot2c_f32_bf16_dpp v13, v17, v33 row_newbcast:8
v_dot2c_f32_bf16_dpp v14, v17, v34 row_newbcast:8
v_dot2c_f32_bf16_dpp v15, v17, v35 row_newbcast:8
s_add_u32 s56, s52, 98304
buffer_load_dwordx4 v[232:235], v1, s[8:11], s56 offen offset:0
s_waitcnt vmcnt(3)
s_add_u32 s56, s52, 98304
buffer_load_dwordx4 v[236:239], v1, s[8:11], s56 offen offset:1024
s_waitcnt vmcnt(3)
v_perm_b32 v28, v244, v240, s80
v_perm_b32 v29, v244, v240, s81
v_perm_b32 v30, v245, v241, s80
v_perm_b32 v31, v245, v241, s81
v_perm_b32 v32, v246, v242, s80
v_perm_b32 v33, v246, v242, s81
v_perm_b32 v34, v247, v243, s80
v_perm_b32 v35, v247, v243, s81
v_dot2c_f32_bf16_dpp v8, v18, v28 row_newbcast:0
v_dot2c_f32_bf16_dpp v9, v18, v29 row_newbcast:0
v_dot2c_f32_bf16_dpp v10, v18, v30 row_newbcast:0
v_dot2c_f32_bf16_dpp v11, v18, v31 row_newbcast:0
v_dot2c_f32_bf16_dpp v12, v18, v32 row_newbcast:0
v_dot2c_f32_bf16_dpp v13, v18, v33 row_newbcast:0
v_dot2c_f32_bf16_dpp v14, v18, v34 row_newbcast:0
v_dot2c_f32_bf16_dpp v15, v18, v35 row_newbcast:0
s_add_u32 s56, s52, 98304
buffer_load_dwordx4 v[240:243], v1, s[8:11], s56 offen offset:2048
s_waitcnt vmcnt(3)
s_add_u32 s56, s52, 98304
buffer_load_dwordx4 v[244:247], v1, s[8:11], s56 offen offset:3072
s_waitcnt vmcnt(3)
v_perm_b32 v28, v252, v248, s80
v_perm_b32 v29, v252, v248, s81
v_perm_b32 v30, v253, v249, s80
v_perm_b32 v31, v253, v249, s81
v_perm_b32 v32, v254, v250, s80
v_perm_b32 v33, v254, v250, s81
v_perm_b32 v34, v255, v251, s80
v_perm_b32 v35, v255, v251, s81
v_dot2c_f32_bf16_dpp v8, v18, v28 row_newbcast:8
v_dot2c_f32_bf16_dpp v9, v18, v29 row_newbcast:8
v_dot2c_f32_bf16_dpp v10, v18, v30 row_newbcast:8
v_dot2c_f32_bf16_dpp v11, v18, v31 row_newbcast:8
v_dot2c_f32_bf16_dpp v12, v18, v32 row_newbcast:8
v_dot2c_f32_bf16_dpp v13, v18, v33 row_newbcast:8
v_dot2c_f32_bf16_dpp v14, v18, v34 row_newbcast:8
v_dot2c_f32_bf16_dpp v15, v18, v35 row_newbcast:8
s_add_u32 s56, s52, 131072
buffer_load_dwordx4 v[248:251], v1, s[8:11], s56 offen offset:0
s_waitcnt vmcnt(3)
s_add_u32 s56, s52, 131072
buffer_load_dwordx4 v[252:255], v1, s[8:11], s56 offen offset:1024
s_waitcnt vmcnt(3)
v_perm_b32 v28, v236, v232, s80
v_perm_b32 v29, v236, v232, s81
v_perm_b32 v30, v237, v233, s80
v_perm_b32 v31, v237, v233, s81
v_perm_b32 v32, v238, v234, s80
v_perm_b32 v33, v238, v234, s81
v_perm_b32 v34, v239, v235, s80
v_perm_b32 v35, v239, v235, s81
v_dot2c_f32_bf16_dpp v8, v19, v28 row_newbcast:0
v_dot2c_f32_bf16_dpp v9, v19, v29 row_newbcast:0
v_dot2c_f32_bf16_dpp v10, v19, v30 row_newbcast:0
v_dot2c_f32_bf16_dpp v11, v19, v31 row_newbcast:0
v_dot2c_f32_bf16_dpp v12, v19, v32 row_newbcast:0
v_dot2c_f32_bf16_dpp v13, v19, v33 row_newbcast:0
v_dot2c_f32_bf16_dpp v14, v19, v34 row_newbcast:0
v_dot2c_f32_bf16_dpp v15, v19, v35 row_newbcast:0
s_add_u32 s56, s52, 131072
buffer_load_dwordx4 v[232:235], v1, s[8:11], s56 offen offset:2048
s_waitcnt vmcnt(3)
s_add_u32 s56, s52, 131072
buffer_load_dwordx4 v[236:239], v1, s[8:11], s56 offen offset:3072
s_waitcnt vmcnt(3)
v_perm_b32 v28, v244, v240, s80
v_perm_b32 v29, v244, v240, s81
v_perm_b32 v30, v245, v241, s80
v_perm_b32 v31, v245, v241, s81
v_perm_b32 v32, v246, v242, s80
v_perm_b32 v33, v246, v242, s81
v_perm_b32 v34, v247, v243, s80
v_perm_b32 v35, v247, v243, s81
v_dot2c_f32_bf16_dpp v8, v19, v28 row_newbcast:8
v_dot2c_f32_bf16_dpp v9, v19, v29 row_newbcast:8
v_dot2c_f32_bf16_dpp v10, v19, v30 row_newbcast:8
v_dot2c_f32_bf16_dpp v11, v19, v31 row_newbcast:8
v_dot2c_f32_bf16_dpp v12, v19, v32 row_newbcast:8
v_dot2c_f32_bf16_dpp v13, v19, v33 row_newbcast:8
v_dot2c_f32_bf16_dpp v14, v19, v34 row_newbcast:8
v_dot2c_f32_bf16_dpp v15, v19, v35 row_newbcast:8
s_add_u32 s56, s52, 163840
buffer_load_dwordx4 v[240:243], v1, s[8:11], s56 offen offset:0 nt
s_waitcnt vmcnt(3)
s_add_u32 s56, s52, 163840
buffer_load_dwordx4 v[244:247], v1, s[8:11], s56 offen offset:1024 nt
s_waitcnt vmcnt(3)
v_and_b32 v32, 31, v3
v_lshlrev_b32 v32, 5, v32
s_lshl_b32 s56, s49, 10
s_add_u32 s56, s56, 0x410000
buffer_load_dwordx4 v[56:59], v32, s[44:47], s56 offen offset:0 sc1
buffer_load_dwordx4 v[60:63], v32, s[44:47], s56 offen offset:16 sc1
v_perm_b32 v28, v252, v248, s80
v_perm_b32 v29, v252, v248, s81
v_perm_b32 v30, v253, v249, s80
v_perm_b32 v31, v253, v249, s81
v_perm_b32 v32, v254, v250, s80
v_perm_b32 v33, v254, v250, s81
v_perm_b32 v34, v255, v251, s80
v_perm_b32 v35, v255, v251, s81
v_dot2c_f32_bf16_dpp v8, v20, v28 row_newbcast:0
v_dot2c_f32_bf16_dpp v9, v20, v29 row_newbcast:0
v_dot2c_f32_bf16_dpp v10, v20, v30 row_newbcast:0
v_dot2c_f32_bf16_dpp v11, v20, v31 row_newbcast:0
v_dot2c_f32_bf16_dpp v12, v20, v32 row_newbcast:0
v_dot2c_f32_bf16_dpp v13, v20, v33 row_newbcast:0
v_dot2c_f32_bf16_dpp v14, v20, v34 row_newbcast:0
v_dot2c_f32_bf16_dpp v15, v20, v35 row_newbcast:0
s_waitcnt vmcnt(3)
s_add_u32 s56, s52, 163840
buffer_load_dwordx4 v[248:251], v1, s[8:11], s56 offen offset:2048 nt
s_waitcnt vmcnt(3)
s_add_u32 s56, s52, 163840
buffer_load_dwordx4 v[252:255], v1, s[8:11], s56 offen offset:3072 nt
v_perm_b32 v28, v236, v232, s80
v_perm_b32 v29, v236, v232, s81
v_perm_b32 v30, v237, v233, s80
v_perm_b32 v31, v237, v233, s81
v_perm_b32 v32, v238, v234, s80
v_perm_b32 v33, v238, v234, s81
v_perm_b32 v34, v239, v235, s80
v_perm_b32 v35, v239, v235, s81
v_dot2c_f32_bf16_dpp v8, v20, v28 row_newbcast:8
v_dot2c_f32_bf16_dpp v9, v20, v29 row_newbcast:8
v_dot2c_f32_bf16_dpp v10, v20, v30 row_newbcast:8
v_dot2c_f32_bf16_dpp v11, v20, v31 row_newbcast:8
v_dot2c_f32_bf16_dpp v12, v20, v32 row_newbcast:8
v_dot2c_f32_bf16_dpp v13, v20, v33 row_newbcast:8
v_dot2c_f32_bf16_dpp v14, v20, v34 row_newbcast:8
v_dot2c_f32_bf16_dpp v15, v20, v35 row_newbcast:8
s_waitcnt vmcnt(3)
s_add_u32 s56, s52, 196608
buffer_load_dwordx4 v[232:235], v1, s[8:11], s56 offen offset:0 nt
s_waitcnt vmcnt(3)
s_add_u32 s56, s52, 196608
buffer_load_dwordx4 v[236:239], v1, s[8:11], s56 offen offset:1024 nt
v_mov_b32 v76, v8
v_mov_b32 v77, v9
v_mov_b32 v78, v10
v_mov_b32 v79, v11
v_mov_b32 v80, v12
v_mov_b32 v81, v13
v_mov_b32 v82, v14
v_mov_b32 v83, v15
v_mov_b32 v64, v16
v_mov_b32 v65, v17
v_mov_b32 v66, v18
v_mov_b32 v67, v19
v_mov_b32 v68, v20
v_mov_b32 v69, v21
v_mov_b32 v70, v22
v_mov_b32 v71, v23
v_mov_b32 v72, v24
v_mov_b32 v73, v25
v_mov_b32 v74, v26
v_mov_b32 v75, v27
v_and_b32 v28, v56, v57
v_and_b32 v28, v28, v58
v_and_b32 v28, v28, v59
v_and_b32 v28, v28, v60
v_and_b32 v28, v28, v61
v_and_b32 v28, v28, v62
v_and_b32 v28, v28, v63
v_and_b32 v28, 1, v28
v_cmp_ne_u32 vcc, 1, v28
s_cbranch_vccz L_qburst_237
s_mov_b32 s60, 0
L_p_q_239:
s_nop 4
v_and_b32 v32, 31, v3
v_lshlrev_b32 v32, 5, v32
s_lshl_b32 s56, s49, 10
s_add_u32 s56, s56, 0x410000
buffer_load_dwordx4 v[56:59], v32, s[44:47], s56 offen offset:0 sc1
buffer_load_dwordx4 v[60:63], v32, s[44:47], s56 offen offset:16 sc1
s_waitcnt vmcnt(0)
v_and_b32 v28, v56, v57
v_and_b32 v28, v28, v58
v_and_b32 v28, v28, v59
v_and_b32 v28, v28, v60
v_and_b32 v28, v28, v61
v_and_b32 v28, v28, v62
v_and_b32 v28, v28, v63
v_and_b32 v28, 1, v28
v_cmp_ne_u32 vcc, 1, v28
s_cbranch_vccz L_d_q_240
s_sleep 1
s_add_u32 s60, s60, 1
s_cmp_lt_u32 s60, 400000
s_cbranch_scc1 L_p_q_239
s_endpgm
L_d_q_240:
s_nop 4
s_branch L_qjoin_238
L_qburst_237:
s_nop 4
L_qjoin_238:
s_nop 4
s_mov_b32 s56, 0x07060302
v_perm_b32 v4, v57, v56, s56
v_perm_b32 v5, v59, v58, s56
v_perm_b32 v6, v61, v60, s56
v_perm_b32 v7, v63, v62, s56
ds_read_b128 v[36:39], v2 offset:0
ds_read_b128 v[40:43], v2 offset:1024
ds_read_b128 v[44:47], v2 offset:2048
ds_read_b128 v[48:51], v2 offset:3072
s_waitcnt lgkmcnt(0)
v_dot2_f32_bf16 v28, v36, v4, 0
v_dot2_f32_bf16 v29, v40, v4, 0
v_dot2_f32_bf16 v30, v44, v4, 0
v_dot2_f32_bf16 v31, v48, v4, 0
v_dot2_f32_bf16 v28, v37, v5, v28
v_dot2_f32_bf16 v29, v41, v5, v29
v_dot2_f32_bf16 v30, v45, v5, v30
v_dot2_f32_bf16 v31, v49, v5, v31
v_dot2_f32_bf16 v28, v38, v6, v28
v_dot2_f32_bf16 v29, v42, v6, v29
v_dot2_f32_bf16 v30, v46, v6, v30
v_dot2_f32_bf16 v31, v50, v6, v31
v_dot2_f32_bf16 v28, v39, v7, v28
v_dot2_f32_bf16 v29, v43, v7, v29
v_dot2_f32_bf16 v30, v47, v7, v30
v_dot2_f32_bf16 v31, v51, v7, v31
s_nop 0
v_permlane16_swap_b32 v28, v29
s_nop 0
v_permlane16_swap_b32 v30, v31
v_add_f32 v28, v28, v29
v_add_f32 v30, v30, v31
s_nop 0
v_add_f32_dpp v16, v28, v28 row_ror:8 row_mask:0xf bank_mask:0x3
v_add_f32_dpp v16, v30, v30 row_ror:8 row_mask:0xf bank_mask:0xc
s_add_u32 m0, s53, 0
s_add_u32 s56, s52, 198656
buffer_load_dwordx4 v1, s[8:11], s56 offen nt lds
s_add_u32 m0, s53, 1024
s_add_u32 s56, s52, 199680
buffer_load_dwordx4 v1, s[8:11], s56 offen nt lds
s_add_u32 m0, s53, 2048
s_add_u32 s56, s52, 229376
buffer_load_dwordx4 v1, s[8:11], s56 offen nt lds
s_add_u32 m0, s53, 3072
s_add_u32 s56, s52, 230400
buffer_load_dwordx4 v1, s[8:11], s56 offen nt lds
ds_read_b128 v[36:39], v2 offset:4096
ds_read_b128 v[40:43], v2 offset:5120
ds_read_b128 v[44:47], v2 offset:6144
ds_read_b128 v[48:51], v2 offset:7168
s_waitcnt lgkmcnt(0)
v_dot2_f32_bf16 v28, v36, v4, 0
v_dot2_f32_bf16 v29, v40, v4, 0
v_dot2_f32_bf16 v30, v44, v4, 0
v_dot2_f32_bf16 v31, v48, v4, 0
v_dot2_f32_bf16 v28, v37, v5, v28
v_dot2_f32_bf16 v29, v41, v5, v29
v_dot2_f32_bf16 v30, v45, v5, v30
v_dot2_f32_bf16 v31, v49, v5, v31
v_dot2_f32_bf16 v28, v38, v6, v28
v_dot2_f32_bf16 v29, v42, v6, v29
v_dot2_f32_bf16 v30, v46, v6, v30
v_dot2_f32_bf16 v31, v50, v6, v31
v_dot2_f32_bf16 v28, v39, v7, v28
v_dot2_f32_bf16 v29, v43, v7, v29
v_dot2_f32_bf16 v30, v47, v7, v30
v_dot2_f32_bf16 v31, v51, v7, v31
s_nop 0
v_permlane16_swap_b32 v28, v29
s_nop 0
v_permlane16_swap_b32 v30, v31
v_add_f32 v28, v28, v29
v_add_f32 v30, v30, v31
s_nop 0
v_add_f32_dpp v17, v28, v28 row_ror:8 row_mask:0xf bank_mask:0x3
v_add_f32_dpp v17, v30, v30 row_ror:8 row_mask:0xf bank_mask:0xc
s_add_u32 m0, s53, 4096
s_add_u32 s56, s52, 231424
buffer_load_dwordx4 v1, s[8:11], s56 offen nt lds
s_add_u32 m0, s53, 5120
s_add_u32 s56, s52, 232448
buffer_load_dwordx4 v1, s[8:11], s56 offen nt lds
s_add_u32 m0, s53, 6144
s_add_u32 s56, s52, 262144
buffer_load_dwordx4 v1, s[8:11], s56 offen nt lds
s_add_u32 m0, s53, 7168
s_add_u32 s56, s52, 263168
buffer_load_dwordx4 v1, s[8:11], s56 offen nt lds
ds_read_b128 v[36:39], v2 offset:8192
ds_read_b128 v[40:43], v2 offset:9216
ds_read_b128 v[44:47], v2 offset:10240
ds_read_b128 v[48:51], v2 offset:11264
s_waitcnt lgkmcnt(0)
v_dot2_f32_bf16 v28, v36, v4, 0
v_dot2_f32_bf16 v29, v40, v4, 0
v_dot2_f32_bf16 v30, v44, v4, 0
v_dot2_f32_bf16 v31, v48, v4, 0
v_dot2_f32_bf16 v28, v37, v5, v28
v_dot2_f32_bf16 v29, v41, v5, v29
v_dot2_f32_bf16 v30, v45, v5, v30
v_dot2_f32_bf16 v31, v49, v5, v31
v_dot2_f32_bf16 v28, v38, v6, v28
v_dot2_f32_bf16 v29, v42, v6, v29
v_dot2_f32_bf16 v30, v46, v6, v30
v_dot2_f32_bf16 v31, v50, v6, v31
v_dot2_f32_bf16 v28, v39, v7, v28
v_dot2_f32_bf16 v29, v43, v7, v29
v_dot2_f32_bf16 v30, v47, v7, v30
v_dot2_f32_bf16 v31, v51, v7, v31
s_nop 0
v_permlane16_swap_b32 v28, v29
s_nop 0
v_permlane16_swap_b32 v30, v31
v_add_f32 v28, v28, v29
v_add_f32 v30, v30, v31
s_nop 0
v_add_f32_dpp v18, v28, v28 row_ror:8 row_mask:0xf bank_mask:0x3
v_add_f32_dpp v18, v30, v30 row_ror:8 row_mask:0xf bank_mask:0xc
ds_read_b128 v[36:39], v2 offset:12288
ds_read_b128 v[40:43], v2 offset:13312
ds_read_b128 v[44:47], v2 offset:14336
ds_read_b128 v[48:51], v2 offset:15360
s_waitcnt lgkmcnt(0)
v_dot2_f32_bf16 v28, v36, v4, 0
v_dot2_f32_bf16 v29, v40, v4, 0
v_dot2_f32_bf16 v30, v44, v4, 0
v_dot2_f32_bf16 v31, v48, v4, 0
v_dot2_f32_bf16 v28, v37, v5, v28
v_dot2_f32_bf16 v29, v41, v5, v29
v_dot2_f32_bf16 v30, v45, v5, v30
v_dot2_f32_bf16 v31, v49, v5, v31
v_dot2_f32_bf16 v28, v38, v6, v28
v_dot2_f32_bf16 v29, v42, v6, v29
v_dot2_f32_bf16 v30, v46, v6, v30
v_dot2_f32_bf16 v31, v50, v6, v31
v_dot2_f32_bf16 v28, v39, v7, v28
v_dot2_f32_bf16 v29, v43, v7, v29
v_dot2_f32_bf16 v30, v47, v7, v30
v_dot2_f32_bf16 v31, v51, v7, v31
s_nop 0
v_permlane16_swap_b32 v28, v29
s_nop 0
v_permlane16_swap_b32 v30, v31
v_add_f32 v28, v28, v29
v_add_f32 v30, v30, v31
s_nop 0
v_add_f32_dpp v19, v28, v28 row_ror:8 row_mask:0xf bank_mask:0x3
v_add_f32_dpp v19, v30, v30 row_ror:8 row_mask:0xf bank_mask:0xc
ds_read_b128 v[36:39], v2 offset:16384
s_waitcnt lgkmcnt(0)
v_dot2_f32_bf16 v28, v36, v4, 0
v_dot2_f32_bf16 v29, v84, v4, 0
v_dot2_f32_bf16 v30, v88, v4, 0
v_dot2_f32_bf16 v31, v92, v4, 0
v_dot2_f32_bf16 v28, v37, v5, v28
v_dot2_f32_bf16 v29, v85, v5, v29
v_dot2_f32_bf16 v30, v89, v5, v30
v_dot2_f32_bf16 v31, v93, v5, v31
v_dot2_f32_bf16 v28, v38, v6, v28
v_dot2_f32_bf16 v29, v86, v6, v29
v_dot2_f32_bf16 v30, v90, v6, v30
v_dot2_f32_bf16 v31, v94, v6, v31
v_dot2_f32_bf16 v28, v39, v7, v28
v_dot2_f32_bf16 v29, v87, v7, v29
v_dot2_f32_bf16 v30, v91, v7, v30
v_dot2_f32_bf16 v31, v95, v7, v31
s_nop 0
v_permlane16_swap_b32 v28, v29
s_nop 0
v_permlane16_swap_b32 v30, v31
v_add_f32 v28, v28, v29
v_add_f32 v30, v30, v31
s_nop 0
v_add_f32_dpp v20, v28, v28 row_ror:8 row_mask:0xf bank_mask:0x3
v_add_f32_dpp v20, v30, v30 row_ror:8 row_mask:0xf bank_mask:0xc
v_dot2_f32_bf16 v28, v96, v4, 0
v_dot2_f32_bf16 v29, v100, v4, 0
v_dot2_f32_bf16 v30, v104, v4, 0
v_dot2_f32_bf16 v31, v108, v4, 0
v_dot2_f32_bf16 v28, v97, v5, v28
v_dot2_f32_bf16 v29, v101, v5, v29
v_dot2_f32_bf16 v30, v105, v5, v30
v_dot2_f32_bf16 v31, v109, v5, v31
v_dot2_f32_bf16 v28, v98, v6, v28
v_dot2_f32_bf16 v29, v102, v6, v29
v_dot2_f32_bf16 v30, v106, v6, v30
v_dot2_f32_bf16 v31, v110, v6, v31
v_dot2_f32_bf16 v28, v99, v7, v28
v_dot2_f32_bf16 v29, v103, v7, v29
v_dot2_f32_bf16 v30, v107, v7, v30
v_dot2_f32_bf16 v31, v111, v7, v31
s_nop 0
v_permlane16_swap_b32 v28, v29
s_nop 0
v_permlane16_swap_b32 v30, v31
v_add_f32 v28, v28, v29
v_add_f32 v30, v30, v31
s_nop 0
v_add_f32_dpp v21, v28, v28 row_ror:8 row_mask:0xf bank_mask:0x3
v_add_f32_dpp v21, v30, v30 row_ror:8 row_mask:0xf bank_mask:0xc
v_dot2_f32_bf16 v28, v112, v4, 0
v_dot2_f32_bf16 v29, v116, v4, 0
v_dot2_f32_bf16 v30, v120, v4, 0
v_dot2_f32_bf16 v31, v124, v4, 0
v_dot2_f32_bf16 v28, v113, v5, v28
v_dot2_f32_bf16 v29, v117, v5, v29
v_dot2_f32_bf16 v30, v121, v5, v30
v_dot2_f32_bf16 v31, v125, v5, v31
v_dot2_f32_bf16 v28, v114, v6, v28
v_dot2_f32_bf16 v29, v118, v6, v29
v_dot2_f32_bf16 v30, v122, v6, v30
v_dot2_f32_bf16 v31, v126, v6, v31
v_dot2_f32_bf16 v28, v115, v7, v28
v_dot2_f32_bf16 v29, v119, v7, v29
v_dot2_f32_bf16 v30, v123, v7, v30
v_dot2_f32_bf16 v31, v127, v7, v31
s_nop 0
v_permlane16_swap_b32 v28, v29
s_nop 0
v_permlane16_swap_b32 v30, v31
v_add_f32 v28, v28, v29
v_add_f32 v30, v30, v31
s_nop 0
v_add_f32_dpp v22, v28, v28 row_ror:8 row_mask:0xf bank_mask:0x3
v_add_f32_dpp v22, v30, v30 row_ror:8 row_mask:0xf bank_mask:0xc
v_dot2_f32_bf16 v28, v128, v4, 0
v_dot2_f32_bf16 v29, v132, v4, 0
v_dot2_f32_bf16 v30, v136, v4, 0
v_dot2_f32_bf16 v31, v140, v4, 0
v_dot2_f32_bf16 v28, v129, v5, v28
v_dot2_f32_bf16 v29, v133, v5, v29
v_dot2_f32_bf16 v30, v137, v5, v30
v_dot2_f32_bf16 v31, v141, v5, v31
v_dot2_f32_bf16 v28, v130, v6, v28
v_dot2_f32_bf16 v29, v134, v6, v29
v_dot2_f32_bf16 v30, v138, v6, v30
v_dot2_f32_bf16 v31, v142, v6, v31
v_dot2_f32_bf16 v28, v131, v7, v28
v_dot2_f32_bf16 v29, v135, v7, v29
v_dot2_f32_bf16 v30, v139, v7, v30
v_dot2_f32_bf16 v31, v143, v7, v31
s_nop 0
v_permlane16_swap_b32 v28, v29
s_nop 0
v_permlane16_swap_b32 v30, v31
v_add_f32 v28, v28, v29
v_add_f32 v30, v30, v31
s_nop 0
v_add_f32_dpp v23, v28, v28 row_ror:8 row_mask:0xf bank_mask:0x3
v_add_f32_dpp v23, v30, v30 row_ror:8 row_mask:0xf bank_mask:0xc
v_dot2_f32_bf16 v28, v144, v4, 0
v_dot2_f32_bf16 v29, v148, v4, 0
v_dot2_f32_bf16 v30, v152, v4, 0
v_dot2_f32_bf16 v31, v156, v4, 0
v_dot2_f32_bf16 v28, v145, v5, v28
v_dot2_f32_bf16 v29, v149, v5, v29
v_dot2_f32_bf16 v30, v153, v5, v30
v_dot2_f32_bf16 v31, v157, v5, v31
v_dot2_f32_bf16 v28, v146, v6, v28
v_dot2_f32_bf16 v29, v150, v6, v29
v_dot2_f32_bf16 v30, v154, v6, v30
v_dot2_f32_bf16 v31, v158, v6, v31
v_dot2_f32_bf16 v28, v147, v7, v28
v_dot2_f32_bf16 v29, v151, v7, v29
v_dot2_f32_bf16 v30, v155, v7, v30
v_dot2_f32_bf16 v31, v159, v7, v31
s_nop 0
v_permlane16_swap_b32 v28, v29
s_nop 0
v_permlane16_swap_b32 v30, v31
v_add_f32 v28, v28, v29
v_add_f32 v30, v30, v31
s_nop 0
v_add_f32_dpp v24, v28, v28 row_ror:8 row_mask:0xf bank_mask:0x3
v_add_f32_dpp v24, v30, v30 row_ror:8 row_mask:0xf bank_mask:0xc
v_dot2_f32_bf16 v28, v160, v4, 0
v_dot2_f32_bf16 v29, v164, v4, 0
v_dot2_f32_bf16 v30, v168, v4, 0
v_dot2_f32_bf16 v31, v172, v4, 0
v_dot2_f32_bf16 v28, v161, v5, v28
v_dot2_f32_bf16 v29, v165, v5, v29
v_dot2_f32_bf16 v30, v169, v5, v30
v_dot2_f32_bf16 v31, v173, v5, v31
v_dot2_f32_bf16 v28, v162, v6, v28
v_dot2_f32_bf16 v29, v166, v6, v29
v_dot2_f32_bf16 v30, v170, v6, v30
v_dot2_f32_bf16 v31, v174, v6, v31
v_dot2_f32_bf16 v28, v163, v7, v28
v_dot2_f32_bf16 v29, v167, v7, v29
v_dot2_f32_bf16 v30, v171, v7, v30
v_dot2_f32_bf16 v31, v175, v7, v31
s_nop 0
v_permlane16_swap_b32 v28, v29
s_nop 0
v_permlane16_swap_b32 v30, v31
v_add_f32 v28, v28, v29
v_add_f32 v30, v30, v31
s_nop 0
v_add_f32_dpp v25, v28, v28 row_ror:8 row_mask:0xf bank_mask:0x3
v_add_f32_dpp v25, v30, v30 row_ror:8 row_mask:0xf bank_mask:0xc
v_add_f32_dpp v16, v16, v16 quad_perm:[1,0,3,2]
v_add_f32_dpp v17, v17, v17 quad_perm:[1,0,3,2]
v_add_f32_dpp v18, v18, v18 quad_perm:[1,0,3,2]
v_add_f32_dpp v19, v19, v19 quad_perm:[1,0,3,2]
v_add_f32_dpp v20, v20, v20 quad_perm:[1,0,3,2]
v_add_f32_dpp v21, v21, v21 quad_perm:[1,0,3,2]
v_add_f32_dpp v22, v22, v22 quad_perm:[1,0,3,2]
v_add_f32_dpp v23, v23, v23 quad_perm:[1,0,3,2]
v_add_f32_dpp v24, v24, v24 quad_perm:[1,0,3,2]
v_add_f32_dpp v25, v25, v25 quad_perm:[1,0,3,2]
v_add_f32_dpp v16, v16, v16 quad_perm:[2,3,0,1]
v_add_f32_dpp v17, v17, v17 quad_perm:[2,3,0,1]
v_add_f32_dpp v18, v18, v18 quad_perm:[2,3,0,1]
v_add_f32_dpp v19, v19, v19 quad_perm:[2,3,0,1]
v_add_f32_dpp v20, v20, v20 quad_perm:[2,3,0,1]
v_add_f32_dpp v21, v21, v21 quad_perm:[2,3,0,1]
v_add_f32_dpp v22, v22, v22 quad_perm:[2,3,0,1]
v_add_f32_dpp v23, v23, v23 quad_perm:[2,3,0,1]
v_add_f32_dpp v24, v24, v24 quad_perm:[2,3,0,1]
v_add_f32_dpp v25, v25, v25 quad_perm:[2,3,0,1]
v_add_f32_dpp v16, v16, v16 row_half_mirror
v_add_f32_dpp v17, v17, v17 row_half_mirror
v_add_f32_dpp v18, v18, v18 row_half_mirror
v_add_f32_dpp v19, v19, v19 row_half_mirror
v_add_f32_dpp v20, v20, v20 row_half_mirror
v_add_f32_dpp v21, v21, v21 row_half_mirror
v_add_f32_dpp v22, v22, v22 row_half_mirror
v_add_f32_dpp v23, v23, v23 row_half_mirror
v_add_f32_dpp v24, v24, v24 row_half_mirror
v_add_f32_dpp v25, v25, v25 row_half_mirror
v_cvt_pk_bf16_f32 v16, v16, v16
v_cvt_pk_bf16_f32 v17, v17, v17
v_cvt_pk_bf16_f32 v18, v18, v18
v_cvt_pk_bf16_f32 v19, v19, v19
v_cvt_pk_bf16_f32 v20, v20, v20
v_cvt_pk_bf16_f32 v21, v21, v21
v_cvt_pk_bf16_f32 v22, v22, v22
v_cvt_pk_bf16_f32 v23, v23, v23
v_cvt_pk_bf16_f32 v24, v24, v24
v_cvt_pk_bf16_f32 v25, v25, v25
v_and_b32 v16, s62, v16
v_and_b32 v17, s62, v17
v_and_b32 v18, s62, v18
v_and_b32 v19, s62, v19
v_and_b32 v20, s62, v20
v_and_b32 v21, s62, v21
v_and_b32 v22, s62, v22
v_and_b32 v23, s62, v23
v_and_b32 v24, s62, v24
v_and_b32 v25, s62, v25
v_mul_f32 v16, 0x3d800000, v16
v_mul_f32 v17, 0x3d800000, v17
v_mul_f32 v18, 0x3d800000, v18
v_mul_f32 v19, 0x3d800000, v19
v_mul_f32 v20, 0x3d800000, v20
v_mul_f32 v21, 0x3d800000, v21
v_mul_f32 v22, 0x3d800000, v22
v_mul_f32 v23, 0x3d800000, v23
v_mul_f32 v24, 0x3d800000, v24
v_mul_f32 v25, 0x3d800000, v25
v_max_f32 v26, v16, v17
v_max_f32 v26, v26, v18
v_max_f32 v26, v26, v19
v_max_f32 v26, v26, v20
v_max_f32 v26, v26, v21
v_max_f32 v26, v26, v22
v_max_f32 v26, v26, v23
v_max_f32 v26, v26, v24
v_max_f32 v26, v26, v25
s_nop 1
v_max_f32_dpp v26, v26, v26 row_ror:8
v_mov_b32 v28, v26
s_nop 1
v_permlane16_swap_b32 v26, v28
v_max_f32 v26, v26, v28
v_mov_b32 v28, v26
s_nop 1
v_permlane32_swap_b32 v26, v28
v_max_f32 v26, v26, v28
v_sub_f32 v16, v16, v26
v_sub_f32 v17, v17, v26
v_sub_f32 v18, v18, v26
v_sub_f32 v19, v19, v26
v_sub_f32 v20, v20, v26
v_sub_f32 v21, v21, v26
v_sub_f32 v22, v22, v26
v_sub_f32 v23, v23, v26
v_sub_f32 v24, v24, v26
v_sub_f32 v25, v25, v26
v_mul_f32 v16, 0x3fb8aa3b, v16
v_mul_f32 v17, 0x3fb8aa3b, v17
v_mul_f32 v18, 0x3fb8aa3b, v18
v_mul_f32 v19, 0x3fb8aa3b, v19
v_mul_f32 v20, 0x3fb8aa3b, v20
v_mul_f32 v21, 0x3fb8aa3b, v21
v_mul_f32 v22, 0x3fb8aa3b, v22
v_mul_f32 v23, 0x3fb8aa3b, v23
v_mul_f32 v24, 0x3fb8aa3b, v24
v_mul_f32 v25, 0x3fb8aa3b, v25
v_exp_f32 v16, v16
v_exp_f32 v17, v17
v_exp_f32 v18, v18
v_exp_f32 v19, v19
v_exp_f32 v20, v20
v_exp_f32 v21, v21
v_exp_f32 v22, v22
v_exp_f32 v23, v23
v_exp_f32 v24, v24
v_exp_f32 v25, v25
v_add_f32 v27, v16, v17
v_add_f32 v27, v27, v18
v_add_f32 v27, v27, v19
v_add_f32 v27, v27, v20
v_add_f32 v27, v27, v21
v_add_f32 v27, v27, v22
v_add_f32 v27, v27, v23
v_add_f32 v27, v27, v24
v_add_f32 v27, v27, v25
s_nop 1
v_add_f32_dpp v27, v27, v27 row_ror:8
v_mov_b32 v28, v27
s_nop 1
v_permlane16_swap_b32 v27, v28
v_add_f32 v27, v27, v28
v_mov_b32 v28, v27
s_nop 1
v_permlane32_swap_b32 v27, v28
v_add_f32 v27, v27, v28
v_mov_b32 v36, v16
v_mov_b32 v37, v17
v_mov_b32 v38, v18
v_mov_b32 v39, v19
v_mov_b32 v40, v20
v_mov_b32 v41, v21
v_mov_b32 v42, v22
v_mov_b32 v43, v23
v_mov_b32 v44, v24
v_mov_b32 v45, v25
v_permlane16_swap_b32 v16, v36
v_permlane16_swap_b32 v17, v37
v_permlane16_swap_b32 v18, v38
v_permlane16_swap_b32 v19, v39
v_permlane16_swap_b32 v20, v40
v_permlane16_swap_b32 v21, v41
v_permlane16_swap_b32 v22, v42
v_permlane16_swap_b32 v23, v43
v_permlane16_swap_b32 v24, v44
v_permlane16_swap_b32 v25, v45
v_cvt_pk_bf16_f32 v16, v16, v36
v_cvt_pk_bf16_f32 v17, v17, v37
v_cvt_pk_bf16_f32 v18, v18, v38
v_cvt_pk_bf16_f32 v19, v19, v39
v_cvt_pk_bf16_f32 v20, v20, v40
v_cvt_pk_bf16_f32 v21, v21, v41
v_cvt_pk_bf16_f32 v22, v22, v42
v_cvt_pk_bf16_f32 v23, v23, v43
v_cvt_pk_bf16_f32 v24, v24, v44
v_cvt_pk_bf16_f32 v25, v25, v45
v_mov_b32 v8, 0
v_mov_b32 v9, 0
v_mov_b32 v10, 0
v_mov_b32 v11, 0
v_mov_b32 v12, 0
v_mov_b32 v13, 0
v_mov_b32 v14, 0
v_mov_b32 v15, 0
v_perm_b32 v28, v180, v176, s80
v_perm_b32 v29, v180, v176, s81
v_perm_b32 v30, v181, v177, s80
v_perm_b32 v31, v181, v177, s81
v_perm_b32 v32, v182, v178, s80
v_perm_b32 v33, v182, v178, s81
v_perm_b32 v34, v183, v179, s80
v_perm_b32 v35, v183, v179, s81
v_dot2c_f32_bf16_dpp v8, v16, v28 row_newbcast:0
v_dot2c_f32_bf16_dpp v9, v16, v29 row_newbcast:0
v_dot2c_f32_bf16_dpp v10, v16, v30 row_newbcast:0
v_dot2c_f32_bf16_dpp v11, v16, v31 row_newbcast:0
v_dot2c_f32_bf16_dpp v12, v16, v32 row_newbcast:0
v_dot2c_f32_bf16_dpp v13, v16, v33 row_newbcast:0
v_dot2c_f32_bf16_dpp v14, v16, v34 row_newbcast:0
v_dot2c_f32_bf16_dpp v15, v16, v35 row_newbcast:0
v_perm_b32 v28, v188, v184, s80
v_perm_b32 v29, v188, v184, s81
v_perm_b32 v30, v189, v185, s80
v_perm_b32 v31, v189, v185, s81
v_perm_b32 v32, v190, v186, s80
v_perm_b32 v33, v190, v186, s81
v_perm_b32 v34, v191, v187, s80
v_perm_b32 v35, v191, v187, s81
v_dot2c_f32_bf16_dpp v8, v16, v28 row_newbcast:8
v_dot2c_f32_bf16_dpp v9, v16, v29 row_newbcast:8
v_dot2c_f32_bf16_dpp v10, v16, v30 row_newbcast:8
v_dot2c_f32_bf16_dpp v11, v16, v31 row_newbcast:8
v_dot2c_f32_bf16_dpp v12, v16, v32 row_newbcast:8
v_dot2c_f32_bf16_dpp v13, v16, v33 row_newbcast:8
v_dot2c_f32_bf16_dpp v14, v16, v34 row_newbcast:8
v_dot2c_f32_bf16_dpp v15, v16, v35 row_newbcast:8
v_perm_b32 v28, v196, v192, s80
v_perm_b32 v29, v196, v192, s81
v_perm_b32 v30, v197, v193, s80
v_perm_b32 v31, v197, v193, s81
v_perm_b32 v32, v198, v194, s80
v_perm_b32 v33, v198, v194, s81
v_perm_b32 v34, v199, v195, s80
v_perm_b32 v35, v199, v195, s81
v_dot2c_f32_bf16_dpp v8, v17, v28 row_newbcast:0
v_dot2c_f32_bf16_dpp v9, v17, v29 row_newbcast:0
v_dot2c_f32_bf16_dpp v10, v17, v30 row_newbcast:0
v_dot2c_f32_bf16_dpp v11, v17, v31 row_newbcast:0
v_dot2c_f32_bf16_dpp v12, v17, v32 row_newbcast:0
v_dot2c_f32_bf16_dpp v13, v17, v33 row_newbcast:0
v_dot2c_f32_bf16_dpp v14, v17, v34 row_newbcast:0
v_dot2c_f32_bf16_dpp v15, v17, v35 row_newbcast:0
v_perm_b32 v28, v204, v200, s80
v_perm_b32 v29, v204, v200, s81
v_perm_b32 v30, v205, v201, s80
v_perm_b32 v31, v205, v201, s81
v_perm_b32 v32, v206, v202, s80
v_perm_b32 v33, v206, v202, s81
v_perm_b32 v34, v207, v203, s80
v_perm_b32 v35, v207, v203, s81
v_dot2c_f32_bf16_dpp v8, v17, v28 row_newbcast:8
v_dot2c_f32_bf16_dpp v9, v17, v29 row_newbcast:8
v_dot2c_f32_bf16_dpp v10, v17, v30 row_newbcast:8
v_dot2c_f32_bf16_dpp v11, v17, v31 row_newbcast:8
v_dot2c_f32_bf16_dpp v12, v17, v32 row_newbcast:8
v_dot2c_f32_bf16_dpp v13, v17, v33 row_newbcast:8
v_dot2c_f32_bf16_dpp v14, v17, v34 row_newbcast:8
v_dot2c_f32_bf16_dpp v15, v17, v35 row_newbcast:8
v_perm_b32 v28, v212, v208, s80
v_perm_b32 v29, v212, v208, s81
v_perm_b32 v30, v213, v209, s80
v_perm_b32 v31, v213, v209, s81
v_perm_b32 v32, v214, v210, s80
v_perm_b32 v33, v214, v210, s81
v_perm_b32 v34, v215, v211, s80
v_perm_b32 v35, v215, v211, s81
v_dot2c_f32_bf16_dpp v8, v18, v28 row_newbcast:0
v_dot2c_f32_bf16_dpp v9, v18, v29 row_newbcast:0
v_dot2c_f32_bf16_dpp v10, v18, v30 row_newbcast:0
v_dot2c_f32_bf16_dpp v11, v18, v31 row_newbcast:0
v_dot2c_f32_bf16_dpp v12, v18, v32 row_newbcast:0
v_dot2c_f32_bf16_dpp v13, v18, v33 row_newbcast:0
v_dot2c_f32_bf16_dpp v14, v18, v34 row_newbcast:0
v_dot2c_f32_bf16_dpp v15, v18, v35 row_newbcast:0
v_perm_b32 v28, v220, v216, s80
v_perm_b32 v29, v220, v216, s81
v_perm_b32 v30, v221, v217, s80
v_perm_b32 v31, v221, v217, s81
v_perm_b32 v32, v222, v218, s80
v_perm_b32 v33, v222, v218, s81
v_perm_b32 v34, v223, v219, s80
v_perm_b32 v35, v223, v219, s81
v_dot2c_f32_bf16_dpp v8, v18, v28 row_newbcast:8
v_dot2c_f32_bf16_dpp v9, v18, v29 row_newbcast:8
v_dot2c_f32_bf16_dpp v10, v18, v30 row_newbcast:8
v_dot2c_f32_bf16_dpp v11, v18, v31 row_newbcast:8
v_dot2c_f32_bf16_dpp v12, v18, v32 row_newbcast:8
v_dot2c_f32_bf16_dpp v13, v18, v33 row_newbcast:8
v_dot2c_f32_bf16_dpp v14, v18, v34 row_newbcast:8
v_dot2c_f32_bf16_dpp v15, v18, v35 row_newbcast:8
v_perm_b32 v28, v228, v224, s80
v_perm_b32 v29, v228, v224, s81
v_perm_b32 v30, v229, v225, s80
v_perm_b32 v31, v229, v225, s81
v_perm_b32 v32, v230, v226, s80
v_perm_b32 v33, v230, v226, s81
v_perm_b32 v34, v231, v227, s80
v_perm_b32 v35, v231, v227, s81
v_dot2c_f32_bf16_dpp v8, v19, v28 row_newbcast:0
v_dot2c_f32_bf16_dpp v9, v19, v29 row_newbcast:0
v_dot2c_f32_bf16_dpp v10, v19, v30 row_newbcast:0
v_dot2c_f32_bf16_dpp v11, v19, v31 row_newbcast:0
v_dot2c_f32_bf16_dpp v12, v19, v32 row_newbcast:0
v_dot2c_f32_bf16_dpp v13, v19, v33 row_newbcast:0
v_dot2c_f32_bf16_dpp v14, v19, v34 row_newbcast:0
v_dot2c_f32_bf16_dpp v15, v19, v35 row_newbcast:0
v_swap_b32 v16, v64
v_swap_b32 v17, v65
v_swap_b32 v18, v66
v_swap_b32 v19, v67
v_swap_b32 v20, v68
v_swap_b32 v21, v69
v_swap_b32 v22, v70
v_swap_b32 v23, v71
v_swap_b32 v24, v72
v_swap_b32 v25, v73
v_swap_b32 v26, v74
v_swap_b32 v27, v75
v_swap_b32 v8, v76
v_swap_b32 v9, v77
v_swap_b32 v10, v78
v_swap_b32 v11, v79
v_swap_b32 v12, v80
v_swap_b32 v13, v81
v_swap_b32 v14, v82
v_swap_b32 v15, v83
v_perm_b32 v28, v244, v240, s80
v_perm_b32 v29, v244, v240, s81
v_perm_b32 v30, v245, v241, s80
v_perm_b32 v31, v245, v241, s81
v_perm_b32 v32, v246, v242, s80
v_perm_b32 v33, v246, v242, s81
v_perm_b32 v34, v247, v243, s80
v_perm_b32 v35, v247, v243, s81
v_dot2c_f32_bf16_dpp v8, v21, v28 row_newbcast:0
v_dot2c_f32_bf16_dpp v9, v21, v29 row_newbcast:0
v_dot2c_f32_bf16_dpp v10, v21, v30 row_newbcast:0
v_dot2c_f32_bf16_dpp v11, v21, v31 row_newbcast:0
v_dot2c_f32_bf16_dpp v12, v21, v32 row_newbcast:0
v_dot2c_f32_bf16_dpp v13, v21, v33 row_newbcast:0
v_dot2c_f32_bf16_dpp v14, v21, v34 row_newbcast:0
v_dot2c_f32_bf16_dpp v15, v21, v35 row_newbcast:0
s_waitcnt vmcnt(11)
s_add_u32 m0, s53, 8192
s_add_u32 s56, s52, 264192
buffer_load_dwordx4 v1, s[8:11], s56 offen nt lds
s_waitcnt vmcnt(11)
s_add_u32 m0, s53, 9216
s_add_u32 s56, s52, 265216
buffer_load_dwordx4 v1, s[8:11], s56 offen nt lds
v_perm_b32 v28, v252, v248, s80
v_perm_b32 v29, v252, v248, s81
v_perm_b32 v30, v253, v249, s80
v_perm_b32 v31, v253, v249, s81
v_perm_b32 v32, v254, v250, s80
v_perm_b32 v33, v254, v250, s81
v_perm_b32 v34, v255, v251, s80
v_perm_b32 v35, v255, v251, s81
v_dot2c_f32_bf16_dpp v8, v21, v28 row_newbcast:8
v_dot2c_f32_bf16_dpp v9, v21, v29 row_newbcast:8
v_dot2c_f32_bf16_dpp v10, v21, v30 row_newbcast:8
v_dot2c_f32_bf16_dpp v11, v21, v31 row_newbcast:8
v_dot2c_f32_bf16_dpp v12, v21, v32 row_newbcast:8
v_dot2c_f32_bf16_dpp v13, v21, v33 row_newbcast:8
v_dot2c_f32_bf16_dpp v14, v21, v34 row_newbcast:8
v_dot2c_f32_bf16_dpp v15, v21, v35 row_newbcast:8
s_waitcnt vmcnt(11)
s_add_u32 m0, s53, 10240
s_add_u32 s56, s52, 294912
buffer_load_dwordx4 v1, s[8:11], s56 offen nt lds
s_waitcnt vmcnt(11)
s_add_u32 m0, s53, 11264
s_add_u32 s56, s52, 295936
buffer_load_dwordx4 v1, s[8:11], s56 offen nt lds
v_perm_b32 v28, v236, v232, s80
v_perm_b32 v29, v236, v232, s81
v_perm_b32 v30, v237, v233, s80
v_perm_b32 v31, v237, v233, s81
v_perm_b32 v32, v238, v234, s80
v_perm_b32 v33, v238, v234, s81
v_perm_b32 v34, v239, v235, s80
v_perm_b32 v35, v239, v235, s81
v_dot2c_f32_bf16_dpp v8, v22, v28 row_newbcast:0
v_dot2c_f32_bf16_dpp v9, v22, v29 row_newbcast:0
v_dot2c_f32_bf16_dpp v10, v22, v30 row_newbcast:0
v_dot2c_f32_bf16_dpp v11, v22, v31 row_newbcast:0
v_dot2c_f32_bf16_dpp v12, v22, v32 row_newbcast:0
v_dot2c_f32_bf16_dpp v13, v22, v33 row_newbcast:0
v_dot2c_f32_bf16_dpp v14, v22, v34 row_newbcast:0
v_dot2c_f32_bf16_dpp v15, v22, v35 row_newbcast:0
s_waitcnt vmcnt(11)
s_add_u32 m0, s53, 12288
s_add_u32 s56, s52, 296960
buffer_load_dwordx4 v1, s[8:11], s56 offen nt lds
s_waitcnt vmcnt(11)
s_add_u32 m0, s53, 13312
s_add_u32 s56, s52, 297984
buffer_load_dwordx4 v1, s[8:11], s56 offen nt lds
ds_read_b128 v[36:39], v2 offset:0
ds_read_b128 v[40:43], v2 offset:1024
s_waitcnt lgkmcnt(0)
v_perm_b32 v28, v40, v36, s80
v_perm_b32 v29, v40, v36, s81
v_perm_b32 v30, v41, v37, s80
v_perm_b32 v31, v41, v37, s81
v_perm_b32 v32, v42, v38, s80
v_perm_b32 v33, v42, v38, s81
v_perm_b32 v34, v43, v39, s80
v_perm_b32 v35, v43, v39, s81
v_dot2c_f32_bf16_dpp v8, v22, v28 row_newbcast:8
v_dot2c_f32_bf16_dpp v9, v22, v29 row_newbcast:8
v_dot2c_f32_bf16_dpp v10, v22, v30 row_newbcast:8
v_dot2c_f32_bf16_dpp v11, v22, v31 row_newbcast:8
v_dot2c_f32_bf16_dpp v12, v22, v32 row_newbcast:8
v_dot2c_f32_bf16_dpp v13, v22, v33 row_newbcast:8
v_dot2c_f32_bf16_dpp v14, v22, v34 row_newbcast:8
v_dot2c_f32_bf16_dpp v15, v22, v35 row_newbcast:8
s_waitcnt vmcnt(11)
s_add_u32 s56, s51, 98304
buffer_load_dwordx4 v[84:87], v1, s[8:11], s56 offen offset:2048 nt
s_waitcnt vmcnt(11)
s_add_u32 s56, s51, 98304
buffer_load_dwordx4 v[88:91], v1, s[8:11], s56 offen offset:3072 nt
ds_read_b128 v[36:39], v2 offset:2048
ds_read_b128 v[40:43], v2 offset:3072
s_waitcnt lgkmcnt(0)
v_perm_b32 v28, v40, v36, s80
v_perm_b32 v29, v40, v36, s81
v_perm_b32 v30, v41, v37, s80
v_perm_b32 v31, v41, v37, s81
v_perm_b32 v32, v42, v38, s80
v_perm_b32 v33, v42, v38, s81
v_perm_b32 v34, v43, v39, s80
v_perm_b32 v35, v43, v39, s81
v_dot2c_f32_bf16_dpp v8, v23, v28 row_newbcast:0
v_dot2c_f32_bf16_dpp v9, v23, v29 row_newbcast:0
v_dot2c_f32_bf16_dpp v10, v23, v30 row_newbcast:0
v_dot2c_f32_bf16_dpp v11, v23, v31 row_newbcast:0
v_dot2c_f32_bf16_dpp v12, v23, v32 row_newbcast:0
v_dot2c_f32_bf16_dpp v13, v23, v33 row_newbcast:0
v_dot2c_f32_bf16_dpp v14, v23, v34 row_newbcast:0
v_dot2c_f32_bf16_dpp v15, v23, v35 row_newbcast:0
s_waitcnt vmcnt(11)
s_add_u32 s56, s51, 131072
buffer_load_dwordx4 v[92:95], v1, s[8:11], s56 offen offset:0 nt
s_waitcnt vmcnt(11)
s_add_u32 s56, s51, 131072
buffer_load_dwordx4 v[96:99], v1, s[8:11], s56 offen offset:1024 nt
ds_read_b128 v[36:39], v2 offset:4096
ds_read_b128 v[40:43], v2 offset:5120
s_waitcnt lgkmcnt(0)
v_perm_b32 v28, v40, v36, s80
v_perm_b32 v29, v40, v36, s81
v_perm_b32 v30, v41, v37, s80
v_perm_b32 v31, v41, v37, s81
v_perm_b32 v32, v42, v38, s80
v_perm_b32 v33, v42, v38, s81
v_perm_b32 v34, v43, v39, s80
v_perm_b32 v35, v43, v39, s81
v_dot2c_f32_bf16_dpp v8, v23, v28 row_newbcast:8
v_dot2c_f32_bf16_dpp v9, v23, v29 row_newbcast:8
v_dot2c_f32_bf16_dpp v10, v23, v30 row_newbcast:8
v_dot2c_f32_bf16_dpp v11, v23, v31 row_newbcast:8
v_dot2c_f32_bf16_dpp v12, v23, v32 row_newbcast:8
v_dot2c_f32_bf16_dpp v13, v23, v33 row_newbcast:8
v_dot2c_f32_bf16_dpp v14, v23, v34 row_newbcast:8
v_dot2c_f32_bf16_dpp v15, v23, v35 row_newbcast:8
s_waitcnt vmcnt(11)
s_add_u32 s56, s51, 131072
buffer_load_dwordx4 v[100:103], v1, s[8:11], s56 offen offset:2048 nt
s_waitcnt vmcnt(11)
s_add_u32 s56, s51, 131072
buffer_load_dwordx4 v[104:107], v1, s[8:11], s56 offen offset:3072 nt
ds_read_b128 v[36:39], v2 offset:6144
ds_read_b128 v[40:43], v2 offset:7168
s_waitcnt lgkmcnt(0)
v_perm_b32 v28, v40, v36, s80
v_perm_b32 v29, v40, v36, s81
v_perm_b32 v30, v41, v37, s80
v_perm_b32 v31, v41, v37, s81
v_perm_b32 v32, v42, v38, s80
v_perm_b32 v33, v42, v38, s81
v_perm_b32 v34, v43, v39, s80
v_perm_b32 v35, v43, v39, s81
v_dot2c_f32_bf16_dpp v8, v24, v28 row_newbcast:0
v_dot2c_f32_bf16_dpp v9, v24, v29 row_newbcast:0
v_dot2c_f32_bf16_dpp v10, v24, v30 row_newbcast:0
v_dot2c_f32_bf16_dpp v11, v24, v31 row_newbcast:0
v_dot2c_f32_bf16_dpp v12, v24, v32 row_newbcast:0
v_dot2c_f32_bf16_dpp v13, v24, v33 row_newbcast:0
v_dot2c_f32_bf16_dpp v14, v24, v34 row_newbcast:0
v_dot2c_f32_bf16_dpp v15, v24, v35 row_newbcast:0
s_waitcnt vmcnt(11)
s_add_u32 s56, s51, 163840
buffer_load_dwordx4 v[108:111], v1, s[8:11], s56 offen offset:0 nt
s_waitcnt vmcnt(11)
s_add_u32 s56, s51, 163840
buffer_load_dwordx4 v[112:115], v1, s[8:11], s56 offen offset:1024 nt
ds_read_b128 v[36:39], v2 offset:8192
ds_read_b128 v[40:43], v2 offset:9216
s_waitcnt lgkmcnt(0)
v_perm_b32 v28, v40, v36, s80
v_perm_b32 v29, v40, v36, s81
v_perm_b32 v30, v41, v37, s80
v_perm_b32 v31, v41, v37, s81
v_perm_b32 v32, v42, v38, s80
v_perm_b32 v33, v42, v38, s81
v_perm_b32 v34, v43, v39, s80
v_perm_b32 v35, v43, v39, s81
v_dot2c_f32_bf16_dpp v8, v24, v28 row_newbcast:8
v_dot2c_f32_bf16_dpp v9, v24, v29 row_newbcast:8
v_dot2c_f32_bf16_dpp v10, v24, v30 row_newbcast:8
v_dot2c_f32_bf16_dpp v11, v24, v31 row_newbcast:8
v_dot2c_f32_bf16_dpp v12, v24, v32 row_newbcast:8
v_dot2c_f32_bf16_dpp v13, v24, v33 row_newbcast:8
v_dot2c_f32_bf16_dpp v14, v24, v34 row_newbcast:8
v_dot2c_f32_bf16_dpp v15, v24, v35 row_newbcast:8
s_waitcnt vmcnt(11)
s_add_u32 s56, s51, 163840
buffer_load_dwordx4 v[116:119], v1, s[8:11], s56 offen offset:2048 nt
s_waitcnt vmcnt(11)
s_add_u32 s56, s51, 163840
buffer_load_dwordx4 v[120:123], v1, s[8:11], s56 offen offset:3072 nt
ds_read_b128 v[36:39], v2 offset:10240
ds_read_b128 v[40:43], v2 offset:11264
s_waitcnt lgkmcnt(0)
v_perm_b32 v28, v40, v36, s80
v_perm_b32 v29, v40, v36, s81
v_perm_b32 v30, v41, v37, s80
v_perm_b32 v31, v41, v37, s81
v_perm_b32 v32, v42, v38, s80
v_perm_b32 v33, v42, v38, s81
v_perm_b32 v34, v43, v39, s80
v_perm_b32 v35, v43, v39, s81
v_dot2c_f32_bf16_dpp v8, v25, v28 row_newbcast:0
v_dot2c_f32_bf16_dpp v9, v25, v29 row_newbcast:0
v_dot2c_f32_bf16_dpp v10, v25, v30 row_newbcast:0
v_dot2c_f32_bf16_dpp v11, v25, v31 row_newbcast:0
v_dot2c_f32_bf16_dpp v12, v25, v32 row_newbcast:0
v_dot2c_f32_bf16_dpp v13, v25, v33 row_newbcast:0
v_dot2c_f32_bf16_dpp v14, v25, v34 row_newbcast:0
v_dot2c_f32_bf16_dpp v15, v25, v35 row_newbcast:0
s_waitcnt vmcnt(11)
s_add_u32 s56, s51, 196608
buffer_load_dwordx4 v[124:127], v1, s[8:11], s56 offen offset:0 nt
s_waitcnt vmcnt(11)
s_add_u32 s56, s51, 196608
buffer_load_dwordx4 v[128:131], v1, s[8:11], s56 offen offset:1024 nt
ds_read_b128 v[36:39], v2 offset:12288
ds_read_b128 v[40:43], v2 offset:13312
s_waitcnt lgkmcnt(0)
v_perm_b32 v28, v40, v36, s80
v_perm_b32 v29, v40, v36, s81
v_perm_b32 v30, v41, v37, s80
v_perm_b32 v31, v41, v37, s81
v_perm_b32 v32, v42, v38, s80
v_perm_b32 v33, v42, v38, s81
v_perm_b32 v34, v43, v39, s80
v_perm_b32 v35, v43, v39, s81
v_dot2c_f32_bf16_dpp v8, v25, v28 row_newbcast:8
v_dot2c_f32_bf16_dpp v9, v25, v29 row_newbcast:8
v_dot2c_f32_bf16_dpp v10, v25, v30 row_newbcast:8
v_dot2c_f32_bf16_dpp v11, v25, v31 row_newbcast:8
v_dot2c_f32_bf16_dpp v12, v25, v32 row_newbcast:8
v_dot2c_f32_bf16_dpp v13, v25, v33 row_newbcast:8
v_dot2c_f32_bf16_dpp v14, v25, v34 row_newbcast:8
v_dot2c_f32_bf16_dpp v15, v25, v35 row_newbcast:8
s_waitcnt vmcnt(11)
s_add_u32 s56, s51, 196608
buffer_load_dwordx4 v[132:135], v1, s[8:11], s56 offen offset:2048 nt
s_waitcnt vmcnt(11)
s_add_u32 s56, s51, 196608
buffer_load_dwordx4 v[136:139], v1, s[8:11], s56 offen offset:3072 nt
v_mov_b32 v36, v8
v_mov_b32 v37, v9
v_mov_b32 v38, v10
v_mov_b32 v39, v11
v_mov_b32 v40, v12
v_mov_b32 v41, v13
v_mov_b32 v42, v14
v_mov_b32 v43, v15
v_permlane32_swap_b32 v8, v36
v_permlane32_swap_b32 v9, v37
v_permlane32_swap_b32 v10, v38
v_permlane32_swap_b32 v11, v39
v_permlane32_swap_b32 v12, v40
v_permlane32_swap_b32 v13, v41
v_permlane32_swap_b32 v14, v42
v_permlane32_swap_b32 v15, v43
v_add_f32 v8, v8, v36
v_add_f32 v9, v9, v37
v_add_f32 v10, v10, v38
v_add_f32 v11, v11, v39
v_add_f32 v12, v12, v40
v_add_f32 v13, v13, v41
v_add_f32 v14, v14, v42
v_add_f32 v15, v15, v43
v_and_b32 v28, 31, v3
v_lshlrev_b32 v28, 5, v28
s_lshl_b32 s56, s48, 10
s_add_u32 s56, s56, 0x2000
v_add_u32 v28, s56, v28
ds_write_b128 v28, v[8:11]
ds_write_b128 v28, v[12:15] offset:16
s_lshl_b32 s56, s48, 3
s_add_u32 s56, s56, 0x4040
v_mov_b32 v29, s56
ds_write_b64 v29, v[26:27]
v_mov_b32 v30, 0x4084
v_mov_b32 v31, 1
s_waitcnt lgkmcnt(0)
s_mov_b64 exec, 1
ds_add_rtn_u32 v28, v30, v31
s_mov_b64 exec, -1
s_waitcnt lgkmcnt(0)
v_readfirstlane_b32 s59, v28
s_nop 0
s_cmp_lg_u32 s59, 7
s_cbranch_scc1 L_nos1_278
s_setprio 3
v_add_u32 v24, 0x2000, v1
v_mov_b32 v25, 0x4040
ds_read_b128 v[8:11], v25 offset:0
ds_read_b128 v[12:15], v25 offset:16
ds_read_b128 v[16:19], v25 offset:32
ds_read_b128 v[20:23], v25 offset:48
ds_read_b128 v[36:39], v24 offset:0
ds_read_b128 v[40:43], v24 offset:1024
ds_read_b128 v[44:47], v24 offset:2048
ds_read_b128 v[48:51], v24 offset:3072
s_waitcnt lgkmcnt(0)
v_max_f32 v26, v8, v10
v_max_f32 v26, v26, v12
v_max_f32 v26, v26, v14
v_max_f32 v26, v26, v16
v_max_f32 v26, v26, v18
v_max_f32 v26, v26, v20
v_max_f32 v26, v26, v22
v_sub_f32 v8, v8, v26
v_sub_f32 v10, v10, v26
v_sub_f32 v12, v12, v26
v_sub_f32 v14, v14, v26
v_sub_f32 v16, v16, v26
v_sub_f32 v18, v18, v26
v_sub_f32 v20, v20, v26
v_sub_f32 v22, v22, v26
v_mul_f32 v8, 0x3fb8aa3b, v8
v_mul_f32 v10, 0x3fb8aa3b, v10
v_mul_f32 v12, 0x3fb8aa3b, v12
v_mul_f32 v14, 0x3fb8aa3b, v14
v_mul_f32 v16, 0x3fb8aa3b, v16
v_mul_f32 v18, 0x3fb8aa3b, v18
v_mul_f32 v20, 0x3fb8aa3b, v20
v_mul_f32 v22, 0x3fb8aa3b, v22
v_exp_f32 v8, v8
v_exp_f32 v10, v10
v_exp_f32 v12, v12
v_exp_f32 v14, v14
v_exp_f32 v16, v16
v_exp_f32 v18, v18
v_exp_f32 v20, v20
v_exp_f32 v22, v22
v_mul_f32 v27, v8, v9
v_fmac_f32 v27, v10, v11
v_fmac_f32 v27, v12, v13
v_fmac_f32 v27, v14, v15
v_fmac_f32 v27, v16, v17
v_fmac_f32 v27, v18, v19
v_fmac_f32 v27, v20, v21
v_fmac_f32 v27, v22, v23
v_mul_f32 v28, v8, v36
v_mul_f32 v29, v8, v37
v_mul_f32 v30, v8, v38
v_mul_f32 v31, v8, v39
v_fmac_f32 v28, v10, v40
v_fmac_f32 v29, v10, v41
v_fmac_f32 v30, v10, v42
v_fmac_f32 v31, v10, v43
v_fmac_f32 v28, v12, v44
v_fmac_f32 v29, v12, v45
v_fmac_f32 v30, v12, v46
v_fmac_f32 v31, v12, v47
v_fmac_f32 v28, v14, v48
v_fmac_f32 v29, v14, v49
v_fmac_f32 v30, v14, v50
v_fmac_f32 v31, v14, v51
ds_read_b128 v[36:39], v24 offset:4096
ds_read_b128 v[40:43], v24 offset:5120
ds_read_b128 v[44:47], v24 offset:6144
ds_read_b128 v[48:51], v24 offset:7168
s_waitcnt lgkmcnt(0)
v_fmac_f32 v28, v16, v36
v_fmac_f32 v29, v16, v37
v_fmac_f32 v30, v16, v38
v_fmac_f32 v31, v16, v39
v_fmac_f32 v28, v18, v40
v_fmac_f32 v29, v18, v41
v_fmac_f32 v30, v18, v42
v_fmac_f32 v31, v18, v43
v_fmac_f32 v28, v20, v44
v_fmac_f32 v29, v20, v45
v_fmac_f32 v30, v20, v46
v_fmac_f32 v31, v20, v47
v_fmac_f32 v28, v22, v48
v_fmac_f32 v29, v22, v49
v_fmac_f32 v30, v22, v50
v_fmac_f32 v31, v22, v51
v_or_b32 v28, 1, v28
v_or_b32 v29, 1, v29
v_or_b32 v30, 1, v30
v_or_b32 v31, 1, v31
v_or_b32 v26, 1, v26
v_or_b32 v27, 1, v27
s_mul_i32 s56, s49, 14
s_add_u32 s56, s56, s50
s_mul_i32 s56, s56, 1088
s_add_u32 s56, s56, 0x13b800
buffer_store_dwordx4 v[28:31], v1, s[44:47], s56 offen sc1
s_mov_b64 exec, 1
buffer_store_dwordx2 v[26:27], v1, s[44:47], s56 offen offset:1024 sc1
s_mov_b64 exec, -1
L_nos1_278:
s_nop 4
v_mov_b32 v28, 0x4084
s_mov_b32 s60, 0
L_p_wgw_293:
s_nop 4
ds_read_b32 v29, v28
s_waitcnt lgkmcnt(0)
v_cmp_ne_u32 vcc, 8, v29
s_cbranch_vccz L_d_wgw_294
s_sleep 1
s_add_u32 s60, s60, 1
s_cmp_lt_u32 s60, 400000
s_cbranch_scc1 L_p_wgw_293
s_endpgm
L_d_wgw_294:
s_nop 4
s_setprio 1
v_mov_b32 v16, v64
v_mov_b32 v17, v65
v_mov_b32 v18, v66
v_mov_b32 v19, v67
v_mov_b32 v20, v68
v_mov_b32 v21, v69
v_mov_b32 v22, v70
v_mov_b32 v23, v71
v_mov_b32 v24, v72
v_mov_b32 v25, v73
v_mov_b32 v26, v74
v_mov_b32 v27, v75
v_mov_b32 v8, v76
v_mov_b32 v9, v77
v_mov_b32 v10, v78
v_mov_b32 v11, v79
v_mov_b32 v12, v80
v_mov_b32 v13, v81
v_mov_b32 v14, v82
v_mov_b32 v15, v83
v_perm_b32 v28, v88, v84, s80
v_perm_b32 v29, v88, v84, s81
v_perm_b32 v30, v89, v85, s80
v_perm_b32 v31, v89, v85, s81
v_perm_b32 v32, v90, v86, s80
v_perm_b32 v33, v90, v86, s81
v_perm_b32 v34, v91, v87, s80
v_perm_b32 v35, v91, v87, s81
v_dot2c_f32_bf16_dpp v8, v19, v28 row_newbcast:8
v_dot2c_f32_bf16_dpp v9, v19, v29 row_newbcast:8
v_dot2c_f32_bf16_dpp v10, v19, v30 row_newbcast:8
v_dot2c_f32_bf16_dpp v11, v19, v31 row_newbcast:8
v_dot2c_f32_bf16_dpp v12, v19, v32 row_newbcast:8
v_dot2c_f32_bf16_dpp v13, v19, v33 row_newbcast:8
v_dot2c_f32_bf16_dpp v14, v19, v34 row_newbcast:8
v_dot2c_f32_bf16_dpp v15, v19, v35 row_newbcast:8
s_waitcnt vmcnt(5)
s_add_u32 s56, s51, 229376
buffer_load_dwordx4 v[140:143], v1, s[8:11], s56 offen offset:0 nt
s_waitcnt vmcnt(5)
s_add_u32 s56, s51, 229376
buffer_load_dwordx4 v[144:147], v1, s[8:11], s56 offen offset:1024 nt
v_perm_b32 v28, v96, v92, s80
v_perm_b32 v29, v96, v92, s81
v_perm_b32 v30, v97, v93, s80
v_perm_b32 v31, v97, v93, s81
v_perm_b32 v32, v98, v94, s80
v_perm_b32 v33, v98, v94, s81
v_perm_b32 v34, v99, v95, s80
v_perm_b32 v35, v99, v95, s81
v_dot2c_f32_bf16_dpp v8, v20, v28 row_newbcast:0
v_dot2c_f32_bf16_dpp v9, v20, v29 row_newbcast:0
v_dot2c_f32_bf16_dpp v10, v20, v30 row_newbcast:0
v_dot2c_f32_bf16_dpp v11, v20, v31 row_newbcast:0
v_dot2c_f32_bf16_dpp v12, v20, v32 row_newbcast:0
v_dot2c_f32_bf16_dpp v13, v20, v33 row_newbcast:0
v_dot2c_f32_bf16_dpp v14, v20, v34 row_newbcast:0
v_dot2c_f32_bf16_dpp v15, v20, v35 row_newbcast:0
s_waitcnt vmcnt(5)
s_add_u32 s56, s51, 229376
buffer_load_dwordx4 v[148:151], v1, s[8:11], s56 offen offset:2048 nt
s_waitcnt vmcnt(5)
s_add_u32 s56, s51, 229376
buffer_load_dwordx4 v[152:155], v1, s[8:11], s56 offen offset:3072 nt
v_perm_b32 v28, v104, v100, s80
v_perm_b32 v29, v104, v100, s81
v_perm_b32 v30, v105, v101, s80
v_perm_b32 v31, v105, v101, s81
v_perm_b32 v32, v106, v102, s80
v_perm_b32 v33, v106, v102, s81
v_perm_b32 v34, v107, v103, s80
v_perm_b32 v35, v107, v103, s81
v_dot2c_f32_bf16_dpp v8, v20, v28 row_newbcast:8
v_dot2c_f32_bf16_dpp v9, v20, v29 row_newbcast:8
v_dot2c_f32_bf16_dpp v10, v20, v30 row_newbcast:8
v_dot2c_f32_bf16_dpp v11, v20, v31 row_newbcast:8
v_dot2c_f32_bf16_dpp v12, v20, v32 row_newbcast:8
v_dot2c_f32_bf16_dpp v13, v20, v33 row_newbcast:8
v_dot2c_f32_bf16_dpp v14, v20, v34 row_newbcast:8
v_dot2c_f32_bf16_dpp v15, v20, v35 row_newbcast:8
s_waitcnt vmcnt(5)
s_add_u32 s56, s51, 262144
buffer_load_dwordx4 v[156:159], v1, s[8:11], s56 offen offset:0 nt
s_waitcnt vmcnt(5)
s_add_u32 s56, s51, 262144
buffer_load_dwordx4 v[160:163], v1, s[8:11], s56 offen offset:1024 nt
v_perm_b32 v28, v112, v108, s80
v_perm_b32 v29, v112, v108, s81
v_perm_b32 v30, v113, v109, s80
v_perm_b32 v31, v113, v109, s81
v_perm_b32 v32, v114, v110, s80
v_perm_b32 v33, v114, v110, s81
v_perm_b32 v34, v115, v111, s80
v_perm_b32 v35, v115, v111, s81
v_dot2c_f32_bf16_dpp v8, v21, v28 row_newbcast:0
v_dot2c_f32_bf16_dpp v9, v21, v29 row_newbcast:0
v_dot2c_f32_bf16_dpp v10, v21, v30 row_newbcast:0
v_dot2c_f32_bf16_dpp v11, v21, v31 row_newbcast:0
v_dot2c_f32_bf16_dpp v12, v21, v32 row_newbcast:0
v_dot2c_f32_bf16_dpp v13, v21, v33 row_newbcast:0
v_dot2c_f32_bf16_dpp v14, v21, v34 row_newbcast:0
v_dot2c_f32_bf16_dpp v15, v21, v35 row_newbcast:0
s_waitcnt vmcnt(5)
s_add_u32 s56, s51, 262144
buffer_load_dwordx4 v[164:167], v1, s[8:11], s56 offen offset:2048 nt
s_waitcnt vmcnt(5)
s_add_u32 s56, s51, 262144
buffer_load_dwordx4 v[168:171], v1, s[8:11], s56 offen offset:3072 nt
v_perm_b32 v28, v120, v116, s80
v_perm_b32 v29, v120, v116, s81
v_perm_b32 v30, v121, v117, s80
v_perm_b32 v31, v121, v117, s81
v_perm_b32 v32, v122, v118, s80
v_perm_b32 v33, v122, v118, s81
v_perm_b32 v34, v123, v119, s80
v_perm_b32 v35, v123, v119, s81
v_dot2c_f32_bf16_dpp v8, v21, v28 row_newbcast:8
v_dot2c_f32_bf16_dpp v9, v21, v29 row_newbcast:8
v_dot2c_f32_bf16_dpp v10, v21, v30 row_newbcast:8
v_dot2c_f32_bf16_dpp v11, v21, v31 row_newbcast:8
v_dot2c_f32_bf16_dpp v12, v21, v32 row_newbcast:8
v_dot2c_f32_bf16_dpp v13, v21, v33 row_newbcast:8
v_dot2c_f32_bf16_dpp v14, v21, v34 row_newbcast:8
v_dot2c_f32_bf16_dpp v15, v21, v35 row_newbcast:8
s_waitcnt vmcnt(5)
s_add_u32 s56, s51, 294912
buffer_load_dwordx4 v[172:175], v1, s[8:11], s56 offen offset:0 nt
s_waitcnt vmcnt(5)
s_add_u32 s56, s51, 294912
buffer_load_dwordx4 v[176:179], v1, s[8:11], s56 offen offset:1024 nt
v_perm_b32 v28, v128, v124, s80
v_perm_b32 v29, v128, v124, s81
v_perm_b32 v30, v129, v125, s80
v_perm_b32 v31, v129, v125, s81
v_perm_b32 v32, v130, v126, s80
v_perm_b32 v33, v130, v126, s81
v_perm_b32 v34, v131, v127, s80
v_perm_b32 v35, v131, v127, s81
v_dot2c_f32_bf16_dpp v8, v22, v28 row_newbcast:0
v_dot2c_f32_bf16_dpp v9, v22, v29 row_newbcast:0
v_dot2c_f32_bf16_dpp v10, v22, v30 row_newbcast:0
v_dot2c_f32_bf16_dpp v11, v22, v31 row_newbcast:0
v_dot2c_f32_bf16_dpp v12, v22, v32 row_newbcast:0
v_dot2c_f32_bf16_dpp v13, v22, v33 row_newbcast:0
v_dot2c_f32_bf16_dpp v14, v22, v34 row_newbcast:0
v_dot2c_f32_bf16_dpp v15, v22, v35 row_newbcast:0
s_waitcnt vmcnt(5)
s_add_u32 s56, s51, 294912
buffer_load_dwordx4 v[180:183], v1, s[8:11], s56 offen offset:2048 nt
s_waitcnt vmcnt(5)
s_add_u32 s56, s51, 294912
buffer_load_dwordx4 v[184:187], v1, s[8:11], s56 offen offset:3072 nt
v_perm_b32 v28, v136, v132, s80
v_perm_b32 v29, v136, v132, s81
v_perm_b32 v30, v137, v133, s80
v_perm_b32 v31, v137, v133, s81
v_perm_b32 v32, v138, v134, s80
v_perm_b32 v33, v138, v134, s81
v_perm_b32 v34, v139, v135, s80
v_perm_b32 v35, v139, v135, s81
v_dot2c_f32_bf16_dpp v8, v22, v28 row_newbcast:8
v_dot2c_f32_bf16_dpp v9, v22, v29 row_newbcast:8
v_dot2c_f32_bf16_dpp v10, v22, v30 row_newbcast:8
v_dot2c_f32_bf16_dpp v11, v22, v31 row_newbcast:8
v_dot2c_f32_bf16_dpp v12, v22, v32 row_newbcast:8
v_dot2c_f32_bf16_dpp v13, v22, v33 row_newbcast:8
v_dot2c_f32_bf16_dpp v14, v22, v34 row_newbcast:8
v_dot2c_f32_bf16_dpp v15, v22, v35 row_newbcast:8
s_waitcnt vmcnt(5)
buffer_load_dwordx4 v[188:191], v1, s[4:7], s52 offen offset:0 nt
s_waitcnt vmcnt(5)
buffer_load_dwordx4 v[192:195], v1, s[4:7], s52 offen offset:1024 nt
v_perm_b32 v28, v144, v140, s80
v_perm_b32 v29, v144, v140, s81
v_perm_b32 v30, v145, v141, s80
v_perm_b32 v31, v145, v141, s81
v_perm_b32 v32, v146, v142, s80
v_perm_b32 v33, v146, v142, s81
v_perm_b32 v34, v147, v143, s80
v_perm_b32 v35, v147, v143, s81
v_dot2c_f32_bf16_dpp v8, v23, v28 row_newbcast:0
v_dot2c_f32_bf16_dpp v9, v23, v29 row_newbcast:0
v_dot2c_f32_bf16_dpp v10, v23, v30 row_newbcast:0
v_dot2c_f32_bf16_dpp v11, v23, v31 row_newbcast:0
v_dot2c_f32_bf16_dpp v12, v23, v32 row_newbcast:0
v_dot2c_f32_bf16_dpp v13, v23, v33 row_newbcast:0
v_dot2c_f32_bf16_dpp v14, v23, v34 row_newbcast:0
v_dot2c_f32_bf16_dpp v15, v23, v35 row_newbcast:0
s_waitcnt vmcnt(5)
buffer_load_dwordx4 v[196:199], v1, s[4:7], s52 offen offset:2048 nt
s_waitcnt vmcnt(5)
buffer_load_dwordx4 v[200:203], v1, s[4:7], s52 offen offset:3072 nt
v_perm_b32 v28, v152, v148, s80
v_perm_b32 v29, v152, v148, s81
v_perm_b32 v30, v153, v149, s80
v_perm_b32 v31, v153, v149, s81
v_perm_b32 v32, v154, v150, s80
v_perm_b32 v33, v154, v150, s81
v_perm_b32 v34, v155, v151, s80
v_perm_b32 v35, v155, v151, s81
v_dot2c_f32_bf16_dpp v8, v23, v28 row_newbcast:8
v_dot2c_f32_bf16_dpp v9, v23, v29 row_newbcast:8
v_dot2c_f32_bf16_dpp v10, v23, v30 row_newbcast:8
v_dot2c_f32_bf16_dpp v11, v23, v31 row_newbcast:8
v_dot2c_f32_bf16_dpp v12, v23, v32 row_newbcast:8
v_dot2c_f32_bf16_dpp v13, v23, v33 row_newbcast:8
v_dot2c_f32_bf16_dpp v14, v23, v34 row_newbcast:8
v_dot2c_f32_bf16_dpp v15, v23, v35 row_newbcast:8
s_waitcnt vmcnt(5)
s_add_u32 s56, s52, 32768
buffer_load_dwordx4 v[204:207], v1, s[4:7], s56 offen offset:0 nt
s_waitcnt vmcnt(5)
s_add_u32 s56, s52, 32768
buffer_load_dwordx4 v[208:211], v1, s[4:7], s56 offen offset:1024 nt
v_perm_b32 v28, v160, v156, s80
v_perm_b32 v29, v160, v156, s81
v_perm_b32 v30, v161, v157, s80
v_perm_b32 v31, v161, v157, s81
v_perm_b32 v32, v162, v158, s80
v_perm_b32 v33, v162, v158, s81
v_perm_b32 v34, v163, v159, s80
v_perm_b32 v35, v163, v159, s81
v_dot2c_f32_bf16_dpp v8, v24, v28 row_newbcast:0
v_dot2c_f32_bf16_dpp v9, v24, v29 row_newbcast:0
v_dot2c_f32_bf16_dpp v10, v24, v30 row_newbcast:0
v_dot2c_f32_bf16_dpp v11, v24, v31 row_newbcast:0
v_dot2c_f32_bf16_dpp v12, v24, v32 row_newbcast:0
v_dot2c_f32_bf16_dpp v13, v24, v33 row_newbcast:0
v_dot2c_f32_bf16_dpp v14, v24, v34 row_newbcast:0
v_dot2c_f32_bf16_dpp v15, v24, v35 row_newbcast:0
s_waitcnt vmcnt(5)
s_add_u32 s56, s52, 32768
buffer_load_dwordx4 v[212:215], v1, s[4:7], s56 offen offset:2048 nt
s_waitcnt vmcnt(5)
s_add_u32 s56, s52, 32768
buffer_load_dwordx4 v[216:219], v1, s[4:7], s56 offen offset:3072 nt
v_perm_b32 v28, v168, v164, s80
v_perm_b32 v29, v168, v164, s81
v_perm_b32 v30, v169, v165, s80
v_perm_b32 v31, v169, v165, s81
v_perm_b32 v32, v170, v166, s80
v_perm_b32 v33, v170, v166, s81
v_perm_b32 v34, v171, v167, s80
v_perm_b32 v35, v171, v167, s81
v_dot2c_f32_bf16_dpp v8, v24, v28 row_newbcast:8
v_dot2c_f32_bf16_dpp v9, v24, v29 row_newbcast:8
v_dot2c_f32_bf16_dpp v10, v24, v30 row_newbcast:8
v_dot2c_f32_bf16_dpp v11, v24, v31 row_newbcast:8
v_dot2c_f32_bf16_dpp v12, v24, v32 row_newbcast:8
v_dot2c_f32_bf16_dpp v13, v24, v33 row_newbcast:8
v_dot2c_f32_bf16_dpp v14, v24, v34 row_newbcast:8
v_dot2c_f32_bf16_dpp v15, v24, v35 row_newbcast:8
s_waitcnt vmcnt(5)
s_add_u32 s56, s52, 65536
buffer_load_dwordx4 v[220:223], v1, s[4:7], s56 offen offset:0 nt
s_waitcnt vmcnt(5)
s_add_u32 s56, s52, 65536
buffer_load_dwordx4 v[224:227], v1, s[4:7], s56 offen offset:1024 nt
v_perm_b32 v28, v176, v172, s80
v_perm_b32 v29, v176, v172, s81
v_perm_b32 v30, v177, v173, s80
v_perm_b32 v31, v177, v173, s81
v_perm_b32 v32, v178, v174, s80
v_perm_b32 v33, v178, v174, s81
v_perm_b32 v34, v179, v175, s80
v_perm_b32 v35, v179, v175, s81
v_dot2c_f32_bf16_dpp v8, v25, v28 row_newbcast:0
v_dot2c_f32_bf16_dpp v9, v25, v29 row_newbcast:0
v_dot2c_f32_bf16_dpp v10, v25, v30 row_newbcast:0
v_dot2c_f32_bf16_dpp v11, v25, v31 row_newbcast:0
v_dot2c_f32_bf16_dpp v12, v25, v32 row_newbcast:0
v_dot2c_f32_bf16_dpp v13, v25, v33 row_newbcast:0
v_dot2c_f32_bf16_dpp v14, v25, v34 row_newbcast:0
v_dot2c_f32_bf16_dpp v15, v25, v35 row_newbcast:0
s_waitcnt vmcnt(5)
s_add_u32 s56, s52, 65536
buffer_load_dwordx4 v[228:231], v1, s[4:7], s56 offen offset:2048 nt
s_waitcnt vmcnt(5)
s_add_u32 s56, s52, 65536
buffer_load_dwordx4 v[84:87], v1, s[4:7], s56 offen offset:3072 nt
v_perm_b32 v28, v184, v180, s80
v_perm_b32 v29, v184, v180, s81
v_perm_b32 v30, v185, v181, s80
v_perm_b32 v31, v185, v181, s81
v_perm_b32 v32, v186, v182, s80
v_perm_b32 v33, v186, v182, s81
v_perm_b32 v34, v187, v183, s80
v_perm_b32 v35, v187, v183, s81
v_dot2c_f32_bf16_dpp v8, v25, v28 row_newbcast:8
v_dot2c_f32_bf16_dpp v9, v25, v29 row_newbcast:8
v_dot2c_f32_bf16_dpp v10, v25, v30 row_newbcast:8
v_dot2c_f32_bf16_dpp v11, v25, v31 row_newbcast:8
v_dot2c_f32_bf16_dpp v12, v25, v32 row_newbcast:8
v_dot2c_f32_bf16_dpp v13, v25, v33 row_newbcast:8
v_dot2c_f32_bf16_dpp v14, v25, v34 row_newbcast:8
v_dot2c_f32_bf16_dpp v15, v25, v35 row_newbcast:8
s_waitcnt vmcnt(5)
s_add_u32 s56, s52, 98304
buffer_load_dwordx4 v[88:91], v1, s[4:7], s56 offen offset:0 nt
s_waitcnt vmcnt(5)
s_add_u32 s56, s52, 98304
buffer_load_dwordx4 v[92:95], v1, s[4:7], s56 offen offset:1024 nt
v_mov_b32 v36, v8
v_mov_b32 v37, v9
v_mov_b32 v38, v10
v_mov_b32 v39, v11
v_mov_b32 v40, v12
v_mov_b32 v41, v13
v_mov_b32 v42, v14
v_mov_b32 v43, v15
v_permlane32_swap_b32 v8, v36
v_permlane32_swap_b32 v9, v37
v_permlane32_swap_b32 v10, v38
v_permlane32_swap_b32 v11, v39
v_permlane32_swap_b32 v12, v40
v_permlane32_swap_b32 v13, v41
v_permlane32_swap_b32 v14, v42
v_permlane32_swap_b32 v15, v43
v_add_f32 v8, v8, v36
v_add_f32 v9, v9, v37
v_add_f32 v10, v10, v38
v_add_f32 v11, v11, v39
v_add_f32 v12, v12, v40
v_add_f32 v13, v13, v41
v_add_f32 v14, v14, v42
v_add_f32 v15, v15, v43
v_and_b32 v28, 31, v3
v_lshlrev_b32 v28, 5, v28
s_lshl_b32 s56, s48, 10
s_add_u32 s56, s56, 0x0
v_add_u32 v28, s56, v28
ds_write_b128 v28, v[8:11]
ds_write_b128 v28, v[12:15] offset:16
s_lshl_b32 s56, s48, 3
s_add_u32 s56, s56, 0x4000
v_mov_b32 v29, s56
ds_write_b64 v29, v[26:27]
v_mov_b32 v30, 0x4088
v_mov_b32 v31, 1
s_waitcnt lgkmcnt(0)
s_mov_b64 exec, 1
ds_add_rtn_u32 v28, v30, v31
s_mov_b64 exec, -1
s_waitcnt lgkmcnt(0)
v_readfirstlane_b32 s59, v28
s_nop 0
s_cmp_lg_u32 s59, 7
s_cbranch_scc1 L_nos1_300
s_setprio 3
v_add_u32 v24, 0x0, v1
v_mov_b32 v25, 0x4000
ds_read_b128 v[8:11], v25 offset:0
ds_read_b128 v[12:15], v25 offset:16
ds_read_b128 v[16:19], v25 offset:32
ds_read_b128 v[20:23], v25 offset:48
ds_read_b128 v[36:39], v24 offset:0
ds_read_b128 v[40:43], v24 offset:1024
ds_read_b128 v[44:47], v24 offset:2048
ds_read_b128 v[48:51], v24 offset:3072
s_waitcnt lgkmcnt(0)
v_max_f32 v26, v8, v10
v_max_f32 v26, v26, v12
v_max_f32 v26, v26, v14
v_max_f32 v26, v26, v16
v_max_f32 v26, v26, v18
v_max_f32 v26, v26, v20
v_max_f32 v26, v26, v22
v_sub_f32 v8, v8, v26
v_sub_f32 v10, v10, v26
v_sub_f32 v12, v12, v26
v_sub_f32 v14, v14, v26
v_sub_f32 v16, v16, v26
v_sub_f32 v18, v18, v26
v_sub_f32 v20, v20, v26
v_sub_f32 v22, v22, v26
v_mul_f32 v8, 0x3fb8aa3b, v8
v_mul_f32 v10, 0x3fb8aa3b, v10
v_mul_f32 v12, 0x3fb8aa3b, v12
v_mul_f32 v14, 0x3fb8aa3b, v14
v_mul_f32 v16, 0x3fb8aa3b, v16
v_mul_f32 v18, 0x3fb8aa3b, v18
v_mul_f32 v20, 0x3fb8aa3b, v20
v_mul_f32 v22, 0x3fb8aa3b, v22
v_exp_f32 v8, v8
v_exp_f32 v10, v10
v_exp_f32 v12, v12
v_exp_f32 v14, v14
v_exp_f32 v16, v16
v_exp_f32 v18, v18
v_exp_f32 v20, v20
v_exp_f32 v22, v22
v_mul_f32 v27, v8, v9
v_fmac_f32 v27, v10, v11
v_fmac_f32 v27, v12, v13
v_fmac_f32 v27, v14, v15
v_fmac_f32 v27, v16, v17
v_fmac_f32 v27, v18, v19
v_fmac_f32 v27, v20, v21
v_fmac_f32 v27, v22, v23
v_mul_f32 v28, v8, v36
v_mul_f32 v29, v8, v37
v_mul_f32 v30, v8, v38
v_mul_f32 v31, v8, v39
v_fmac_f32 v28, v10, v40
v_fmac_f32 v29, v10, v41
v_fmac_f32 v30, v10, v42
v_fmac_f32 v31, v10, v43
v_fmac_f32 v28, v12, v44
v_fmac_f32 v29, v12, v45
v_fmac_f32 v30, v12, v46
v_fmac_f32 v31, v12, v47
v_fmac_f32 v28, v14, v48
v_fmac_f32 v29, v14, v49
v_fmac_f32 v30, v14, v50
v_fmac_f32 v31, v14, v51
ds_read_b128 v[36:39], v24 offset:4096
ds_read_b128 v[40:43], v24 offset:5120
ds_read_b128 v[44:47], v24 offset:6144
ds_read_b128 v[48:51], v24 offset:7168
s_waitcnt lgkmcnt(0)
v_fmac_f32 v28, v16, v36
v_fmac_f32 v29, v16, v37
v_fmac_f32 v30, v16, v38
v_fmac_f32 v31, v16, v39
v_fmac_f32 v28, v18, v40
v_fmac_f32 v29, v18, v41
v_fmac_f32 v30, v18, v42
v_fmac_f32 v31, v18, v43
v_fmac_f32 v28, v20, v44
v_fmac_f32 v29, v20, v45
v_fmac_f32 v30, v20, v46
v_fmac_f32 v31, v20, v47
v_fmac_f32 v28, v22, v48
v_fmac_f32 v29, v22, v49
v_fmac_f32 v30, v22, v50
v_fmac_f32 v31, v22, v51
v_or_b32 v28, 1, v28
v_or_b32 v29, 1, v29
v_or_b32 v30, 1, v30
v_or_b32 v31, 1, v31
v_or_b32 v26, 1, v26
v_or_b32 v27, 1, v27
s_mul_i32 s56, s49, 14
s_add_u32 s56, s56, s50
s_mul_i32 s56, s56, 1088
s_add_u32 s56, s56, 0x177000
buffer_store_dwordx4 v[28:31], v1, s[44:47], s56 offen sc1
s_mov_b64 exec, 1
buffer_store_dwordx2 v[26:27], v1, s[44:47], s56 offen offset:1024 sc1
s_mov_b64 exec, -1
L_nos1_300:
s_nop 4
s_setprio 0
s_waitcnt vmcnt(5)
s_add_u32 s56, s52, 98304
buffer_load_dwordx4 v[96:99], v1, s[4:7], s56 offen offset:2048 nt
s_waitcnt vmcnt(5)
s_add_u32 s56, s52, 98304
buffer_load_dwordx4 v[100:103], v1, s[4:7], s56 offen offset:3072 nt
s_waitcnt vmcnt(5)
s_add_u32 s56, s52, 131072
buffer_load_dwordx4 v[104:107], v1, s[4:7], s56 offen offset:0 nt
s_waitcnt vmcnt(5)
s_add_u32 s56, s52, 131072
buffer_load_dwordx4 v[108:111], v1, s[4:7], s56 offen offset:1024 nt
s_waitcnt vmcnt(5)
s_add_u32 s56, s52, 131072
buffer_load_dwordx4 v[112:115], v1, s[4:7], s56 offen offset:2048 nt
s_waitcnt vmcnt(5)
s_add_u32 s56, s52, 131072
buffer_load_dwordx4 v[116:119], v1, s[4:7], s56 offen offset:3072 nt
s_waitcnt vmcnt(5)
s_add_u32 s56, s52, 163840
buffer_load_dwordx4 v[120:123], v1, s[4:7], s56 offen offset:0 nt
s_waitcnt vmcnt(5)
s_add_u32 s56, s52, 163840
buffer_load_dwordx4 v[124:127], v1, s[4:7], s56 offen offset:1024 nt
s_waitcnt vmcnt(5)
s_add_u32 s56, s52, 163840
buffer_load_dwordx4 v[128:131], v1, s[4:7], s56 offen offset:2048 nt
s_waitcnt vmcnt(5)
s_add_u32 s56, s52, 163840
buffer_load_dwordx4 v[132:135], v1, s[4:7], s56 offen offset:3072 nt
s_waitcnt vmcnt(5)
s_add_u32 s56, s52, 196608
buffer_load_dwordx4 v[136:139], v1, s[4:7], s56 offen offset:0 nt
s_waitcnt vmcnt(5)
s_add_u32 s56, s52, 196608
buffer_load_dwordx4 v[140:143], v1, s[4:7], s56 offen offset:1024 nt
s_waitcnt vmcnt(5)
s_add_u32 s56, s52, 196608
buffer_load_dwordx4 v[144:147], v1, s[4:7], s56 offen offset:2048 nt
s_waitcnt vmcnt(5)
s_add_u32 s56, s52, 196608
buffer_load_dwordx4 v[148:151], v1, s[4:7], s56 offen offset:3072 nt
s_waitcnt vmcnt(5)
s_add_u32 s56, s52, 229376
buffer_load_dwordx4 v[152:155], v1, s[4:7], s56 offen offset:0 nt
s_waitcnt vmcnt(5)
s_add_u32 s56, s52, 229376
buffer_load_dwordx4 v[156:159], v1, s[4:7], s56 offen offset:1024 nt
s_waitcnt vmcnt(5)
s_add_u32 s56, s52, 229376
buffer_load_dwordx4 v[160:163], v1, s[4:7], s56 offen offset:2048 nt
s_waitcnt vmcnt(5)
s_add_u32 s56, s52, 229376
buffer_load_dwordx4 v[164:167], v1, s[4:7], s56 offen offset:3072 nt
s_waitcnt vmcnt(5)
s_add_u32 s56, s52, 262144
buffer_load_dwordx4 v[168:171], v1, s[4:7], s56 offen offset:0 nt
s_waitcnt vmcnt(5)
s_add_u32 s56, s52, 262144
buffer_load_dwordx4 v[172:175], v1, s[4:7], s56 offen offset:1024 nt
v_and_b32 v32, 31, v3
v_lshlrev_b32 v32, 5, v32
s_lshl_b32 s56, s49, 10
s_add_u32 s56, s56, 0x414000
buffer_load_dwordx4 v[56:59], v32, s[44:47], s56 offen offset:0 sc1
buffer_load_dwordx4 v[60:63], v32, s[44:47], s56 offen offset:16 sc1
s_waitcnt vmcnt(5)
s_add_u32 s56, s52, 262144
buffer_load_dwordx4 v[176:179], v1, s[4:7], s56 offen offset:2048 nt
s_waitcnt vmcnt(5)
s_add_u32 s56, s52, 262144
buffer_load_dwordx4 v[180:183], v1, s[4:7], s56 offen offset:3072 nt
s_waitcnt vmcnt(5)
s_add_u32 s56, s52, 294912
buffer_load_dwordx4 v[184:187], v1, s[4:7], s56 offen offset:0 nt
s_waitcnt vmcnt(5)
s_add_u32 m0, s53, 14336
s_add_u32 s56, s52, 295936
buffer_load_dwordx4 v1, s[4:7], s56 offen nt lds
s_waitcnt vmcnt(5)
s_add_u32 m0, s53, 15360
s_add_u32 s56, s52, 296960
buffer_load_dwordx4 v1, s[4:7], s56 offen lds
s_waitcnt vmcnt(5)
s_add_u32 m0, s53, 16384
s_add_u32 s56, s52, 297984
buffer_load_dwordx4 v1, s[4:7], s56 offen lds
v_and_b32 v28, v56, v57
v_and_b32 v28, v28, v58
v_and_b32 v28, v28, v59
v_and_b32 v28, v28, v60
v_and_b32 v28, v28, v61
v_and_b32 v28, v28, v62
v_and_b32 v28, v28, v63
v_and_b32 v28, 1, v28
v_cmp_ne_u32 vcc, 1, v28
s_cbranch_vccz L_qburst_317
s_mov_b32 s60, 0
L_p_q_319:
s_nop 4
v_and_b32 v32, 31, v3
v_lshlrev_b32 v32, 5, v32
s_lshl_b32 s56, s49, 10
s_add_u32 s56, s56, 0x414000
buffer_load_dwordx4 v[56:59], v32, s[44:47], s56 offen offset:0 sc1
buffer_load_dwordx4 v[60:63], v32, s[44:47], s56 offen offset:16 sc1
s_waitcnt vmcnt(0)
v_and_b32 v28, v56, v57
v_and_b32 v28, v28, v58
v_and_b32 v28, v28, v59
v_and_b32 v28, v28, v60
v_and_b32 v28, v28, v61
v_and_b32 v28, v28, v62
v_and_b32 v28, v28, v63
v_and_b32 v28, 1, v28
v_cmp_ne_u32 vcc, 1, v28
s_cbranch_vccz L_d_q_320
s_sleep 1
s_add_u32 s60, s60, 1
s_cmp_lt_u32 s60, 400000
s_cbranch_scc1 L_p_q_319
s_endpgm
L_d_q_320:
s_nop 4
s_branch L_qjoin_318
L_qburst_317:
s_nop 4
L_qjoin_318:
s_nop 4
s_mov_b32 s56, 0x07060302
v_perm_b32 v4, v57, v56, s56
v_perm_b32 v5, v59, v58, s56
v_perm_b32 v6, v61, v60, s56
v_perm_b32 v7, v63, v62, s56
v_dot2_f32_bf16 v28, v188, v4, 0
v_dot2_f32_bf16 v29, v192, v4, 0
v_dot2_f32_bf16 v30, v196, v4, 0
v_dot2_f32_bf16 v31, v200, v4, 0
v_dot2_f32_bf16 v28, v189, v5, v28
v_dot2_f32_bf16 v29, v193, v5, v29
v_dot2_f32_bf16 v30, v197, v5, v30
v_dot2_f32_bf16 v31, v201, v5, v31
v_dot2_f32_bf16 v28, v190, v6, v28
v_dot2_f32_bf16 v29, v194, v6, v29
v_dot2_f32_bf16 v30, v198, v6, v30
v_dot2_f32_bf16 v31, v202, v6, v31
v_dot2_f32_bf16 v28, v191, v7, v28
v_dot2_f32_bf16 v29, v195, v7, v29
v_dot2_f32_bf16 v30, v199, v7, v30
v_dot2_f32_bf16 v31, v203, v7, v31
s_nop 0
v_permlane16_swap_b32 v28, v29
s_nop 0
v_permlane16_swap_b32 v30, v31
v_add_f32 v28, v28, v29
v_add_f32 v30, v30, v31
s_nop 0
v_add_f32_dpp v16, v28, v28 row_ror:8 row_mask:0xf bank_mask:0x3
v_add_f32_dpp v16, v30, v30 row_ror:8 row_mask:0xf bank_mask:0xc
buffer_load_dwordx4 v[188:191], v1, s[8:11], s52 offen offset:0
buffer_load_dwordx4 v[192:195], v1, s[8:11], s52 offen offset:1024
buffer_load_dwordx4 v[196:199], v1, s[8:11], s52 offen offset:2048
buffer_load_dwordx4 v[200:203], v1, s[8:11], s52 offen offset:3072
v_dot2_f32_bf16 v28, v204, v4, 0
v_dot2_f32_bf16 v29, v208, v4, 0
v_dot2_f32_bf16 v30, v212, v4, 0
v_dot2_f32_bf16 v31, v216, v4, 0
v_dot2_f32_bf16 v28, v205, v5, v28
v_dot2_f32_bf16 v29, v209, v5, v29
v_dot2_f32_bf16 v30, v213, v5, v30
v_dot2_f32_bf16 v31, v217, v5, v31
v_dot2_f32_bf16 v28, v206, v6, v28
v_dot2_f32_bf16 v29, v210, v6, v29
v_dot2_f32_bf16 v30, v214, v6, v30
v_dot2_f32_bf16 v31, v218, v6, v31
v_dot2_f32_bf16 v28, v207, v7, v28
v_dot2_f32_bf16 v29, v211, v7, v29
v_dot2_f32_bf16 v30, v215, v7, v30
v_dot2_f32_bf16 v31, v219, v7, v31
s_nop 0
v_permlane16_swap_b32 v28, v29
s_nop 0
v_permlane16_swap_b32 v30, v31
v_add_f32 v28, v28, v29
v_add_f32 v30, v30, v31
s_nop 0
v_add_f32_dpp v17, v28, v28 row_ror:8 row_mask:0xf bank_mask:0x3
v_add_f32_dpp v17, v30, v30 row_ror:8 row_mask:0xf bank_mask:0xc
s_add_u32 s56, s52, 32768
buffer_load_dwordx4 v[204:207], v1, s[8:11], s56 offen offset:0
s_add_u32 s56, s52, 32768
buffer_load_dwordx4 v[208:211], v1, s[8:11], s56 offen offset:1024
s_waitcnt vmcnt(11)
s_add_u32 s56, s52, 32768
buffer_load_dwordx4 v[212:215], v1, s[8:11], s56 offen offset:2048
s_waitcnt vmcnt(11)
s_add_u32 s56, s52, 32768
buffer_load_dwordx4 v[216:219], v1, s[8:11], s56 offen offset:3072
s_waitcnt vmcnt(11)
v_dot2_f32_bf16 v28, v220, v4, 0
v_dot2_f32_bf16 v29, v224, v4, 0
v_dot2_f32_bf16 v30, v228, v4, 0
v_dot2_f32_bf16 v31, v84, v4, 0
v_dot2_f32_bf16 v28, v221, v5, v28
v_dot2_f32_bf16 v29, v225, v5, v29
v_dot2_f32_bf16 v30, v229, v5, v30
v_dot2_f32_bf16 v31, v85, v5, v31
v_dot2_f32_bf16 v28, v222, v6, v28
v_dot2_f32_bf16 v29, v226, v6, v29
v_dot2_f32_bf16 v30, v230, v6, v30
v_dot2_f32_bf16 v31, v86, v6, v31
v_dot2_f32_bf16 v28, v223, v7, v28
v_dot2_f32_bf16 v29, v227, v7, v29
v_dot2_f32_bf16 v30, v231, v7, v30
v_dot2_f32_bf16 v31, v87, v7, v31
s_nop 0
v_permlane16_swap_b32 v28, v29
s_nop 0
v_permlane16_swap_b32 v30, v31
v_add_f32 v28, v28, v29
v_add_f32 v30, v30, v31
s_nop 0
v_add_f32_dpp v18, v28, v28 row_ror:8 row_mask:0xf bank_mask:0x3
v_add_f32_dpp v18, v30, v30 row_ror:8 row_mask:0xf bank_mask:0xc
s_add_u32 s56, s52, 65536
buffer_load_dwordx4 v[220:223], v1, s[8:11], s56 offen offset:0
s_waitcnt vmcnt(11)
s_add_u32 s56, s52, 65536
buffer_load_dwordx4 v[224:227], v1, s[8:11], s56 offen offset:1024
s_waitcnt vmcnt(11)
s_add_u32 s56, s52, 65536
buffer_load_dwordx4 v[228:231], v1, s[8:11], s56 offen offset:2048
s_waitcnt vmcnt(11)
s_add_u32 s56, s52, 65536
buffer_load_dwordx4 v[84:87], v1, s[8:11], s56 offen offset:3072
s_waitcnt vmcnt(11)
v_dot2_f32_bf16 v28, v88, v4, 0
v_dot2_f32_bf16 v29, v92, v4, 0
v_dot2_f32_bf16 v30, v96, v4, 0
v_dot2_f32_bf16 v31, v100, v4, 0
v_dot2_f32_bf16 v28, v89, v5, v28
v_dot2_f32_bf16 v29, v93, v5, v29
v_dot2_f32_bf16 v30, v97, v5, v30
v_dot2_f32_bf16 v31, v101, v5, v31
v_dot2_f32_bf16 v28, v90, v6, v28
v_dot2_f32_bf16 v29, v94, v6, v29
v_dot2_f32_bf16 v30, v98, v6, v30
v_dot2_f32_bf16 v31, v102, v6, v31
v_dot2_f32_bf16 v28, v91, v7, v28
v_dot2_f32_bf16 v29, v95, v7, v29
v_dot2_f32_bf16 v30, v99, v7, v30
v_dot2_f32_bf16 v31, v103, v7, v31
s_nop 0
v_permlane16_swap_b32 v28, v29
s_nop 0
v_permlane16_swap_b32 v30, v31
v_add_f32 v28, v28, v29
v_add_f32 v30, v30, v31
s_nop 0
v_add_f32_dpp v19, v28, v28 row_ror:8 row_mask:0xf bank_mask:0x3
v_add_f32_dpp v19, v30, v30 row_ror:8 row_mask:0xf bank_mask:0xc
s_add_u32 s56, s52, 98304
buffer_load_dwordx4 v[88:91], v1, s[8:11], s56 offen offset:0
s_waitcnt vmcnt(11)
s_add_u32 s56, s52, 98304
buffer_load_dwordx4 v[92:95], v1, s[8:11], s56 offen offset:1024
s_waitcnt vmcnt(11)
s_add_u32 s56, s52, 98304
buffer_load_dwordx4 v[96:99], v1, s[8:11], s56 offen offset:2048
s_waitcnt vmcnt(11)
s_add_u32 s56, s52, 98304
buffer_load_dwordx4 v[100:103], v1, s[8:11], s56 offen offset:3072
s_waitcnt vmcnt(11)
v_dot2_f32_bf16 v28, v104, v4, 0
v_dot2_f32_bf16 v29, v108, v4, 0
v_dot2_f32_bf16 v30, v112, v4, 0
v_dot2_f32_bf16 v31, v116, v4, 0
v_dot2_f32_bf16 v28, v105, v5, v28
v_dot2_f32_bf16 v29, v109, v5, v29
v_dot2_f32_bf16 v30, v113, v5, v30
v_dot2_f32_bf16 v31, v117, v5, v31
v_dot2_f32_bf16 v28, v106, v6, v28
v_dot2_f32_bf16 v29, v110, v6, v29
v_dot2_f32_bf16 v30, v114, v6, v30
v_dot2_f32_bf16 v31, v118, v6, v31
v_dot2_f32_bf16 v28, v107, v7, v28
v_dot2_f32_bf16 v29, v111, v7, v29
v_dot2_f32_bf16 v30, v115, v7, v30
v_dot2_f32_bf16 v31, v119, v7, v31
s_nop 0
v_permlane16_swap_b32 v28, v29
s_nop 0
v_permlane16_swap_b32 v30, v31
v_add_f32 v28, v28, v29
v_add_f32 v30, v30, v31
s_nop 0
v_add_f32_dpp v20, v28, v28 row_ror:8 row_mask:0xf bank_mask:0x3
v_add_f32_dpp v20, v30, v30 row_ror:8 row_mask:0xf bank_mask:0xc
s_add_u32 s56, s52, 131072
buffer_load_dwordx4 v[104:107], v1, s[8:11], s56 offen offset:0
s_waitcnt vmcnt(11)
s_add_u32 s56, s52, 131072
buffer_load_dwordx4 v[108:111], v1, s[8:11], s56 offen offset:1024
s_waitcnt vmcnt(11)
s_add_u32 s56, s52, 131072
buffer_load_dwordx4 v[112:115], v1, s[8:11], s56 offen offset:2048
s_waitcnt vmcnt(11)
s_add_u32 s56, s52, 131072
buffer_load_dwordx4 v[116:119], v1, s[8:11], s56 offen offset:3072
s_waitcnt vmcnt(11)
v_dot2_f32_bf16 v28, v120, v4, 0
v_dot2_f32_bf16 v29, v124, v4, 0
v_dot2_f32_bf16 v30, v128, v4, 0
v_dot2_f32_bf16 v31, v132, v4, 0
v_dot2_f32_bf16 v28, v121, v5, v28
v_dot2_f32_bf16 v29, v125, v5, v29
v_dot2_f32_bf16 v30, v129, v5, v30
v_dot2_f32_bf16 v31, v133, v5, v31
v_dot2_f32_bf16 v28, v122, v6, v28
v_dot2_f32_bf16 v29, v126, v6, v29
v_dot2_f32_bf16 v30, v130, v6, v30
v_dot2_f32_bf16 v31, v134, v6, v31
v_dot2_f32_bf16 v28, v123, v7, v28
v_dot2_f32_bf16 v29, v127, v7, v29
v_dot2_f32_bf16 v30, v131, v7, v30
v_dot2_f32_bf16 v31, v135, v7, v31
s_nop 0
v_permlane16_swap_b32 v28, v29
s_nop 0
v_permlane16_swap_b32 v30, v31
v_add_f32 v28, v28, v29
v_add_f32 v30, v30, v31
s_nop 0
v_add_f32_dpp v21, v28, v28 row_ror:8 row_mask:0xf bank_mask:0x3
v_add_f32_dpp v21, v30, v30 row_ror:8 row_mask:0xf bank_mask:0xc
v_dot2_f32_bf16 v28, v136, v4, 0
v_dot2_f32_bf16 v29, v140, v4, 0
v_dot2_f32_bf16 v30, v144, v4, 0
v_dot2_f32_bf16 v31, v148, v4, 0
v_dot2_f32_bf16 v28, v137, v5, v28
v_dot2_f32_bf16 v29, v141, v5, v29
v_dot2_f32_bf16 v30, v145, v5, v30
v_dot2_f32_bf16 v31, v149, v5, v31
v_dot2_f32_bf16 v28, v138, v6, v28
v_dot2_f32_bf16 v29, v142, v6, v29
v_dot2_f32_bf16 v30, v146, v6, v30
v_dot2_f32_bf16 v31, v150, v6, v31
v_dot2_f32_bf16 v28, v139, v7, v28
v_dot2_f32_bf16 v29, v143, v7, v29
v_dot2_f32_bf16 v30, v147, v7, v30
v_dot2_f32_bf16 v31, v151, v7, v31
s_nop 0
v_permlane16_swap_b32 v28, v29
s_nop 0
v_permlane16_swap_b32 v30, v31
v_add_f32 v28, v28, v29
v_add_f32 v30, v30, v31
s_nop 0
v_add_f32_dpp v22, v28, v28 row_ror:8 row_mask:0xf bank_mask:0x3
v_add_f32_dpp v22, v30, v30 row_ror:8 row_mask:0xf bank_mask:0xc
v_dot2_f32_bf16 v28, v152, v4, 0
v_dot2_f32_bf16 v29, v156, v4, 0
v_dot2_f32_bf16 v30, v160, v4, 0
v_dot2_f32_bf16 v31, v164, v4, 0
v_dot2_f32_bf16 v28, v153, v5, v28
v_dot2_f32_bf16 v29, v157, v5, v29
v_dot2_f32_bf16 v30, v161, v5, v30
v_dot2_f32_bf16 v31, v165, v5, v31
v_dot2_f32_bf16 v28, v154, v6, v28
v_dot2_f32_bf16 v29, v158, v6, v29
v_dot2_f32_bf16 v30, v162, v6, v30
v_dot2_f32_bf16 v31, v166, v6, v31
v_dot2_f32_bf16 v28, v155, v7, v28
v_dot2_f32_bf16 v29, v159, v7, v29
v_dot2_f32_bf16 v30, v163, v7, v30
v_dot2_f32_bf16 v31, v167, v7, v31
s_nop 0
v_permlane16_swap_b32 v28, v29
s_nop 0
v_permlane16_swap_b32 v30, v31
v_add_f32 v28, v28, v29
v_add_f32 v30, v30, v31
s_nop 0
v_add_f32_dpp v23, v28, v28 row_ror:8 row_mask:0xf bank_mask:0x3
v_add_f32_dpp v23, v30, v30 row_ror:8 row_mask:0xf bank_mask:0xc
v_dot2_f32_bf16 v28, v168, v4, 0
v_dot2_f32_bf16 v29, v172, v4, 0
v_dot2_f32_bf16 v30, v176, v4, 0
v_dot2_f32_bf16 v31, v180, v4, 0
v_dot2_f32_bf16 v28, v169, v5, v28
v_dot2_f32_bf16 v29, v173, v5, v29
v_dot2_f32_bf16 v30, v177, v5, v30
v_dot2_f32_bf16 v31, v181, v5, v31
v_dot2_f32_bf16 v28, v170, v6, v28
v_dot2_f32_bf16 v29, v174, v6, v29
v_dot2_f32_bf16 v30, v178, v6, v30
v_dot2_f32_bf16 v31, v182, v6, v31
v_dot2_f32_bf16 v28, v171, v7, v28
v_dot2_f32_bf16 v29, v175, v7, v29
v_dot2_f32_bf16 v30, v179, v7, v30
v_dot2_f32_bf16 v31, v183, v7, v31
s_nop 0
v_permlane16_swap_b32 v28, v29
s_nop 0
v_permlane16_swap_b32 v30, v31
v_add_f32 v28, v28, v29
v_add_f32 v30, v30, v31
s_nop 0
v_add_f32_dpp v24, v28, v28 row_ror:8 row_mask:0xf bank_mask:0x3
v_add_f32_dpp v24, v30, v30 row_ror:8 row_mask:0xf bank_mask:0xc
ds_read_b128 v[36:39], v2 offset:14336
ds_read_b128 v[40:43], v2 offset:15360
ds_read_b128 v[44:47], v2 offset:16384
s_waitcnt lgkmcnt(0)
v_dot2_f32_bf16 v28, v184, v4, 0
v_dot2_f32_bf16 v29, v36, v4, 0
v_dot2_f32_bf16 v30, v40, v4, 0
v_dot2_f32_bf16 v31, v44, v4, 0
v_dot2_f32_bf16 v28, v185, v5, v28
v_dot2_f32_bf16 v29, v37, v5, v29
v_dot2_f32_bf16 v30, v41, v5, v30
v_dot2_f32_bf16 v31, v45, v5, v31
v_dot2_f32_bf16 v28, v186, v6, v28
v_dot2_f32_bf16 v29, v38, v6, v29
v_dot2_f32_bf16 v30, v42, v6, v30
v_dot2_f32_bf16 v31, v46, v6, v31
v_dot2_f32_bf16 v28, v187, v7, v28
v_dot2_f32_bf16 v29, v39, v7, v29
v_dot2_f32_bf16 v30, v43, v7, v30
v_dot2_f32_bf16 v31, v47, v7, v31
s_nop 0
v_permlane16_swap_b32 v28, v29
s_nop 0
v_permlane16_swap_b32 v30, v31
v_add_f32 v28, v28, v29
v_add_f32 v30, v30, v31
s_nop 0
v_add_f32_dpp v25, v28, v28 row_ror:8 row_mask:0xf bank_mask:0x3
v_add_f32_dpp v25, v30, v30 row_ror:8 row_mask:0xf bank_mask:0xc
v_add_f32_dpp v16, v16, v16 quad_perm:[1,0,3,2]
v_add_f32_dpp v17, v17, v17 quad_perm:[1,0,3,2]
v_add_f32_dpp v18, v18, v18 quad_perm:[1,0,3,2]
v_add_f32_dpp v19, v19, v19 quad_perm:[1,0,3,2]
v_add_f32_dpp v20, v20, v20 quad_perm:[1,0,3,2]
v_add_f32_dpp v21, v21, v21 quad_perm:[1,0,3,2]
v_add_f32_dpp v22, v22, v22 quad_perm:[1,0,3,2]
v_add_f32_dpp v23, v23, v23 quad_perm:[1,0,3,2]
v_add_f32_dpp v24, v24, v24 quad_perm:[1,0,3,2]
v_add_f32_dpp v25, v25, v25 quad_perm:[1,0,3,2]
v_add_f32_dpp v16, v16, v16 quad_perm:[2,3,0,1]
v_add_f32_dpp v17, v17, v17 quad_perm:[2,3,0,1]
v_add_f32_dpp v18, v18, v18 quad_perm:[2,3,0,1]
v_add_f32_dpp v19, v19, v19 quad_perm:[2,3,0,1]
v_add_f32_dpp v20, v20, v20 quad_perm:[2,3,0,1]
v_add_f32_dpp v21, v21, v21 quad_perm:[2,3,0,1]
v_add_f32_dpp v22, v22, v22 quad_perm:[2,3,0,1]
v_add_f32_dpp v23, v23, v23 quad_perm:[2,3,0,1]
v_add_f32_dpp v24, v24, v24 quad_perm:[2,3,0,1]
v_add_f32_dpp v25, v25, v25 quad_perm:[2,3,0,1]
v_add_f32_dpp v16, v16, v16 row_half_mirror
v_add_f32_dpp v17, v17, v17 row_half_mirror
v_add_f32_dpp v18, v18, v18 row_half_mirror
v_add_f32_dpp v19, v19, v19 row_half_mirror
v_add_f32_dpp v20, v20, v20 row_half_mirror
v_add_f32_dpp v21, v21, v21 row_half_mirror
v_add_f32_dpp v22, v22, v22 row_half_mirror
v_add_f32_dpp v23, v23, v23 row_half_mirror
v_add_f32_dpp v24, v24, v24 row_half_mirror
v_add_f32_dpp v25, v25, v25 row_half_mirror
v_cvt_pk_bf16_f32 v16, v16, v16
v_cvt_pk_bf16_f32 v17, v17, v17
v_cvt_pk_bf16_f32 v18, v18, v18
v_cvt_pk_bf16_f32 v19, v19, v19
v_cvt_pk_bf16_f32 v20, v20, v20
v_cvt_pk_bf16_f32 v21, v21, v21
v_cvt_pk_bf16_f32 v22, v22, v22
v_cvt_pk_bf16_f32 v23, v23, v23
v_cvt_pk_bf16_f32 v24, v24, v24
v_cvt_pk_bf16_f32 v25, v25, v25
v_and_b32 v16, s62, v16
v_and_b32 v17, s62, v17
v_and_b32 v18, s62, v18
v_and_b32 v19, s62, v19
v_and_b32 v20, s62, v20
v_and_b32 v21, s62, v21
v_and_b32 v22, s62, v22
v_and_b32 v23, s62, v23
v_and_b32 v24, s62, v24
v_and_b32 v25, s62, v25
v_mul_f32 v16, 0x3d800000, v16
v_mul_f32 v17, 0x3d800000, v17
v_mul_f32 v18, 0x3d800000, v18
v_mul_f32 v19, 0x3d800000, v19
v_mul_f32 v20, 0x3d800000, v20
v_mul_f32 v21, 0x3d800000, v21
v_mul_f32 v22, 0x3d800000, v22
v_mul_f32 v23, 0x3d800000, v23
v_mul_f32 v24, 0x3d800000, v24
v_mul_f32 v25, 0x3d800000, v25
v_max_f32 v26, v16, v17
v_max_f32 v26, v26, v18
v_max_f32 v26, v26, v19
v_max_f32 v26, v26, v20
v_max_f32 v26, v26, v21
v_max_f32 v26, v26, v22
v_max_f32 v26, v26, v23
v_max_f32 v26, v26, v24
v_max_f32 v26, v26, v25
s_nop 1
v_max_f32_dpp v26, v26, v26 row_ror:8
v_mov_b32 v28, v26
s_nop 1
v_permlane16_swap_b32 v26, v28
v_max_f32 v26, v26, v28
v_mov_b32 v28, v26
s_nop 1
v_permlane32_swap_b32 v26, v28
v_max_f32 v26, v26, v28
v_sub_f32 v16, v16, v26
v_sub_f32 v17, v17, v26
v_sub_f32 v18, v18, v26
v_sub_f32 v19, v19, v26
v_sub_f32 v20, v20, v26
v_sub_f32 v21, v21, v26
v_sub_f32 v22, v22, v26
v_sub_f32 v23, v23, v26
v_sub_f32 v24, v24, v26
v_sub_f32 v25, v25, v26
v_mul_f32 v16, 0x3fb8aa3b, v16
v_mul_f32 v17, 0x3fb8aa3b, v17
v_mul_f32 v18, 0x3fb8aa3b, v18
v_mul_f32 v19, 0x3fb8aa3b, v19
v_mul_f32 v20, 0x3fb8aa3b, v20
v_mul_f32 v21, 0x3fb8aa3b, v21
v_mul_f32 v22, 0x3fb8aa3b, v22
v_mul_f32 v23, 0x3fb8aa3b, v23
v_mul_f32 v24, 0x3fb8aa3b, v24
v_mul_f32 v25, 0x3fb8aa3b, v25
v_exp_f32 v16, v16
v_exp_f32 v17, v17
v_exp_f32 v18, v18
v_exp_f32 v19, v19
v_exp_f32 v20, v20
v_exp_f32 v21, v21
v_exp_f32 v22, v22
v_exp_f32 v23, v23
v_exp_f32 v24, v24
v_exp_f32 v25, v25
v_add_f32 v27, v16, v17
v_add_f32 v27, v27, v18
v_add_f32 v27, v27, v19
v_add_f32 v27, v27, v20
v_add_f32 v27, v27, v21
v_add_f32 v27, v27, v22
v_add_f32 v27, v27, v23
v_add_f32 v27, v27, v24
v_add_f32 v27, v27, v25
s_nop 1
v_add_f32_dpp v27, v27, v27 row_ror:8
v_mov_b32 v28, v27
s_nop 1
v_permlane16_swap_b32 v27, v28
v_add_f32 v27, v27, v28
v_mov_b32 v28, v27
s_nop 1
v_permlane32_swap_b32 v27, v28
v_add_f32 v27, v27, v28
v_mov_b32 v36, v16
v_mov_b32 v37, v17
v_mov_b32 v38, v18
v_mov_b32 v39, v19
v_mov_b32 v40, v20
v_mov_b32 v41, v21
v_mov_b32 v42, v22
v_mov_b32 v43, v23
v_mov_b32 v44, v24
v_mov_b32 v45, v25
v_permlane16_swap_b32 v16, v36
v_permlane16_swap_b32 v17, v37
v_permlane16_swap_b32 v18, v38
v_permlane16_swap_b32 v19, v39
v_permlane16_swap_b32 v20, v40
v_permlane16_swap_b32 v21, v41
v_permlane16_swap_b32 v22, v42
v_permlane16_swap_b32 v23, v43
v_permlane16_swap_b32 v24, v44
v_permlane16_swap_b32 v25, v45
v_cvt_pk_bf16_f32 v16, v16, v36
v_cvt_pk_bf16_f32 v17, v17, v37
v_cvt_pk_bf16_f32 v18, v18, v38
v_cvt_pk_bf16_f32 v19, v19, v39
v_cvt_pk_bf16_f32 v20, v20, v40
v_cvt_pk_bf16_f32 v21, v21, v41
v_cvt_pk_bf16_f32 v22, v22, v42
v_cvt_pk_bf16_f32 v23, v23, v43
v_cvt_pk_bf16_f32 v24, v24, v44
v_cvt_pk_bf16_f32 v25, v25, v45
v_mov_b32 v8, 0
v_mov_b32 v9, 0
v_mov_b32 v10, 0
v_mov_b32 v11, 0
v_mov_b32 v12, 0
v_mov_b32 v13, 0
v_mov_b32 v14, 0
v_mov_b32 v15, 0
v_perm_b32 v28, v192, v188, s80
v_perm_b32 v29, v192, v188, s81
v_perm_b32 v30, v193, v189, s80
v_perm_b32 v31, v193, v189, s81
v_perm_b32 v32, v194, v190, s80
v_perm_b32 v33, v194, v190, s81
v_perm_b32 v34, v195, v191, s80
v_perm_b32 v35, v195, v191, s81
v_dot2c_f32_bf16_dpp v8, v16, v28 row_newbcast:0
v_dot2c_f32_bf16_dpp v9, v16, v29 row_newbcast:0
v_dot2c_f32_bf16_dpp v10, v16, v30 row_newbcast:0
v_dot2c_f32_bf16_dpp v11, v16, v31 row_newbcast:0
v_dot2c_f32_bf16_dpp v12, v16, v32 row_newbcast:0
v_dot2c_f32_bf16_dpp v13, v16, v33 row_newbcast:0
v_dot2c_f32_bf16_dpp v14, v16, v34 row_newbcast:0
v_dot2c_f32_bf16_dpp v15, v16, v35 row_newbcast:0
v_perm_b32 v28, v200, v196, s80
v_perm_b32 v29, v200, v196, s81
v_perm_b32 v30, v201, v197, s80
v_perm_b32 v31, v201, v197, s81
v_perm_b32 v32, v202, v198, s80
v_perm_b32 v33, v202, v198, s81
v_perm_b32 v34, v203, v199, s80
v_perm_b32 v35, v203, v199, s81
v_dot2c_f32_bf16_dpp v8, v16, v28 row_newbcast:8
v_dot2c_f32_bf16_dpp v9, v16, v29 row_newbcast:8
v_dot2c_f32_bf16_dpp v10, v16, v30 row_newbcast:8
v_dot2c_f32_bf16_dpp v11, v16, v31 row_newbcast:8
v_dot2c_f32_bf16_dpp v12, v16, v32 row_newbcast:8
v_dot2c_f32_bf16_dpp v13, v16, v33 row_newbcast:8
v_dot2c_f32_bf16_dpp v14, v16, v34 row_newbcast:8
v_dot2c_f32_bf16_dpp v15, v16, v35 row_newbcast:8
v_perm_b32 v28, v208, v204, s80
v_perm_b32 v29, v208, v204, s81
v_perm_b32 v30, v209, v205, s80
v_perm_b32 v31, v209, v205, s81
v_perm_b32 v32, v210, v206, s80
v_perm_b32 v33, v210, v206, s81
v_perm_b32 v34, v211, v207, s80
v_perm_b32 v35, v211, v207, s81
v_dot2c_f32_bf16_dpp v8, v17, v28 row_newbcast:0
v_dot2c_f32_bf16_dpp v9, v17, v29 row_newbcast:0
v_dot2c_f32_bf16_dpp v10, v17, v30 row_newbcast:0
v_dot2c_f32_bf16_dpp v11, v17, v31 row_newbcast:0
v_dot2c_f32_bf16_dpp v12, v17, v32 row_newbcast:0
v_dot2c_f32_bf16_dpp v13, v17, v33 row_newbcast:0
v_dot2c_f32_bf16_dpp v14, v17, v34 row_newbcast:0
v_dot2c_f32_bf16_dpp v15, v17, v35 row_newbcast:0
v_perm_b32 v28, v216, v212, s80
v_perm_b32 v29, v216, v212, s81
v_perm_b32 v30, v217, v213, s80
v_perm_b32 v31, v217, v213, s81
v_perm_b32 v32, v218, v214, s80
v_perm_b32 v33, v218, v214, s81
v_perm_b32 v34, v219, v215, s80
v_perm_b32 v35, v219, v215, s81
v_dot2c_f32_bf16_dpp v8, v17, v28 row_newbcast:8
v_dot2c_f32_bf16_dpp v9, v17, v29 row_newbcast:8
v_dot2c_f32_bf16_dpp v10, v17, v30 row_newbcast:8
v_dot2c_f32_bf16_dpp v11, v17, v31 row_newbcast:8
v_dot2c_f32_bf16_dpp v12, v17, v32 row_newbcast:8
v_dot2c_f32_bf16_dpp v13, v17, v33 row_newbcast:8
v_dot2c_f32_bf16_dpp v14, v17, v34 row_newbcast:8
v_dot2c_f32_bf16_dpp v15, v17, v35 row_newbcast:8
s_waitcnt vmcnt(10)
v_perm_b32 v28, v224, v220, s80
v_perm_b32 v29, v224, v220, s81
v_perm_b32 v30, v225, v221, s80
v_perm_b32 v31, v225, v221, s81
v_perm_b32 v32, v226, v222, s80
v_perm_b32 v33, v226, v222, s81
v_perm_b32 v34, v227, v223, s80
v_perm_b32 v35, v227, v223, s81
v_dot2c_f32_bf16_dpp v8, v18, v28 row_newbcast:0
v_dot2c_f32_bf16_dpp v9, v18, v29 row_newbcast:0
v_dot2c_f32_bf16_dpp v10, v18, v30 row_newbcast:0
v_dot2c_f32_bf16_dpp v11, v18, v31 row_newbcast:0
v_dot2c_f32_bf16_dpp v12, v18, v32 row_newbcast:0
v_dot2c_f32_bf16_dpp v13, v18, v33 row_newbcast:0
v_dot2c_f32_bf16_dpp v14, v18, v34 row_newbcast:0
v_dot2c_f32_bf16_dpp v15, v18, v35 row_newbcast:0
s_waitcnt vmcnt(9)
s_waitcnt vmcnt(8)
v_perm_b32 v28, v84, v228, s80
v_perm_b32 v29, v84, v228, s81
v_perm_b32 v30, v85, v229, s80
v_perm_b32 v31, v85, v229, s81
v_perm_b32 v32, v86, v230, s80
v_perm_b32 v33, v86, v230, s81
v_perm_b32 v34, v87, v231, s80
v_perm_b32 v35, v87, v231, s81
v_dot2c_f32_bf16_dpp v8, v18, v28 row_newbcast:8
v_dot2c_f32_bf16_dpp v9, v18, v29 row_newbcast:8
v_dot2c_f32_bf16_dpp v10, v18, v30 row_newbcast:8
v_dot2c_f32_bf16_dpp v11, v18, v31 row_newbcast:8
v_dot2c_f32_bf16_dpp v12, v18, v32 row_newbcast:8
v_dot2c_f32_bf16_dpp v13, v18, v33 row_newbcast:8
v_dot2c_f32_bf16_dpp v14, v18, v34 row_newbcast:8
v_dot2c_f32_bf16_dpp v15, v18, v35 row_newbcast:8
s_waitcnt vmcnt(7)
s_waitcnt vmcnt(6)
v_perm_b32 v28, v92, v88, s80
v_perm_b32 v29, v92, v88, s81
v_perm_b32 v30, v93, v89, s80
v_perm_b32 v31, v93, v89, s81
v_perm_b32 v32, v94, v90, s80
v_perm_b32 v33, v94, v90, s81
v_perm_b32 v34, v95, v91, s80
v_perm_b32 v35, v95, v91, s81
v_dot2c_f32_bf16_dpp v8, v19, v28 row_newbcast:0
v_dot2c_f32_bf16_dpp v9, v19, v29 row_newbcast:0
v_dot2c_f32_bf16_dpp v10, v19, v30 row_newbcast:0
v_dot2c_f32_bf16_dpp v11, v19, v31 row_newbcast:0
v_dot2c_f32_bf16_dpp v12, v19, v32 row_newbcast:0
v_dot2c_f32_bf16_dpp v13, v19, v33 row_newbcast:0
v_dot2c_f32_bf16_dpp v14, v19, v34 row_newbcast:0
v_dot2c_f32_bf16_dpp v15, v19, v35 row_newbcast:0
s_waitcnt vmcnt(5)
s_waitcnt vmcnt(4)
v_perm_b32 v28, v100, v96, s80
v_perm_b32 v29, v100, v96, s81
v_perm_b32 v30, v101, v97, s80
v_perm_b32 v31, v101, v97, s81
v_perm_b32 v32, v102, v98, s80
v_perm_b32 v33, v102, v98, s81
v_perm_b32 v34, v103, v99, s80
v_perm_b32 v35, v103, v99, s81
v_dot2c_f32_bf16_dpp v8, v19, v28 row_newbcast:8
v_dot2c_f32_bf16_dpp v9, v19, v29 row_newbcast:8
v_dot2c_f32_bf16_dpp v10, v19, v30 row_newbcast:8
v_dot2c_f32_bf16_dpp v11, v19, v31 row_newbcast:8
v_dot2c_f32_bf16_dpp v12, v19, v32 row_newbcast:8
v_dot2c_f32_bf16_dpp v13, v19, v33 row_newbcast:8
v_dot2c_f32_bf16_dpp v14, v19, v34 row_newbcast:8
v_dot2c_f32_bf16_dpp v15, v19, v35 row_newbcast:8
s_waitcnt vmcnt(3)
s_waitcnt vmcnt(2)
v_perm_b32 v28, v108, v104, s80
v_perm_b32 v29, v108, v104, s81
v_perm_b32 v30, v109, v105, s80
v_perm_b32 v31, v109, v105, s81
v_perm_b32 v32, v110, v106, s80
v_perm_b32 v33, v110, v106, s81
v_perm_b32 v34, v111, v107, s80
v_perm_b32 v35, v111, v107, s81
v_dot2c_f32_bf16_dpp v8, v20, v28 row_newbcast:0
v_dot2c_f32_bf16_dpp v9, v20, v29 row_newbcast:0
v_dot2c_f32_bf16_dpp v10, v20, v30 row_newbcast:0
v_dot2c_f32_bf16_dpp v11, v20, v31 row_newbcast:0
v_dot2c_f32_bf16_dpp v12, v20, v32 row_newbcast:0
v_dot2c_f32_bf16_dpp v13, v20, v33 row_newbcast:0
v_dot2c_f32_bf16_dpp v14, v20, v34 row_newbcast:0
v_dot2c_f32_bf16_dpp v15, v20, v35 row_newbcast:0
s_waitcnt vmcnt(1)
s_waitcnt vmcnt(0)
v_perm_b32 v28, v116, v112, s80
v_perm_b32 v29, v116, v112, s81
v_perm_b32 v30, v117, v113, s80
v_perm_b32 v31, v117, v113, s81
v_perm_b32 v32, v118, v114, s80
v_perm_b32 v33, v118, v114, s81
v_perm_b32 v34, v119, v115, s80
v_perm_b32 v35, v119, v115, s81
v_dot2c_f32_bf16_dpp v8, v20, v28 row_newbcast:8
v_dot2c_f32_bf16_dpp v9, v20, v29 row_newbcast:8
v_dot2c_f32_bf16_dpp v10, v20, v30 row_newbcast:8
v_dot2c_f32_bf16_dpp v11, v20, v31 row_newbcast:8
v_dot2c_f32_bf16_dpp v12, v20, v32 row_newbcast:8
v_dot2c_f32_bf16_dpp v13, v20, v33 row_newbcast:8
v_dot2c_f32_bf16_dpp v14, v20, v34 row_newbcast:8
v_dot2c_f32_bf16_dpp v15, v20, v35 row_newbcast:8
v_perm_b32 v28, v244, v240, s80
v_perm_b32 v29, v244, v240, s81
v_perm_b32 v30, v245, v241, s80
v_perm_b32 v31, v245, v241, s81
v_perm_b32 v32, v246, v242, s80
v_perm_b32 v33, v246, v242, s81
v_perm_b32 v34, v247, v243, s80
v_perm_b32 v35, v247, v243, s81
v_dot2c_f32_bf16_dpp v8, v21, v28 row_newbcast:0
v_dot2c_f32_bf16_dpp v9, v21, v29 row_newbcast:0
v_dot2c_f32_bf16_dpp v10, v21, v30 row_newbcast:0
v_dot2c_f32_bf16_dpp v11, v21, v31 row_newbcast:0
v_dot2c_f32_bf16_dpp v12, v21, v32 row_newbcast:0
v_dot2c_f32_bf16_dpp v13, v21, v33 row_newbcast:0
v_dot2c_f32_bf16_dpp v14, v21, v34 row_newbcast:0
v_dot2c_f32_bf16_dpp v15, v21, v35 row_newbcast:0
v_perm_b32 v28, v252, v248, s80
v_perm_b32 v29, v252, v248, s81
v_perm_b32 v30, v253, v249, s80
v_perm_b32 v31, v253, v249, s81
v_perm_b32 v32, v254, v250, s80
v_perm_b32 v33, v254, v250, s81
v_perm_b32 v34, v255, v251, s80
v_perm_b32 v35, v255, v251, s81
v_dot2c_f32_bf16_dpp v8, v21, v28 row_newbcast:8
v_dot2c_f32_bf16_dpp v9, v21, v29 row_newbcast:8
v_dot2c_f32_bf16_dpp v10, v21, v30 row_newbcast:8
v_dot2c_f32_bf16_dpp v11, v21, v31 row_newbcast:8
v_dot2c_f32_bf16_dpp v12, v21, v32 row_newbcast:8
v_dot2c_f32_bf16_dpp v13, v21, v33 row_newbcast:8
v_dot2c_f32_bf16_dpp v14, v21, v34 row_newbcast:8
v_dot2c_f32_bf16_dpp v15, v21, v35 row_newbcast:8
v_perm_b32 v28, v236, v232, s80
v_perm_b32 v29, v236, v232, s81
v_perm_b32 v30, v237, v233, s80
v_perm_b32 v31, v237, v233, s81
v_perm_b32 v32, v238, v234, s80
v_perm_b32 v33, v238, v234, s81
v_perm_b32 v34, v239, v235, s80
v_perm_b32 v35, v239, v235, s81
v_dot2c_f32_bf16_dpp v8, v22, v28 row_newbcast:0
v_dot2c_f32_bf16_dpp v9, v22, v29 row_newbcast:0
v_dot2c_f32_bf16_dpp v10, v22, v30 row_newbcast:0
v_dot2c_f32_bf16_dpp v11, v22, v31 row_newbcast:0
v_dot2c_f32_bf16_dpp v12, v22, v32 row_newbcast:0
v_dot2c_f32_bf16_dpp v13, v22, v33 row_newbcast:0
v_dot2c_f32_bf16_dpp v14, v22, v34 row_newbcast:0
v_dot2c_f32_bf16_dpp v15, v22, v35 row_newbcast:0
ds_read_b128 v[36:39], v2 offset:0
ds_read_b128 v[40:43], v2 offset:1024
s_waitcnt lgkmcnt(0)
v_perm_b32 v28, v40, v36, s80
v_perm_b32 v29, v40, v36, s81
v_perm_b32 v30, v41, v37, s80
v_perm_b32 v31, v41, v37, s81
v_perm_b32 v32, v42, v38, s80
v_perm_b32 v33, v42, v38, s81
v_perm_b32 v34, v43, v39, s80
v_perm_b32 v35, v43, v39, s81
v_dot2c_f32_bf16_dpp v8, v22, v28 row_newbcast:8
v_dot2c_f32_bf16_dpp v9, v22, v29 row_newbcast:8
v_dot2c_f32_bf16_dpp v10, v22, v30 row_newbcast:8
v_dot2c_f32_bf16_dpp v11, v22, v31 row_newbcast:8
v_dot2c_f32_bf16_dpp v12, v22, v32 row_newbcast:8
v_dot2c_f32_bf16_dpp v13, v22, v33 row_newbcast:8
v_dot2c_f32_bf16_dpp v14, v22, v34 row_newbcast:8
v_dot2c_f32_bf16_dpp v15, v22, v35 row_newbcast:8
ds_read_b128 v[36:39], v2 offset:2048
ds_read_b128 v[40:43], v2 offset:3072
s_waitcnt lgkmcnt(0)
v_perm_b32 v28, v40, v36, s80
v_perm_b32 v29, v40, v36, s81
v_perm_b32 v30, v41, v37, s80
v_perm_b32 v31, v41, v37, s81
v_perm_b32 v32, v42, v38, s80
v_perm_b32 v33, v42, v38, s81
v_perm_b32 v34, v43, v39, s80
v_perm_b32 v35, v43, v39, s81
v_dot2c_f32_bf16_dpp v8, v23, v28 row_newbcast:0
v_dot2c_f32_bf16_dpp v9, v23, v29 row_newbcast:0
v_dot2c_f32_bf16_dpp v10, v23, v30 row_newbcast:0
v_dot2c_f32_bf16_dpp v11, v23, v31 row_newbcast:0
v_dot2c_f32_bf16_dpp v12, v23, v32 row_newbcast:0
v_dot2c_f32_bf16_dpp v13, v23, v33 row_newbcast:0
v_dot2c_f32_bf16_dpp v14, v23, v34 row_newbcast:0
v_dot2c_f32_bf16_dpp v15, v23, v35 row_newbcast:0
ds_read_b128 v[36:39], v2 offset:4096
ds_read_b128 v[40:43], v2 offset:5120
s_waitcnt lgkmcnt(0)
v_perm_b32 v28, v40, v36, s80
v_perm_b32 v29, v40, v36, s81
v_perm_b32 v30, v41, v37, s80
v_perm_b32 v31, v41, v37, s81
v_perm_b32 v32, v42, v38, s80
v_perm_b32 v33, v42, v38, s81
v_perm_b32 v34, v43, v39, s80
v_perm_b32 v35, v43, v39, s81
v_dot2c_f32_bf16_dpp v8, v23, v28 row_newbcast:8
v_dot2c_f32_bf16_dpp v9, v23, v29 row_newbcast:8
v_dot2c_f32_bf16_dpp v10, v23, v30 row_newbcast:8
v_dot2c_f32_bf16_dpp v11, v23, v31 row_newbcast:8
v_dot2c_f32_bf16_dpp v12, v23, v32 row_newbcast:8
v_dot2c_f32_bf16_dpp v13, v23, v33 row_newbcast:8
v_dot2c_f32_bf16_dpp v14, v23, v34 row_newbcast:8
v_dot2c_f32_bf16_dpp v15, v23, v35 row_newbcast:8
ds_read_b128 v[36:39], v2 offset:6144
ds_read_b128 v[40:43], v2 offset:7168
s_waitcnt lgkmcnt(0)
v_perm_b32 v28, v40, v36, s80
v_perm_b32 v29, v40, v36, s81
v_perm_b32 v30, v41, v37, s80
v_perm_b32 v31, v41, v37, s81
v_perm_b32 v32, v42, v38, s80
v_perm_b32 v33, v42, v38, s81
v_perm_b32 v34, v43, v39, s80
v_perm_b32 v35, v43, v39, s81
v_dot2c_f32_bf16_dpp v8, v24, v28 row_newbcast:0
v_dot2c_f32_bf16_dpp v9, v24, v29 row_newbcast:0
v_dot2c_f32_bf16_dpp v10, v24, v30 row_newbcast:0
v_dot2c_f32_bf16_dpp v11, v24, v31 row_newbcast:0
v_dot2c_f32_bf16_dpp v12, v24, v32 row_newbcast:0
v_dot2c_f32_bf16_dpp v13, v24, v33 row_newbcast:0
v_dot2c_f32_bf16_dpp v14, v24, v34 row_newbcast:0
v_dot2c_f32_bf16_dpp v15, v24, v35 row_newbcast:0
ds_read_b128 v[36:39], v2 offset:8192
ds_read_b128 v[40:43], v2 offset:9216
s_waitcnt lgkmcnt(0)
v_perm_b32 v28, v40, v36, s80
v_perm_b32 v29, v40, v36, s81
v_perm_b32 v30, v41, v37, s80
v_perm_b32 v31, v41, v37, s81
v_perm_b32 v32, v42, v38, s80
v_perm_b32 v33, v42, v38, s81
v_perm_b32 v34, v43, v39, s80
v_perm_b32 v35, v43, v39, s81
v_dot2c_f32_bf16_dpp v8, v24, v28 row_newbcast:8
v_dot2c_f32_bf16_dpp v9, v24, v29 row_newbcast:8
v_dot2c_f32_bf16_dpp v10, v24, v30 row_newbcast:8
v_dot2c_f32_bf16_dpp v11, v24, v31 row_newbcast:8
v_dot2c_f32_bf16_dpp v12, v24, v32 row_newbcast:8
v_dot2c_f32_bf16_dpp v13, v24, v33 row_newbcast:8
v_dot2c_f32_bf16_dpp v14, v24, v34 row_newbcast:8
v_dot2c_f32_bf16_dpp v15, v24, v35 row_newbcast:8
ds_read_b128 v[36:39], v2 offset:10240
ds_read_b128 v[40:43], v2 offset:11264
s_waitcnt lgkmcnt(0)
v_perm_b32 v28, v40, v36, s80
v_perm_b32 v29, v40, v36, s81
v_perm_b32 v30, v41, v37, s80
v_perm_b32 v31, v41, v37, s81
v_perm_b32 v32, v42, v38, s80
v_perm_b32 v33, v42, v38, s81
v_perm_b32 v34, v43, v39, s80
v_perm_b32 v35, v43, v39, s81
v_dot2c_f32_bf16_dpp v8, v25, v28 row_newbcast:0
v_dot2c_f32_bf16_dpp v9, v25, v29 row_newbcast:0
v_dot2c_f32_bf16_dpp v10, v25, v30 row_newbcast:0
v_dot2c_f32_bf16_dpp v11, v25, v31 row_newbcast:0
v_dot2c_f32_bf16_dpp v12, v25, v32 row_newbcast:0
v_dot2c_f32_bf16_dpp v13, v25, v33 row_newbcast:0
v_dot2c_f32_bf16_dpp v14, v25, v34 row_newbcast:0
v_dot2c_f32_bf16_dpp v15, v25, v35 row_newbcast:0
ds_read_b128 v[36:39], v2 offset:12288
ds_read_b128 v[40:43], v2 offset:13312
s_waitcnt lgkmcnt(0)
v_perm_b32 v28, v40, v36, s80
v_perm_b32 v29, v40, v36, s81
v_perm_b32 v30, v41, v37, s80
v_perm_b32 v31, v41, v37, s81
v_perm_b32 v32, v42, v38, s80
v_perm_b32 v33, v42, v38, s81
v_perm_b32 v34, v43, v39, s80
v_perm_b32 v35, v43, v39, s81
v_dot2c_f32_bf16_dpp v8, v25, v28 row_newbcast:8
v_dot2c_f32_bf16_dpp v9, v25, v29 row_newbcast:8
v_dot2c_f32_bf16_dpp v10, v25, v30 row_newbcast:8
v_dot2c_f32_bf16_dpp v11, v25, v31 row_newbcast:8
v_dot2c_f32_bf16_dpp v12, v25, v32 row_newbcast:8
v_dot2c_f32_bf16_dpp v13, v25, v33 row_newbcast:8
v_dot2c_f32_bf16_dpp v14, v25, v34 row_newbcast:8
v_dot2c_f32_bf16_dpp v15, v25, v35 row_newbcast:8
v_mov_b32 v36, v8
v_mov_b32 v37, v9
v_mov_b32 v38, v10
v_mov_b32 v39, v11
v_mov_b32 v40, v12
v_mov_b32 v41, v13
v_mov_b32 v42, v14
v_mov_b32 v43, v15
v_permlane32_swap_b32 v8, v36
v_permlane32_swap_b32 v9, v37
v_permlane32_swap_b32 v10, v38
v_permlane32_swap_b32 v11, v39
v_permlane32_swap_b32 v12, v40
v_permlane32_swap_b32 v13, v41
v_permlane32_swap_b32 v14, v42
v_permlane32_swap_b32 v15, v43
v_add_f32 v8, v8, v36
v_add_f32 v9, v9, v37
v_add_f32 v10, v10, v38
v_add_f32 v11, v11, v39
v_add_f32 v12, v12, v40
v_add_f32 v13, v13, v41
v_add_f32 v14, v14, v42
v_add_f32 v15, v15, v43
v_and_b32 v28, 31, v3
v_lshlrev_b32 v28, 5, v28
s_lshl_b32 s56, s48, 10
s_add_u32 s56, s56, 0x2000
v_add_u32 v28, s56, v28
ds_write_b128 v28, v[8:11]
ds_write_b128 v28, v[12:15] offset:16
s_lshl_b32 s56, s48, 3
s_add_u32 s56, s56, 0x4040
v_mov_b32 v29, s56
ds_write_b64 v29, v[26:27]
v_mov_b32 v30, 0x408c
v_mov_b32 v31, 1
s_waitcnt lgkmcnt(0)
s_mov_b64 exec, 1
ds_add_rtn_u32 v28, v30, v31
s_mov_b64 exec, -1
s_waitcnt lgkmcnt(0)
v_readfirstlane_b32 s59, v28
s_nop 0
s_cmp_lg_u32 s59, 7
s_cbranch_scc1 L_nos1_344
s_setprio 3
v_add_u32 v24, 0x2000, v1
v_mov_b32 v25, 0x4040
ds_read_b128 v[8:11], v25 offset:0
ds_read_b128 v[12:15], v25 offset:16
ds_read_b128 v[16:19], v25 offset:32
ds_read_b128 v[20:23], v25 offset:48
ds_read_b128 v[36:39], v24 offset:0
ds_read_b128 v[40:43], v24 offset:1024
ds_read_b128 v[44:47], v24 offset:2048
ds_read_b128 v[48:51], v24 offset:3072
s_waitcnt lgkmcnt(0)
v_max_f32 v26, v8, v10
v_max_f32 v26, v26, v12
v_max_f32 v26, v26, v14
v_max_f32 v26, v26, v16
v_max_f32 v26, v26, v18
v_max_f32 v26, v26, v20
v_max_f32 v26, v26, v22
v_sub_f32 v8, v8, v26
v_sub_f32 v10, v10, v26
v_sub_f32 v12, v12, v26
v_sub_f32 v14, v14, v26
v_sub_f32 v16, v16, v26
v_sub_f32 v18, v18, v26
v_sub_f32 v20, v20, v26
v_sub_f32 v22, v22, v26
v_mul_f32 v8, 0x3fb8aa3b, v8
v_mul_f32 v10, 0x3fb8aa3b, v10
v_mul_f32 v12, 0x3fb8aa3b, v12
v_mul_f32 v14, 0x3fb8aa3b, v14
v_mul_f32 v16, 0x3fb8aa3b, v16
v_mul_f32 v18, 0x3fb8aa3b, v18
v_mul_f32 v20, 0x3fb8aa3b, v20
v_mul_f32 v22, 0x3fb8aa3b, v22
v_exp_f32 v8, v8
v_exp_f32 v10, v10
v_exp_f32 v12, v12
v_exp_f32 v14, v14
v_exp_f32 v16, v16
v_exp_f32 v18, v18
v_exp_f32 v20, v20
v_exp_f32 v22, v22
v_mul_f32 v27, v8, v9
v_fmac_f32 v27, v10, v11
v_fmac_f32 v27, v12, v13
v_fmac_f32 v27, v14, v15
v_fmac_f32 v27, v16, v17
v_fmac_f32 v27, v18, v19
v_fmac_f32 v27, v20, v21
v_fmac_f32 v27, v22, v23
v_mul_f32 v28, v8, v36
v_mul_f32 v29, v8, v37
v_mul_f32 v30, v8, v38
v_mul_f32 v31, v8, v39
v_fmac_f32 v28, v10, v40
v_fmac_f32 v29, v10, v41
v_fmac_f32 v30, v10, v42
v_fmac_f32 v31, v10, v43
v_fmac_f32 v28, v12, v44
v_fmac_f32 v29, v12, v45
v_fmac_f32 v30, v12, v46
v_fmac_f32 v31, v12, v47
v_fmac_f32 v28, v14, v48
v_fmac_f32 v29, v14, v49
v_fmac_f32 v30, v14, v50
v_fmac_f32 v31, v14, v51
ds_read_b128 v[36:39], v24 offset:4096
ds_read_b128 v[40:43], v24 offset:5120
ds_read_b128 v[44:47], v24 offset:6144
ds_read_b128 v[48:51], v24 offset:7168
s_waitcnt lgkmcnt(0)
v_fmac_f32 v28, v16, v36
v_fmac_f32 v29, v16, v37
v_fmac_f32 v30, v16, v38
v_fmac_f32 v31, v16, v39
v_fmac_f32 v28, v18, v40
v_fmac_f32 v29, v18, v41
v_fmac_f32 v30, v18, v42
v_fmac_f32 v31, v18, v43
v_fmac_f32 v28, v20, v44
v_fmac_f32 v29, v20, v45
v_fmac_f32 v30, v20, v46
v_fmac_f32 v31, v20, v47
v_fmac_f32 v28, v22, v48
v_fmac_f32 v29, v22, v49
v_fmac_f32 v30, v22, v50
v_fmac_f32 v31, v22, v51
v_or_b32 v28, 1, v28
v_or_b32 v29, 1, v29
v_or_b32 v30, 1, v30
v_or_b32 v31, 1, v31
v_or_b32 v26, 1, v26
v_or_b32 v27, 1, v27
s_mul_i32 s56, s49, 14
s_add_u32 s56, s56, s50
s_mul_i32 s56, s56, 1088
s_add_u32 s56, s56, 0x1b2800
buffer_store_dwordx4 v[28:31], v1, s[44:47], s56 offen sc1
s_mov_b64 exec, 1
buffer_store_dwordx2 v[26:27], v1, s[44:47], s56 offen offset:1024 sc1
s_mov_b64 exec, -1
L_nos1_344:
s_nop 4
s_endpgm
L_chain:
s_nop 4
s_setprio 3
s_waitcnt vmcnt(0)
v_mov_b32 v44, 0
v_mov_b32 v45, 0
v_mov_b32 v46, 0
v_mov_b32 v47, 0
s_lshr_b32 s49, s2, 1
s_and_b32 s50, s2, 1
s_mul_i32 s56, s49, 14
s_mul_i32 s57, s50, 7
s_add_u32 s56, s56, s57
s_min_u32 s57, s48, 6
s_add_u32 s56, s56, s57
s_mul_i32 s56, s56, 1088
s_add_u32 s57, s56, 0x100000
buffer_store_dwordx4 v[44:47], v1, s[44:47], s57 offen sc1
s_mov_b64 exec, 15
buffer_store_dwordx4 v[44:47], v1, s[44:47], s57 offen offset:1024 sc1
s_mov_b64 exec, -1
s_add_u32 s57, s56, 0x13b800
buffer_store_dwordx4 v[44:47], v1, s[44:47], s57 offen sc1
s_mov_b64 exec, 15
buffer_store_dwordx4 v[44:47], v1, s[44:47], s57 offen offset:1024 sc1
s_mov_b64 exec, -1
s_add_u32 s57, s56, 0x177000
buffer_store_dwordx4 v[44:47], v1, s[44:47], s57 offen sc1
s_mov_b64 exec, 15
buffer_store_dwordx4 v[44:47], v1, s[44:47], s57 offen offset:1024 sc1
s_mov_b64 exec, -1
s_add_u32 s57, s56, 0x1b2800
buffer_store_dwordx4 v[44:47], v1, s[44:47], s57 offen sc1
s_mov_b64 exec, 15
buffer_store_dwordx4 v[44:47], v1, s[44:47], s57 offen offset:1024 sc1
s_mov_b64 exec, -1
s_and_b32 s56, s48, 3
s_mul_i32 s56, s56, 57344
s_lshr_b32 s57, s48, 2
s_mul_i32 s57, s57, 524288
s_add_u32 s56, s56, s57
s_mul_i32 s57, s2, 1792
s_add_u32 s56, s56, s57
s_add_u32 s56, s56, 0x300000
buffer_store_dwordx4 v[44:47], v1, s[44:47], s56 offen sc1
s_mov_b32 exec_hi, 0x0000ffff
buffer_store_dwordx4 v[44:47], v1, s[44:47], s56 offen offset:1024 sc1
s_mov_b32 exec_hi, -1
s_lshl_b32 s56, s2, 9
s_lshl_b32 s57, s48, 6
s_add_u32 s56, s56, s57
s_add_u32 s56, s56, 0x410000
s_add_u32 s57, s56, 0x4000
s_mov_b64 exec, 15
buffer_store_dwordx4 v[44:47], v1, s[44:47], s56 offen sc1
buffer_store_dwordx4 v[44:47], v1, s[44:47], s57 offen sc1
s_mov_b64 exec, -1
v_lshrrev_b32 v4, 4, v3
v_lshlrev_b32 v4, 13, v4
v_and_b32 v5, 15, v3
v_lshl_add_u32 v4, v5, 4, v4
s_lshl_b32 s58, s2, 8
s_mul_i32 s59, s48, 458752
s_add_u32 s58, s58, s59
s_add_u32 s59, s58, 0
buffer_load_dwordx4 v[184:187], v4, s[12:15], s59 offen nt
s_add_u32 s59, s58, 32768
buffer_load_dwordx4 v[188:191], v4, s[12:15], s59 offen nt
s_add_u32 s59, s58, 65536
buffer_load_dwordx4 v[192:195], v4, s[12:15], s59 offen nt
s_add_u32 s59, s58, 98304
buffer_load_dwordx4 v[196:199], v4, s[12:15], s59 offen nt
s_add_u32 s59, s58, 131072
buffer_load_dwordx4 v[200:203], v4, s[12:15], s59 offen nt
s_add_u32 s59, s58, 163840
buffer_load_dwordx4 v[204:207], v4, s[12:15], s59 offen nt
s_add_u32 s59, s58, 196608
buffer_load_dwordx4 v[208:211], v4, s[12:15], s59 offen nt
s_add_u32 s59, s58, 229376
buffer_load_dwordx4 v[212:215], v4, s[12:15], s59 offen nt
s_add_u32 s59, s58, 262144
buffer_load_dwordx4 v[216:219], v4, s[12:15], s59 offen nt
s_add_u32 s59, s58, 294912
buffer_load_dwordx4 v[220:223], v4, s[12:15], s59 offen nt
s_add_u32 s59, s58, 327680
buffer_load_dwordx4 v[224:227], v4, s[12:15], s59 offen nt
s_add_u32 s59, s58, 360448
buffer_load_dwordx4 v[228:231], v4, s[12:15], s59 offen nt
s_add_u32 s59, s58, 393216
buffer_load_dwordx4 v[232:235], v4, s[12:15], s59 offen nt
s_add_u32 s59, s58, 425984
buffer_load_dwordx4 v[236:239], v4, s[12:15], s59 offen nt
v_and_b32 v5, 15, v3
v_lshlrev_b32 v5, 3, v5
s_lshl_b32 s56, s48, 7
buffer_load_dwordx2 v[38:39], v5, s[32:35], s56 offen offset:0
buffer_load_dwordx2 v[40:41], v5, s[32:35], s56 offen offset:896
s_mov_b32 s80, 0x05040100
s_mov_b32 s81, 0x07060302
s_waitcnt vmcnt(0)
v_perm_b32 v4, v188, v184, s80
v_perm_b32 v188, v188, v184, s81
v_mov_b32 v184, v4
v_perm_b32 v4, v189, v185, s80
v_perm_b32 v189, v189, v185, s81
v_mov_b32 v185, v4
v_perm_b32 v4, v190, v186, s80
v_perm_b32 v190, v190, v186, s81
v_mov_b32 v186, v4
v_perm_b32 v4, v191, v187, s80
v_perm_b32 v191, v191, v187, s81
v_mov_b32 v187, v4
v_perm_b32 v4, v196, v192, s80
v_perm_b32 v196, v196, v192, s81
v_mov_b32 v192, v4
v_perm_b32 v4, v197, v193, s80
v_perm_b32 v197, v197, v193, s81
v_mov_b32 v193, v4
v_perm_b32 v4, v198, v194, s80
v_perm_b32 v198, v198, v194, s81
v_mov_b32 v194, v4
v_perm_b32 v4, v199, v195, s80
v_perm_b32 v199, v199, v195, s81
v_mov_b32 v195, v4
v_perm_b32 v4, v204, v200, s80
v_perm_b32 v204, v204, v200, s81
v_mov_b32 v200, v4
v_perm_b32 v4, v205, v201, s80
v_perm_b32 v205, v205, v201, s81
v_mov_b32 v201, v4
v_perm_b32 v4, v206, v202, s80
v_perm_b32 v206, v206, v202, s81
v_mov_b32 v202, v4
v_perm_b32 v4, v207, v203, s80
v_perm_b32 v207, v207, v203, s81
v_mov_b32 v203, v4
v_perm_b32 v4, v212, v208, s80
v_perm_b32 v212, v212, v208, s81
v_mov_b32 v208, v4
v_perm_b32 v4, v213, v209, s80
v_perm_b32 v213, v213, v209, s81
v_mov_b32 v209, v4
v_perm_b32 v4, v214, v210, s80
v_perm_b32 v214, v214, v210, s81
v_mov_b32 v210, v4
v_perm_b32 v4, v215, v211, s80
v_perm_b32 v215, v215, v211, s81
v_mov_b32 v211, v4
v_perm_b32 v4, v220, v216, s80
v_perm_b32 v220, v220, v216, s81
v_mov_b32 v216, v4
v_perm_b32 v4, v221, v217, s80
v_perm_b32 v221, v221, v217, s81
v_mov_b32 v217, v4
v_perm_b32 v4, v222, v218, s80
v_perm_b32 v222, v222, v218, s81
v_mov_b32 v218, v4
v_perm_b32 v4, v223, v219, s80
v_perm_b32 v223, v223, v219, s81
v_mov_b32 v219, v4
v_perm_b32 v4, v228, v224, s80
v_perm_b32 v228, v228, v224, s81
v_mov_b32 v224, v4
v_perm_b32 v4, v229, v225, s80
v_perm_b32 v229, v229, v225, s81
v_mov_b32 v225, v4
v_perm_b32 v4, v230, v226, s80
v_perm_b32 v230, v230, v226, s81
v_mov_b32 v226, v4
v_perm_b32 v4, v231, v227, s80
v_perm_b32 v231, v231, v227, s81
v_mov_b32 v227, v4
v_perm_b32 v4, v236, v232, s80
v_perm_b32 v236, v236, v232, s81
v_mov_b32 v232, v4
v_perm_b32 v4, v237, v233, s80
v_perm_b32 v237, v237, v233, s81
v_mov_b32 v233, v4
v_perm_b32 v4, v238, v234, s80
v_perm_b32 v238, v238, v234, s81
v_mov_b32 v234, v4
v_perm_b32 v4, v239, v235, s80
v_perm_b32 v239, v239, v235, s81
v_mov_b32 v235, v4
v_lshlrev_b32 v240, 16, v38
v_and_b32 v241, s62, v38
v_lshlrev_b32 v242, 16, v39
v_and_b32 v243, s62, v39
v_lshlrev_b32 v244, 16, v40
v_and_b32 v245, s62, v40
v_lshlrev_b32 v246, 16, v41
v_and_b32 v247, s62, v41
v_and_b32 v4, 15, v3
v_lshlrev_b32 v4, 4, v4
s_lshl_b32 s56, s48, 8
v_add_u32 v4, s56, v4
ds_write_b128 v4, v[240:243] offset:0
ds_write_b128 v4, v[244:247] offset:2048
s_waitcnt lgkmcnt(0)
s_barrier
v_mov_b32 v4, 0
s_mov_b32 s60, 0
L_p_epoch_389:
s_nop 4
buffer_load_dwordx4 v[48:51], v4, s[40:43], 0 offen sc1
s_waitcnt vmcnt(0)
v_and_b32 v5, v49, v51
v_cmp_ne_u32 vcc, 1, v5
s_cbranch_vccz L_d_epoch_390
s_sleep 1
s_add_u32 s60, s60, 1
s_cmp_lt_u32 s60, 400000
s_cbranch_scc1 L_p_epoch_389
s_endpgm
L_d_epoch_390:
s_nop 4
v_mov_b32 v52, v48
v_and_b32 v53, 0xff, v50
v_lshlrev_b32 v4, 2, v3
ds_read_b32 v16, v4 offset:0
ds_read_b32 v17, v4 offset:256
ds_read_b32 v18, v4 offset:512
ds_read_b32 v19, v4 offset:768
ds_read_b32 v20, v4 offset:1024
ds_read_b32 v21, v4 offset:1280
ds_read_b32 v22, v4 offset:1536
v_lshrrev_b32 v5, 4, v3
v_lshlrev_b32 v5, 2, v5
s_mul_i32 s56, s48, 224
v_add_u32 v5, s56, v5
s_waitcnt lgkmcnt(0)
ds_read_b32 v24, v5 offset:0
ds_read_b32 v25, v5 offset:16
ds_read_b32 v26, v5 offset:32
ds_read_b32 v27, v5 offset:48
ds_read_b32 v28, v5 offset:64
ds_read_b32 v29, v5 offset:80
ds_read_b32 v30, v5 offset:96
ds_read_b32 v31, v5 offset:112
ds_read_b32 v32, v5 offset:128
ds_read_b32 v33, v5 offset:144
ds_read_b32 v34, v5 offset:160
ds_read_b32 v35, v5 offset:176
ds_read_b32 v36, v5 offset:192
ds_read_b32 v37, v5 offset:208
v_add_f32 v6, v16, v17
v_add_f32 v6, v6, v18
v_add_f32 v6, v6, v19
v_add_f32 v6, v6, v20
v_add_f32 v6, v6, v21
v_add_f32 v6, v6, v22
s_nop 1
v_add_f32_dpp v6, v6, v6 quad_perm:[1,0,3,2]
s_nop 1
v_add_f32_dpp v6, v6, v6 quad_perm:[2,3,0,1]
s_nop 1
v_add_f32_dpp v6, v6, v6 row_ror:4
s_nop 1
v_add_f32_dpp v6, v6, v6 row_ror:8
v_mov_b32 v7, v6
s_nop 1
v_permlane16_swap_b32 v6, v7
v_add_f32 v6, v6, v7
v_mov_b32 v7, v6
s_nop 1
v_permlane32_swap_b32 v6, v7
v_add_f32 v6, v6, v7
v_mul_f32 v8, 0x3b124925, v6
v_sub_f32 v10, v16, v8
v_sub_f32 v11, v17, v8
v_sub_f32 v12, v18, v8
v_sub_f32 v13, v19, v8
v_sub_f32 v14, v20, v8
v_sub_f32 v15, v21, v8
v_sub_f32 v16, v22, v8
v_mul_f32 v9, v10, v10
v_fmac_f32 v9, v11, v11
v_fmac_f32 v9, v12, v12
v_fmac_f32 v9, v13, v13
v_fmac_f32 v9, v14, v14
v_fmac_f32 v9, v15, v15
v_fmac_f32 v9, v16, v16
s_nop 1
v_add_f32_dpp v9, v9, v9 quad_perm:[1,0,3,2]
s_nop 1
v_add_f32_dpp v9, v9, v9 quad_perm:[2,3,0,1]
s_nop 1
v_add_f32_dpp v9, v9, v9 row_ror:4
s_nop 1
v_add_f32_dpp v9, v9, v9 row_ror:8
v_mov_b32 v7, v9
s_nop 1
v_permlane16_swap_b32 v9, v7
v_add_f32 v9, v9, v7
v_mov_b32 v7, v9
s_nop 1
v_permlane32_swap_b32 v9, v7
v_add_f32 v9, v9, v7
v_mul_f32 v9, 0x3b124925, v9
v_cvt_pk_bf16_f32 v9, v9, v9
v_cvt_pk_bf16_f32 v8, v8, v8
v_and_b32 v9, s62, v9
v_and_b32 v8, s62, v8
v_add_f32 v9, 0x3727c5ac, v9
v_cvt_pk_bf16_f32 v9, v9, v9
v_and_b32 v9, s62, v9
v_sqrt_f32 v9, v9
s_nop 0
v_cvt_pk_bf16_f32 v9, v9, v9
v_and_b32 v9, s62, v9
v_rcp_f32 v6, v9
s_waitcnt lgkmcnt(0)
v_sub_f32 v24, v24, v8
v_sub_f32 v25, v25, v8
v_sub_f32 v26, v26, v8
v_sub_f32 v27, v27, v8
v_sub_f32 v28, v28, v8
v_sub_f32 v29, v29, v8
v_sub_f32 v30, v30, v8
v_sub_f32 v31, v31, v8
v_sub_f32 v32, v32, v8
v_sub_f32 v33, v33, v8
v_sub_f32 v34, v34, v8
v_sub_f32 v35, v35, v8
v_sub_f32 v36, v36, v8
v_sub_f32 v37, v37, v8
v_cvt_pk_bf16_f32 v24, v24, v24
v_cvt_pk_bf16_f32 v25, v25, v25
v_cvt_pk_bf16_f32 v26, v26, v26
v_cvt_pk_bf16_f32 v27, v27, v27
v_cvt_pk_bf16_f32 v28, v28, v28
v_cvt_pk_bf16_f32 v29, v29, v29
v_cvt_pk_bf16_f32 v30, v30, v30
v_cvt_pk_bf16_f32 v31, v31, v31
v_cvt_pk_bf16_f32 v32, v32, v32
v_cvt_pk_bf16_f32 v33, v33, v33
v_cvt_pk_bf16_f32 v34, v34, v34
v_cvt_pk_bf16_f32 v35, v35, v35
v_cvt_pk_bf16_f32 v36, v36, v36
v_cvt_pk_bf16_f32 v37, v37, v37
v_and_b32 v24, s62, v24
v_and_b32 v25, s62, v25
v_and_b32 v26, s62, v26
v_and_b32 v27, s62, v27
v_and_b32 v28, s62, v28
v_and_b32 v29, s62, v29
v_and_b32 v30, s62, v30
v_and_b32 v31, s62, v31
v_and_b32 v32, s62, v32
v_and_b32 v33, s62, v33
v_and_b32 v34, s62, v34
v_and_b32 v35, s62, v35
v_and_b32 v36, s62, v36
v_and_b32 v37, s62, v37
v_mul_f32 v38, v24, v6
v_mul_f32 v39, v25, v6
v_mul_f32 v40, v26, v6
v_mul_f32 v41, v27, v6
v_mul_f32 v42, v28, v6
v_mul_f32 v43, v29, v6
v_mul_f32 v44, v30, v6
v_mul_f32 v45, v31, v6
v_mul_f32 v46, v32, v6
v_mul_f32 v47, v33, v6
v_mul_f32 v48, v34, v6
v_mul_f32 v49, v35, v6
v_mul_f32 v50, v36, v6
v_mul_f32 v51, v37, v6
v_fma_f32 v24, -v38, v9, v24
v_fma_f32 v25, -v39, v9, v25
v_fma_f32 v26, -v40, v9, v26
v_fma_f32 v27, -v41, v9, v27
v_fma_f32 v28, -v42, v9, v28
v_fma_f32 v29, -v43, v9, v29
v_fma_f32 v30, -v44, v9, v30
v_fma_f32 v31, -v45, v9, v31
v_fma_f32 v32, -v46, v9, v32
v_fma_f32 v33, -v47, v9, v33
v_fma_f32 v34, -v48, v9, v34
v_fma_f32 v35, -v49, v9, v35
v_fma_f32 v36, -v50, v9, v36
v_fma_f32 v37, -v51, v9, v37
v_fma_f32 v24, v24, v6, v38
v_fma_f32 v25, v25, v6, v39
v_fma_f32 v26, v26, v6, v40
v_fma_f32 v27, v27, v6, v41
v_fma_f32 v28, v28, v6, v42
v_fma_f32 v29, v29, v6, v43
v_fma_f32 v30, v30, v6, v44
v_fma_f32 v31, v31, v6, v45
v_fma_f32 v32, v32, v6, v46
v_fma_f32 v33, v33, v6, v47
v_fma_f32 v34, v34, v6, v48
v_fma_f32 v35, v35, v6, v49
v_fma_f32 v36, v36, v6, v50
v_fma_f32 v37, v37, v6, v51
v_cvt_pk_bf16_f32 v24, v24, v24
v_cvt_pk_bf16_f32 v25, v25, v25
v_cvt_pk_bf16_f32 v26, v26, v26
v_cvt_pk_bf16_f32 v27, v27, v27
v_cvt_pk_bf16_f32 v28, v28, v28
v_cvt_pk_bf16_f32 v29, v29, v29
v_cvt_pk_bf16_f32 v30, v30, v30
v_cvt_pk_bf16_f32 v31, v31, v31
v_cvt_pk_bf16_f32 v32, v32, v32
v_cvt_pk_bf16_f32 v33, v33, v33
v_cvt_pk_bf16_f32 v34, v34, v34
v_cvt_pk_bf16_f32 v35, v35, v35
v_cvt_pk_bf16_f32 v36, v36, v36
v_cvt_pk_bf16_f32 v37, v37, v37
v_and_b32 v24, s62, v24
v_and_b32 v25, s62, v25
v_and_b32 v26, s62, v26
v_and_b32 v27, s62, v27
v_and_b32 v28, s62, v28
v_and_b32 v29, s62, v29
v_and_b32 v30, s62, v30
v_and_b32 v31, s62, v31
v_and_b32 v32, s62, v32
v_and_b32 v33, s62, v33
v_and_b32 v34, s62, v34
v_and_b32 v35, s62, v35
v_and_b32 v36, s62, v36
v_and_b32 v37, s62, v37
v_cvt_pk_bf16_f32 v24, v24, v25
v_cvt_pk_bf16_f32 v26, v26, v27
v_cvt_pk_bf16_f32 v28, v28, v29
v_cvt_pk_bf16_f32 v30, v30, v31
v_cvt_pk_bf16_f32 v32, v32, v33
v_cvt_pk_bf16_f32 v34, v34, v35
v_cvt_pk_bf16_f32 v36, v36, v37
v_dot2_f32_bf16 v4, v184, v24, 0
v_dot2_f32_bf16 v5, v188, v24, 0
v_dot2_f32_bf16 v6, v185, v24, 0
v_dot2_f32_bf16 v7, v189, v24, 0
v_dot2_f32_bf16 v8, v186, v24, 0
v_dot2_f32_bf16 v9, v190, v24, 0
v_dot2_f32_bf16 v10, v187, v24, 0
v_dot2_f32_bf16 v11, v191, v24, 0
v_dot2_f32_bf16 v4, v192, v26, v4
v_dot2_f32_bf16 v5, v196, v26, v5
v_dot2_f32_bf16 v6, v193, v26, v6
v_dot2_f32_bf16 v7, v197, v26, v7
v_dot2_f32_bf16 v8, v194, v26, v8
v_dot2_f32_bf16 v9, v198, v26, v9
v_dot2_f32_bf16 v10, v195, v26, v10
v_dot2_f32_bf16 v11, v199, v26, v11
v_dot2_f32_bf16 v4, v200, v28, v4
v_dot2_f32_bf16 v5, v204, v28, v5
v_dot2_f32_bf16 v6, v201, v28, v6
v_dot2_f32_bf16 v7, v205, v28, v7
v_dot2_f32_bf16 v8, v202, v28, v8
v_dot2_f32_bf16 v9, v206, v28, v9
v_dot2_f32_bf16 v10, v203, v28, v10
v_dot2_f32_bf16 v11, v207, v28, v11
v_dot2_f32_bf16 v4, v208, v30, v4
v_dot2_f32_bf16 v5, v212, v30, v5
v_dot2_f32_bf16 v6, v209, v30, v6
v_dot2_f32_bf16 v7, v213, v30, v7
v_dot2_f32_bf16 v8, v210, v30, v8
v_dot2_f32_bf16 v9, v214, v30, v9
v_dot2_f32_bf16 v10, v211, v30, v10
v_dot2_f32_bf16 v11, v215, v30, v11
v_dot2_f32_bf16 v4, v216, v32, v4
v_dot2_f32_bf16 v5, v220, v32, v5
v_dot2_f32_bf16 v6, v217, v32, v6
v_dot2_f32_bf16 v7, v221, v32, v7
v_dot2_f32_bf16 v8, v218, v32, v8
v_dot2_f32_bf16 v9, v222, v32, v9
v_dot2_f32_bf16 v10, v219, v32, v10
v_dot2_f32_bf16 v11, v223, v32, v11
v_dot2_f32_bf16 v4, v224, v34, v4
v_dot2_f32_bf16 v5, v228, v34, v5
v_dot2_f32_bf16 v6, v225, v34, v6
v_dot2_f32_bf16 v7, v229, v34, v7
v_dot2_f32_bf16 v8, v226, v34, v8
v_dot2_f32_bf16 v9, v230, v34, v9
v_dot2_f32_bf16 v10, v227, v34, v10
v_dot2_f32_bf16 v11, v231, v34, v11
v_dot2_f32_bf16 v4, v232, v36, v4
v_dot2_f32_bf16 v5, v236, v36, v5
v_dot2_f32_bf16 v6, v233, v36, v6
v_dot2_f32_bf16 v7, v237, v36, v7
v_dot2_f32_bf16 v8, v234, v36, v8
v_dot2_f32_bf16 v9, v238, v36, v9
v_dot2_f32_bf16 v10, v235, v36, v10
v_dot2_f32_bf16 v11, v239, v36, v11
v_permlane32_swap_b32 v4, v8
v_permlane32_swap_b32 v5, v9
v_permlane32_swap_b32 v6, v10
v_permlane32_swap_b32 v7, v11
v_add_f32 v4, v4, v8
v_add_f32 v5, v5, v9
v_add_f32 v6, v6, v10
v_add_f32 v7, v7, v11
s_nop 0
v_permlane16_swap_b32 v4, v6
v_permlane16_swap_b32 v5, v7
v_add_f32 v4, v4, v6
v_add_f32 v5, v5, v7
v_lshlrev_b32 v14, 3, v3
s_lshl_b32 s56, s48, 9
v_add_u32 v15, s56, v14
ds_write_b64 v15, v[4:5] offset:4096
s_waitcnt lgkmcnt(0)
s_barrier
ds_read_b64 v[16:17], v14 offset:4096
ds_read_b64 v[18:19], v14 offset:4608
ds_read_b64 v[20:21], v14 offset:5120
ds_read_b64 v[22:23], v14 offset:5632
ds_read_b64 v[38:39], v14 offset:6144
ds_read_b64 v[40:41], v14 offset:6656
ds_read_b64 v[42:43], v14 offset:7168
ds_read_b64 v[44:45], v14 offset:7680
s_waitcnt lgkmcnt(0)
v_add_f32 v4, v16, v18
v_add_f32 v5, v17, v19
v_add_f32 v4, v4, v20
v_add_f32 v5, v5, v21
v_add_f32 v4, v4, v22
v_add_f32 v5, v5, v23
v_add_f32 v4, v4, v38
v_add_f32 v5, v5, v39
v_add_f32 v4, v4, v40
v_add_f32 v5, v5, v41
v_add_f32 v4, v4, v42
v_add_f32 v5, v5, v43
v_add_f32 v4, v4, v44
v_add_f32 v5, v5, v45
v_cvt_pk_bf16_f32 v4, v4, v4
v_cvt_pk_bf16_f32 v5, v5, v5
v_and_b32 v4, s62, v4
v_and_b32 v5, s62, v5
s_cmp_lg_u32 s48, 0
s_cbranch_scc1 L_q0pub_422
v_mov_b32 v48, v52
v_cvt_pk_bf16_f32 v49, v4, v5
v_and_b32 v22, 15, v3
v_lshlrev_b32 v22, 3, v22
v_lshrrev_b32 v23, 4, v3
v_lshl_add_u32 v22, v23, 1, v22
v_lshlrev_b32 v22, 2, v22
s_lshl_b32 s56, s2, 9
s_add_u32 s56, s56, 0x400000
buffer_store_dwordx2 v[48:49], v22, s[44:47], s56 offen sc1
L_q0pub_422:
s_nop 4
s_barrier
v_lshlrev_b32 v4, 2, v3
ds_read_b32 v16, v4 offset:2048
ds_read_b32 v17, v4 offset:2304
ds_read_b32 v18, v4 offset:2560
ds_read_b32 v19, v4 offset:2816
ds_read_b32 v20, v4 offset:3072
ds_read_b32 v21, v4 offset:3328
ds_read_b32 v22, v4 offset:3584
v_lshrrev_b32 v5, 4, v3
v_lshlrev_b32 v5, 2, v5
s_mul_i32 s56, s48, 224
v_add_u32 v5, s56, v5
s_waitcnt lgkmcnt(0)
ds_read_b32 v24, v5 offset:2048
ds_read_b32 v25, v5 offset:2064
ds_read_b32 v26, v5 offset:2080
ds_read_b32 v27, v5 offset:2096
ds_read_b32 v28, v5 offset:2112
ds_read_b32 v29, v5 offset:2128
ds_read_b32 v30, v5 offset:2144
ds_read_b32 v31, v5 offset:2160
ds_read_b32 v32, v5 offset:2176
ds_read_b32 v33, v5 offset:2192
ds_read_b32 v34, v5 offset:2208
ds_read_b32 v35, v5 offset:2224
ds_read_b32 v36, v5 offset:2240
ds_read_b32 v37, v5 offset:2256
v_add_f32 v6, v16, v17
v_add_f32 v6, v6, v18
v_add_f32 v6, v6, v19
v_add_f32 v6, v6, v20
v_add_f32 v6, v6, v21
v_add_f32 v6, v6, v22
s_nop 1
v_add_f32_dpp v6, v6, v6 quad_perm:[1,0,3,2]
s_nop 1
v_add_f32_dpp v6, v6, v6 quad_perm:[2,3,0,1]
s_nop 1
v_add_f32_dpp v6, v6, v6 row_ror:4
s_nop 1
v_add_f32_dpp v6, v6, v6 row_ror:8
v_mov_b32 v7, v6
s_nop 1
v_permlane16_swap_b32 v6, v7
v_add_f32 v6, v6, v7
v_mov_b32 v7, v6
s_nop 1
v_permlane32_swap_b32 v6, v7
v_add_f32 v6, v6, v7
v_mul_f32 v8, 0x3b124925, v6
v_sub_f32 v10, v16, v8
v_sub_f32 v11, v17, v8
v_sub_f32 v12, v18, v8
v_sub_f32 v13, v19, v8
v_sub_f32 v14, v20, v8
v_sub_f32 v15, v21, v8
v_sub_f32 v16, v22, v8
v_mul_f32 v9, v10, v10
v_fmac_f32 v9, v11, v11
v_fmac_f32 v9, v12, v12
v_fmac_f32 v9, v13, v13
v_fmac_f32 v9, v14, v14
v_fmac_f32 v9, v15, v15
v_fmac_f32 v9, v16, v16
s_nop 1
v_add_f32_dpp v9, v9, v9 quad_perm:[1,0,3,2]
s_nop 1
v_add_f32_dpp v9, v9, v9 quad_perm:[2,3,0,1]
s_nop 1
v_add_f32_dpp v9, v9, v9 row_ror:4
s_nop 1
v_add_f32_dpp v9, v9, v9 row_ror:8
v_mov_b32 v7, v9
s_nop 1
v_permlane16_swap_b32 v9, v7
v_add_f32 v9, v9, v7
v_mov_b32 v7, v9
s_nop 1
v_permlane32_swap_b32 v9, v7
v_add_f32 v9, v9, v7
v_mul_f32 v9, 0x3b124925, v9
v_cvt_pk_bf16_f32 v9, v9, v9
v_cvt_pk_bf16_f32 v8, v8, v8
v_and_b32 v9, s62, v9
v_and_b32 v8, s62, v8
v_add_f32 v9, 0x3727c5ac, v9
v_cvt_pk_bf16_f32 v9, v9, v9
v_and_b32 v9, s62, v9
v_sqrt_f32 v9, v9
s_nop 0
v_cvt_pk_bf16_f32 v9, v9, v9
v_and_b32 v9, s62, v9
v_rcp_f32 v6, v9
s_waitcnt lgkmcnt(0)
v_sub_f32 v24, v24, v8
v_sub_f32 v25, v25, v8
v_sub_f32 v26, v26, v8
v_sub_f32 v27, v27, v8
v_sub_f32 v28, v28, v8
v_sub_f32 v29, v29, v8
v_sub_f32 v30, v30, v8
v_sub_f32 v31, v31, v8
v_sub_f32 v32, v32, v8
v_sub_f32 v33, v33, v8
v_sub_f32 v34, v34, v8
v_sub_f32 v35, v35, v8
v_sub_f32 v36, v36, v8
v_sub_f32 v37, v37, v8
v_cvt_pk_bf16_f32 v24, v24, v24
v_cvt_pk_bf16_f32 v25, v25, v25
v_cvt_pk_bf16_f32 v26, v26, v26
v_cvt_pk_bf16_f32 v27, v27, v27
v_cvt_pk_bf16_f32 v28, v28, v28
v_cvt_pk_bf16_f32 v29, v29, v29
v_cvt_pk_bf16_f32 v30, v30, v30
v_cvt_pk_bf16_f32 v31, v31, v31
v_cvt_pk_bf16_f32 v32, v32, v32
v_cvt_pk_bf16_f32 v33, v33, v33
v_cvt_pk_bf16_f32 v34, v34, v34
v_cvt_pk_bf16_f32 v35, v35, v35
v_cvt_pk_bf16_f32 v36, v36, v36
v_cvt_pk_bf16_f32 v37, v37, v37
v_and_b32 v24, s62, v24
v_and_b32 v25, s62, v25
v_and_b32 v26, s62, v26
v_and_b32 v27, s62, v27
v_and_b32 v28, s62, v28
v_and_b32 v29, s62, v29
v_and_b32 v30, s62, v30
v_and_b32 v31, s62, v31
v_and_b32 v32, s62, v32
v_and_b32 v33, s62, v33
v_and_b32 v34, s62, v34
v_and_b32 v35, s62, v35
v_and_b32 v36, s62, v36
v_and_b32 v37, s62, v37
v_mul_f32 v38, v24, v6
v_mul_f32 v39, v25, v6
v_mul_f32 v40, v26, v6
v_mul_f32 v41, v27, v6
v_mul_f32 v42, v28, v6
v_mul_f32 v43, v29, v6
v_mul_f32 v44, v30, v6
v_mul_f32 v45, v31, v6
v_mul_f32 v46, v32, v6
v_mul_f32 v47, v33, v6
v_mul_f32 v48, v34, v6
v_mul_f32 v49, v35, v6
v_mul_f32 v50, v36, v6
v_mul_f32 v51, v37, v6
v_fma_f32 v24, -v38, v9, v24
v_fma_f32 v25, -v39, v9, v25
v_fma_f32 v26, -v40, v9, v26
v_fma_f32 v27, -v41, v9, v27
v_fma_f32 v28, -v42, v9, v28
v_fma_f32 v29, -v43, v9, v29
v_fma_f32 v30, -v44, v9, v30
v_fma_f32 v31, -v45, v9, v31
v_fma_f32 v32, -v46, v9, v32
v_fma_f32 v33, -v47, v9, v33
v_fma_f32 v34, -v48, v9, v34
v_fma_f32 v35, -v49, v9, v35
v_fma_f32 v36, -v50, v9, v36
v_fma_f32 v37, -v51, v9, v37
v_fma_f32 v24, v24, v6, v38
v_fma_f32 v25, v25, v6, v39
v_fma_f32 v26, v26, v6, v40
v_fma_f32 v27, v27, v6, v41
v_fma_f32 v28, v28, v6, v42
v_fma_f32 v29, v29, v6, v43
v_fma_f32 v30, v30, v6, v44
v_fma_f32 v31, v31, v6, v45
v_fma_f32 v32, v32, v6, v46
v_fma_f32 v33, v33, v6, v47
v_fma_f32 v34, v34, v6, v48
v_fma_f32 v35, v35, v6, v49
v_fma_f32 v36, v36, v6, v50
v_fma_f32 v37, v37, v6, v51
v_cvt_pk_bf16_f32 v24, v24, v24
v_cvt_pk_bf16_f32 v25, v25, v25
v_cvt_pk_bf16_f32 v26, v26, v26
v_cvt_pk_bf16_f32 v27, v27, v27
v_cvt_pk_bf16_f32 v28, v28, v28
v_cvt_pk_bf16_f32 v29, v29, v29
v_cvt_pk_bf16_f32 v30, v30, v30
v_cvt_pk_bf16_f32 v31, v31, v31
v_cvt_pk_bf16_f32 v32, v32, v32
v_cvt_pk_bf16_f32 v33, v33, v33
v_cvt_pk_bf16_f32 v34, v34, v34
v_cvt_pk_bf16_f32 v35, v35, v35
v_cvt_pk_bf16_f32 v36, v36, v36
v_cvt_pk_bf16_f32 v37, v37, v37
v_and_b32 v24, s62, v24
v_and_b32 v25, s62, v25
v_and_b32 v26, s62, v26
v_and_b32 v27, s62, v27
v_and_b32 v28, s62, v28
v_and_b32 v29, s62, v29
v_and_b32 v30, s62, v30
v_and_b32 v31, s62, v31
v_and_b32 v32, s62, v32
v_and_b32 v33, s62, v33
v_and_b32 v34, s62, v34
v_and_b32 v35, s62, v35
v_and_b32 v36, s62, v36
v_and_b32 v37, s62, v37
v_cvt_pk_bf16_f32 v24, v24, v25
v_cvt_pk_bf16_f32 v26, v26, v27
v_cvt_pk_bf16_f32 v28, v28, v29
v_cvt_pk_bf16_f32 v30, v30, v31
v_cvt_pk_bf16_f32 v32, v32, v33
v_cvt_pk_bf16_f32 v34, v34, v35
v_cvt_pk_bf16_f32 v36, v36, v37
v_dot2_f32_bf16 v4, v184, v24, 0
v_dot2_f32_bf16 v5, v188, v24, 0
v_dot2_f32_bf16 v6, v185, v24, 0
v_dot2_f32_bf16 v7, v189, v24, 0
v_dot2_f32_bf16 v8, v186, v24, 0
v_dot2_f32_bf16 v9, v190, v24, 0
v_dot2_f32_bf16 v10, v187, v24, 0
v_dot2_f32_bf16 v11, v191, v24, 0
v_dot2_f32_bf16 v4, v192, v26, v4
v_dot2_f32_bf16 v5, v196, v26, v5
v_dot2_f32_bf16 v6, v193, v26, v6
v_dot2_f32_bf16 v7, v197, v26, v7
v_dot2_f32_bf16 v8, v194, v26, v8
v_dot2_f32_bf16 v9, v198, v26, v9
v_dot2_f32_bf16 v10, v195, v26, v10
v_dot2_f32_bf16 v11, v199, v26, v11
v_dot2_f32_bf16 v4, v200, v28, v4
v_dot2_f32_bf16 v5, v204, v28, v5
v_dot2_f32_bf16 v6, v201, v28, v6
v_dot2_f32_bf16 v7, v205, v28, v7
v_dot2_f32_bf16 v8, v202, v28, v8
v_dot2_f32_bf16 v9, v206, v28, v9
v_dot2_f32_bf16 v10, v203, v28, v10
v_dot2_f32_bf16 v11, v207, v28, v11
v_dot2_f32_bf16 v4, v208, v30, v4
v_dot2_f32_bf16 v5, v212, v30, v5
v_dot2_f32_bf16 v6, v209, v30, v6
v_dot2_f32_bf16 v7, v213, v30, v7
v_dot2_f32_bf16 v8, v210, v30, v8
v_dot2_f32_bf16 v9, v214, v30, v9
v_dot2_f32_bf16 v10, v211, v30, v10
v_dot2_f32_bf16 v11, v215, v30, v11
v_dot2_f32_bf16 v4, v216, v32, v4
v_dot2_f32_bf16 v5, v220, v32, v5
v_dot2_f32_bf16 v6, v217, v32, v6
v_dot2_f32_bf16 v7, v221, v32, v7
v_dot2_f32_bf16 v8, v218, v32, v8
v_dot2_f32_bf16 v9, v222, v32, v9
v_dot2_f32_bf16 v10, v219, v32, v10
v_dot2_f32_bf16 v11, v223, v32, v11
v_dot2_f32_bf16 v4, v224, v34, v4
v_dot2_f32_bf16 v5, v228, v34, v5
v_dot2_f32_bf16 v6, v225, v34, v6
v_dot2_f32_bf16 v7, v229, v34, v7
v_dot2_f32_bf16 v8, v226, v34, v8
v_dot2_f32_bf16 v9, v230, v34, v9
v_dot2_f32_bf16 v10, v227, v34, v10
v_dot2_f32_bf16 v11, v231, v34, v11
v_dot2_f32_bf16 v4, v232, v36, v4
v_dot2_f32_bf16 v5, v236, v36, v5
v_dot2_f32_bf16 v6, v233, v36, v6
v_dot2_f32_bf16 v7, v237, v36, v7
v_dot2_f32_bf16 v8, v234, v36, v8
v_dot2_f32_bf16 v9, v238, v36, v9
v_dot2_f32_bf16 v10, v235, v36, v10
v_dot2_f32_bf16 v11, v239, v36, v11
v_permlane32_swap_b32 v4, v8
v_permlane32_swap_b32 v5, v9
v_permlane32_swap_b32 v6, v10
v_permlane32_swap_b32 v7, v11
v_add_f32 v4, v4, v8
v_add_f32 v5, v5, v9
v_add_f32 v6, v6, v10
v_add_f32 v7, v7, v11
s_nop 0
v_permlane16_swap_b32 v4, v6
v_permlane16_swap_b32 v5, v7
v_add_f32 v4, v4, v6
v_add_f32 v5, v5, v7
v_lshlrev_b32 v14, 3, v3
s_lshl_b32 s56, s48, 9
v_add_u32 v15, s56, v14
ds_write_b64 v15, v[4:5] offset:4096
s_waitcnt lgkmcnt(0)
s_barrier
ds_read_b64 v[16:17], v14 offset:4096
ds_read_b64 v[18:19], v14 offset:4608
ds_read_b64 v[20:21], v14 offset:5120
ds_read_b64 v[22:23], v14 offset:5632
ds_read_b64 v[38:39], v14 offset:6144
ds_read_b64 v[40:41], v14 offset:6656
ds_read_b64 v[42:43], v14 offset:7168
ds_read_b64 v[44:45], v14 offset:7680
s_waitcnt lgkmcnt(0)
v_add_f32 v4, v16, v18
v_add_f32 v5, v17, v19
v_add_f32 v4, v4, v20
v_add_f32 v5, v5, v21
v_add_f32 v4, v4, v22
v_add_f32 v5, v5, v23
v_add_f32 v4, v4, v38
v_add_f32 v5, v5, v39
v_add_f32 v4, v4, v40
v_add_f32 v5, v5, v41
v_add_f32 v4, v4, v42
v_add_f32 v5, v5, v43
v_add_f32 v4, v4, v44
v_add_f32 v5, v5, v45
v_cvt_pk_bf16_f32 v4, v4, v4
v_cvt_pk_bf16_f32 v5, v5, v5
v_and_b32 v4, s62, v4
v_and_b32 v5, s62, v5
s_cmp_lg_u32 s48, 1
s_cbranch_scc1 L_q0pub_454
v_mov_b32 v48, v52
v_cvt_pk_bf16_f32 v49, v4, v5
v_and_b32 v22, 15, v3
v_lshlrev_b32 v22, 3, v22
v_lshrrev_b32 v23, 4, v3
v_lshl_add_u32 v22, v23, 1, v22
v_lshlrev_b32 v22, 2, v22
s_lshl_b32 s56, s2, 9
s_add_u32 s56, s56, 0x408000
buffer_store_dwordx2 v[48:49], v22, s[44:47], s56 offen sc1
L_q0pub_454:
s_nop 4
s_waitcnt vmcnt(0)
s_barrier
v_mov_b32 v50, 0
v_add_u32 v49, 0x80, v50
v_and_b32 v49, 0xffffff00, v49
v_or_b32 v49, v53, v49
v_mov_b32 v48, v52
s_lshl_b32 s56, s2, 3
s_add_u32 s56, s56, 0x420000
s_mov_b64 exec, 1
buffer_store_dwordx2 v[48:49], v50, s[44:47], s56 offen sc1
s_mov_b64 exec, -1
s_lshl_b32 s58, s2, 7
s_lshl_b32 s59, s48, 4
s_add_u32 s58, s58, s59
s_mul_i32 s58, s58, 896
s_mov_b32 exec_hi, 0x00ffffff
s_add_u32 s59, s58, 0
buffer_load_dwordx4 v[56:59], v1, s[16:19], s59 offen nt
s_add_u32 s59, s58, 896
buffer_load_dwordx4 v[60:63], v1, s[16:19], s59 offen nt
s_add_u32 s59, s58, 1792
buffer_load_dwordx4 v[64:67], v1, s[16:19], s59 offen nt
s_add_u32 s59, s58, 2688
buffer_load_dwordx4 v[68:71], v1, s[16:19], s59 offen nt
s_add_u32 s59, s58, 3584
buffer_load_dwordx4 v[72:75], v1, s[16:19], s59 offen nt
s_add_u32 s59, s58, 4480
buffer_load_dwordx4 v[76:79], v1, s[16:19], s59 offen nt
s_add_u32 s59, s58, 5376
buffer_load_dwordx4 v[80:83], v1, s[16:19], s59 offen nt
s_add_u32 s59, s58, 6272
buffer_load_dwordx4 v[84:87], v1, s[16:19], s59 offen nt
s_add_u32 s59, s58, 7168
buffer_load_dwordx4 v[88:91], v1, s[16:19], s59 offen nt
s_add_u32 s59, s58, 8064
buffer_load_dwordx4 v[92:95], v1, s[16:19], s59 offen nt
s_add_u32 s59, s58, 8960
buffer_load_dwordx4 v[96:99], v1, s[16:19], s59 offen nt
s_add_u32 s59, s58, 9856
buffer_load_dwordx4 v[100:103], v1, s[16:19], s59 offen nt
s_add_u32 s59, s58, 10752
buffer_load_dwordx4 v[104:107], v1, s[16:19], s59 offen nt
s_add_u32 s59, s58, 11648
buffer_load_dwordx4 v[108:111], v1, s[16:19], s59 offen nt
s_add_u32 s59, s58, 12544
buffer_load_dwordx4 v[112:115], v1, s[16:19], s59 offen nt
s_add_u32 s59, s58, 13440
buffer_load_dwordx4 v[116:119], v1, s[16:19], s59 offen nt
s_mul_i32 s56, s2, 7
s_min_u32 s57, s48, 6
s_add_u32 s56, s56, s57
s_mul_i32 s58, s56, 7168
s_mul_i32 s53, s48, 8192
s_add_u32 s59, s58, 0
buffer_load_dwordx4 v[12:15], v1, s[28:31], s59 offen nt
s_add_u32 s59, s58, 896
buffer_load_dwordx4 v[16:19], v1, s[28:31], s59 offen nt
s_add_u32 s59, s58, 1792
buffer_load_dwordx4 v[20:23], v1, s[28:31], s59 offen nt
s_add_u32 s59, s58, 2688
buffer_load_dwordx4 v[24:27], v1, s[28:31], s59 offen nt
s_add_u32 s59, s58, 3584
buffer_load_dwordx4 v[28:31], v1, s[28:31], s59 offen nt
s_add_u32 s59, s58, 4480
buffer_load_dwordx4 v[32:35], v1, s[28:31], s59 offen nt
s_add_u32 s59, s58, 5376
buffer_load_dwordx4 v[36:39], v1, s[28:31], s59 offen nt
s_add_u32 s59, s58, 6272
buffer_load_dwordx4 v[40:43], v1, s[28:31], s59 offen nt
s_mov_b32 exec_hi, -1
v_add_u32 v2, s53, v1
v_lshrrev_b32 v4, 3, v3
v_mul_u32_u24 v4, 3584, v4
v_and_b32 v5, 7, v3
v_lshl_add_u32 v4, v5, 4, v4
s_mul_i32 s58, s2, 112
s_mul_i32 s59, s48, 200704
s_add_u32 s58, s58, s59
s_add_u32 s59, s58, 0
buffer_load_dwordx4 v[120:123], v4, s[20:23], s59 offen nt
buffer_load_dwordx4 v[152:155], v4, s[24:27], s59 offen nt
s_add_u32 s59, s58, 28672
buffer_load_dwordx4 v[124:127], v4, s[20:23], s59 offen nt
buffer_load_dwordx4 v[156:159], v4, s[24:27], s59 offen nt
s_add_u32 s59, s58, 57344
buffer_load_dwordx4 v[128:131], v4, s[20:23], s59 offen nt
buffer_load_dwordx4 v[160:163], v4, s[24:27], s59 offen nt
s_add_u32 s59, s58, 86016
buffer_load_dwordx4 v[132:135], v4, s[20:23], s59 offen nt
buffer_load_dwordx4 v[164:167], v4, s[24:27], s59 offen nt
s_add_u32 s59, s58, 114688
buffer_load_dwordx4 v[136:139], v4, s[20:23], s59 offen nt
buffer_load_dwordx4 v[168:171], v4, s[24:27], s59 offen nt
s_add_u32 s59, s58, 143360
buffer_load_dwordx4 v[140:143], v4, s[20:23], s59 offen nt
buffer_load_dwordx4 v[172:175], v4, s[24:27], s59 offen nt
s_add_u32 s59, s58, 172032
buffer_load_dwordx4 v[144:147], v4, s[20:23], s59 offen nt
buffer_load_dwordx4 v[176:179], v4, s[24:27], s59 offen nt
v_and_b32 v4, 31, v3
v_lshlrev_b32 v4, 3, v4
s_mov_b32 s56, 0x420000
s_mov_b32 s60, 0
L_p_rdy_495:
s_nop 4
buffer_load_dwordx2 v[6:7], v4, s[44:47], s56 offen sc1
s_waitcnt vmcnt(0)
v_mov_b32 v8, 0
v_xor_b32 v9, v53, v7
v_and_or_b32 v8, v9, s61, v8
v_xor_b32 v9, v52, v6
v_or_b32 v8, v9, v8
v_cmp_ne_u32 vcc, 0, v8
s_cbranch_vccz L_d_rdy_496
s_sleep 1
s_add_u32 s60, s60, 1
s_cmp_lt_u32 s60, 400000
s_cbranch_scc1 L_p_rdy_495
s_endpgm
L_d_rdy_496:
s_nop 4
v_mov_b32 v148, 0
v_mov_b32 v180, 0
v_mov_b32 v149, 0
v_mov_b32 v181, 0
v_mov_b32 v150, 0
v_mov_b32 v182, 0
v_mov_b32 v151, 0
v_mov_b32 v183, 0
v_perm_b32 v4, v60, v56, s80
v_perm_b32 v60, v60, v56, s81
v_mov_b32 v56, v4
v_perm_b32 v4, v61, v57, s80
v_perm_b32 v61, v61, v57, s81
v_mov_b32 v57, v4
v_perm_b32 v4, v62, v58, s80
v_perm_b32 v62, v62, v58, s81
v_mov_b32 v58, v4
v_perm_b32 v4, v63, v59, s80
v_perm_b32 v63, v63, v59, s81
v_mov_b32 v59, v4
v_perm_b32 v4, v68, v64, s80
v_perm_b32 v68, v68, v64, s81
v_mov_b32 v64, v4
v_perm_b32 v4, v69, v65, s80
v_perm_b32 v69, v69, v65, s81
v_mov_b32 v65, v4
v_perm_b32 v4, v70, v66, s80
v_perm_b32 v70, v70, v66, s81
v_mov_b32 v66, v4
v_perm_b32 v4, v71, v67, s80
v_perm_b32 v71, v71, v67, s81
v_mov_b32 v67, v4
v_perm_b32 v4, v76, v72, s80
v_perm_b32 v76, v76, v72, s81
v_mov_b32 v72, v4
v_perm_b32 v4, v77, v73, s80
v_perm_b32 v77, v77, v73, s81
v_mov_b32 v73, v4
v_perm_b32 v4, v78, v74, s80
v_perm_b32 v78, v78, v74, s81
v_mov_b32 v74, v4
v_perm_b32 v4, v79, v75, s80
v_perm_b32 v79, v79, v75, s81
v_mov_b32 v75, v4
v_perm_b32 v4, v84, v80, s80
v_perm_b32 v84, v84, v80, s81
v_mov_b32 v80, v4
v_perm_b32 v4, v85, v81, s80
v_perm_b32 v85, v85, v81, s81
v_mov_b32 v81, v4
v_perm_b32 v4, v86, v82, s80
v_perm_b32 v86, v86, v82, s81
v_mov_b32 v82, v4
v_perm_b32 v4, v87, v83, s80
v_perm_b32 v87, v87, v83, s81
v_mov_b32 v83, v4
v_perm_b32 v4, v92, v88, s80
v_perm_b32 v92, v92, v88, s81
v_mov_b32 v88, v4
v_perm_b32 v4, v93, v89, s80
v_perm_b32 v93, v93, v89, s81
v_mov_b32 v89, v4
v_perm_b32 v4, v94, v90, s80
v_perm_b32 v94, v94, v90, s81
v_mov_b32 v90, v4
v_perm_b32 v4, v95, v91, s80
v_perm_b32 v95, v95, v91, s81
v_mov_b32 v91, v4
v_perm_b32 v4, v100, v96, s80
v_perm_b32 v100, v100, v96, s81
v_mov_b32 v96, v4
v_perm_b32 v4, v101, v97, s80
v_perm_b32 v101, v101, v97, s81
v_mov_b32 v97, v4
v_perm_b32 v4, v102, v98, s80
v_perm_b32 v102, v102, v98, s81
v_mov_b32 v98, v4
v_perm_b32 v4, v103, v99, s80
v_perm_b32 v103, v103, v99, s81
v_mov_b32 v99, v4
v_perm_b32 v4, v108, v104, s80
v_perm_b32 v108, v108, v104, s81
v_mov_b32 v104, v4
v_perm_b32 v4, v109, v105, s80
v_perm_b32 v109, v109, v105, s81
v_mov_b32 v105, v4
v_perm_b32 v4, v110, v106, s80
v_perm_b32 v110, v110, v106, s81
v_mov_b32 v106, v4
v_perm_b32 v4, v111, v107, s80
v_perm_b32 v111, v111, v107, s81
v_mov_b32 v107, v4
v_perm_b32 v4, v116, v112, s80
v_perm_b32 v116, v116, v112, s81
v_mov_b32 v112, v4
v_perm_b32 v4, v117, v113, s80
v_perm_b32 v117, v117, v113, s81
v_mov_b32 v113, v4
v_perm_b32 v4, v118, v114, s80
v_perm_b32 v118, v118, v114, s81
v_mov_b32 v114, v4
v_perm_b32 v4, v119, v115, s80
v_perm_b32 v119, v119, v115, s81
v_mov_b32 v115, v4
v_perm_b32 v4, v124, v120, s80
v_perm_b32 v124, v124, v120, s81
v_mov_b32 v120, v4
v_perm_b32 v4, v125, v121, s80
v_perm_b32 v125, v125, v121, s81
v_mov_b32 v121, v4
v_perm_b32 v4, v126, v122, s80
v_perm_b32 v126, v126, v122, s81
v_mov_b32 v122, v4
v_perm_b32 v4, v127, v123, s80
v_perm_b32 v127, v127, v123, s81
v_mov_b32 v123, v4
v_perm_b32 v4, v132, v128, s80
v_perm_b32 v132, v132, v128, s81
v_mov_b32 v128, v4
v_perm_b32 v4, v133, v129, s80
v_perm_b32 v133, v133, v129, s81
v_mov_b32 v129, v4
v_perm_b32 v4, v134, v130, s80
v_perm_b32 v134, v134, v130, s81
v_mov_b32 v130, v4
v_perm_b32 v4, v135, v131, s80
v_perm_b32 v135, v135, v131, s81
v_mov_b32 v131, v4
v_perm_b32 v4, v140, v136, s80
v_perm_b32 v140, v140, v136, s81
v_mov_b32 v136, v4
v_perm_b32 v4, v141, v137, s80
v_perm_b32 v141, v141, v137, s81
v_mov_b32 v137, v4
v_perm_b32 v4, v142, v138, s80
v_perm_b32 v142, v142, v138, s81
v_mov_b32 v138, v4
v_perm_b32 v4, v143, v139, s80
v_perm_b32 v143, v143, v139, s81
v_mov_b32 v139, v4
v_perm_b32 v4, v148, v144, s80
v_perm_b32 v148, v148, v144, s81
v_mov_b32 v144, v4
v_perm_b32 v4, v149, v145, s80
v_perm_b32 v149, v149, v145, s81
v_mov_b32 v145, v4
v_perm_b32 v4, v150, v146, s80
v_perm_b32 v150, v150, v146, s81
v_mov_b32 v146, v4
v_perm_b32 v4, v151, v147, s80
v_perm_b32 v151, v151, v147, s81
v_mov_b32 v147, v4
v_perm_b32 v4, v156, v152, s80
v_perm_b32 v156, v156, v152, s81
v_mov_b32 v152, v4
v_perm_b32 v4, v157, v153, s80
v_perm_b32 v157, v157, v153, s81
v_mov_b32 v153, v4
v_perm_b32 v4, v158, v154, s80
v_perm_b32 v158, v158, v154, s81
v_mov_b32 v154, v4
v_perm_b32 v4, v159, v155, s80
v_perm_b32 v159, v159, v155, s81
v_mov_b32 v155, v4
v_perm_b32 v4, v164, v160, s80
v_perm_b32 v164, v164, v160, s81
v_mov_b32 v160, v4
v_perm_b32 v4, v165, v161, s80
v_perm_b32 v165, v165, v161, s81
v_mov_b32 v161, v4
v_perm_b32 v4, v166, v162, s80
v_perm_b32 v166, v166, v162, s81
v_mov_b32 v162, v4
v_perm_b32 v4, v167, v163, s80
v_perm_b32 v167, v167, v163, s81
v_mov_b32 v163, v4
v_perm_b32 v4, v172, v168, s80
v_perm_b32 v172, v172, v168, s81
v_mov_b32 v168, v4
v_perm_b32 v4, v173, v169, s80
v_perm_b32 v173, v173, v169, s81
v_mov_b32 v169, v4
v_perm_b32 v4, v174, v170, s80
v_perm_b32 v174, v174, v170, s81
v_mov_b32 v170, v4
v_perm_b32 v4, v175, v171, s80
v_perm_b32 v175, v175, v171, s81
v_mov_b32 v171, v4
v_perm_b32 v4, v180, v176, s80
v_perm_b32 v180, v180, v176, s81
v_mov_b32 v176, v4
v_perm_b32 v4, v181, v177, s80
v_perm_b32 v181, v181, v177, s81
v_mov_b32 v177, v4
v_perm_b32 v4, v182, v178, s80
v_perm_b32 v182, v182, v178, s81
v_mov_b32 v178, v4
v_perm_b32 v4, v183, v179, s80
v_perm_b32 v183, v183, v179, s81
v_mov_b32 v179, v4
v_perm_b32 v4, v16, v12, s80
v_perm_b32 v16, v16, v12, s81
v_mov_b32 v12, v4
v_perm_b32 v4, v17, v13, s80
v_perm_b32 v17, v17, v13, s81
v_mov_b32 v13, v4
v_perm_b32 v4, v18, v14, s80
v_perm_b32 v18, v18, v14, s81
v_mov_b32 v14, v4
v_perm_b32 v4, v19, v15, s80
v_perm_b32 v19, v19, v15, s81
v_mov_b32 v15, v4
v_perm_b32 v4, v24, v20, s80
v_perm_b32 v24, v24, v20, s81
v_mov_b32 v20, v4
v_perm_b32 v4, v25, v21, s80
v_perm_b32 v25, v25, v21, s81
v_mov_b32 v21, v4
v_perm_b32 v4, v26, v22, s80
v_perm_b32 v26, v26, v22, s81
v_mov_b32 v22, v4
v_perm_b32 v4, v27, v23, s80
v_perm_b32 v27, v27, v23, s81
v_mov_b32 v23, v4
v_perm_b32 v4, v32, v28, s80
v_perm_b32 v32, v32, v28, s81
v_mov_b32 v28, v4
v_perm_b32 v4, v33, v29, s80
v_perm_b32 v33, v33, v29, s81
v_mov_b32 v29, v4
v_perm_b32 v4, v34, v30, s80
v_perm_b32 v34, v34, v30, s81
v_mov_b32 v30, v4
v_perm_b32 v4, v35, v31, s80
v_perm_b32 v35, v35, v31, s81
v_mov_b32 v31, v4
v_perm_b32 v4, v40, v36, s80
v_perm_b32 v40, v40, v36, s81
v_mov_b32 v36, v4
v_perm_b32 v4, v41, v37, s80
v_perm_b32 v41, v41, v37, s81
v_mov_b32 v37, v4
v_perm_b32 v4, v42, v38, s80
v_perm_b32 v42, v42, v38, s81
v_mov_b32 v38, v4
v_perm_b32 v4, v43, v39, s80
v_perm_b32 v43, v43, v39, s81
v_mov_b32 v39, v4
ds_write_b128 v2, v[12:15] offset:22528
ds_write_b128 v2, v[16:19] offset:23552
ds_write_b128 v2, v[20:23] offset:24576
ds_write_b128 v2, v[24:27] offset:25600
ds_write_b128 v2, v[28:31] offset:26624
ds_write_b128 v2, v[32:35] offset:27648
ds_write_b128 v2, v[36:39] offset:28672
ds_write_b128 v2, v[40:43] offset:29696
s_waitcnt lgkmcnt(0)
v_lshrrev_b32 v10, 2, v3
v_min_u32 v10, 13, v10
v_mul_u32_u24 v11, 1088, v10
v_and_b32 v10, 3, v3
v_lshl_add_u32 v10, v10, 4, v11
s_mul_i32 s56, s49, 15232
s_add_u32 s56, s56, 0x100000
s_lshl_b32 s57, s50, 9
s_lshl_b32 s58, s48, 6
s_add_u32 s57, s57, s58
s_add_u32 s57, s57, s56
s_mov_b32 s60, 0
L_p_pa_506:
s_nop 4
buffer_load_dwordx4 v[4:7], v10, s[44:47], s57 offen sc1
buffer_load_dwordx2 v[8:9], v11, s[44:47], s56 offen offset:1024 sc1
s_waitcnt vmcnt(0)
v_and_b32 v12, v4, v5
v_and_b32 v12, v12, v6
v_and_b32 v12, v12, v7
v_and_b32 v12, v12, v8
v_and_b32 v12, v12, v9
v_and_b32 v12, 1, v12
v_cmp_ne_u32 vcc, 1, v12
s_cbranch_vccz L_d_pa_507
s_sleep 1
s_add_u32 s60, s60, 1
s_cmp_lt_u32 s60, 400000
s_cbranch_scc1 L_p_pa_506
s_endpgm
L_d_pa_507:
s_nop 4
v_mov_b32 v15, v8
s_nop 1
v_max_f32_dpp v15, v15, v15 row_ror:4
s_nop 1
v_max_f32_dpp v15, v15, v15 row_ror:8
v_mov_b32 v13, v15
s_nop 1
v_permlane16_swap_b32 v15, v13
v_max_f32 v15, v15, v13
v_mov_b32 v13, v15
s_nop 1
v_permlane32_swap_b32 v15, v13
v_max_f32 v15, v15, v13
v_sub_f32 v8, v8, v15
v_mul_f32 v8, 0x3fb8aa3b, v8
v_exp_f32 v8, v8
v_cmp_gt_u32 vcc, 56, v3
s_nop 1
v_cndmask_b32 v8, 0, v8, vcc
v_mul_f32 v4, v8, v4
v_mul_f32 v5, v8, v5
v_mul_f32 v6, v8, v6
v_mul_f32 v7, v8, v7
v_mul_f32 v9, v8, v9
v_add_f32_dpp v4, v4, v4 row_ror:4
v_add_f32_dpp v5, v5, v5 row_ror:4
v_add_f32_dpp v6, v6, v6 row_ror:4
v_add_f32_dpp v7, v7, v7 row_ror:4
v_add_f32_dpp v9, v9, v9 row_ror:4
v_add_f32_dpp v4, v4, v4 row_ror:8
v_add_f32_dpp v5, v5, v5 row_ror:8
v_add_f32_dpp v6, v6, v6 row_ror:8
v_add_f32_dpp v7, v7, v7 row_ror:8
v_add_f32_dpp v9, v9, v9 row_ror:8
v_mov_b32 v16, v4
v_mov_b32 v17, v5
v_mov_b32 v18, v6
v_mov_b32 v19, v7
v_mov_b32 v20, v9
v_permlane16_swap_b32 v4, v16
v_permlane16_swap_b32 v5, v17
v_permlane16_swap_b32 v6, v18
v_permlane16_swap_b32 v7, v19
v_permlane16_swap_b32 v9, v20
v_add_f32 v4, v4, v16
v_add_f32 v5, v5, v17
v_add_f32 v6, v6, v18
v_add_f32 v7, v7, v19
v_add_f32 v9, v9, v20
v_mov_b32 v16, v4
v_mov_b32 v17, v5
v_mov_b32 v18, v6
v_mov_b32 v19, v7
v_mov_b32 v20, v9
v_permlane32_swap_b32 v4, v16
v_permlane32_swap_b32 v5, v17
v_permlane32_swap_b32 v6, v18
v_permlane32_swap_b32 v7, v19
v_permlane32_swap_b32 v9, v20
v_add_f32 v4, v4, v16
v_add_f32 v5, v5, v17
v_add_f32 v6, v6, v18
v_add_f32 v7, v7, v19
v_add_f32 v9, v9, v20
v_rcp_f32 v13, v9
s_nop 0
v_mul_f32 v16, v4, v13
v_mul_f32 v17, v5, v13
v_mul_f32 v18, v6, v13
v_mul_f32 v19, v7, v13
v_fma_f32 v4, -v16, v9, v4
v_fma_f32 v5, -v17, v9, v5
v_fma_f32 v6, -v18, v9, v6
v_fma_f32 v7, -v19, v9, v7
v_fma_f32 v4, v4, v13, v16
v_fma_f32 v5, v5, v13, v17
v_fma_f32 v6, v6, v13, v18
v_fma_f32 v7, v7, v13, v19
v_cvt_pk_bf16_f32 v4, v4, v5
v_cvt_pk_bf16_f32 v6, v6, v7
v_readlane_b32 s64, v4, 0
v_readlane_b32 s65, v6, 0
v_readlane_b32 s66, v4, 1
v_readlane_b32 s67, v6, 1
v_readlane_b32 s68, v4, 2
v_readlane_b32 s69, v6, 2
v_readlane_b32 s70, v4, 3
v_readlane_b32 s71, v6, 3
v_dot2_f32_bf16 v24, v56, s64, 0
v_dot2_f32_bf16 v25, v60, s64, 0
v_dot2_f32_bf16 v26, v57, s64, 0
v_dot2_f32_bf16 v27, v61, s64, 0
v_dot2_f32_bf16 v28, v58, s64, 0
v_dot2_f32_bf16 v29, v62, s64, 0
v_dot2_f32_bf16 v30, v59, s64, 0
v_dot2_f32_bf16 v31, v63, s64, 0
v_dot2_f32_bf16 v24, v64, s65, v24
v_dot2_f32_bf16 v25, v68, s65, v25
v_dot2_f32_bf16 v26, v65, s65, v26
v_dot2_f32_bf16 v27, v69, s65, v27
v_dot2_f32_bf16 v28, v66, s65, v28
v_dot2_f32_bf16 v29, v70, s65, v29
v_dot2_f32_bf16 v30, v67, s65, v30
v_dot2_f32_bf16 v31, v71, s65, v31
v_dot2_f32_bf16 v24, v72, s66, v24
v_dot2_f32_bf16 v25, v76, s66, v25
v_dot2_f32_bf16 v26, v73, s66, v26
v_dot2_f32_bf16 v27, v77, s66, v27
v_dot2_f32_bf16 v28, v74, s66, v28
v_dot2_f32_bf16 v29, v78, s66, v29
v_dot2_f32_bf16 v30, v75, s66, v30
v_dot2_f32_bf16 v31, v79, s66, v31
v_dot2_f32_bf16 v24, v80, s67, v24
v_dot2_f32_bf16 v25, v84, s67, v25
v_dot2_f32_bf16 v26, v81, s67, v26
v_dot2_f32_bf16 v27, v85, s67, v27
v_dot2_f32_bf16 v28, v82, s67, v28
v_dot2_f32_bf16 v29, v86, s67, v29
v_dot2_f32_bf16 v30, v83, s67, v30
v_dot2_f32_bf16 v31, v87, s67, v31
v_dot2_f32_bf16 v24, v88, s68, v24
v_dot2_f32_bf16 v25, v92, s68, v25
v_dot2_f32_bf16 v26, v89, s68, v26
v_dot2_f32_bf16 v27, v93, s68, v27
v_dot2_f32_bf16 v28, v90, s68, v28
v_dot2_f32_bf16 v29, v94, s68, v29
v_dot2_f32_bf16 v30, v91, s68, v30
v_dot2_f32_bf16 v31, v95, s68, v31
v_dot2_f32_bf16 v24, v96, s69, v24
v_dot2_f32_bf16 v25, v100, s69, v25
v_dot2_f32_bf16 v26, v97, s69, v26
v_dot2_f32_bf16 v27, v101, s69, v27
v_dot2_f32_bf16 v28, v98, s69, v28
v_dot2_f32_bf16 v29, v102, s69, v29
v_dot2_f32_bf16 v30, v99, s69, v30
v_dot2_f32_bf16 v31, v103, s69, v31
v_dot2_f32_bf16 v24, v104, s70, v24
v_dot2_f32_bf16 v25, v108, s70, v25
v_dot2_f32_bf16 v26, v105, s70, v26
v_dot2_f32_bf16 v27, v109, s70, v27
v_dot2_f32_bf16 v28, v106, s70, v28
v_dot2_f32_bf16 v29, v110, s70, v29
v_dot2_f32_bf16 v30, v107, s70, v30
v_dot2_f32_bf16 v31, v111, s70, v31
v_dot2_f32_bf16 v24, v112, s71, v24
v_dot2_f32_bf16 v25, v116, s71, v25
v_dot2_f32_bf16 v26, v113, s71, v26
v_dot2_f32_bf16 v27, v117, s71, v27
v_dot2_f32_bf16 v28, v114, s71, v28
v_dot2_f32_bf16 v29, v118, s71, v29
v_dot2_f32_bf16 v30, v115, s71, v30
v_dot2_f32_bf16 v31, v119, s71, v31
v_lshlrev_b32 v32, 5, v3
s_mul_i32 s56, s48, 1792
s_add_u32 s56, s56, 8192
v_add_u32 v32, s56, v32
s_mov_b32 exec_hi, 0x00ffffff
ds_write_b128 v32, v[24:27]
ds_write_b128 v32, v[28:31] offset:16
s_mov_b32 exec_hi, -1
s_waitcnt lgkmcnt(0)
s_barrier
s_mul_i32 s56, s48, 224
v_lshlrev_b32 v33, 2, v3
v_add_u32 v33, s56, v33
v_add_u32 v32, 8192, v33
ds_read_b32 v34, v32 offset:0
ds_read_b32 v35, v32 offset:1792
ds_read_b32 v36, v32 offset:3584
ds_read_b32 v37, v32 offset:5376
ds_read_b32 v38, v32 offset:7168
ds_read_b32 v39, v32 offset:8960
ds_read_b32 v40, v32 offset:10752
ds_read_b32 v41, v32 offset:12544
s_waitcnt lgkmcnt(0)
v_add_f32 v34, v34, v35
v_add_f32 v34, v34, v36
v_add_f32 v34, v34, v37
v_add_f32 v34, v34, v38
v_add_f32 v34, v34, v39
v_add_f32 v34, v34, v40
v_add_f32 v34, v34, v41
v_or_b32 v34, 1, v34
s_mul_i32 s56, s2, 1792
s_add_u32 s56, s56, 0x300000
s_mov_b32 exec_hi, 0x00ffffff
buffer_store_dword v34, v33, s[44:47], s56 offen sc1
s_mov_b32 exec_hi, -1
s_cmp_eq_u32 s48, 7
s_cbranch_scc1 L_gx_521
v_lshrrev_b32 v36, 4, v3
v_mul_u32_u24 v36, 1792, v36
v_and_b32 v37, 15, v3
v_lshl_add_u32 v36, v37, 4, v36
s_lshl_b32 s56, s48, 8
s_add_u32 s56, s56, 0x300000
s_mov_b32 s60, 0
L_p_gx_522:
s_nop 4
s_add_u32 s57, s56, 0
buffer_load_dwordx4 v[4:7], v36, s[44:47], s57 offen sc1
s_add_u32 s57, s56, 7168
buffer_load_dwordx4 v[8:11], v36, s[44:47], s57 offen sc1
s_add_u32 s57, s56, 14336
buffer_load_dwordx4 v[12:15], v36, s[44:47], s57 offen sc1
s_add_u32 s57, s56, 21504
buffer_load_dwordx4 v[16:19], v36, s[44:47], s57 offen sc1
s_add_u32 s57, s56, 28672
buffer_load_dwordx4 v[20:23], v36, s[44:47], s57 offen sc1
s_add_u32 s57, s56, 35840
buffer_load_dwordx4 v[24:27], v36, s[44:47], s57 offen sc1
s_add_u32 s57, s56, 43008
buffer_load_dwordx4 v[28:31], v36, s[44:47], s57 offen sc1
s_add_u32 s57, s56, 50176
buffer_load_dwordx4 v[32:35], v36, s[44:47], s57 offen sc1
s_waitcnt vmcnt(0)
v_and_b32 v37, v4, v5
v_and_b32 v37, v37, v6
v_and_b32 v37, v37, v7
v_and_b32 v37, v37, v8
v_and_b32 v37, v37, v9
v_and_b32 v37, v37, v10
v_and_b32 v37, v37, v11
v_and_b32 v37, v37, v12
v_and_b32 v37, v37, v13
v_and_b32 v37, v37, v14
v_and_b32 v37, v37, v15
v_and_b32 v37, v37, v16
v_and_b32 v37, v37, v17
v_and_b32 v37, v37, v18
v_and_b32 v37, v37, v19
v_and_b32 v37, v37, v20
v_and_b32 v37, v37, v21
v_and_b32 v37, v37, v22
v_and_b32 v37, v37, v23
v_and_b32 v37, v37, v24
v_and_b32 v37, v37, v25
v_and_b32 v37, v37, v26
v_and_b32 v37, v37, v27
v_and_b32 v37, v37, v28
v_and_b32 v37, v37, v29
v_and_b32 v37, v37, v30
v_and_b32 v37, v37, v31
v_and_b32 v37, v37, v32
v_and_b32 v37, v37, v33
v_and_b32 v37, v37, v34
v_and_b32 v37, v37, v35
v_and_b32 v37, 1, v37
v_cmp_ne_u32 vcc, 1, v37
s_cbranch_vccz L_d_gx_523
s_sleep 1
s_add_u32 s60, s60, 1
s_cmp_lt_u32 s60, 400000
s_cbranch_scc1 L_p_gx_522
s_endpgm
L_d_gx_523:
s_nop 4
v_add_f32 v4, v4, v8
v_add_f32 v5, v5, v9
v_add_f32 v6, v6, v10
v_add_f32 v7, v7, v11
v_add_f32 v4, v4, v12
v_add_f32 v5, v5, v13
v_add_f32 v6, v6, v14
v_add_f32 v7, v7, v15
v_add_f32 v4, v4, v16
v_add_f32 v5, v5, v17
v_add_f32 v6, v6, v18
v_add_f32 v7, v7, v19
v_add_f32 v4, v4, v20
v_add_f32 v5, v5, v21
v_add_f32 v6, v6, v22
v_add_f32 v7, v7, v23
v_add_f32 v4, v4, v24
v_add_f32 v5, v5, v25
v_add_f32 v6, v6, v26
v_add_f32 v7, v7, v27
v_add_f32 v4, v4, v28
v_add_f32 v5, v5, v29
v_add_f32 v6, v6, v30
v_add_f32 v7, v7, v31
v_add_f32 v4, v4, v32
v_add_f32 v5, v5, v33
v_add_f32 v6, v6, v34
v_add_f32 v7, v7, v35
v_mov_b32 v38, v4
v_mov_b32 v39, v5
v_mov_b32 v40, v6
v_mov_b32 v41, v7
v_permlane16_swap_b32 v4, v38
v_permlane16_swap_b32 v5, v39
v_permlane16_swap_b32 v6, v40
v_permlane16_swap_b32 v7, v41
v_add_f32 v4, v4, v38
v_add_f32 v5, v5, v39
v_add_f32 v6, v6, v40
v_add_f32 v7, v7, v41
v_mov_b32 v38, v4
v_mov_b32 v39, v5
v_mov_b32 v40, v6
v_mov_b32 v41, v7
v_permlane32_swap_b32 v4, v38
v_permlane32_swap_b32 v5, v39
v_permlane32_swap_b32 v6, v40
v_permlane32_swap_b32 v7, v41
v_add_f32 v4, v4, v38
v_add_f32 v5, v5, v39
v_add_f32 v6, v6, v40
v_add_f32 v7, v7, v41
v_cvt_pk_bf16_f32 v4, v4, v4
v_cvt_pk_bf16_f32 v5, v5, v5
v_cvt_pk_bf16_f32 v6, v6, v6
v_cvt_pk_bf16_f32 v7, v7, v7
v_and_b32 v4, s62, v4
v_and_b32 v5, s62, v5
v_and_b32 v6, s62, v6
v_and_b32 v7, s62, v7
v_add_f32 v240, v240, v4
v_add_f32 v241, v241, v5
v_add_f32 v242, v242, v6
v_add_f32 v243, v243, v7
v_cvt_pk_bf16_f32 v240, v240, v240
v_cvt_pk_bf16_f32 v241, v241, v241
v_cvt_pk_bf16_f32 v242, v242, v242
v_cvt_pk_bf16_f32 v243, v243, v243
v_and_b32 v240, s62, v240
v_and_b32 v241, s62, v241
v_and_b32 v242, s62, v242
v_and_b32 v243, s62, v243
v_and_b32 v36, 15, v3
v_lshlrev_b32 v36, 4, v36
s_lshl_b32 s56, s48, 8
s_add_u32 s56, s56, 0
v_add_u32 v36, s56, v36
v_mov_b32 v4, v240
v_mov_b32 v5, v241
v_mov_b32 v6, v242
v_mov_b32 v7, v243
ds_write_b128 v36, v[4:7]
s_waitcnt lgkmcnt(0)
L_gx_521:
s_nop 4
s_barrier
v_lshlrev_b32 v4, 2, v3
ds_read_b32 v16, v4 offset:0
ds_read_b32 v17, v4 offset:256
ds_read_b32 v18, v4 offset:512
ds_read_b32 v19, v4 offset:768
ds_read_b32 v20, v4 offset:1024
ds_read_b32 v21, v4 offset:1280
ds_read_b32 v22, v4 offset:1536
v_lshrrev_b32 v5, 3, v3
v_lshlrev_b32 v5, 2, v5
s_mul_i32 s56, s48, 224
v_add_u32 v5, s56, v5
s_waitcnt lgkmcnt(0)
ds_read_b32 v24, v5 offset:0
ds_read_b32 v25, v5 offset:32
ds_read_b32 v26, v5 offset:64
ds_read_b32 v27, v5 offset:96
ds_read_b32 v28, v5 offset:128
ds_read_b32 v29, v5 offset:160
ds_read_b32 v30, v5 offset:192
v_add_f32 v6, v16, v17
v_add_f32 v6, v6, v18
v_add_f32 v6, v6, v19
v_add_f32 v6, v6, v20
v_add_f32 v6, v6, v21
v_add_f32 v6, v6, v22
s_nop 1
v_add_f32_dpp v6, v6, v6 quad_perm:[1,0,3,2]
s_nop 1
v_add_f32_dpp v6, v6, v6 quad_perm:[2,3,0,1]
s_nop 1
v_add_f32_dpp v6, v6, v6 row_ror:4
s_nop 1
v_add_f32_dpp v6, v6, v6 row_ror:8
v_mov_b32 v7, v6
s_nop 1
v_permlane16_swap_b32 v6, v7
v_add_f32 v6, v6, v7
v_mov_b32 v7, v6
s_nop 1
v_permlane32_swap_b32 v6, v7
v_add_f32 v6, v6, v7
v_mul_f32 v8, 0x3b124925, v6
v_sub_f32 v10, v16, v8
v_sub_f32 v11, v17, v8
v_sub_f32 v12, v18, v8
v_sub_f32 v13, v19, v8
v_sub_f32 v14, v20, v8
v_sub_f32 v15, v21, v8
v_sub_f32 v16, v22, v8
v_mul_f32 v9, v10, v10
v_fmac_f32 v9, v11, v11
v_fmac_f32 v9, v12, v12
v_fmac_f32 v9, v13, v13
v_fmac_f32 v9, v14, v14
v_fmac_f32 v9, v15, v15
v_fmac_f32 v9, v16, v16
s_nop 1
v_add_f32_dpp v9, v9, v9 quad_perm:[1,0,3,2]
s_nop 1
v_add_f32_dpp v9, v9, v9 quad_perm:[2,3,0,1]
s_nop 1
v_add_f32_dpp v9, v9, v9 row_ror:4
s_nop 1
v_add_f32_dpp v9, v9, v9 row_ror:8
v_mov_b32 v7, v9
s_nop 1
v_permlane16_swap_b32 v9, v7
v_add_f32 v9, v9, v7
v_mov_b32 v7, v9
s_nop 1
v_permlane32_swap_b32 v9, v7
v_add_f32 v9, v9, v7
v_mul_f32 v9, 0x3b124925, v9
v_cvt_pk_bf16_f32 v9, v9, v9
v_cvt_pk_bf16_f32 v8, v8, v8
v_and_b32 v9, s62, v9
v_and_b32 v8, s62, v8
v_add_f32 v9, 0x3727c5ac, v9
v_cvt_pk_bf16_f32 v9, v9, v9
v_and_b32 v9, s62, v9
v_sqrt_f32 v9, v9
s_nop 0
v_cvt_pk_bf16_f32 v9, v9, v9
v_and_b32 v9, s62, v9
v_rcp_f32 v6, v9
s_waitcnt lgkmcnt(0)
v_sub_f32 v24, v24, v8
v_sub_f32 v25, v25, v8
v_sub_f32 v26, v26, v8
v_sub_f32 v27, v27, v8
v_sub_f32 v28, v28, v8
v_sub_f32 v29, v29, v8
v_sub_f32 v30, v30, v8
v_cvt_pk_bf16_f32 v24, v24, v24
v_cvt_pk_bf16_f32 v25, v25, v25
v_cvt_pk_bf16_f32 v26, v26, v26
v_cvt_pk_bf16_f32 v27, v27, v27
v_cvt_pk_bf16_f32 v28, v28, v28
v_cvt_pk_bf16_f32 v29, v29, v29
v_cvt_pk_bf16_f32 v30, v30, v30
v_and_b32 v24, s62, v24
v_and_b32 v25, s62, v25
v_and_b32 v26, s62, v26
v_and_b32 v27, s62, v27
v_and_b32 v28, s62, v28
v_and_b32 v29, s62, v29
v_and_b32 v30, s62, v30
v_mul_f32 v38, v24, v6
v_mul_f32 v39, v25, v6
v_mul_f32 v40, v26, v6
v_mul_f32 v41, v27, v6
v_mul_f32 v42, v28, v6
v_mul_f32 v43, v29, v6
v_mul_f32 v44, v30, v6
v_fma_f32 v24, -v38, v9, v24
v_fma_f32 v25, -v39, v9, v25
v_fma_f32 v26, -v40, v9, v26
v_fma_f32 v27, -v41, v9, v27
v_fma_f32 v28, -v42, v9, v28
v_fma_f32 v29, -v43, v9, v29
v_fma_f32 v30, -v44, v9, v30
v_fma_f32 v24, v24, v6, v38
v_fma_f32 v25, v25, v6, v39
v_fma_f32 v26, v26, v6, v40
v_fma_f32 v27, v27, v6, v41
v_fma_f32 v28, v28, v6, v42
v_fma_f32 v29, v29, v6, v43
v_fma_f32 v30, v30, v6, v44
v_cvt_pk_bf16_f32 v24, v24, v24
v_cvt_pk_bf16_f32 v25, v25, v25
v_cvt_pk_bf16_f32 v26, v26, v26
v_cvt_pk_bf16_f32 v27, v27, v27
v_cvt_pk_bf16_f32 v28, v28, v28
v_cvt_pk_bf16_f32 v29, v29, v29
v_cvt_pk_bf16_f32 v30, v30, v30
v_and_b32 v24, s62, v24
v_and_b32 v25, s62, v25
v_and_b32 v26, s62, v26
v_and_b32 v27, s62, v27
v_and_b32 v28, s62, v28
v_and_b32 v29, s62, v29
v_and_b32 v30, s62, v30
ds_read_b128 v[32:35], v2 offset:22528
ds_read_b128 v[36:39], v2 offset:23552
ds_read_b128 v[40:43], v2 offset:24576
ds_read_b128 v[44:47], v2 offset:25600
v_cvt_pk_bf16_f32 v24, v24, v25
v_cvt_pk_bf16_f32 v26, v26, v27
v_cvt_pk_bf16_f32 v28, v28, v29
v_cvt_pk_bf16_f32 v30, v30, 0
v_dot2_f32_bf16 v4, v120, v24, 0
v_dot2_f32_bf16 v5, v124, v24, 0
v_dot2_f32_bf16 v6, v121, v24, 0
v_dot2_f32_bf16 v7, v125, v24, 0
v_dot2_f32_bf16 v8, v122, v24, 0
v_dot2_f32_bf16 v9, v126, v24, 0
v_dot2_f32_bf16 v10, v123, v24, 0
v_dot2_f32_bf16 v11, v127, v24, 0
v_dot2_f32_bf16 v12, v152, v24, 0
v_dot2_f32_bf16 v13, v156, v24, 0
v_dot2_f32_bf16 v14, v153, v24, 0
v_dot2_f32_bf16 v15, v157, v24, 0
v_dot2_f32_bf16 v16, v154, v24, 0
v_dot2_f32_bf16 v17, v158, v24, 0
v_dot2_f32_bf16 v18, v155, v24, 0
v_dot2_f32_bf16 v19, v159, v24, 0
v_dot2_f32_bf16 v4, v128, v26, v4
v_dot2_f32_bf16 v5, v132, v26, v5
v_dot2_f32_bf16 v6, v129, v26, v6
v_dot2_f32_bf16 v7, v133, v26, v7
v_dot2_f32_bf16 v8, v130, v26, v8
v_dot2_f32_bf16 v9, v134, v26, v9
v_dot2_f32_bf16 v10, v131, v26, v10
v_dot2_f32_bf16 v11, v135, v26, v11
v_dot2_f32_bf16 v12, v160, v26, v12
v_dot2_f32_bf16 v13, v164, v26, v13
v_dot2_f32_bf16 v14, v161, v26, v14
v_dot2_f32_bf16 v15, v165, v26, v15
v_dot2_f32_bf16 v16, v162, v26, v16
v_dot2_f32_bf16 v17, v166, v26, v17
v_dot2_f32_bf16 v18, v163, v26, v18
v_dot2_f32_bf16 v19, v167, v26, v19
v_dot2_f32_bf16 v4, v136, v28, v4
v_dot2_f32_bf16 v5, v140, v28, v5
v_dot2_f32_bf16 v6, v137, v28, v6
v_dot2_f32_bf16 v7, v141, v28, v7
v_dot2_f32_bf16 v8, v138, v28, v8
v_dot2_f32_bf16 v9, v142, v28, v9
v_dot2_f32_bf16 v10, v139, v28, v10
v_dot2_f32_bf16 v11, v143, v28, v11
v_dot2_f32_bf16 v12, v168, v28, v12
v_dot2_f32_bf16 v13, v172, v28, v13
v_dot2_f32_bf16 v14, v169, v28, v14
v_dot2_f32_bf16 v15, v173, v28, v15
v_dot2_f32_bf16 v16, v170, v28, v16
v_dot2_f32_bf16 v17, v174, v28, v17
v_dot2_f32_bf16 v18, v171, v28, v18
v_dot2_f32_bf16 v19, v175, v28, v19
v_dot2_f32_bf16 v4, v144, v30, v4
v_dot2_f32_bf16 v5, v148, v30, v5
v_dot2_f32_bf16 v6, v145, v30, v6
v_dot2_f32_bf16 v7, v149, v30, v7
v_dot2_f32_bf16 v8, v146, v30, v8
v_dot2_f32_bf16 v9, v150, v30, v9
v_dot2_f32_bf16 v10, v147, v30, v10
v_dot2_f32_bf16 v11, v151, v30, v11
v_dot2_f32_bf16 v12, v176, v30, v12
v_dot2_f32_bf16 v13, v180, v30, v13
v_dot2_f32_bf16 v14, v177, v30, v14
v_dot2_f32_bf16 v15, v181, v30, v15
v_dot2_f32_bf16 v16, v178, v30, v16
v_dot2_f32_bf16 v17, v182, v30, v17
v_dot2_f32_bf16 v18, v179, v30, v18
v_dot2_f32_bf16 v19, v183, v30, v19
v_permlane32_swap_b32 v4, v12
v_permlane32_swap_b32 v5, v13
v_permlane32_swap_b32 v6, v14
v_permlane32_swap_b32 v7, v15
v_permlane32_swap_b32 v8, v16
v_permlane32_swap_b32 v9, v17
v_permlane32_swap_b32 v10, v18
v_permlane32_swap_b32 v11, v19
v_add_f32 v4, v4, v12
v_add_f32 v5, v5, v13
v_add_f32 v6, v6, v14
v_add_f32 v7, v7, v15
v_add_f32 v8, v8, v16
v_add_f32 v9, v9, v17
v_add_f32 v10, v10, v18
v_add_f32 v11, v11, v19
v_permlane16_swap_b32 v4, v8
v_permlane16_swap_b32 v5, v9
v_permlane16_swap_b32 v6, v10
v_permlane16_swap_b32 v7, v11
v_add_f32 v4, v4, v8
v_add_f32 v5, v5, v9
v_add_f32 v6, v6, v10
v_add_f32 v7, v7, v11
v_add_f32_dpp v4, v4, v4 row_ror:8 row_mask:0xf bank_mask:0x3
v_add_f32_dpp v4, v6, v6 row_ror:8 row_mask:0xf bank_mask:0xc
v_add_f32_dpp v5, v5, v5 row_ror:8 row_mask:0xf bank_mask:0x3
v_add_f32_dpp v5, v7, v7 row_ror:8 row_mask:0xf bank_mask:0xc
s_waitcnt lgkmcnt(0)
v_lshlrev_b32 v12, 3, v3
s_lshl_b32 s56, s48, 9
v_add_u32 v13, s56, v12
ds_write_b64 v13, v[4:5] offset:4096
s_waitcnt lgkmcnt(0)
s_barrier
ds_read_b64 v[14:15], v12 offset:4096
ds_read_b64 v[16:17], v12 offset:4608
ds_read_b64 v[18:19], v12 offset:5120
ds_read_b64 v[20:21], v12 offset:5632
ds_read_b64 v[22:23], v12 offset:6144
ds_read_b64 v[24:25], v12 offset:6656
ds_read_b64 v[26:27], v12 offset:7168
ds_read_b64 v[28:29], v12 offset:7680
s_waitcnt lgkmcnt(0)
v_add_f32 v4, v14, v16
v_add_f32 v5, v15, v17
v_add_f32 v4, v4, v18
v_add_f32 v5, v5, v19
v_add_f32 v4, v4, v20
v_add_f32 v5, v5, v21
v_add_f32 v4, v4, v22
v_add_f32 v5, v5, v23
v_add_f32 v4, v4, v24
v_add_f32 v5, v5, v25
v_add_f32 v4, v4, v26
v_add_f32 v5, v5, v27
v_add_f32 v4, v4, v28
v_add_f32 v5, v5, v29
v_cvt_pk_bf16_f32 v4, v4, v4
v_cvt_pk_bf16_f32 v5, v5, v5
v_and_b32 v4, s62, v4
v_and_b32 v5, s62, v5
v_mov_b32 v6, v4
v_mov_b32 v7, v5
s_nop 0
v_permlane32_swap_b32 v4, v6
v_permlane32_swap_b32 v5, v7
v_mul_f32 v4, v4, v6
v_mul_f32 v5, v5, v7
v_cvt_pk_bf16_f32 v4, v4, v5
s_add_u32 s56, s48, 0
v_readlane_b32 s64, v4, s56
s_add_u32 s56, s48, 8
v_readlane_b32 s65, v4, s56
s_add_u32 s56, s48, 16
v_readlane_b32 s66, v4, s56
s_add_u32 s56, s48, 24
v_readlane_b32 s67, v4, s56
s_cmp_eq_u32 s48, 7
s_cselect_b32 s64, 0, s64
s_cselect_b32 s65, 0, s65
s_cselect_b32 s66, 0, s66
s_cselect_b32 s67, 0, s67
ds_read_b128 v[4:7], v2 offset:26624
ds_read_b128 v[8:11], v2 offset:27648
ds_read_b128 v[20:23], v2 offset:28672
ds_read_b128 v[24:27], v2 offset:29696
v_dot2_f32_bf16 v12, v32, s64, 0
v_dot2_f32_bf16 v13, v36, s64, 0
v_dot2_f32_bf16 v14, v33, s64, 0
v_dot2_f32_bf16 v15, v37, s64, 0
v_dot2_f32_bf16 v16, v34, s64, 0
v_dot2_f32_bf16 v17, v38, s64, 0
v_dot2_f32_bf16 v18, v35, s64, 0
v_dot2_f32_bf16 v19, v39, s64, 0
v_dot2_f32_bf16 v12, v40, s65, v12
v_dot2_f32_bf16 v13, v44, s65, v13
v_dot2_f32_bf16 v14, v41, s65, v14
v_dot2_f32_bf16 v15, v45, s65, v15
v_dot2_f32_bf16 v16, v42, s65, v16
v_dot2_f32_bf16 v17, v46, s65, v17
v_dot2_f32_bf16 v18, v43, s65, v18
v_dot2_f32_bf16 v19, v47, s65, v19
s_waitcnt lgkmcnt(0)
v_dot2_f32_bf16 v12, v4, s66, v12
v_dot2_f32_bf16 v13, v8, s66, v13
v_dot2_f32_bf16 v14, v5, s66, v14
v_dot2_f32_bf16 v15, v9, s66, v15
v_dot2_f32_bf16 v16, v6, s66, v16
v_dot2_f32_bf16 v17, v10, s66, v17
v_dot2_f32_bf16 v18, v7, s66, v18
v_dot2_f32_bf16 v19, v11, s66, v19
v_dot2_f32_bf16 v12, v20, s67, v12
v_dot2_f32_bf16 v13, v24, s67, v13
v_dot2_f32_bf16 v14, v21, s67, v14
v_dot2_f32_bf16 v15, v25, s67, v15
v_dot2_f32_bf16 v16, v22, s67, v16
v_dot2_f32_bf16 v17, v26, s67, v17
v_dot2_f32_bf16 v18, v23, s67, v18
v_dot2_f32_bf16 v19, v27, s67, v19
v_lshlrev_b32 v32, 5, v3
s_mul_i32 s56, s48, 1792
s_add_u32 s56, s56, 8192
v_add_u32 v32, s56, v32
s_mov_b32 exec_hi, 0x00ffffff
ds_write_b128 v32, v[12:15]
ds_write_b128 v32, v[16:19] offset:16
s_mov_b32 exec_hi, -1
s_waitcnt lgkmcnt(0)
s_barrier
s_mul_i32 s56, s48, 224
v_lshlrev_b32 v33, 2, v3
v_add_u32 v33, s56, v33
v_add_u32 v32, 8192, v33
ds_read_b32 v34, v32 offset:0
ds_read_b32 v35, v32 offset:1792
ds_read_b32 v36, v32 offset:3584
ds_read_b32 v37, v32 offset:5376
ds_read_b32 v38, v32 offset:7168
ds_read_b32 v39, v32 offset:8960
ds_read_b32 v40, v32 offset:10752
ds_read_b32 v41, v32 offset:12544
s_waitcnt lgkmcnt(0)
v_add_f32 v34, v34, v35
v_add_f32 v34, v34, v36
v_add_f32 v34, v34, v37
v_add_f32 v34, v34, v38
v_add_f32 v34, v34, v39
v_add_f32 v34, v34, v40
v_add_f32 v34, v34, v41
v_or_b32 v34, 1, v34
s_mul_i32 s56, s2, 1792
s_add_u32 s56, s56, 0x380000
s_mov_b32 exec_hi, 0x00ffffff
buffer_store_dword v34, v33, s[44:47], s56 offen sc1
s_mov_b32 exec_hi, -1
s_cmp_eq_u32 s48, 7
s_cbranch_scc1 L_gx_575
v_lshrrev_b32 v36, 4, v3
v_mul_u32_u24 v36, 1792, v36
v_and_b32 v37, 15, v3
v_lshl_add_u32 v36, v37, 4, v36
s_lshl_b32 s56, s48, 8
s_add_u32 s56, s56, 0x380000
s_mov_b32 s60, 0
L_p_gx_576:
s_nop 4
s_add_u32 s57, s56, 0
buffer_load_dwordx4 v[4:7], v36, s[44:47], s57 offen sc1
s_add_u32 s57, s56, 7168
buffer_load_dwordx4 v[8:11], v36, s[44:47], s57 offen sc1
s_add_u32 s57, s56, 14336
buffer_load_dwordx4 v[12:15], v36, s[44:47], s57 offen sc1
s_add_u32 s57, s56, 21504
buffer_load_dwordx4 v[16:19], v36, s[44:47], s57 offen sc1
s_add_u32 s57, s56, 28672
buffer_load_dwordx4 v[20:23], v36, s[44:47], s57 offen sc1
s_add_u32 s57, s56, 35840
buffer_load_dwordx4 v[24:27], v36, s[44:47], s57 offen sc1
s_add_u32 s57, s56, 43008
buffer_load_dwordx4 v[28:31], v36, s[44:47], s57 offen sc1
s_add_u32 s57, s56, 50176
buffer_load_dwordx4 v[32:35], v36, s[44:47], s57 offen sc1
s_waitcnt vmcnt(0)
v_and_b32 v37, v4, v5
v_and_b32 v37, v37, v6
v_and_b32 v37, v37, v7
v_and_b32 v37, v37, v8
v_and_b32 v37, v37, v9
v_and_b32 v37, v37, v10
v_and_b32 v37, v37, v11
v_and_b32 v37, v37, v12
v_and_b32 v37, v37, v13
v_and_b32 v37, v37, v14
v_and_b32 v37, v37, v15
v_and_b32 v37, v37, v16
v_and_b32 v37, v37, v17
v_and_b32 v37, v37, v18
v_and_b32 v37, v37, v19
v_and_b32 v37, v37, v20
v_and_b32 v37, v37, v21
v_and_b32 v37, v37, v22
v_and_b32 v37, v37, v23
v_and_b32 v37, v37, v24
v_and_b32 v37, v37, v25
v_and_b32 v37, v37, v26
v_and_b32 v37, v37, v27
v_and_b32 v37, v37, v28
v_and_b32 v37, v37, v29
v_and_b32 v37, v37, v30
v_and_b32 v37, v37, v31
v_and_b32 v37, v37, v32
v_and_b32 v37, v37, v33
v_and_b32 v37, v37, v34
v_and_b32 v37, v37, v35
v_and_b32 v37, 1, v37
v_cmp_ne_u32 vcc, 1, v37
s_cbranch_vccz L_d_gx_577
s_sleep 1
s_add_u32 s60, s60, 1
s_cmp_lt_u32 s60, 400000
s_cbranch_scc1 L_p_gx_576
s_endpgm
L_d_gx_577:
s_nop 4
v_add_f32 v4, v4, v8
v_add_f32 v5, v5, v9
v_add_f32 v6, v6, v10
v_add_f32 v7, v7, v11
v_add_f32 v4, v4, v12
v_add_f32 v5, v5, v13
v_add_f32 v6, v6, v14
v_add_f32 v7, v7, v15
v_add_f32 v4, v4, v16
v_add_f32 v5, v5, v17
v_add_f32 v6, v6, v18
v_add_f32 v7, v7, v19
v_add_f32 v4, v4, v20
v_add_f32 v5, v5, v21
v_add_f32 v6, v6, v22
v_add_f32 v7, v7, v23
v_add_f32 v4, v4, v24
v_add_f32 v5, v5, v25
v_add_f32 v6, v6, v26
v_add_f32 v7, v7, v27
v_add_f32 v4, v4, v28
v_add_f32 v5, v5, v29
v_add_f32 v6, v6, v30
v_add_f32 v7, v7, v31
v_add_f32 v4, v4, v32
v_add_f32 v5, v5, v33
v_add_f32 v6, v6, v34
v_add_f32 v7, v7, v35
v_mov_b32 v38, v4
v_mov_b32 v39, v5
v_mov_b32 v40, v6
v_mov_b32 v41, v7
v_permlane16_swap_b32 v4, v38
v_permlane16_swap_b32 v5, v39
v_permlane16_swap_b32 v6, v40
v_permlane16_swap_b32 v7, v41
v_add_f32 v4, v4, v38
v_add_f32 v5, v5, v39
v_add_f32 v6, v6, v40
v_add_f32 v7, v7, v41
v_mov_b32 v38, v4
v_mov_b32 v39, v5
v_mov_b32 v40, v6
v_mov_b32 v41, v7
v_permlane32_swap_b32 v4, v38
v_permlane32_swap_b32 v5, v39
v_permlane32_swap_b32 v6, v40
v_permlane32_swap_b32 v7, v41
v_add_f32 v4, v4, v38
v_add_f32 v5, v5, v39
v_add_f32 v6, v6, v40
v_add_f32 v7, v7, v41
v_cvt_pk_bf16_f32 v4, v4, v4
v_cvt_pk_bf16_f32 v5, v5, v5
v_cvt_pk_bf16_f32 v6, v6, v6
v_cvt_pk_bf16_f32 v7, v7, v7
v_and_b32 v4, s62, v4
v_and_b32 v5, s62, v5
v_and_b32 v6, s62, v6
v_and_b32 v7, s62, v7
v_add_f32 v240, v240, v4
v_add_f32 v241, v241, v5
v_add_f32 v242, v242, v6
v_add_f32 v243, v243, v7
v_cvt_pk_bf16_f32 v240, v240, v240
v_cvt_pk_bf16_f32 v241, v241, v241
v_cvt_pk_bf16_f32 v242, v242, v242
v_cvt_pk_bf16_f32 v243, v243, v243
v_and_b32 v240, s62, v240
v_and_b32 v241, s62, v241
v_and_b32 v242, s62, v242
v_and_b32 v243, s62, v243
v_and_b32 v36, 15, v3
v_lshlrev_b32 v36, 4, v36
s_lshl_b32 s56, s48, 8
s_add_u32 s56, s56, 0
v_add_u32 v36, s56, v36
v_mov_b32 v4, v240
v_mov_b32 v5, v241
v_mov_b32 v6, v242
v_mov_b32 v7, v243
ds_write_b128 v36, v[4:7]
s_waitcnt lgkmcnt(0)
L_gx_575:
s_nop 4
s_barrier
v_lshlrev_b32 v4, 2, v3
ds_read_b32 v16, v4 offset:0
ds_read_b32 v17, v4 offset:256
ds_read_b32 v18, v4 offset:512
ds_read_b32 v19, v4 offset:768
ds_read_b32 v20, v4 offset:1024
ds_read_b32 v21, v4 offset:1280
ds_read_b32 v22, v4 offset:1536
v_lshrrev_b32 v5, 4, v3
v_lshlrev_b32 v5, 2, v5
s_mul_i32 s56, s48, 224
v_add_u32 v5, s56, v5
s_waitcnt lgkmcnt(0)
ds_read_b32 v24, v5 offset:0
ds_read_b32 v25, v5 offset:16
ds_read_b32 v26, v5 offset:32
ds_read_b32 v27, v5 offset:48
ds_read_b32 v28, v5 offset:64
ds_read_b32 v29, v5 offset:80
ds_read_b32 v30, v5 offset:96
ds_read_b32 v31, v5 offset:112
ds_read_b32 v32, v5 offset:128
ds_read_b32 v33, v5 offset:144
ds_read_b32 v34, v5 offset:160
ds_read_b32 v35, v5 offset:176
ds_read_b32 v36, v5 offset:192
ds_read_b32 v37, v5 offset:208
v_add_f32 v6, v16, v17
v_add_f32 v6, v6, v18
v_add_f32 v6, v6, v19
v_add_f32 v6, v6, v20
v_add_f32 v6, v6, v21
v_add_f32 v6, v6, v22
s_nop 1
v_add_f32_dpp v6, v6, v6 quad_perm:[1,0,3,2]
s_nop 1
v_add_f32_dpp v6, v6, v6 quad_perm:[2,3,0,1]
s_nop 1
v_add_f32_dpp v6, v6, v6 row_ror:4
s_nop 1
v_add_f32_dpp v6, v6, v6 row_ror:8
v_mov_b32 v7, v6
s_nop 1
v_permlane16_swap_b32 v6, v7
v_add_f32 v6, v6, v7
v_mov_b32 v7, v6
s_nop 1
v_permlane32_swap_b32 v6, v7
v_add_f32 v6, v6, v7
v_mul_f32 v8, 0x3b124925, v6
v_sub_f32 v10, v16, v8
v_sub_f32 v11, v17, v8
v_sub_f32 v12, v18, v8
v_sub_f32 v13, v19, v8
v_sub_f32 v14, v20, v8
v_sub_f32 v15, v21, v8
v_sub_f32 v16, v22, v8
v_mul_f32 v9, v10, v10
v_fmac_f32 v9, v11, v11
v_fmac_f32 v9, v12, v12
v_fmac_f32 v9, v13, v13
v_fmac_f32 v9, v14, v14
v_fmac_f32 v9, v15, v15
v_fmac_f32 v9, v16, v16
s_nop 1
v_add_f32_dpp v9, v9, v9 quad_perm:[1,0,3,2]
s_nop 1
v_add_f32_dpp v9, v9, v9 quad_perm:[2,3,0,1]
s_nop 1
v_add_f32_dpp v9, v9, v9 row_ror:4
s_nop 1
v_add_f32_dpp v9, v9, v9 row_ror:8
v_mov_b32 v7, v9
s_nop 1
v_permlane16_swap_b32 v9, v7
v_add_f32 v9, v9, v7
v_mov_b32 v7, v9
s_nop 1
v_permlane32_swap_b32 v9, v7
v_add_f32 v9, v9, v7
v_mul_f32 v9, 0x3b124925, v9
v_cvt_pk_bf16_f32 v9, v9, v9
v_cvt_pk_bf16_f32 v8, v8, v8
v_and_b32 v9, s62, v9
v_and_b32 v8, s62, v8
v_add_f32 v9, 0x3727c5ac, v9
v_cvt_pk_bf16_f32 v9, v9, v9
v_and_b32 v9, s62, v9
v_sqrt_f32 v9, v9
s_nop 0
v_cvt_pk_bf16_f32 v9, v9, v9
v_and_b32 v9, s62, v9
v_rcp_f32 v6, v9
s_waitcnt lgkmcnt(0)
v_sub_f32 v24, v24, v8
v_sub_f32 v25, v25, v8
v_sub_f32 v26, v26, v8
v_sub_f32 v27, v27, v8
v_sub_f32 v28, v28, v8
v_sub_f32 v29, v29, v8
v_sub_f32 v30, v30, v8
v_sub_f32 v31, v31, v8
v_sub_f32 v32, v32, v8
v_sub_f32 v33, v33, v8
v_sub_f32 v34, v34, v8
v_sub_f32 v35, v35, v8
v_sub_f32 v36, v36, v8
v_sub_f32 v37, v37, v8
v_cvt_pk_bf16_f32 v24, v24, v24
v_cvt_pk_bf16_f32 v25, v25, v25
v_cvt_pk_bf16_f32 v26, v26, v26
v_cvt_pk_bf16_f32 v27, v27, v27
v_cvt_pk_bf16_f32 v28, v28, v28
v_cvt_pk_bf16_f32 v29, v29, v29
v_cvt_pk_bf16_f32 v30, v30, v30
v_cvt_pk_bf16_f32 v31, v31, v31
v_cvt_pk_bf16_f32 v32, v32, v32
v_cvt_pk_bf16_f32 v33, v33, v33
v_cvt_pk_bf16_f32 v34, v34, v34
v_cvt_pk_bf16_f32 v35, v35, v35
v_cvt_pk_bf16_f32 v36, v36, v36
v_cvt_pk_bf16_f32 v37, v37, v37
v_and_b32 v24, s62, v24
v_and_b32 v25, s62, v25
v_and_b32 v26, s62, v26
v_and_b32 v27, s62, v27
v_and_b32 v28, s62, v28
v_and_b32 v29, s62, v29
v_and_b32 v30, s62, v30
v_and_b32 v31, s62, v31
v_and_b32 v32, s62, v32
v_and_b32 v33, s62, v33
v_and_b32 v34, s62, v34
v_and_b32 v35, s62, v35
v_and_b32 v36, s62, v36
v_and_b32 v37, s62, v37
v_mul_f32 v38, v24, v6
v_mul_f32 v39, v25, v6
v_mul_f32 v40, v26, v6
v_mul_f32 v41, v27, v6
v_mul_f32 v42, v28, v6
v_mul_f32 v43, v29, v6
v_mul_f32 v44, v30, v6
v_mul_f32 v45, v31, v6
v_mul_f32 v46, v32, v6
v_mul_f32 v47, v33, v6
v_mul_f32 v48, v34, v6
v_mul_f32 v49, v35, v6
v_mul_f32 v50, v36, v6
v_mul_f32 v51, v37, v6
v_fma_f32 v24, -v38, v9, v24
v_fma_f32 v25, -v39, v9, v25
v_fma_f32 v26, -v40, v9, v26
v_fma_f32 v27, -v41, v9, v27
v_fma_f32 v28, -v42, v9, v28
v_fma_f32 v29, -v43, v9, v29
v_fma_f32 v30, -v44, v9, v30
v_fma_f32 v31, -v45, v9, v31
v_fma_f32 v32, -v46, v9, v32
v_fma_f32 v33, -v47, v9, v33
v_fma_f32 v34, -v48, v9, v34
v_fma_f32 v35, -v49, v9, v35
v_fma_f32 v36, -v50, v9, v36
v_fma_f32 v37, -v51, v9, v37
v_fma_f32 v24, v24, v6, v38
v_fma_f32 v25, v25, v6, v39
v_fma_f32 v26, v26, v6, v40
v_fma_f32 v27, v27, v6, v41
v_fma_f32 v28, v28, v6, v42
v_fma_f32 v29, v29, v6, v43
v_fma_f32 v30, v30, v6, v44
v_fma_f32 v31, v31, v6, v45
v_fma_f32 v32, v32, v6, v46
v_fma_f32 v33, v33, v6, v47
v_fma_f32 v34, v34, v6, v48
v_fma_f32 v35, v35, v6, v49
v_fma_f32 v36, v36, v6, v50
v_fma_f32 v37, v37, v6, v51
v_cvt_pk_bf16_f32 v24, v24, v24
v_cvt_pk_bf16_f32 v25, v25, v25
v_cvt_pk_bf16_f32 v26, v26, v26
v_cvt_pk_bf16_f32 v27, v27, v27
v_cvt_pk_bf16_f32 v28, v28, v28
v_cvt_pk_bf16_f32 v29, v29, v29
v_cvt_pk_bf16_f32 v30, v30, v30
v_cvt_pk_bf16_f32 v31, v31, v31
v_cvt_pk_bf16_f32 v32, v32, v32
v_cvt_pk_bf16_f32 v33, v33, v33
v_cvt_pk_bf16_f32 v34, v34, v34
v_cvt_pk_bf16_f32 v35, v35, v35
v_cvt_pk_bf16_f32 v36, v36, v36
v_cvt_pk_bf16_f32 v37, v37, v37
v_and_b32 v24, s62, v24
v_and_b32 v25, s62, v25
v_and_b32 v26, s62, v26
v_and_b32 v27, s62, v27
v_and_b32 v28, s62, v28
v_and_b32 v29, s62, v29
v_and_b32 v30, s62, v30
v_and_b32 v31, s62, v31
v_and_b32 v32, s62, v32
v_and_b32 v33, s62, v33
v_and_b32 v34, s62, v34
v_and_b32 v35, s62, v35
v_and_b32 v36, s62, v36
v_and_b32 v37, s62, v37
v_cvt_pk_bf16_f32 v24, v24, v25
v_cvt_pk_bf16_f32 v26, v26, v27
v_cvt_pk_bf16_f32 v28, v28, v29
v_cvt_pk_bf16_f32 v30, v30, v31
v_cvt_pk_bf16_f32 v32, v32, v33
v_cvt_pk_bf16_f32 v34, v34, v35
v_cvt_pk_bf16_f32 v36, v36, v37
v_dot2_f32_bf16 v4, v184, v24, 0
v_dot2_f32_bf16 v5, v188, v24, 0
v_dot2_f32_bf16 v6, v185, v24, 0
v_dot2_f32_bf16 v7, v189, v24, 0
v_dot2_f32_bf16 v8, v186, v24, 0
v_dot2_f32_bf16 v9, v190, v24, 0
v_dot2_f32_bf16 v10, v187, v24, 0
v_dot2_f32_bf16 v11, v191, v24, 0
v_dot2_f32_bf16 v4, v192, v26, v4
v_dot2_f32_bf16 v5, v196, v26, v5
v_dot2_f32_bf16 v6, v193, v26, v6
v_dot2_f32_bf16 v7, v197, v26, v7
v_dot2_f32_bf16 v8, v194, v26, v8
v_dot2_f32_bf16 v9, v198, v26, v9
v_dot2_f32_bf16 v10, v195, v26, v10
v_dot2_f32_bf16 v11, v199, v26, v11
v_dot2_f32_bf16 v4, v200, v28, v4
v_dot2_f32_bf16 v5, v204, v28, v5
v_dot2_f32_bf16 v6, v201, v28, v6
v_dot2_f32_bf16 v7, v205, v28, v7
v_dot2_f32_bf16 v8, v202, v28, v8
v_dot2_f32_bf16 v9, v206, v28, v9
v_dot2_f32_bf16 v10, v203, v28, v10
v_dot2_f32_bf16 v11, v207, v28, v11
v_dot2_f32_bf16 v4, v208, v30, v4
v_dot2_f32_bf16 v5, v212, v30, v5
v_dot2_f32_bf16 v6, v209, v30, v6
v_dot2_f32_bf16 v7, v213, v30, v7
v_dot2_f32_bf16 v8, v210, v30, v8
v_dot2_f32_bf16 v9, v214, v30, v9
v_dot2_f32_bf16 v10, v211, v30, v10
v_dot2_f32_bf16 v11, v215, v30, v11
v_dot2_f32_bf16 v4, v216, v32, v4
v_dot2_f32_bf16 v5, v220, v32, v5
v_dot2_f32_bf16 v6, v217, v32, v6
v_dot2_f32_bf16 v7, v221, v32, v7
v_dot2_f32_bf16 v8, v218, v32, v8
v_dot2_f32_bf16 v9, v222, v32, v9
v_dot2_f32_bf16 v10, v219, v32, v10
v_dot2_f32_bf16 v11, v223, v32, v11
v_dot2_f32_bf16 v4, v224, v34, v4
v_dot2_f32_bf16 v5, v228, v34, v5
v_dot2_f32_bf16 v6, v225, v34, v6
v_dot2_f32_bf16 v7, v229, v34, v7
v_dot2_f32_bf16 v8, v226, v34, v8
v_dot2_f32_bf16 v9, v230, v34, v9
v_dot2_f32_bf16 v10, v227, v34, v10
v_dot2_f32_bf16 v11, v231, v34, v11
v_dot2_f32_bf16 v4, v232, v36, v4
v_dot2_f32_bf16 v5, v236, v36, v5
v_dot2_f32_bf16 v6, v233, v36, v6
v_dot2_f32_bf16 v7, v237, v36, v7
v_dot2_f32_bf16 v8, v234, v36, v8
v_dot2_f32_bf16 v9, v238, v36, v9
v_dot2_f32_bf16 v10, v235, v36, v10
v_dot2_f32_bf16 v11, v239, v36, v11
v_permlane32_swap_b32 v4, v8
v_permlane32_swap_b32 v5, v9
v_permlane32_swap_b32 v6, v10
v_permlane32_swap_b32 v7, v11
v_add_f32 v4, v4, v8
v_add_f32 v5, v5, v9
v_add_f32 v6, v6, v10
v_add_f32 v7, v7, v11
s_nop 0
v_permlane16_swap_b32 v4, v6
v_permlane16_swap_b32 v5, v7
v_add_f32 v4, v4, v6
v_add_f32 v5, v5, v7
v_lshlrev_b32 v14, 3, v3
s_lshl_b32 s56, s48, 9
v_add_u32 v15, s56, v14
ds_write_b64 v15, v[4:5] offset:4096
s_waitcnt lgkmcnt(0)
s_barrier
ds_read_b64 v[16:17], v14 offset:4096
ds_read_b64 v[18:19], v14 offset:4608
ds_read_b64 v[20:21], v14 offset:5120
ds_read_b64 v[22:23], v14 offset:5632
ds_read_b64 v[38:39], v14 offset:6144
ds_read_b64 v[40:41], v14 offset:6656
ds_read_b64 v[42:43], v14 offset:7168
ds_read_b64 v[44:45], v14 offset:7680
s_waitcnt lgkmcnt(0)
v_add_f32 v4, v16, v18
v_add_f32 v5, v17, v19
v_add_f32 v4, v4, v20
v_add_f32 v5, v5, v21
v_add_f32 v4, v4, v22
v_add_f32 v5, v5, v23
v_add_f32 v4, v4, v38
v_add_f32 v5, v5, v39
v_add_f32 v4, v4, v40
v_add_f32 v5, v5, v41
v_add_f32 v4, v4, v42
v_add_f32 v5, v5, v43
v_add_f32 v4, v4, v44
v_add_f32 v5, v5, v45
v_cvt_pk_bf16_f32 v4, v4, v4
v_cvt_pk_bf16_f32 v5, v5, v5
v_and_b32 v4, s62, v4
v_and_b32 v5, s62, v5
s_cmp_lg_u32 s48, 0
s_cbranch_scc1 L_q1pub_617
v_or_b32 v4, 1, v4
v_or_b32 v5, 1, v5
v_and_b32 v22, 15, v3
v_lshlrev_b32 v22, 3, v22
v_lshrrev_b32 v23, 4, v3
v_lshl_add_u32 v22, v23, 1, v22
v_lshlrev_b32 v22, 2, v22
s_lshl_b32 s56, s2, 9
s_add_u32 s56, s56, 0x410000
buffer_store_dwordx2 v[4:5], v22, s[44:47], s56 offen sc1
L_q1pub_617:
s_nop 4
v_lshrrev_b32 v10, 2, v3
v_min_u32 v10, 13, v10
v_mul_u32_u24 v11, 1088, v10
v_and_b32 v10, 3, v3
v_lshl_add_u32 v10, v10, 4, v11
s_mul_i32 s56, s49, 15232
s_add_u32 s56, s56, 0x13b800
s_lshl_b32 s57, s50, 9
s_lshl_b32 s58, s48, 6
s_add_u32 s57, s57, s58
s_add_u32 s57, s57, s56
s_mov_b32 s60, 0
L_p_pa_619:
s_nop 4
buffer_load_dwordx4 v[4:7], v10, s[44:47], s57 offen sc1
buffer_load_dwordx2 v[8:9], v11, s[44:47], s56 offen offset:1024 sc1
s_waitcnt vmcnt(0)
v_and_b32 v12, v4, v5
v_and_b32 v12, v12, v6
v_and_b32 v12, v12, v7
v_and_b32 v12, v12, v8
v_and_b32 v12, v12, v9
v_and_b32 v12, 1, v12
v_cmp_ne_u32 vcc, 1, v12
s_cbranch_vccz L_d_pa_620
s_sleep 1
s_add_u32 s60, s60, 1
s_cmp_lt_u32 s60, 400000
s_cbranch_scc1 L_p_pa_619
s_endpgm
L_d_pa_620:
s_nop 4
v_mov_b32 v15, v8
s_nop 1
v_max_f32_dpp v15, v15, v15 row_ror:4
s_nop 1
v_max_f32_dpp v15, v15, v15 row_ror:8
v_mov_b32 v13, v15
s_nop 1
v_permlane16_swap_b32 v15, v13
v_max_f32 v15, v15, v13
v_mov_b32 v13, v15
s_nop 1
v_permlane32_swap_b32 v15, v13
v_max_f32 v15, v15, v13
v_sub_f32 v8, v8, v15
v_mul_f32 v8, 0x3fb8aa3b, v8
v_exp_f32 v8, v8
v_cmp_gt_u32 vcc, 56, v3
s_nop 1
v_cndmask_b32 v8, 0, v8, vcc
v_mul_f32 v4, v8, v4
v_mul_f32 v5, v8, v5
v_mul_f32 v6, v8, v6
v_mul_f32 v7, v8, v7
v_mul_f32 v9, v8, v9
v_add_f32_dpp v4, v4, v4 row_ror:4
v_add_f32_dpp v5, v5, v5 row_ror:4
v_add_f32_dpp v6, v6, v6 row_ror:4
v_add_f32_dpp v7, v7, v7 row_ror:4
v_add_f32_dpp v9, v9, v9 row_ror:4
v_add_f32_dpp v4, v4, v4 row_ror:8
v_add_f32_dpp v5, v5, v5 row_ror:8
v_add_f32_dpp v6, v6, v6 row_ror:8
v_add_f32_dpp v7, v7, v7 row_ror:8
v_add_f32_dpp v9, v9, v9 row_ror:8
v_mov_b32 v16, v4
v_mov_b32 v17, v5
v_mov_b32 v18, v6
v_mov_b32 v19, v7
v_mov_b32 v20, v9
v_permlane16_swap_b32 v4, v16
v_permlane16_swap_b32 v5, v17
v_permlane16_swap_b32 v6, v18
v_permlane16_swap_b32 v7, v19
v_permlane16_swap_b32 v9, v20
v_add_f32 v4, v4, v16
v_add_f32 v5, v5, v17
v_add_f32 v6, v6, v18
v_add_f32 v7, v7, v19
v_add_f32 v9, v9, v20
v_mov_b32 v16, v4
v_mov_b32 v17, v5
v_mov_b32 v18, v6
v_mov_b32 v19, v7
v_mov_b32 v20, v9
v_permlane32_swap_b32 v4, v16
v_permlane32_swap_b32 v5, v17
v_permlane32_swap_b32 v6, v18
v_permlane32_swap_b32 v7, v19
v_permlane32_swap_b32 v9, v20
v_add_f32 v4, v4, v16
v_add_f32 v5, v5, v17
v_add_f32 v6, v6, v18
v_add_f32 v7, v7, v19
v_add_f32 v9, v9, v20
v_rcp_f32 v13, v9
s_nop 0
v_mul_f32 v16, v4, v13
v_mul_f32 v17, v5, v13
v_mul_f32 v18, v6, v13
v_mul_f32 v19, v7, v13
v_fma_f32 v4, -v16, v9, v4
v_fma_f32 v5, -v17, v9, v5
v_fma_f32 v6, -v18, v9, v6
v_fma_f32 v7, -v19, v9, v7
v_fma_f32 v4, v4, v13, v16
v_fma_f32 v5, v5, v13, v17
v_fma_f32 v6, v6, v13, v18
v_fma_f32 v7, v7, v13, v19
v_cvt_pk_bf16_f32 v4, v4, v5
v_cvt_pk_bf16_f32 v6, v6, v7
v_readlane_b32 s64, v4, 0
v_readlane_b32 s65, v6, 0
v_readlane_b32 s66, v4, 1
v_readlane_b32 s67, v6, 1
v_readlane_b32 s68, v4, 2
v_readlane_b32 s69, v6, 2
v_readlane_b32 s70, v4, 3
v_readlane_b32 s71, v6, 3
v_dot2_f32_bf16 v24, v56, s64, 0
v_dot2_f32_bf16 v25, v60, s64, 0
v_dot2_f32_bf16 v26, v57, s64, 0
v_dot2_f32_bf16 v27, v61, s64, 0
v_dot2_f32_bf16 v28, v58, s64, 0
v_dot2_f32_bf16 v29, v62, s64, 0
v_dot2_f32_bf16 v30, v59, s64, 0
v_dot2_f32_bf16 v31, v63, s64, 0
v_dot2_f32_bf16 v24, v64, s65, v24
v_dot2_f32_bf16 v25, v68, s65, v25
v_dot2_f32_bf16 v26, v65, s65, v26
v_dot2_f32_bf16 v27, v69, s65, v27
v_dot2_f32_bf16 v28, v66, s65, v28
v_dot2_f32_bf16 v29, v70, s65, v29
v_dot2_f32_bf16 v30, v67, s65, v30
v_dot2_f32_bf16 v31, v71, s65, v31
v_dot2_f32_bf16 v24, v72, s66, v24
v_dot2_f32_bf16 v25, v76, s66, v25
v_dot2_f32_bf16 v26, v73, s66, v26
v_dot2_f32_bf16 v27, v77, s66, v27
v_dot2_f32_bf16 v28, v74, s66, v28
v_dot2_f32_bf16 v29, v78, s66, v29
v_dot2_f32_bf16 v30, v75, s66, v30
v_dot2_f32_bf16 v31, v79, s66, v31
v_dot2_f32_bf16 v24, v80, s67, v24
v_dot2_f32_bf16 v25, v84, s67, v25
v_dot2_f32_bf16 v26, v81, s67, v26
v_dot2_f32_bf16 v27, v85, s67, v27
v_dot2_f32_bf16 v28, v82, s67, v28
v_dot2_f32_bf16 v29, v86, s67, v29
v_dot2_f32_bf16 v30, v83, s67, v30
v_dot2_f32_bf16 v31, v87, s67, v31
v_dot2_f32_bf16 v24, v88, s68, v24
v_dot2_f32_bf16 v25, v92, s68, v25
v_dot2_f32_bf16 v26, v89, s68, v26
v_dot2_f32_bf16 v27, v93, s68, v27
v_dot2_f32_bf16 v28, v90, s68, v28
v_dot2_f32_bf16 v29, v94, s68, v29
v_dot2_f32_bf16 v30, v91, s68, v30
v_dot2_f32_bf16 v31, v95, s68, v31
v_dot2_f32_bf16 v24, v96, s69, v24
v_dot2_f32_bf16 v25, v100, s69, v25
v_dot2_f32_bf16 v26, v97, s69, v26
v_dot2_f32_bf16 v27, v101, s69, v27
v_dot2_f32_bf16 v28, v98, s69, v28
v_dot2_f32_bf16 v29, v102, s69, v29
v_dot2_f32_bf16 v30, v99, s69, v30
v_dot2_f32_bf16 v31, v103, s69, v31
v_dot2_f32_bf16 v24, v104, s70, v24
v_dot2_f32_bf16 v25, v108, s70, v25
v_dot2_f32_bf16 v26, v105, s70, v26
v_dot2_f32_bf16 v27, v109, s70, v27
v_dot2_f32_bf16 v28, v106, s70, v28
v_dot2_f32_bf16 v29, v110, s70, v29
v_dot2_f32_bf16 v30, v107, s70, v30
v_dot2_f32_bf16 v31, v111, s70, v31
v_dot2_f32_bf16 v24, v112, s71, v24
v_dot2_f32_bf16 v25, v116, s71, v25
v_dot2_f32_bf16 v26, v113, s71, v26
v_dot2_f32_bf16 v27, v117, s71, v27
v_dot2_f32_bf16 v28, v114, s71, v28
v_dot2_f32_bf16 v29, v118, s71, v29
v_dot2_f32_bf16 v30, v115, s71, v30
v_dot2_f32_bf16 v31, v119, s71, v31
v_lshlrev_b32 v32, 5, v3
s_mul_i32 s56, s48, 1792
s_add_u32 s56, s56, 8192
v_add_u32 v32, s56, v32
s_mov_b32 exec_hi, 0x00ffffff
ds_write_b128 v32, v[24:27]
ds_write_b128 v32, v[28:31] offset:16
s_mov_b32 exec_hi, -1
s_waitcnt lgkmcnt(0)
s_barrier
s_mul_i32 s56, s48, 224
v_lshlrev_b32 v33, 2, v3
v_add_u32 v33, s56, v33
v_add_u32 v32, 8192, v33
ds_read_b32 v34, v32 offset:0
ds_read_b32 v35, v32 offset:1792
ds_read_b32 v36, v32 offset:3584
ds_read_b32 v37, v32 offset:5376
ds_read_b32 v38, v32 offset:7168
ds_read_b32 v39, v32 offset:8960
ds_read_b32 v40, v32 offset:10752
ds_read_b32 v41, v32 offset:12544
s_waitcnt lgkmcnt(0)
v_add_f32 v34, v34, v35
v_add_f32 v34, v34, v36
v_add_f32 v34, v34, v37
v_add_f32 v34, v34, v38
v_add_f32 v34, v34, v39
v_add_f32 v34, v34, v40
v_add_f32 v34, v34, v41
v_or_b32 v34, 1, v34
s_mul_i32 s56, s2, 1792
s_add_u32 s56, s56, 0x30e000
s_mov_b32 exec_hi, 0x00ffffff
buffer_store_dword v34, v33, s[44:47], s56 offen sc1
s_mov_b32 exec_hi, -1
s_cmp_eq_u32 s48, 7
s_cbranch_scc1 L_gx_634
v_lshrrev_b32 v36, 4, v3
v_mul_u32_u24 v36, 1792, v36
v_and_b32 v37, 15, v3
v_lshl_add_u32 v36, v37, 4, v36
s_lshl_b32 s56, s48, 8
s_add_u32 s56, s56, 0x30e000
s_mov_b32 s60, 0
L_p_gx_635:
s_nop 4
s_add_u32 s57, s56, 0
buffer_load_dwordx4 v[4:7], v36, s[44:47], s57 offen sc1
s_add_u32 s57, s56, 7168
buffer_load_dwordx4 v[8:11], v36, s[44:47], s57 offen sc1
s_add_u32 s57, s56, 14336
buffer_load_dwordx4 v[12:15], v36, s[44:47], s57 offen sc1
s_add_u32 s57, s56, 21504
buffer_load_dwordx4 v[16:19], v36, s[44:47], s57 offen sc1
s_add_u32 s57, s56, 28672
buffer_load_dwordx4 v[20:23], v36, s[44:47], s57 offen sc1
s_add_u32 s57, s56, 35840
buffer_load_dwordx4 v[24:27], v36, s[44:47], s57 offen sc1
s_add_u32 s57, s56, 43008
buffer_load_dwordx4 v[28:31], v36, s[44:47], s57 offen sc1
s_add_u32 s57, s56, 50176
buffer_load_dwordx4 v[32:35], v36, s[44:47], s57 offen sc1
s_waitcnt vmcnt(0)
v_and_b32 v37, v4, v5
v_and_b32 v37, v37, v6
v_and_b32 v37, v37, v7
v_and_b32 v37, v37, v8
v_and_b32 v37, v37, v9
v_and_b32 v37, v37, v10
v_and_b32 v37, v37, v11
v_and_b32 v37, v37, v12
v_and_b32 v37, v37, v13
v_and_b32 v37, v37, v14
v_and_b32 v37, v37, v15
v_and_b32 v37, v37, v16
v_and_b32 v37, v37, v17
v_and_b32 v37, v37, v18
v_and_b32 v37, v37, v19
v_and_b32 v37, v37, v20
v_and_b32 v37, v37, v21
v_and_b32 v37, v37, v22
v_and_b32 v37, v37, v23
v_and_b32 v37, v37, v24
v_and_b32 v37, v37, v25
v_and_b32 v37, v37, v26
v_and_b32 v37, v37, v27
v_and_b32 v37, v37, v28
v_and_b32 v37, v37, v29
v_and_b32 v37, v37, v30
v_and_b32 v37, v37, v31
v_and_b32 v37, v37, v32
v_and_b32 v37, v37, v33
v_and_b32 v37, v37, v34
v_and_b32 v37, v37, v35
v_and_b32 v37, 1, v37
v_cmp_ne_u32 vcc, 1, v37
s_cbranch_vccz L_d_gx_636
s_sleep 1
s_add_u32 s60, s60, 1
s_cmp_lt_u32 s60, 400000
s_cbranch_scc1 L_p_gx_635
s_endpgm
L_d_gx_636:
s_nop 4
v_add_f32 v4, v4, v8
v_add_f32 v5, v5, v9
v_add_f32 v6, v6, v10
v_add_f32 v7, v7, v11
v_add_f32 v4, v4, v12
v_add_f32 v5, v5, v13
v_add_f32 v6, v6, v14
v_add_f32 v7, v7, v15
v_add_f32 v4, v4, v16
v_add_f32 v5, v5, v17
v_add_f32 v6, v6, v18
v_add_f32 v7, v7, v19
v_add_f32 v4, v4, v20
v_add_f32 v5, v5, v21
v_add_f32 v6, v6, v22
v_add_f32 v7, v7, v23
v_add_f32 v4, v4, v24
v_add_f32 v5, v5, v25
v_add_f32 v6, v6, v26
v_add_f32 v7, v7, v27
v_add_f32 v4, v4, v28
v_add_f32 v5, v5, v29
v_add_f32 v6, v6, v30
v_add_f32 v7, v7, v31
v_add_f32 v4, v4, v32
v_add_f32 v5, v5, v33
v_add_f32 v6, v6, v34
v_add_f32 v7, v7, v35
v_mov_b32 v38, v4
v_mov_b32 v39, v5
v_mov_b32 v40, v6
v_mov_b32 v41, v7
v_permlane16_swap_b32 v4, v38
v_permlane16_swap_b32 v5, v39
v_permlane16_swap_b32 v6, v40
v_permlane16_swap_b32 v7, v41
v_add_f32 v4, v4, v38
v_add_f32 v5, v5, v39
v_add_f32 v6, v6, v40
v_add_f32 v7, v7, v41
v_mov_b32 v38, v4
v_mov_b32 v39, v5
v_mov_b32 v40, v6
v_mov_b32 v41, v7
v_permlane32_swap_b32 v4, v38
v_permlane32_swap_b32 v5, v39
v_permlane32_swap_b32 v6, v40
v_permlane32_swap_b32 v7, v41
v_add_f32 v4, v4, v38
v_add_f32 v5, v5, v39
v_add_f32 v6, v6, v40
v_add_f32 v7, v7, v41
v_cvt_pk_bf16_f32 v4, v4, v4
v_cvt_pk_bf16_f32 v5, v5, v5
v_cvt_pk_bf16_f32 v6, v6, v6
v_cvt_pk_bf16_f32 v7, v7, v7
v_and_b32 v4, s62, v4
v_and_b32 v5, s62, v5
v_and_b32 v6, s62, v6
v_and_b32 v7, s62, v7
v_add_f32 v244, v244, v4
v_add_f32 v245, v245, v5
v_add_f32 v246, v246, v6
v_add_f32 v247, v247, v7
v_cvt_pk_bf16_f32 v244, v244, v244
v_cvt_pk_bf16_f32 v245, v245, v245
v_cvt_pk_bf16_f32 v246, v246, v246
v_cvt_pk_bf16_f32 v247, v247, v247
v_and_b32 v244, s62, v244
v_and_b32 v245, s62, v245
v_and_b32 v246, s62, v246
v_and_b32 v247, s62, v247
v_and_b32 v36, 15, v3
v_lshlrev_b32 v36, 4, v36
s_lshl_b32 s56, s48, 8
s_add_u32 s56, s56, 2048
v_add_u32 v36, s56, v36
v_mov_b32 v4, v244
v_mov_b32 v5, v245
v_mov_b32 v6, v246
v_mov_b32 v7, v247
ds_write_b128 v36, v[4:7]
s_waitcnt lgkmcnt(0)
L_gx_634:
s_nop 4
s_barrier
v_lshlrev_b32 v4, 2, v3
ds_read_b32 v16, v4 offset:2048
ds_read_b32 v17, v4 offset:2304
ds_read_b32 v18, v4 offset:2560
ds_read_b32 v19, v4 offset:2816
ds_read_b32 v20, v4 offset:3072
ds_read_b32 v21, v4 offset:3328
ds_read_b32 v22, v4 offset:3584
v_lshrrev_b32 v5, 3, v3
v_lshlrev_b32 v5, 2, v5
s_mul_i32 s56, s48, 224
v_add_u32 v5, s56, v5
s_waitcnt lgkmcnt(0)
ds_read_b32 v24, v5 offset:2048
ds_read_b32 v25, v5 offset:2080
ds_read_b32 v26, v5 offset:2112
ds_read_b32 v27, v5 offset:2144
ds_read_b32 v28, v5 offset:2176
ds_read_b32 v29, v5 offset:2208
ds_read_b32 v30, v5 offset:2240
v_add_f32 v6, v16, v17
v_add_f32 v6, v6, v18
v_add_f32 v6, v6, v19
v_add_f32 v6, v6, v20
v_add_f32 v6, v6, v21
v_add_f32 v6, v6, v22
s_nop 1
v_add_f32_dpp v6, v6, v6 quad_perm:[1,0,3,2]
s_nop 1
v_add_f32_dpp v6, v6, v6 quad_perm:[2,3,0,1]
s_nop 1
v_add_f32_dpp v6, v6, v6 row_ror:4
s_nop 1
v_add_f32_dpp v6, v6, v6 row_ror:8
v_mov_b32 v7, v6
s_nop 1
v_permlane16_swap_b32 v6, v7
v_add_f32 v6, v6, v7
v_mov_b32 v7, v6
s_nop 1
v_permlane32_swap_b32 v6, v7
v_add_f32 v6, v6, v7
v_mul_f32 v8, 0x3b124925, v6
v_sub_f32 v10, v16, v8
v_sub_f32 v11, v17, v8
v_sub_f32 v12, v18, v8
v_sub_f32 v13, v19, v8
v_sub_f32 v14, v20, v8
v_sub_f32 v15, v21, v8
v_sub_f32 v16, v22, v8
v_mul_f32 v9, v10, v10
v_fmac_f32 v9, v11, v11
v_fmac_f32 v9, v12, v12
v_fmac_f32 v9, v13, v13
v_fmac_f32 v9, v14, v14
v_fmac_f32 v9, v15, v15
v_fmac_f32 v9, v16, v16
s_nop 1
v_add_f32_dpp v9, v9, v9 quad_perm:[1,0,3,2]
s_nop 1
v_add_f32_dpp v9, v9, v9 quad_perm:[2,3,0,1]
s_nop 1
v_add_f32_dpp v9, v9, v9 row_ror:4
s_nop 1
v_add_f32_dpp v9, v9, v9 row_ror:8
v_mov_b32 v7, v9
s_nop 1
v_permlane16_swap_b32 v9, v7
v_add_f32 v9, v9, v7
v_mov_b32 v7, v9
s_nop 1
v_permlane32_swap_b32 v9, v7
v_add_f32 v9, v9, v7
v_mul_f32 v9, 0x3b124925, v9
v_cvt_pk_bf16_f32 v9, v9, v9
v_cvt_pk_bf16_f32 v8, v8, v8
v_and_b32 v9, s62, v9
v_and_b32 v8, s62, v8
v_add_f32 v9, 0x3727c5ac, v9
v_cvt_pk_bf16_f32 v9, v9, v9
v_and_b32 v9, s62, v9
v_sqrt_f32 v9, v9
s_nop 0
v_cvt_pk_bf16_f32 v9, v9, v9
v_and_b32 v9, s62, v9
v_rcp_f32 v6, v9
s_waitcnt lgkmcnt(0)
v_sub_f32 v24, v24, v8
v_sub_f32 v25, v25, v8
v_sub_f32 v26, v26, v8
v_sub_f32 v27, v27, v8
v_sub_f32 v28, v28, v8
v_sub_f32 v29, v29, v8
v_sub_f32 v30, v30, v8
v_cvt_pk_bf16_f32 v24, v24, v24
v_cvt_pk_bf16_f32 v25, v25, v25
v_cvt_pk_bf16_f32 v26, v26, v26
v_cvt_pk_bf16_f32 v27, v27, v27
v_cvt_pk_bf16_f32 v28, v28, v28
v_cvt_pk_bf16_f32 v29, v29, v29
v_cvt_pk_bf16_f32 v30, v30, v30
v_and_b32 v24, s62, v24
v_and_b32 v25, s62, v25
v_and_b32 v26, s62, v26
v_and_b32 v27, s62, v27
v_and_b32 v28, s62, v28
v_and_b32 v29, s62, v29
v_and_b32 v30, s62, v30
v_mul_f32 v38, v24, v6
v_mul_f32 v39, v25, v6
v_mul_f32 v40, v26, v6
v_mul_f32 v41, v27, v6
v_mul_f32 v42, v28, v6
v_mul_f32 v43, v29, v6
v_mul_f32 v44, v30, v6
v_fma_f32 v24, -v38, v9, v24
v_fma_f32 v25, -v39, v9, v25
v_fma_f32 v26, -v40, v9, v26
v_fma_f32 v27, -v41, v9, v27
v_fma_f32 v28, -v42, v9, v28
v_fma_f32 v29, -v43, v9, v29
v_fma_f32 v30, -v44, v9, v30
v_fma_f32 v24, v24, v6, v38
v_fma_f32 v25, v25, v6, v39
v_fma_f32 v26, v26, v6, v40
v_fma_f32 v27, v27, v6, v41
v_fma_f32 v28, v28, v6, v42
v_fma_f32 v29, v29, v6, v43
v_fma_f32 v30, v30, v6, v44
v_cvt_pk_bf16_f32 v24, v24, v24
v_cvt_pk_bf16_f32 v25, v25, v25
v_cvt_pk_bf16_f32 v26, v26, v26
v_cvt_pk_bf16_f32 v27, v27, v27
v_cvt_pk_bf16_f32 v28, v28, v28
v_cvt_pk_bf16_f32 v29, v29, v29
v_cvt_pk_bf16_f32 v30, v30, v30
v_and_b32 v24, s62, v24
v_and_b32 v25, s62, v25
v_and_b32 v26, s62, v26
v_and_b32 v27, s62, v27
v_and_b32 v28, s62, v28
v_and_b32 v29, s62, v29
v_and_b32 v30, s62, v30
ds_read_b128 v[32:35], v2 offset:22528
ds_read_b128 v[36:39], v2 offset:23552
ds_read_b128 v[40:43], v2 offset:24576
ds_read_b128 v[44:47], v2 offset:25600
v_cvt_pk_bf16_f32 v24, v24, v25
v_cvt_pk_bf16_f32 v26, v26, v27
v_cvt_pk_bf16_f32 v28, v28, v29
v_cvt_pk_bf16_f32 v30, v30, 0
v_dot2_f32_bf16 v4, v120, v24, 0
v_dot2_f32_bf16 v5, v124, v24, 0
v_dot2_f32_bf16 v6, v121, v24, 0
v_dot2_f32_bf16 v7, v125, v24, 0
v_dot2_f32_bf16 v8, v122, v24, 0
v_dot2_f32_bf16 v9, v126, v24, 0
v_dot2_f32_bf16 v10, v123, v24, 0
v_dot2_f32_bf16 v11, v127, v24, 0
v_dot2_f32_bf16 v12, v152, v24, 0
v_dot2_f32_bf16 v13, v156, v24, 0
v_dot2_f32_bf16 v14, v153, v24, 0
v_dot2_f32_bf16 v15, v157, v24, 0
v_dot2_f32_bf16 v16, v154, v24, 0
v_dot2_f32_bf16 v17, v158, v24, 0
v_dot2_f32_bf16 v18, v155, v24, 0
v_dot2_f32_bf16 v19, v159, v24, 0
v_dot2_f32_bf16 v4, v128, v26, v4
v_dot2_f32_bf16 v5, v132, v26, v5
v_dot2_f32_bf16 v6, v129, v26, v6
v_dot2_f32_bf16 v7, v133, v26, v7
v_dot2_f32_bf16 v8, v130, v26, v8
v_dot2_f32_bf16 v9, v134, v26, v9
v_dot2_f32_bf16 v10, v131, v26, v10
v_dot2_f32_bf16 v11, v135, v26, v11
v_dot2_f32_bf16 v12, v160, v26, v12
v_dot2_f32_bf16 v13, v164, v26, v13
v_dot2_f32_bf16 v14, v161, v26, v14
v_dot2_f32_bf16 v15, v165, v26, v15
v_dot2_f32_bf16 v16, v162, v26, v16
v_dot2_f32_bf16 v17, v166, v26, v17
v_dot2_f32_bf16 v18, v163, v26, v18
v_dot2_f32_bf16 v19, v167, v26, v19
v_dot2_f32_bf16 v4, v136, v28, v4
v_dot2_f32_bf16 v5, v140, v28, v5
v_dot2_f32_bf16 v6, v137, v28, v6
v_dot2_f32_bf16 v7, v141, v28, v7
v_dot2_f32_bf16 v8, v138, v28, v8
v_dot2_f32_bf16 v9, v142, v28, v9
v_dot2_f32_bf16 v10, v139, v28, v10
v_dot2_f32_bf16 v11, v143, v28, v11
v_dot2_f32_bf16 v12, v168, v28, v12
v_dot2_f32_bf16 v13, v172, v28, v13
v_dot2_f32_bf16 v14, v169, v28, v14
v_dot2_f32_bf16 v15, v173, v28, v15
v_dot2_f32_bf16 v16, v170, v28, v16
v_dot2_f32_bf16 v17, v174, v28, v17
v_dot2_f32_bf16 v18, v171, v28, v18
v_dot2_f32_bf16 v19, v175, v28, v19
v_dot2_f32_bf16 v4, v144, v30, v4
v_dot2_f32_bf16 v5, v148, v30, v5
v_dot2_f32_bf16 v6, v145, v30, v6
v_dot2_f32_bf16 v7, v149, v30, v7
v_dot2_f32_bf16 v8, v146, v30, v8
v_dot2_f32_bf16 v9, v150, v30, v9
v_dot2_f32_bf16 v10, v147, v30, v10
v_dot2_f32_bf16 v11, v151, v30, v11
v_dot2_f32_bf16 v12, v176, v30, v12
v_dot2_f32_bf16 v13, v180, v30, v13
v_dot2_f32_bf16 v14, v177, v30, v14
v_dot2_f32_bf16 v15, v181, v30, v15
v_dot2_f32_bf16 v16, v178, v30, v16
v_dot2_f32_bf16 v17, v182, v30, v17
v_dot2_f32_bf16 v18, v179, v30, v18
v_dot2_f32_bf16 v19, v183, v30, v19
v_permlane32_swap_b32 v4, v12
v_permlane32_swap_b32 v5, v13
v_permlane32_swap_b32 v6, v14
v_permlane32_swap_b32 v7, v15
v_permlane32_swap_b32 v8, v16
v_permlane32_swap_b32 v9, v17
v_permlane32_swap_b32 v10, v18
v_permlane32_swap_b32 v11, v19
v_add_f32 v4, v4, v12
v_add_f32 v5, v5, v13
v_add_f32 v6, v6, v14
v_add_f32 v7, v7, v15
v_add_f32 v8, v8, v16
v_add_f32 v9, v9, v17
v_add_f32 v10, v10, v18
v_add_f32 v11, v11, v19
v_permlane16_swap_b32 v4, v8
v_permlane16_swap_b32 v5, v9
v_permlane16_swap_b32 v6, v10
v_permlane16_swap_b32 v7, v11
v_add_f32 v4, v4, v8
v_add_f32 v5, v5, v9
v_add_f32 v6, v6, v10
v_add_f32 v7, v7, v11
v_add_f32_dpp v4, v4, v4 row_ror:8 row_mask:0xf bank_mask:0x3
v_add_f32_dpp v4, v6, v6 row_ror:8 row_mask:0xf bank_mask:0xc
v_add_f32_dpp v5, v5, v5 row_ror:8 row_mask:0xf bank_mask:0x3
v_add_f32_dpp v5, v7, v7 row_ror:8 row_mask:0xf bank_mask:0xc
s_waitcnt lgkmcnt(0)
v_lshlrev_b32 v12, 3, v3
s_lshl_b32 s56, s48, 9
v_add_u32 v13, s56, v12
ds_write_b64 v13, v[4:5] offset:4096
s_waitcnt lgkmcnt(0)
s_barrier
ds_read_b64 v[14:15], v12 offset:4096
ds_read_b64 v[16:17], v12 offset:4608
ds_read_b64 v[18:19], v12 offset:5120
ds_read_b64 v[20:21], v12 offset:5632
ds_read_b64 v[22:23], v12 offset:6144
ds_read_b64 v[24:25], v12 offset:6656
ds_read_b64 v[26:27], v12 offset:7168
ds_read_b64 v[28:29], v12 offset:7680
s_waitcnt lgkmcnt(0)
v_add_f32 v4, v14, v16
v_add_f32 v5, v15, v17
v_add_f32 v4, v4, v18
v_add_f32 v5, v5, v19
v_add_f32 v4, v4, v20
v_add_f32 v5, v5, v21
v_add_f32 v4, v4, v22
v_add_f32 v5, v5, v23
v_add_f32 v4, v4, v24
v_add_f32 v5, v5, v25
v_add_f32 v4, v4, v26
v_add_f32 v5, v5, v27
v_add_f32 v4, v4, v28
v_add_f32 v5, v5, v29
v_cvt_pk_bf16_f32 v4, v4, v4
v_cvt_pk_bf16_f32 v5, v5, v5
v_and_b32 v4, s62, v4
v_and_b32 v5, s62, v5
v_mov_b32 v6, v4
v_mov_b32 v7, v5
s_nop 0
v_permlane32_swap_b32 v4, v6
v_permlane32_swap_b32 v5, v7
v_mul_f32 v4, v4, v6
v_mul_f32 v5, v5, v7
v_cvt_pk_bf16_f32 v4, v4, v5
s_add_u32 s56, s48, 0
v_readlane_b32 s64, v4, s56
s_add_u32 s56, s48, 8
v_readlane_b32 s65, v4, s56
s_add_u32 s56, s48, 16
v_readlane_b32 s66, v4, s56
s_add_u32 s56, s48, 24
v_readlane_b32 s67, v4, s56
s_cmp_eq_u32 s48, 7
s_cselect_b32 s64, 0, s64
s_cselect_b32 s65, 0, s65
s_cselect_b32 s66, 0, s66
s_cselect_b32 s67, 0, s67
ds_read_b128 v[4:7], v2 offset:26624
ds_read_b128 v[8:11], v2 offset:27648
ds_read_b128 v[20:23], v2 offset:28672
ds_read_b128 v[24:27], v2 offset:29696
v_dot2_f32_bf16 v12, v32, s64, 0
v_dot2_f32_bf16 v13, v36, s64, 0
v_dot2_f32_bf16 v14, v33, s64, 0
v_dot2_f32_bf16 v15, v37, s64, 0
v_dot2_f32_bf16 v16, v34, s64, 0
v_dot2_f32_bf16 v17, v38, s64, 0
v_dot2_f32_bf16 v18, v35, s64, 0
v_dot2_f32_bf16 v19, v39, s64, 0
v_dot2_f32_bf16 v12, v40, s65, v12
v_dot2_f32_bf16 v13, v44, s65, v13
v_dot2_f32_bf16 v14, v41, s65, v14
v_dot2_f32_bf16 v15, v45, s65, v15
v_dot2_f32_bf16 v16, v42, s65, v16
v_dot2_f32_bf16 v17, v46, s65, v17
v_dot2_f32_bf16 v18, v43, s65, v18
v_dot2_f32_bf16 v19, v47, s65, v19
s_waitcnt lgkmcnt(0)
v_dot2_f32_bf16 v12, v4, s66, v12
v_dot2_f32_bf16 v13, v8, s66, v13
v_dot2_f32_bf16 v14, v5, s66, v14
v_dot2_f32_bf16 v15, v9, s66, v15
v_dot2_f32_bf16 v16, v6, s66, v16
v_dot2_f32_bf16 v17, v10, s66, v17
v_dot2_f32_bf16 v18, v7, s66, v18
v_dot2_f32_bf16 v19, v11, s66, v19
v_dot2_f32_bf16 v12, v20, s67, v12
v_dot2_f32_bf16 v13, v24, s67, v13
v_dot2_f32_bf16 v14, v21, s67, v14
v_dot2_f32_bf16 v15, v25, s67, v15
v_dot2_f32_bf16 v16, v22, s67, v16
v_dot2_f32_bf16 v17, v26, s67, v17
v_dot2_f32_bf16 v18, v23, s67, v18
v_dot2_f32_bf16 v19, v27, s67, v19
v_lshlrev_b32 v32, 5, v3
s_mul_i32 s56, s48, 1792
s_add_u32 s56, s56, 8192
v_add_u32 v32, s56, v32
s_mov_b32 exec_hi, 0x00ffffff
ds_write_b128 v32, v[12:15]
ds_write_b128 v32, v[16:19] offset:16
s_mov_b32 exec_hi, -1
s_waitcnt lgkmcnt(0)
s_barrier
s_mul_i32 s56, s48, 224
v_lshlrev_b32 v33, 2, v3
v_add_u32 v33, s56, v33
v_add_u32 v32, 8192, v33
ds_read_b32 v34, v32 offset:0
ds_read_b32 v35, v32 offset:1792
ds_read_b32 v36, v32 offset:3584
ds_read_b32 v37, v32 offset:5376
ds_read_b32 v38, v32 offset:7168
ds_read_b32 v39, v32 offset:8960
ds_read_b32 v40, v32 offset:10752
ds_read_b32 v41, v32 offset:12544
s_waitcnt lgkmcnt(0)
v_add_f32 v34, v34, v35
v_add_f32 v34, v34, v36
v_add_f32 v34, v34, v37
v_add_f32 v34, v34, v38
v_add_f32 v34, v34, v39
v_add_f32 v34, v34, v40
v_add_f32 v34, v34, v41
v_or_b32 v34, 1, v34
s_mul_i32 s56, s2, 1792
s_add_u32 s56, s56, 0x38e000
s_mov_b32 exec_hi, 0x00ffffff
buffer_store_dword v34, v33, s[44:47], s56 offen sc1
s_mov_b32 exec_hi, -1
s_cmp_eq_u32 s48, 7
s_cbranch_scc1 L_gx_688
v_lshrrev_b32 v36, 4, v3
v_mul_u32_u24 v36, 1792, v36
v_and_b32 v37, 15, v3
v_lshl_add_u32 v36, v37, 4, v36
s_lshl_b32 s56, s48, 8
s_add_u32 s56, s56, 0x38e000
s_mov_b32 s60, 0
L_p_gx_689:
s_nop 4
s_add_u32 s57, s56, 0
buffer_load_dwordx4 v[4:7], v36, s[44:47], s57 offen sc1
s_add_u32 s57, s56, 7168
buffer_load_dwordx4 v[8:11], v36, s[44:47], s57 offen sc1
s_add_u32 s57, s56, 14336
buffer_load_dwordx4 v[12:15], v36, s[44:47], s57 offen sc1
s_add_u32 s57, s56, 21504
buffer_load_dwordx4 v[16:19], v36, s[44:47], s57 offen sc1
s_add_u32 s57, s56, 28672
buffer_load_dwordx4 v[20:23], v36, s[44:47], s57 offen sc1
s_add_u32 s57, s56, 35840
buffer_load_dwordx4 v[24:27], v36, s[44:47], s57 offen sc1
s_add_u32 s57, s56, 43008
buffer_load_dwordx4 v[28:31], v36, s[44:47], s57 offen sc1
s_add_u32 s57, s56, 50176
buffer_load_dwordx4 v[32:35], v36, s[44:47], s57 offen sc1
s_waitcnt vmcnt(0)
v_and_b32 v37, v4, v5
v_and_b32 v37, v37, v6
v_and_b32 v37, v37, v7
v_and_b32 v37, v37, v8
v_and_b32 v37, v37, v9
v_and_b32 v37, v37, v10
v_and_b32 v37, v37, v11
v_and_b32 v37, v37, v12
v_and_b32 v37, v37, v13
v_and_b32 v37, v37, v14
v_and_b32 v37, v37, v15
v_and_b32 v37, v37, v16
v_and_b32 v37, v37, v17
v_and_b32 v37, v37, v18
v_and_b32 v37, v37, v19
v_and_b32 v37, v37, v20
v_and_b32 v37, v37, v21
v_and_b32 v37, v37, v22
v_and_b32 v37, v37, v23
v_and_b32 v37, v37, v24
v_and_b32 v37, v37, v25
v_and_b32 v37, v37, v26
v_and_b32 v37, v37, v27
v_and_b32 v37, v37, v28
v_and_b32 v37, v37, v29
v_and_b32 v37, v37, v30
v_and_b32 v37, v37, v31
v_and_b32 v37, v37, v32
v_and_b32 v37, v37, v33
v_and_b32 v37, v37, v34
v_and_b32 v37, v37, v35
v_and_b32 v37, 1, v37
v_cmp_ne_u32 vcc, 1, v37
s_cbranch_vccz L_d_gx_690
s_sleep 1
s_add_u32 s60, s60, 1
s_cmp_lt_u32 s60, 400000
s_cbranch_scc1 L_p_gx_689
s_endpgm
L_d_gx_690:
s_nop 4
v_add_f32 v4, v4, v8
v_add_f32 v5, v5, v9
v_add_f32 v6, v6, v10
v_add_f32 v7, v7, v11
v_add_f32 v4, v4, v12
v_add_f32 v5, v5, v13
v_add_f32 v6, v6, v14
v_add_f32 v7, v7, v15
v_add_f32 v4, v4, v16
v_add_f32 v5, v5, v17
v_add_f32 v6, v6, v18
v_add_f32 v7, v7, v19
v_add_f32 v4, v4, v20
v_add_f32 v5, v5, v21
v_add_f32 v6, v6, v22
v_add_f32 v7, v7, v23
v_add_f32 v4, v4, v24
v_add_f32 v5, v5, v25
v_add_f32 v6, v6, v26
v_add_f32 v7, v7, v27
v_add_f32 v4, v4, v28
v_add_f32 v5, v5, v29
v_add_f32 v6, v6, v30
v_add_f32 v7, v7, v31
v_add_f32 v4, v4, v32
v_add_f32 v5, v5, v33
v_add_f32 v6, v6, v34
v_add_f32 v7, v7, v35
v_mov_b32 v38, v4
v_mov_b32 v39, v5
v_mov_b32 v40, v6
v_mov_b32 v41, v7
v_permlane16_swap_b32 v4, v38
v_permlane16_swap_b32 v5, v39
v_permlane16_swap_b32 v6, v40
v_permlane16_swap_b32 v7, v41
v_add_f32 v4, v4, v38
v_add_f32 v5, v5, v39
v_add_f32 v6, v6, v40
v_add_f32 v7, v7, v41
v_mov_b32 v38, v4
v_mov_b32 v39, v5
v_mov_b32 v40, v6
v_mov_b32 v41, v7
v_permlane32_swap_b32 v4, v38
v_permlane32_swap_b32 v5, v39
v_permlane32_swap_b32 v6, v40
v_permlane32_swap_b32 v7, v41
v_add_f32 v4, v4, v38
v_add_f32 v5, v5, v39
v_add_f32 v6, v6, v40
v_add_f32 v7, v7, v41
v_cvt_pk_bf16_f32 v4, v4, v4
v_cvt_pk_bf16_f32 v5, v5, v5
v_cvt_pk_bf16_f32 v6, v6, v6
v_cvt_pk_bf16_f32 v7, v7, v7
v_and_b32 v4, s62, v4
v_and_b32 v5, s62, v5
v_and_b32 v6, s62, v6
v_and_b32 v7, s62, v7
v_add_f32 v244, v244, v4
v_add_f32 v245, v245, v5
v_add_f32 v246, v246, v6
v_add_f32 v247, v247, v7
v_cvt_pk_bf16_f32 v244, v244, v244
v_cvt_pk_bf16_f32 v245, v245, v245
v_cvt_pk_bf16_f32 v246, v246, v246
v_cvt_pk_bf16_f32 v247, v247, v247
v_and_b32 v244, s62, v244
v_and_b32 v245, s62, v245
v_and_b32 v246, s62, v246
v_and_b32 v247, s62, v247
v_and_b32 v36, 15, v3
v_lshlrev_b32 v36, 4, v36
s_lshl_b32 s56, s48, 8
s_add_u32 s56, s56, 2048
v_add_u32 v36, s56, v36
v_mov_b32 v4, v244
v_mov_b32 v5, v245
v_mov_b32 v6, v246
v_mov_b32 v7, v247
ds_write_b128 v36, v[4:7]
s_waitcnt lgkmcnt(0)
L_gx_688:
s_nop 4
s_barrier
v_lshlrev_b32 v4, 2, v3
ds_read_b32 v16, v4 offset:2048
ds_read_b32 v17, v4 offset:2304
ds_read_b32 v18, v4 offset:2560
ds_read_b32 v19, v4 offset:2816
ds_read_b32 v20, v4 offset:3072
ds_read_b32 v21, v4 offset:3328
ds_read_b32 v22, v4 offset:3584
v_lshrrev_b32 v5, 4, v3
v_lshlrev_b32 v5, 2, v5
s_mul_i32 s56, s48, 224
v_add_u32 v5, s56, v5
s_waitcnt lgkmcnt(0)
ds_read_b32 v24, v5 offset:2048
ds_read_b32 v25, v5 offset:2064
ds_read_b32 v26, v5 offset:2080
ds_read_b32 v27, v5 offset:2096
ds_read_b32 v28, v5 offset:2112
ds_read_b32 v29, v5 offset:2128
ds_read_b32 v30, v5 offset:2144
ds_read_b32 v31, v5 offset:2160
ds_read_b32 v32, v5 offset:2176
ds_read_b32 v33, v5 offset:2192
ds_read_b32 v34, v5 offset:2208
ds_read_b32 v35, v5 offset:2224
ds_read_b32 v36, v5 offset:2240
ds_read_b32 v37, v5 offset:2256
v_add_f32 v6, v16, v17
v_add_f32 v6, v6, v18
v_add_f32 v6, v6, v19
v_add_f32 v6, v6, v20
v_add_f32 v6, v6, v21
v_add_f32 v6, v6, v22
s_nop 1
v_add_f32_dpp v6, v6, v6 quad_perm:[1,0,3,2]
s_nop 1
v_add_f32_dpp v6, v6, v6 quad_perm:[2,3,0,1]
s_nop 1
v_add_f32_dpp v6, v6, v6 row_ror:4
s_nop 1
v_add_f32_dpp v6, v6, v6 row_ror:8
v_mov_b32 v7, v6
s_nop 1
v_permlane16_swap_b32 v6, v7
v_add_f32 v6, v6, v7
v_mov_b32 v7, v6
s_nop 1
v_permlane32_swap_b32 v6, v7
v_add_f32 v6, v6, v7
v_mul_f32 v8, 0x3b124925, v6
v_sub_f32 v10, v16, v8
v_sub_f32 v11, v17, v8
v_sub_f32 v12, v18, v8
v_sub_f32 v13, v19, v8
v_sub_f32 v14, v20, v8
v_sub_f32 v15, v21, v8
v_sub_f32 v16, v22, v8
v_mul_f32 v9, v10, v10
v_fmac_f32 v9, v11, v11
v_fmac_f32 v9, v12, v12
v_fmac_f32 v9, v13, v13
v_fmac_f32 v9, v14, v14
v_fmac_f32 v9, v15, v15
v_fmac_f32 v9, v16, v16
s_nop 1
v_add_f32_dpp v9, v9, v9 quad_perm:[1,0,3,2]
s_nop 1
v_add_f32_dpp v9, v9, v9 quad_perm:[2,3,0,1]
s_nop 1
v_add_f32_dpp v9, v9, v9 row_ror:4
s_nop 1
v_add_f32_dpp v9, v9, v9 row_ror:8
v_mov_b32 v7, v9
s_nop 1
v_permlane16_swap_b32 v9, v7
v_add_f32 v9, v9, v7
v_mov_b32 v7, v9
s_nop 1
v_permlane32_swap_b32 v9, v7
v_add_f32 v9, v9, v7
v_mul_f32 v9, 0x3b124925, v9
v_cvt_pk_bf16_f32 v9, v9, v9
v_cvt_pk_bf16_f32 v8, v8, v8
v_and_b32 v9, s62, v9
v_and_b32 v8, s62, v8
v_add_f32 v9, 0x3727c5ac, v9
v_cvt_pk_bf16_f32 v9, v9, v9
v_and_b32 v9, s62, v9
v_sqrt_f32 v9, v9
s_nop 0
v_cvt_pk_bf16_f32 v9, v9, v9
v_and_b32 v9, s62, v9
v_rcp_f32 v6, v9
s_waitcnt lgkmcnt(0)
v_sub_f32 v24, v24, v8
v_sub_f32 v25, v25, v8
v_sub_f32 v26, v26, v8
v_sub_f32 v27, v27, v8
v_sub_f32 v28, v28, v8
v_sub_f32 v29, v29, v8
v_sub_f32 v30, v30, v8
v_sub_f32 v31, v31, v8
v_sub_f32 v32, v32, v8
v_sub_f32 v33, v33, v8
v_sub_f32 v34, v34, v8
v_sub_f32 v35, v35, v8
v_sub_f32 v36, v36, v8
v_sub_f32 v37, v37, v8
v_cvt_pk_bf16_f32 v24, v24, v24
v_cvt_pk_bf16_f32 v25, v25, v25
v_cvt_pk_bf16_f32 v26, v26, v26
v_cvt_pk_bf16_f32 v27, v27, v27
v_cvt_pk_bf16_f32 v28, v28, v28
v_cvt_pk_bf16_f32 v29, v29, v29
v_cvt_pk_bf16_f32 v30, v30, v30
v_cvt_pk_bf16_f32 v31, v31, v31
v_cvt_pk_bf16_f32 v32, v32, v32
v_cvt_pk_bf16_f32 v33, v33, v33
v_cvt_pk_bf16_f32 v34, v34, v34
v_cvt_pk_bf16_f32 v35, v35, v35
v_cvt_pk_bf16_f32 v36, v36, v36
v_cvt_pk_bf16_f32 v37, v37, v37
v_and_b32 v24, s62, v24
v_and_b32 v25, s62, v25
v_and_b32 v26, s62, v26
v_and_b32 v27, s62, v27
v_and_b32 v28, s62, v28
v_and_b32 v29, s62, v29
v_and_b32 v30, s62, v30
v_and_b32 v31, s62, v31
v_and_b32 v32, s62, v32
v_and_b32 v33, s62, v33
v_and_b32 v34, s62, v34
v_and_b32 v35, s62, v35
v_and_b32 v36, s62, v36
v_and_b32 v37, s62, v37
v_mul_f32 v38, v24, v6
v_mul_f32 v39, v25, v6
v_mul_f32 v40, v26, v6
v_mul_f32 v41, v27, v6
v_mul_f32 v42, v28, v6
v_mul_f32 v43, v29, v6
v_mul_f32 v44, v30, v6
v_mul_f32 v45, v31, v6
v_mul_f32 v46, v32, v6
v_mul_f32 v47, v33, v6
v_mul_f32 v48, v34, v6
v_mul_f32 v49, v35, v6
v_mul_f32 v50, v36, v6
v_mul_f32 v51, v37, v6
v_fma_f32 v24, -v38, v9, v24
v_fma_f32 v25, -v39, v9, v25
v_fma_f32 v26, -v40, v9, v26
v_fma_f32 v27, -v41, v9, v27
v_fma_f32 v28, -v42, v9, v28
v_fma_f32 v29, -v43, v9, v29
v_fma_f32 v30, -v44, v9, v30
v_fma_f32 v31, -v45, v9, v31
v_fma_f32 v32, -v46, v9, v32
v_fma_f32 v33, -v47, v9, v33
v_fma_f32 v34, -v48, v9, v34
v_fma_f32 v35, -v49, v9, v35
v_fma_f32 v36, -v50, v9, v36
v_fma_f32 v37, -v51, v9, v37
v_fma_f32 v24, v24, v6, v38
v_fma_f32 v25, v25, v6, v39
v_fma_f32 v26, v26, v6, v40
v_fma_f32 v27, v27, v6, v41
v_fma_f32 v28, v28, v6, v42
v_fma_f32 v29, v29, v6, v43
v_fma_f32 v30, v30, v6, v44
v_fma_f32 v31, v31, v6, v45
v_fma_f32 v32, v32, v6, v46
v_fma_f32 v33, v33, v6, v47
v_fma_f32 v34, v34, v6, v48
v_fma_f32 v35, v35, v6, v49
v_fma_f32 v36, v36, v6, v50
v_fma_f32 v37, v37, v6, v51
v_cvt_pk_bf16_f32 v24, v24, v24
v_cvt_pk_bf16_f32 v25, v25, v25
v_cvt_pk_bf16_f32 v26, v26, v26
v_cvt_pk_bf16_f32 v27, v27, v27
v_cvt_pk_bf16_f32 v28, v28, v28
v_cvt_pk_bf16_f32 v29, v29, v29
v_cvt_pk_bf16_f32 v30, v30, v30
v_cvt_pk_bf16_f32 v31, v31, v31
v_cvt_pk_bf16_f32 v32, v32, v32
v_cvt_pk_bf16_f32 v33, v33, v33
v_cvt_pk_bf16_f32 v34, v34, v34
v_cvt_pk_bf16_f32 v35, v35, v35
v_cvt_pk_bf16_f32 v36, v36, v36
v_cvt_pk_bf16_f32 v37, v37, v37
v_and_b32 v24, s62, v24
v_and_b32 v25, s62, v25
v_and_b32 v26, s62, v26
v_and_b32 v27, s62, v27
v_and_b32 v28, s62, v28
v_and_b32 v29, s62, v29
v_and_b32 v30, s62, v30
v_and_b32 v31, s62, v31
v_and_b32 v32, s62, v32
v_and_b32 v33, s62, v33
v_and_b32 v34, s62, v34
v_and_b32 v35, s62, v35
v_and_b32 v36, s62, v36
v_and_b32 v37, s62, v37
v_cvt_pk_bf16_f32 v24, v24, v25
v_cvt_pk_bf16_f32 v26, v26, v27
v_cvt_pk_bf16_f32 v28, v28, v29
v_cvt_pk_bf16_f32 v30, v30, v31
v_cvt_pk_bf16_f32 v32, v32, v33
v_cvt_pk_bf16_f32 v34, v34, v35
v_cvt_pk_bf16_f32 v36, v36, v37
v_dot2_f32_bf16 v4, v184, v24, 0
v_dot2_f32_bf16 v5, v188, v24, 0
v_dot2_f32_bf16 v6, v185, v24, 0
v_dot2_f32_bf16 v7, v189, v24, 0
v_dot2_f32_bf16 v8, v186, v24, 0
v_dot2_f32_bf16 v9, v190, v24, 0
v_dot2_f32_bf16 v10, v187, v24, 0
v_dot2_f32_bf16 v11, v191, v24, 0
v_dot2_f32_bf16 v4, v192, v26, v4
v_dot2_f32_bf16 v5, v196, v26, v5
v_dot2_f32_bf16 v6, v193, v26, v6
v_dot2_f32_bf16 v7, v197, v26, v7
v_dot2_f32_bf16 v8, v194, v26, v8
v_dot2_f32_bf16 v9, v198, v26, v9
v_dot2_f32_bf16 v10, v195, v26, v10
v_dot2_f32_bf16 v11, v199, v26, v11
v_dot2_f32_bf16 v4, v200, v28, v4
v_dot2_f32_bf16 v5, v204, v28, v5
v_dot2_f32_bf16 v6, v201, v28, v6
v_dot2_f32_bf16 v7, v205, v28, v7
v_dot2_f32_bf16 v8, v202, v28, v8
v_dot2_f32_bf16 v9, v206, v28, v9
v_dot2_f32_bf16 v10, v203, v28, v10
v_dot2_f32_bf16 v11, v207, v28, v11
v_dot2_f32_bf16 v4, v208, v30, v4
v_dot2_f32_bf16 v5, v212, v30, v5
v_dot2_f32_bf16 v6, v209, v30, v6
v_dot2_f32_bf16 v7, v213, v30, v7
v_dot2_f32_bf16 v8, v210, v30, v8
v_dot2_f32_bf16 v9, v214, v30, v9
v_dot2_f32_bf16 v10, v211, v30, v10
v_dot2_f32_bf16 v11, v215, v30, v11
v_dot2_f32_bf16 v4, v216, v32, v4
v_dot2_f32_bf16 v5, v220, v32, v5
v_dot2_f32_bf16 v6, v217, v32, v6
v_dot2_f32_bf16 v7, v221, v32, v7
v_dot2_f32_bf16 v8, v218, v32, v8
v_dot2_f32_bf16 v9, v222, v32, v9
v_dot2_f32_bf16 v10, v219, v32, v10
v_dot2_f32_bf16 v11, v223, v32, v11
v_dot2_f32_bf16 v4, v224, v34, v4
v_dot2_f32_bf16 v5, v228, v34, v5
v_dot2_f32_bf16 v6, v225, v34, v6
v_dot2_f32_bf16 v7, v229, v34, v7
v_dot2_f32_bf16 v8, v226, v34, v8
v_dot2_f32_bf16 v9, v230, v34, v9
v_dot2_f32_bf16 v10, v227, v34, v10
v_dot2_f32_bf16 v11, v231, v34, v11
v_dot2_f32_bf16 v4, v232, v36, v4
v_dot2_f32_bf16 v5, v236, v36, v5
v_dot2_f32_bf16 v6, v233, v36, v6
v_dot2_f32_bf16 v7, v237, v36, v7
v_dot2_f32_bf16 v8, v234, v36, v8
v_dot2_f32_bf16 v9, v238, v36, v9
v_dot2_f32_bf16 v10, v235, v36, v10
v_dot2_f32_bf16 v11, v239, v36, v11
v_permlane32_swap_b32 v4, v8
v_permlane32_swap_b32 v5, v9
v_permlane32_swap_b32 v6, v10
v_permlane32_swap_b32 v7, v11
v_add_f32 v4, v4, v8
v_add_f32 v5, v5, v9
v_add_f32 v6, v6, v10
v_add_f32 v7, v7, v11
s_nop 0
v_permlane16_swap_b32 v4, v6
v_permlane16_swap_b32 v5, v7
v_add_f32 v4, v4, v6
v_add_f32 v5, v5, v7
v_lshlrev_b32 v14, 3, v3
s_lshl_b32 s56, s48, 9
v_add_u32 v15, s56, v14
ds_write_b64 v15, v[4:5] offset:4096
s_waitcnt lgkmcnt(0)
s_barrier
ds_read_b64 v[16:17], v14 offset:4096
ds_read_b64 v[18:19], v14 offset:4608
ds_read_b64 v[20:21], v14 offset:5120
ds_read_b64 v[22:23], v14 offset:5632
ds_read_b64 v[38:39], v14 offset:6144
ds_read_b64 v[40:41], v14 offset:6656
ds_read_b64 v[42:43], v14 offset:7168
ds_read_b64 v[44:45], v14 offset:7680
s_waitcnt lgkmcnt(0)
v_add_f32 v4, v16, v18
v_add_f32 v5, v17, v19
v_add_f32 v4, v4, v20
v_add_f32 v5, v5, v21
v_add_f32 v4, v4, v22
v_add_f32 v5, v5, v23
v_add_f32 v4, v4, v38
v_add_f32 v5, v5, v39
v_add_f32 v4, v4, v40
v_add_f32 v5, v5, v41
v_add_f32 v4, v4, v42
v_add_f32 v5, v5, v43
v_add_f32 v4, v4, v44
v_add_f32 v5, v5, v45
v_cvt_pk_bf16_f32 v4, v4, v4
v_cvt_pk_bf16_f32 v5, v5, v5
v_and_b32 v4, s62, v4
v_and_b32 v5, s62, v5
s_cmp_lg_u32 s48, 0
s_cbranch_scc1 L_q1pub_730
v_or_b32 v4, 1, v4
v_or_b32 v5, 1, v5
v_and_b32 v22, 15, v3
v_lshlrev_b32 v22, 3, v22
v_lshrrev_b32 v23, 4, v3
v_lshl_add_u32 v22, v23, 1, v22
v_lshlrev_b32 v22, 2, v22
s_lshl_b32 s56, s2, 9
s_add_u32 s56, s56, 0x414000
buffer_store_dwordx2 v[4:5], v22, s[44:47], s56 offen sc1
L_q1pub_730:
s_nop 4
v_lshrrev_b32 v10, 2, v3
v_min_u32 v10, 13, v10
v_mul_u32_u24 v11, 1088, v10
v_and_b32 v10, 3, v3
v_lshl_add_u32 v10, v10, 4, v11
s_mul_i32 s56, s49, 15232
s_add_u32 s56, s56, 0x177000
s_lshl_b32 s57, s50, 9
s_lshl_b32 s58, s48, 6
s_add_u32 s57, s57, s58
s_add_u32 s57, s57, s56
s_mov_b32 s60, 0
L_p_pa_732:
s_nop 4
buffer_load_dwordx4 v[4:7], v10, s[44:47], s57 offen sc1
buffer_load_dwordx2 v[8:9], v11, s[44:47], s56 offen offset:1024 sc1
s_waitcnt vmcnt(0)
v_and_b32 v12, v4, v5
v_and_b32 v12, v12, v6
v_and_b32 v12, v12, v7
v_and_b32 v12, v12, v8
v_and_b32 v12, v12, v9
v_and_b32 v12, 1, v12
v_cmp_ne_u32 vcc, 1, v12
s_cbranch_vccz L_d_pa_733
s_sleep 1
s_add_u32 s60, s60, 1
s_cmp_lt_u32 s60, 400000
s_cbranch_scc1 L_p_pa_732
s_endpgm
L_d_pa_733:
s_nop 4
v_mov_b32 v15, v8
s_nop 1
v_max_f32_dpp v15, v15, v15 row_ror:4
s_nop 1
v_max_f32_dpp v15, v15, v15 row_ror:8
v_mov_b32 v13, v15
s_nop 1
v_permlane16_swap_b32 v15, v13
v_max_f32 v15, v15, v13
v_mov_b32 v13, v15
s_nop 1
v_permlane32_swap_b32 v15, v13
v_max_f32 v15, v15, v13
v_sub_f32 v8, v8, v15
v_mul_f32 v8, 0x3fb8aa3b, v8
v_exp_f32 v8, v8
v_cmp_gt_u32 vcc, 56, v3
s_nop 1
v_cndmask_b32 v8, 0, v8, vcc
v_mul_f32 v4, v8, v4
v_mul_f32 v5, v8, v5
v_mul_f32 v6, v8, v6
v_mul_f32 v7, v8, v7
v_mul_f32 v9, v8, v9
v_add_f32_dpp v4, v4, v4 row_ror:4
v_add_f32_dpp v5, v5, v5 row_ror:4
v_add_f32_dpp v6, v6, v6 row_ror:4
v_add_f32_dpp v7, v7, v7 row_ror:4
v_add_f32_dpp v9, v9, v9 row_ror:4
v_add_f32_dpp v4, v4, v4 row_ror:8
v_add_f32_dpp v5, v5, v5 row_ror:8
v_add_f32_dpp v6, v6, v6 row_ror:8
v_add_f32_dpp v7, v7, v7 row_ror:8
v_add_f32_dpp v9, v9, v9 row_ror:8
v_mov_b32 v16, v4
v_mov_b32 v17, v5
v_mov_b32 v18, v6
v_mov_b32 v19, v7
v_mov_b32 v20, v9
v_permlane16_swap_b32 v4, v16
v_permlane16_swap_b32 v5, v17
v_permlane16_swap_b32 v6, v18
v_permlane16_swap_b32 v7, v19
v_permlane16_swap_b32 v9, v20
v_add_f32 v4, v4, v16
v_add_f32 v5, v5, v17
v_add_f32 v6, v6, v18
v_add_f32 v7, v7, v19
v_add_f32 v9, v9, v20
v_mov_b32 v16, v4
v_mov_b32 v17, v5
v_mov_b32 v18, v6
v_mov_b32 v19, v7
v_mov_b32 v20, v9
v_permlane32_swap_b32 v4, v16
v_permlane32_swap_b32 v5, v17
v_permlane32_swap_b32 v6, v18
v_permlane32_swap_b32 v7, v19
v_permlane32_swap_b32 v9, v20
v_add_f32 v4, v4, v16
v_add_f32 v5, v5, v17
v_add_f32 v6, v6, v18
v_add_f32 v7, v7, v19
v_add_f32 v9, v9, v20
v_rcp_f32 v13, v9
s_nop 0
v_mul_f32 v16, v4, v13
v_mul_f32 v17, v5, v13
v_mul_f32 v18, v6, v13
v_mul_f32 v19, v7, v13
v_fma_f32 v4, -v16, v9, v4
v_fma_f32 v5, -v17, v9, v5
v_fma_f32 v6, -v18, v9, v6
v_fma_f32 v7, -v19, v9, v7
v_fma_f32 v4, v4, v13, v16
v_fma_f32 v5, v5, v13, v17
v_fma_f32 v6, v6, v13, v18
v_fma_f32 v7, v7, v13, v19
v_cvt_pk_bf16_f32 v4, v4, v5
v_cvt_pk_bf16_f32 v6, v6, v7
v_readlane_b32 s64, v4, 0
v_readlane_b32 s65, v6, 0
v_readlane_b32 s66, v4, 1
v_readlane_b32 s67, v6, 1
v_readlane_b32 s68, v4, 2
v_readlane_b32 s69, v6, 2
v_readlane_b32 s70, v4, 3
v_readlane_b32 s71, v6, 3
v_dot2_f32_bf16 v24, v56, s64, 0
v_dot2_f32_bf16 v25, v60, s64, 0
v_dot2_f32_bf16 v26, v57, s64, 0
v_dot2_f32_bf16 v27, v61, s64, 0
v_dot2_f32_bf16 v28, v58, s64, 0
v_dot2_f32_bf16 v29, v62, s64, 0
v_dot2_f32_bf16 v30, v59, s64, 0
v_dot2_f32_bf16 v31, v63, s64, 0
v_dot2_f32_bf16 v24, v64, s65, v24
v_dot2_f32_bf16 v25, v68, s65, v25
v_dot2_f32_bf16 v26, v65, s65, v26
v_dot2_f32_bf16 v27, v69, s65, v27
v_dot2_f32_bf16 v28, v66, s65, v28
v_dot2_f32_bf16 v29, v70, s65, v29
v_dot2_f32_bf16 v30, v67, s65, v30
v_dot2_f32_bf16 v31, v71, s65, v31
v_dot2_f32_bf16 v24, v72, s66, v24
v_dot2_f32_bf16 v25, v76, s66, v25
v_dot2_f32_bf16 v26, v73, s66, v26
v_dot2_f32_bf16 v27, v77, s66, v27
v_dot2_f32_bf16 v28, v74, s66, v28
v_dot2_f32_bf16 v29, v78, s66, v29
v_dot2_f32_bf16 v30, v75, s66, v30
v_dot2_f32_bf16 v31, v79, s66, v31
v_dot2_f32_bf16 v24, v80, s67, v24
v_dot2_f32_bf16 v25, v84, s67, v25
v_dot2_f32_bf16 v26, v81, s67, v26
v_dot2_f32_bf16 v27, v85, s67, v27
v_dot2_f32_bf16 v28, v82, s67, v28
v_dot2_f32_bf16 v29, v86, s67, v29
v_dot2_f32_bf16 v30, v83, s67, v30
v_dot2_f32_bf16 v31, v87, s67, v31
v_dot2_f32_bf16 v24, v88, s68, v24
v_dot2_f32_bf16 v25, v92, s68, v25
v_dot2_f32_bf16 v26, v89, s68, v26
v_dot2_f32_bf16 v27, v93, s68, v27
v_dot2_f32_bf16 v28, v90, s68, v28
v_dot2_f32_bf16 v29, v94, s68, v29
v_dot2_f32_bf16 v30, v91, s68, v30
v_dot2_f32_bf16 v31, v95, s68, v31
v_dot2_f32_bf16 v24, v96, s69, v24
v_dot2_f32_bf16 v25, v100, s69, v25
v_dot2_f32_bf16 v26, v97, s69, v26
v_dot2_f32_bf16 v27, v101, s69, v27
v_dot2_f32_bf16 v28, v98, s69, v28
v_dot2_f32_bf16 v29, v102, s69, v29
v_dot2_f32_bf16 v30, v99, s69, v30
v_dot2_f32_bf16 v31, v103, s69, v31
v_dot2_f32_bf16 v24, v104, s70, v24
v_dot2_f32_bf16 v25, v108, s70, v25
v_dot2_f32_bf16 v26, v105, s70, v26
v_dot2_f32_bf16 v27, v109, s70, v27
v_dot2_f32_bf16 v28, v106, s70, v28
v_dot2_f32_bf16 v29, v110, s70, v29
v_dot2_f32_bf16 v30, v107, s70, v30
v_dot2_f32_bf16 v31, v111, s70, v31
v_dot2_f32_bf16 v24, v112, s71, v24
v_dot2_f32_bf16 v25, v116, s71, v25
v_dot2_f32_bf16 v26, v113, s71, v26
v_dot2_f32_bf16 v27, v117, s71, v27
v_dot2_f32_bf16 v28, v114, s71, v28
v_dot2_f32_bf16 v29, v118, s71, v29
v_dot2_f32_bf16 v30, v115, s71, v30
v_dot2_f32_bf16 v31, v119, s71, v31
v_lshlrev_b32 v32, 5, v3
s_mul_i32 s56, s48, 1792
s_add_u32 s56, s56, 8192
v_add_u32 v32, s56, v32
s_mov_b32 exec_hi, 0x00ffffff
ds_write_b128 v32, v[24:27]
ds_write_b128 v32, v[28:31] offset:16
s_mov_b32 exec_hi, -1
s_waitcnt lgkmcnt(0)
s_barrier
s_mul_i32 s56, s48, 224
v_lshlrev_b32 v33, 2, v3
v_add_u32 v33, s56, v33
v_add_u32 v32, 8192, v33
ds_read_b32 v34, v32 offset:0
ds_read_b32 v35, v32 offset:1792
ds_read_b32 v36, v32 offset:3584
ds_read_b32 v37, v32 offset:5376
ds_read_b32 v38, v32 offset:7168
ds_read_b32 v39, v32 offset:8960
ds_read_b32 v40, v32 offset:10752
ds_read_b32 v41, v32 offset:12544
s_waitcnt lgkmcnt(0)
v_add_f32 v34, v34, v35
v_add_f32 v34, v34, v36
v_add_f32 v34, v34, v37
v_add_f32 v34, v34, v38
v_add_f32 v34, v34, v39
v_add_f32 v34, v34, v40
v_add_f32 v34, v34, v41
v_or_b32 v34, 1, v34
s_mul_i32 s56, s2, 1792
s_add_u32 s56, s56, 0x31c000
s_mov_b32 exec_hi, 0x00ffffff
buffer_store_dword v34, v33, s[44:47], s56 offen sc1
s_mov_b32 exec_hi, -1
s_cmp_eq_u32 s48, 7
s_cbranch_scc1 L_gx_747
v_lshrrev_b32 v36, 4, v3
v_mul_u32_u24 v36, 1792, v36
v_and_b32 v37, 15, v3
v_lshl_add_u32 v36, v37, 4, v36
s_lshl_b32 s56, s48, 8
s_add_u32 s56, s56, 0x31c000
s_mov_b32 s60, 0
L_p_gx_748:
s_nop 4
s_add_u32 s57, s56, 0
buffer_load_dwordx4 v[4:7], v36, s[44:47], s57 offen sc1
s_add_u32 s57, s56, 7168
buffer_load_dwordx4 v[8:11], v36, s[44:47], s57 offen sc1
s_add_u32 s57, s56, 14336
buffer_load_dwordx4 v[12:15], v36, s[44:47], s57 offen sc1
s_add_u32 s57, s56, 21504
buffer_load_dwordx4 v[16:19], v36, s[44:47], s57 offen sc1
s_add_u32 s57, s56, 28672
buffer_load_dwordx4 v[20:23], v36, s[44:47], s57 offen sc1
s_add_u32 s57, s56, 35840
buffer_load_dwordx4 v[24:27], v36, s[44:47], s57 offen sc1
s_add_u32 s57, s56, 43008
buffer_load_dwordx4 v[28:31], v36, s[44:47], s57 offen sc1
s_add_u32 s57, s56, 50176
buffer_load_dwordx4 v[32:35], v36, s[44:47], s57 offen sc1
s_waitcnt vmcnt(0)
v_and_b32 v37, v4, v5
v_and_b32 v37, v37, v6
v_and_b32 v37, v37, v7
v_and_b32 v37, v37, v8
v_and_b32 v37, v37, v9
v_and_b32 v37, v37, v10
v_and_b32 v37, v37, v11
v_and_b32 v37, v37, v12
v_and_b32 v37, v37, v13
v_and_b32 v37, v37, v14
v_and_b32 v37, v37, v15
v_and_b32 v37, v37, v16
v_and_b32 v37, v37, v17
v_and_b32 v37, v37, v18
v_and_b32 v37, v37, v19
v_and_b32 v37, v37, v20
v_and_b32 v37, v37, v21
v_and_b32 v37, v37, v22
v_and_b32 v37, v37, v23
v_and_b32 v37, v37, v24
v_and_b32 v37, v37, v25
v_and_b32 v37, v37, v26
v_and_b32 v37, v37, v27
v_and_b32 v37, v37, v28
v_and_b32 v37, v37, v29
v_and_b32 v37, v37, v30
v_and_b32 v37, v37, v31
v_and_b32 v37, v37, v32
v_and_b32 v37, v37, v33
v_and_b32 v37, v37, v34
v_and_b32 v37, v37, v35
v_and_b32 v37, 1, v37
v_cmp_ne_u32 vcc, 1, v37
s_cbranch_vccz L_d_gx_749
s_sleep 1
s_add_u32 s60, s60, 1
s_cmp_lt_u32 s60, 400000
s_cbranch_scc1 L_p_gx_748
s_endpgm
L_d_gx_749:
s_nop 4
v_add_f32 v4, v4, v8
v_add_f32 v5, v5, v9
v_add_f32 v6, v6, v10
v_add_f32 v7, v7, v11
v_add_f32 v4, v4, v12
v_add_f32 v5, v5, v13
v_add_f32 v6, v6, v14
v_add_f32 v7, v7, v15
v_add_f32 v4, v4, v16
v_add_f32 v5, v5, v17
v_add_f32 v6, v6, v18
v_add_f32 v7, v7, v19
v_add_f32 v4, v4, v20
v_add_f32 v5, v5, v21
v_add_f32 v6, v6, v22
v_add_f32 v7, v7, v23
v_add_f32 v4, v4, v24
v_add_f32 v5, v5, v25
v_add_f32 v6, v6, v26
v_add_f32 v7, v7, v27
v_add_f32 v4, v4, v28
v_add_f32 v5, v5, v29
v_add_f32 v6, v6, v30
v_add_f32 v7, v7, v31
v_add_f32 v4, v4, v32
v_add_f32 v5, v5, v33
v_add_f32 v6, v6, v34
v_add_f32 v7, v7, v35
v_mov_b32 v38, v4
v_mov_b32 v39, v5
v_mov_b32 v40, v6
v_mov_b32 v41, v7
v_permlane16_swap_b32 v4, v38
v_permlane16_swap_b32 v5, v39
v_permlane16_swap_b32 v6, v40
v_permlane16_swap_b32 v7, v41
v_add_f32 v4, v4, v38
v_add_f32 v5, v5, v39
v_add_f32 v6, v6, v40
v_add_f32 v7, v7, v41
v_mov_b32 v38, v4
v_mov_b32 v39, v5
v_mov_b32 v40, v6
v_mov_b32 v41, v7
v_permlane32_swap_b32 v4, v38
v_permlane32_swap_b32 v5, v39
v_permlane32_swap_b32 v6, v40
v_permlane32_swap_b32 v7, v41
v_add_f32 v4, v4, v38
v_add_f32 v5, v5, v39
v_add_f32 v6, v6, v40
v_add_f32 v7, v7, v41
v_cvt_pk_bf16_f32 v4, v4, v4
v_cvt_pk_bf16_f32 v5, v5, v5
v_cvt_pk_bf16_f32 v6, v6, v6
v_cvt_pk_bf16_f32 v7, v7, v7
v_and_b32 v4, s62, v4
v_and_b32 v5, s62, v5
v_and_b32 v6, s62, v6
v_and_b32 v7, s62, v7
v_add_f32 v240, v240, v4
v_add_f32 v241, v241, v5
v_add_f32 v242, v242, v6
v_add_f32 v243, v243, v7
v_cvt_pk_bf16_f32 v240, v240, v240
v_cvt_pk_bf16_f32 v241, v241, v241
v_cvt_pk_bf16_f32 v242, v242, v242
v_cvt_pk_bf16_f32 v243, v243, v243
v_and_b32 v240, s62, v240
v_and_b32 v241, s62, v241
v_and_b32 v242, s62, v242
v_and_b32 v243, s62, v243
v_and_b32 v36, 15, v3
v_lshlrev_b32 v36, 4, v36
s_lshl_b32 s56, s48, 8
s_add_u32 s56, s56, 0
v_add_u32 v36, s56, v36
v_mov_b32 v4, v240
v_mov_b32 v5, v241
v_mov_b32 v6, v242
v_mov_b32 v7, v243
ds_write_b128 v36, v[4:7]
s_waitcnt lgkmcnt(0)
L_gx_747:
s_nop 4
s_barrier
v_lshlrev_b32 v4, 2, v3
ds_read_b32 v16, v4 offset:0
ds_read_b32 v17, v4 offset:256
ds_read_b32 v18, v4 offset:512
ds_read_b32 v19, v4 offset:768
ds_read_b32 v20, v4 offset:1024
ds_read_b32 v21, v4 offset:1280
ds_read_b32 v22, v4 offset:1536
v_lshrrev_b32 v5, 3, v3
v_lshlrev_b32 v5, 2, v5
s_mul_i32 s56, s48, 224
v_add_u32 v5, s56, v5
s_waitcnt lgkmcnt(0)
ds_read_b32 v24, v5 offset:0
ds_read_b32 v25, v5 offset:32
ds_read_b32 v26, v5 offset:64
ds_read_b32 v27, v5 offset:96
ds_read_b32 v28, v5 offset:128
ds_read_b32 v29, v5 offset:160
ds_read_b32 v30, v5 offset:192
v_add_f32 v6, v16, v17
v_add_f32 v6, v6, v18
v_add_f32 v6, v6, v19
v_add_f32 v6, v6, v20
v_add_f32 v6, v6, v21
v_add_f32 v6, v6, v22
s_nop 1
v_add_f32_dpp v6, v6, v6 quad_perm:[1,0,3,2]
s_nop 1
v_add_f32_dpp v6, v6, v6 quad_perm:[2,3,0,1]
s_nop 1
v_add_f32_dpp v6, v6, v6 row_ror:4
s_nop 1
v_add_f32_dpp v6, v6, v6 row_ror:8
v_mov_b32 v7, v6
s_nop 1
v_permlane16_swap_b32 v6, v7
v_add_f32 v6, v6, v7
v_mov_b32 v7, v6
s_nop 1
v_permlane32_swap_b32 v6, v7
v_add_f32 v6, v6, v7
v_mul_f32 v8, 0x3b124925, v6
v_sub_f32 v10, v16, v8
v_sub_f32 v11, v17, v8
v_sub_f32 v12, v18, v8
v_sub_f32 v13, v19, v8
v_sub_f32 v14, v20, v8
v_sub_f32 v15, v21, v8
v_sub_f32 v16, v22, v8
v_mul_f32 v9, v10, v10
v_fmac_f32 v9, v11, v11
v_fmac_f32 v9, v12, v12
v_fmac_f32 v9, v13, v13
v_fmac_f32 v9, v14, v14
v_fmac_f32 v9, v15, v15
v_fmac_f32 v9, v16, v16
s_nop 1
v_add_f32_dpp v9, v9, v9 quad_perm:[1,0,3,2]
s_nop 1
v_add_f32_dpp v9, v9, v9 quad_perm:[2,3,0,1]
s_nop 1
v_add_f32_dpp v9, v9, v9 row_ror:4
s_nop 1
v_add_f32_dpp v9, v9, v9 row_ror:8
v_mov_b32 v7, v9
s_nop 1
v_permlane16_swap_b32 v9, v7
v_add_f32 v9, v9, v7
v_mov_b32 v7, v9
s_nop 1
v_permlane32_swap_b32 v9, v7
v_add_f32 v9, v9, v7
v_mul_f32 v9, 0x3b124925, v9
v_cvt_pk_bf16_f32 v9, v9, v9
v_cvt_pk_bf16_f32 v8, v8, v8
v_and_b32 v9, s62, v9
v_and_b32 v8, s62, v8
v_add_f32 v9, 0x3727c5ac, v9
v_cvt_pk_bf16_f32 v9, v9, v9
v_and_b32 v9, s62, v9
v_sqrt_f32 v9, v9
s_nop 0
v_cvt_pk_bf16_f32 v9, v9, v9
v_and_b32 v9, s62, v9
v_rcp_f32 v6, v9
s_waitcnt lgkmcnt(0)
v_sub_f32 v24, v24, v8
v_sub_f32 v25, v25, v8
v_sub_f32 v26, v26, v8
v_sub_f32 v27, v27, v8
v_sub_f32 v28, v28, v8
v_sub_f32 v29, v29, v8
v_sub_f32 v30, v30, v8
v_cvt_pk_bf16_f32 v24, v24, v24
v_cvt_pk_bf16_f32 v25, v25, v25
v_cvt_pk_bf16_f32 v26, v26, v26
v_cvt_pk_bf16_f32 v27, v27, v27
v_cvt_pk_bf16_f32 v28, v28, v28
v_cvt_pk_bf16_f32 v29, v29, v29
v_cvt_pk_bf16_f32 v30, v30, v30
v_and_b32 v24, s62, v24
v_and_b32 v25, s62, v25
v_and_b32 v26, s62, v26
v_and_b32 v27, s62, v27
v_and_b32 v28, s62, v28
v_and_b32 v29, s62, v29
v_and_b32 v30, s62, v30
v_mul_f32 v38, v24, v6
v_mul_f32 v39, v25, v6
v_mul_f32 v40, v26, v6
v_mul_f32 v41, v27, v6
v_mul_f32 v42, v28, v6
v_mul_f32 v43, v29, v6
v_mul_f32 v44, v30, v6
v_fma_f32 v24, -v38, v9, v24
v_fma_f32 v25, -v39, v9, v25
v_fma_f32 v26, -v40, v9, v26
v_fma_f32 v27, -v41, v9, v27
v_fma_f32 v28, -v42, v9, v28
v_fma_f32 v29, -v43, v9, v29
v_fma_f32 v30, -v44, v9, v30
v_fma_f32 v24, v24, v6, v38
v_fma_f32 v25, v25, v6, v39
v_fma_f32 v26, v26, v6, v40
v_fma_f32 v27, v27, v6, v41
v_fma_f32 v28, v28, v6, v42
v_fma_f32 v29, v29, v6, v43
v_fma_f32 v30, v30, v6, v44
v_cvt_pk_bf16_f32 v24, v24, v24
v_cvt_pk_bf16_f32 v25, v25, v25
v_cvt_pk_bf16_f32 v26, v26, v26
v_cvt_pk_bf16_f32 v27, v27, v27
v_cvt_pk_bf16_f32 v28, v28, v28
v_cvt_pk_bf16_f32 v29, v29, v29
v_cvt_pk_bf16_f32 v30, v30, v30
v_and_b32 v24, s62, v24
v_and_b32 v25, s62, v25
v_and_b32 v26, s62, v26
v_and_b32 v27, s62, v27
v_and_b32 v28, s62, v28
v_and_b32 v29, s62, v29
v_and_b32 v30, s62, v30
ds_read_b128 v[32:35], v2 offset:22528
ds_read_b128 v[36:39], v2 offset:23552
ds_read_b128 v[40:43], v2 offset:24576
ds_read_b128 v[44:47], v2 offset:25600
v_cvt_pk_bf16_f32 v24, v24, v25
v_cvt_pk_bf16_f32 v26, v26, v27
v_cvt_pk_bf16_f32 v28, v28, v29
v_cvt_pk_bf16_f32 v30, v30, 0
v_dot2_f32_bf16 v4, v120, v24, 0
v_dot2_f32_bf16 v5, v124, v24, 0
v_dot2_f32_bf16 v6, v121, v24, 0
v_dot2_f32_bf16 v7, v125, v24, 0
v_dot2_f32_bf16 v8, v122, v24, 0
v_dot2_f32_bf16 v9, v126, v24, 0
v_dot2_f32_bf16 v10, v123, v24, 0
v_dot2_f32_bf16 v11, v127, v24, 0
v_dot2_f32_bf16 v12, v152, v24, 0
v_dot2_f32_bf16 v13, v156, v24, 0
v_dot2_f32_bf16 v14, v153, v24, 0
v_dot2_f32_bf16 v15, v157, v24, 0
v_dot2_f32_bf16 v16, v154, v24, 0
v_dot2_f32_bf16 v17, v158, v24, 0
v_dot2_f32_bf16 v18, v155, v24, 0
v_dot2_f32_bf16 v19, v159, v24, 0
v_dot2_f32_bf16 v4, v128, v26, v4
v_dot2_f32_bf16 v5, v132, v26, v5
v_dot2_f32_bf16 v6, v129, v26, v6
v_dot2_f32_bf16 v7, v133, v26, v7
v_dot2_f32_bf16 v8, v130, v26, v8
v_dot2_f32_bf16 v9, v134, v26, v9
v_dot2_f32_bf16 v10, v131, v26, v10
v_dot2_f32_bf16 v11, v135, v26, v11
v_dot2_f32_bf16 v12, v160, v26, v12
v_dot2_f32_bf16 v13, v164, v26, v13
v_dot2_f32_bf16 v14, v161, v26, v14
v_dot2_f32_bf16 v15, v165, v26, v15
v_dot2_f32_bf16 v16, v162, v26, v16
v_dot2_f32_bf16 v17, v166, v26, v17
v_dot2_f32_bf16 v18, v163, v26, v18
v_dot2_f32_bf16 v19, v167, v26, v19
v_dot2_f32_bf16 v4, v136, v28, v4
v_dot2_f32_bf16 v5, v140, v28, v5
v_dot2_f32_bf16 v6, v137, v28, v6
v_dot2_f32_bf16 v7, v141, v28, v7
v_dot2_f32_bf16 v8, v138, v28, v8
v_dot2_f32_bf16 v9, v142, v28, v9
v_dot2_f32_bf16 v10, v139, v28, v10
v_dot2_f32_bf16 v11, v143, v28, v11
v_dot2_f32_bf16 v12, v168, v28, v12
v_dot2_f32_bf16 v13, v172, v28, v13
v_dot2_f32_bf16 v14, v169, v28, v14
v_dot2_f32_bf16 v15, v173, v28, v15
v_dot2_f32_bf16 v16, v170, v28, v16
v_dot2_f32_bf16 v17, v174, v28, v17
v_dot2_f32_bf16 v18, v171, v28, v18
v_dot2_f32_bf16 v19, v175, v28, v19
v_dot2_f32_bf16 v4, v144, v30, v4
v_dot2_f32_bf16 v5, v148, v30, v5
v_dot2_f32_bf16 v6, v145, v30, v6
v_dot2_f32_bf16 v7, v149, v30, v7
v_dot2_f32_bf16 v8, v146, v30, v8
v_dot2_f32_bf16 v9, v150, v30, v9
v_dot2_f32_bf16 v10, v147, v30, v10
v_dot2_f32_bf16 v11, v151, v30, v11
v_dot2_f32_bf16 v12, v176, v30, v12
v_dot2_f32_bf16 v13, v180, v30, v13
v_dot2_f32_bf16 v14, v177, v30, v14
v_dot2_f32_bf16 v15, v181, v30, v15
v_dot2_f32_bf16 v16, v178, v30, v16
v_dot2_f32_bf16 v17, v182, v30, v17
v_dot2_f32_bf16 v18, v179, v30, v18
v_dot2_f32_bf16 v19, v183, v30, v19
v_permlane32_swap_b32 v4, v12
v_permlane32_swap_b32 v5, v13
v_permlane32_swap_b32 v6, v14
v_permlane32_swap_b32 v7, v15
v_permlane32_swap_b32 v8, v16
v_permlane32_swap_b32 v9, v17
v_permlane32_swap_b32 v10, v18
v_permlane32_swap_b32 v11, v19
v_add_f32 v4, v4, v12
v_add_f32 v5, v5, v13
v_add_f32 v6, v6, v14
v_add_f32 v7, v7, v15
v_add_f32 v8, v8, v16
v_add_f32 v9, v9, v17
v_add_f32 v10, v10, v18
v_add_f32 v11, v11, v19
v_permlane16_swap_b32 v4, v8
v_permlane16_swap_b32 v5, v9
v_permlane16_swap_b32 v6, v10
v_permlane16_swap_b32 v7, v11
v_add_f32 v4, v4, v8
v_add_f32 v5, v5, v9
v_add_f32 v6, v6, v10
v_add_f32 v7, v7, v11
v_add_f32_dpp v4, v4, v4 row_ror:8 row_mask:0xf bank_mask:0x3
v_add_f32_dpp v4, v6, v6 row_ror:8 row_mask:0xf bank_mask:0xc
v_add_f32_dpp v5, v5, v5 row_ror:8 row_mask:0xf bank_mask:0x3
v_add_f32_dpp v5, v7, v7 row_ror:8 row_mask:0xf bank_mask:0xc
s_waitcnt lgkmcnt(0)
v_lshlrev_b32 v12, 3, v3
s_lshl_b32 s56, s48, 9
v_add_u32 v13, s56, v12
ds_write_b64 v13, v[4:5] offset:4096
s_waitcnt lgkmcnt(0)
s_barrier
ds_read_b64 v[14:15], v12 offset:4096
ds_read_b64 v[16:17], v12 offset:4608
ds_read_b64 v[18:19], v12 offset:5120
ds_read_b64 v[20:21], v12 offset:5632
ds_read_b64 v[22:23], v12 offset:6144
ds_read_b64 v[24:25], v12 offset:6656
ds_read_b64 v[26:27], v12 offset:7168
ds_read_b64 v[28:29], v12 offset:7680
s_waitcnt lgkmcnt(0)
v_add_f32 v4, v14, v16
v_add_f32 v5, v15, v17
v_add_f32 v4, v4, v18
v_add_f32 v5, v5, v19
v_add_f32 v4, v4, v20
v_add_f32 v5, v5, v21
v_add_f32 v4, v4, v22
v_add_f32 v5, v5, v23
v_add_f32 v4, v4, v24
v_add_f32 v5, v5, v25
v_add_f32 v4, v4, v26
v_add_f32 v5, v5, v27
v_add_f32 v4, v4, v28
v_add_f32 v5, v5, v29
v_cvt_pk_bf16_f32 v4, v4, v4
v_cvt_pk_bf16_f32 v5, v5, v5
v_and_b32 v4, s62, v4
v_and_b32 v5, s62, v5
v_mov_b32 v6, v4
v_mov_b32 v7, v5
s_nop 0
v_permlane32_swap_b32 v4, v6
v_permlane32_swap_b32 v5, v7
v_mul_f32 v4, v4, v6
v_mul_f32 v5, v5, v7
v_cvt_pk_bf16_f32 v4, v4, v5
s_add_u32 s56, s48, 0
v_readlane_b32 s64, v4, s56
s_add_u32 s56, s48, 8
v_readlane_b32 s65, v4, s56
s_add_u32 s56, s48, 16
v_readlane_b32 s66, v4, s56
s_add_u32 s56, s48, 24
v_readlane_b32 s67, v4, s56
s_cmp_eq_u32 s48, 7
s_cselect_b32 s64, 0, s64
s_cselect_b32 s65, 0, s65
s_cselect_b32 s66, 0, s66
s_cselect_b32 s67, 0, s67
ds_read_b128 v[4:7], v2 offset:26624
ds_read_b128 v[8:11], v2 offset:27648
ds_read_b128 v[20:23], v2 offset:28672
ds_read_b128 v[24:27], v2 offset:29696
v_dot2_f32_bf16 v12, v32, s64, 0
v_dot2_f32_bf16 v13, v36, s64, 0
v_dot2_f32_bf16 v14, v33, s64, 0
v_dot2_f32_bf16 v15, v37, s64, 0
v_dot2_f32_bf16 v16, v34, s64, 0
v_dot2_f32_bf16 v17, v38, s64, 0
v_dot2_f32_bf16 v18, v35, s64, 0
v_dot2_f32_bf16 v19, v39, s64, 0
v_dot2_f32_bf16 v12, v40, s65, v12
v_dot2_f32_bf16 v13, v44, s65, v13
v_dot2_f32_bf16 v14, v41, s65, v14
v_dot2_f32_bf16 v15, v45, s65, v15
v_dot2_f32_bf16 v16, v42, s65, v16
v_dot2_f32_bf16 v17, v46, s65, v17
v_dot2_f32_bf16 v18, v43, s65, v18
v_dot2_f32_bf16 v19, v47, s65, v19
s_waitcnt lgkmcnt(0)
v_dot2_f32_bf16 v12, v4, s66, v12
v_dot2_f32_bf16 v13, v8, s66, v13
v_dot2_f32_bf16 v14, v5, s66, v14
v_dot2_f32_bf16 v15, v9, s66, v15
v_dot2_f32_bf16 v16, v6, s66, v16
v_dot2_f32_bf16 v17, v10, s66, v17
v_dot2_f32_bf16 v18, v7, s66, v18
v_dot2_f32_bf16 v19, v11, s66, v19
v_dot2_f32_bf16 v12, v20, s67, v12
v_dot2_f32_bf16 v13, v24, s67, v13
v_dot2_f32_bf16 v14, v21, s67, v14
v_dot2_f32_bf16 v15, v25, s67, v15
v_dot2_f32_bf16 v16, v22, s67, v16
v_dot2_f32_bf16 v17, v26, s67, v17
v_dot2_f32_bf16 v18, v23, s67, v18
v_dot2_f32_bf16 v19, v27, s67, v19
v_lshlrev_b32 v32, 5, v3
s_mul_i32 s56, s48, 1792
s_add_u32 s56, s56, 8192
v_add_u32 v32, s56, v32
s_mov_b32 exec_hi, 0x00ffffff
ds_write_b128 v32, v[12:15]
ds_write_b128 v32, v[16:19] offset:16
s_mov_b32 exec_hi, -1
s_waitcnt lgkmcnt(0)
s_barrier
s_mul_i32 s56, s48, 224
v_lshlrev_b32 v33, 2, v3
v_add_u32 v33, s56, v33
v_add_u32 v32, 8192, v33
ds_read_b32 v34, v32 offset:0
ds_read_b32 v35, v32 offset:1792
ds_read_b32 v36, v32 offset:3584
ds_read_b32 v37, v32 offset:5376
ds_read_b32 v38, v32 offset:7168
ds_read_b32 v39, v32 offset:8960
ds_read_b32 v40, v32 offset:10752
ds_read_b32 v41, v32 offset:12544
s_waitcnt lgkmcnt(0)
v_add_f32 v34, v34, v35
v_add_f32 v34, v34, v36
v_add_f32 v34, v34, v37
v_add_f32 v34, v34, v38
v_add_f32 v34, v34, v39
v_add_f32 v34, v34, v40
v_add_f32 v34, v34, v41
v_or_b32 v34, 1, v34
s_mul_i32 s56, s2, 1792
s_add_u32 s56, s56, 0x39c000
s_mov_b32 exec_hi, 0x00ffffff
buffer_store_dword v34, v33, s[44:47], s56 offen sc1
s_mov_b32 exec_hi, -1
s_cmp_lg_u32 s2, 0
s_cbranch_scc1 L_nofinal_801
s_cmp_eq_u32 s48, 7
s_cbranch_scc1 L_gx_802
v_lshrrev_b32 v36, 4, v3
v_mul_u32_u24 v36, 1792, v36
v_and_b32 v37, 15, v3
v_lshl_add_u32 v36, v37, 4, v36
s_lshl_b32 s56, s48, 8
s_add_u32 s56, s56, 0x39c000
s_mov_b32 s60, 0
L_p_gx_803:
s_nop 4
s_add_u32 s57, s56, 0
buffer_load_dwordx4 v[4:7], v36, s[44:47], s57 offen sc1
s_add_u32 s57, s56, 7168
buffer_load_dwordx4 v[8:11], v36, s[44:47], s57 offen sc1
s_add_u32 s57, s56, 14336
buffer_load_dwordx4 v[12:15], v36, s[44:47], s57 offen sc1
s_add_u32 s57, s56, 21504
buffer_load_dwordx4 v[16:19], v36, s[44:47], s57 offen sc1
s_add_u32 s57, s56, 28672
buffer_load_dwordx4 v[20:23], v36, s[44:47], s57 offen sc1
s_add_u32 s57, s56, 35840
buffer_load_dwordx4 v[24:27], v36, s[44:47], s57 offen sc1
s_add_u32 s57, s56, 43008
buffer_load_dwordx4 v[28:31], v36, s[44:47], s57 offen sc1
s_add_u32 s57, s56, 50176
buffer_load_dwordx4 v[32:35], v36, s[44:47], s57 offen sc1
s_waitcnt vmcnt(0)
v_and_b32 v37, v4, v5
v_and_b32 v37, v37, v6
v_and_b32 v37, v37, v7
v_and_b32 v37, v37, v8
v_and_b32 v37, v37, v9
v_and_b32 v37, v37, v10
v_and_b32 v37, v37, v11
v_and_b32 v37, v37, v12
v_and_b32 v37, v37, v13
v_and_b32 v37, v37, v14
v_and_b32 v37, v37, v15
v_and_b32 v37, v37, v16
v_and_b32 v37, v37, v17
v_and_b32 v37, v37, v18
v_and_b32 v37, v37, v19
v_and_b32 v37, v37, v20
v_and_b32 v37, v37, v21
v_and_b32 v37, v37, v22
v_and_b32 v37, v37, v23
v_and_b32 v37, v37, v24
v_and_b32 v37, v37, v25
v_and_b32 v37, v37, v26
v_and_b32 v37, v37, v27
v_and_b32 v37, v37, v28
v_and_b32 v37, v37, v29
v_and_b32 v37, v37, v30
v_and_b32 v37, v37, v31
v_and_b32 v37, v37, v32
v_and_b32 v37, v37, v33
v_and_b32 v37, v37, v34
v_and_b32 v37, v37, v35
v_and_b32 v37, 1, v37
v_cmp_ne_u32 vcc, 1, v37
s_cbranch_vccz L_d_gx_804
s_sleep 1
s_add_u32 s60, s60, 1
s_cmp_lt_u32 s60, 400000
s_cbranch_scc1 L_p_gx_803
s_endpgm
L_d_gx_804:
s_nop 4
v_add_f32 v4, v4, v8
v_add_f32 v5, v5, v9
v_add_f32 v6, v6, v10
v_add_f32 v7, v7, v11
v_add_f32 v4, v4, v12
v_add_f32 v5, v5, v13
v_add_f32 v6, v6, v14
v_add_f32 v7, v7, v15
v_add_f32 v4, v4, v16
v_add_f32 v5, v5, v17
v_add_f32 v6, v6, v18
v_add_f32 v7, v7, v19
v_add_f32 v4, v4, v20
v_add_f32 v5, v5, v21
v_add_f32 v6, v6, v22
v_add_f32 v7, v7, v23
v_add_f32 v4, v4, v24
v_add_f32 v5, v5, v25
v_add_f32 v6, v6, v26
v_add_f32 v7, v7, v27
v_add_f32 v4, v4, v28
v_add_f32 v5, v5, v29
v_add_f32 v6, v6, v30
v_add_f32 v7, v7, v31
v_add_f32 v4, v4, v32
v_add_f32 v5, v5, v33
v_add_f32 v6, v6, v34
v_add_f32 v7, v7, v35
v_mov_b32 v38, v4
v_mov_b32 v39, v5
v_mov_b32 v40, v6
v_mov_b32 v41, v7
v_permlane16_swap_b32 v4, v38
v_permlane16_swap_b32 v5, v39
v_permlane16_swap_b32 v6, v40
v_permlane16_swap_b32 v7, v41
v_add_f32 v4, v4, v38
v_add_f32 v5, v5, v39
v_add_f32 v6, v6, v40
v_add_f32 v7, v7, v41
v_mov_b32 v38, v4
v_mov_b32 v39, v5
v_mov_b32 v40, v6
v_mov_b32 v41, v7
v_permlane32_swap_b32 v4, v38
v_permlane32_swap_b32 v5, v39
v_permlane32_swap_b32 v6, v40
v_permlane32_swap_b32 v7, v41
v_add_f32 v4, v4, v38
v_add_f32 v5, v5, v39
v_add_f32 v6, v6, v40
v_add_f32 v7, v7, v41
v_cvt_pk_bf16_f32 v4, v4, v4
v_cvt_pk_bf16_f32 v5, v5, v5
v_cvt_pk_bf16_f32 v6, v6, v6
v_cvt_pk_bf16_f32 v7, v7, v7
v_and_b32 v4, s62, v4
v_and_b32 v5, s62, v5
v_and_b32 v6, s62, v6
v_and_b32 v7, s62, v7
v_add_f32 v240, v240, v4
v_add_f32 v241, v241, v5
v_add_f32 v242, v242, v6
v_add_f32 v243, v243, v7
v_cvt_pk_bf16_f32 v240, v240, v240
v_cvt_pk_bf16_f32 v241, v241, v241
v_cvt_pk_bf16_f32 v242, v242, v242
v_cvt_pk_bf16_f32 v243, v243, v243
v_and_b32 v240, s62, v240
v_and_b32 v241, s62, v241
v_and_b32 v242, s62, v242
v_and_b32 v243, s62, v243
v_cvt_pk_bf16_f32 v4, v240, v241
v_cvt_pk_bf16_f32 v5, v242, v243
v_lshlrev_b32 v36, 3, v3
s_lshl_b32 s56, s48, 7
s_add_u32 s56, s56, 0
s_mov_b64 exec, 0xffff
buffer_store_dwordx2 v[4:5], v36, s[36:39], s56 offen
s_mov_b64 exec, -1
L_gx_802:
s_nop 4
L_nofinal_801:
s_nop 4
s_barrier
v_lshrrev_b32 v10, 2, v3
v_min_u32 v10, 13, v10
v_mul_u32_u24 v11, 1088, v10
v_and_b32 v10, 3, v3
v_lshl_add_u32 v10, v10, 4, v11
s_mul_i32 s56, s49, 15232
s_add_u32 s56, s56, 0x1b2800
s_lshl_b32 s57, s50, 9
s_lshl_b32 s58, s48, 6
s_add_u32 s57, s57, s58
s_add_u32 s57, s57, s56
s_mov_b32 s60, 0
L_p_pa_814:
s_nop 4
buffer_load_dwordx4 v[4:7], v10, s[44:47], s57 offen sc1
buffer_load_dwordx2 v[8:9], v11, s[44:47], s56 offen offset:1024 sc1
s_waitcnt vmcnt(0)
v_and_b32 v12, v4, v5
v_and_b32 v12, v12, v6
v_and_b32 v12, v12, v7
v_and_b32 v12, v12, v8
v_and_b32 v12, v12, v9
v_and_b32 v12, 1, v12
v_cmp_ne_u32 vcc, 1, v12
s_cbranch_vccz L_d_pa_815
s_sleep 1
s_add_u32 s60, s60, 1
s_cmp_lt_u32 s60, 400000
s_cbranch_scc1 L_p_pa_814
s_endpgm
L_d_pa_815:
s_nop 4
v_mov_b32 v15, v8
s_nop 1
v_max_f32_dpp v15, v15, v15 row_ror:4
s_nop 1
v_max_f32_dpp v15, v15, v15 row_ror:8
v_mov_b32 v13, v15
s_nop 1
v_permlane16_swap_b32 v15, v13
v_max_f32 v15, v15, v13
v_mov_b32 v13, v15
s_nop 1
v_permlane32_swap_b32 v15, v13
v_max_f32 v15, v15, v13
v_sub_f32 v8, v8, v15
v_mul_f32 v8, 0x3fb8aa3b, v8
v_exp_f32 v8, v8
v_cmp_gt_u32 vcc, 56, v3
s_nop 1
v_cndmask_b32 v8, 0, v8, vcc
v_mul_f32 v4, v8, v4
v_mul_f32 v5, v8, v5
v_mul_f32 v6, v8, v6
v_mul_f32 v7, v8, v7
v_mul_f32 v9, v8, v9
v_add_f32_dpp v4, v4, v4 row_ror:4
v_add_f32_dpp v5, v5, v5 row_ror:4
v_add_f32_dpp v6, v6, v6 row_ror:4
v_add_f32_dpp v7, v7, v7 row_ror:4
v_add_f32_dpp v9, v9, v9 row_ror:4
v_add_f32_dpp v4, v4, v4 row_ror:8
v_add_f32_dpp v5, v5, v5 row_ror:8
v_add_f32_dpp v6, v6, v6 row_ror:8
v_add_f32_dpp v7, v7, v7 row_ror:8
v_add_f32_dpp v9, v9, v9 row_ror:8
v_mov_b32 v16, v4
v_mov_b32 v17, v5
v_mov_b32 v18, v6
v_mov_b32 v19, v7
v_mov_b32 v20, v9
v_permlane16_swap_b32 v4, v16
v_permlane16_swap_b32 v5, v17
v_permlane16_swap_b32 v6, v18
v_permlane16_swap_b32 v7, v19
v_permlane16_swap_b32 v9, v20
v_add_f32 v4, v4, v16
v_add_f32 v5, v5, v17
v_add_f32 v6, v6, v18
v_add_f32 v7, v7, v19
v_add_f32 v9, v9, v20
v_mov_b32 v16, v4
v_mov_b32 v17, v5
v_mov_b32 v18, v6
v_mov_b32 v19, v7
v_mov_b32 v20, v9
v_permlane32_swap_b32 v4, v16
v_permlane32_swap_b32 v5, v17
v_permlane32_swap_b32 v6, v18
v_permlane32_swap_b32 v7, v19
v_permlane32_swap_b32 v9, v20
v_add_f32 v4, v4, v16
v_add_f32 v5, v5, v17
v_add_f32 v6, v6, v18
v_add_f32 v7, v7, v19
v_add_f32 v9, v9, v20
v_rcp_f32 v13, v9
s_nop 0
v_mul_f32 v16, v4, v13
v_mul_f32 v17, v5, v13
v_mul_f32 v18, v6, v13
v_mul_f32 v19, v7, v13
v_fma_f32 v4, -v16, v9, v4
v_fma_f32 v5, -v17, v9, v5
v_fma_f32 v6, -v18, v9, v6
v_fma_f32 v7, -v19, v9, v7
v_fma_f32 v4, v4, v13, v16
v_fma_f32 v5, v5, v13, v17
v_fma_f32 v6, v6, v13, v18
v_fma_f32 v7, v7, v13, v19
v_cvt_pk_bf16_f32 v4, v4, v5
v_cvt_pk_bf16_f32 v6, v6, v7
v_readlane_b32 s64, v4, 0
v_readlane_b32 s65, v6, 0
v_readlane_b32 s66, v4, 1
v_readlane_b32 s67, v6, 1
v_readlane_b32 s68, v4, 2
v_readlane_b32 s69, v6, 2
v_readlane_b32 s70, v4, 3
v_readlane_b32 s71, v6, 3
v_dot2_f32_bf16 v24, v56, s64, 0
v_dot2_f32_bf16 v25, v60, s64, 0
v_dot2_f32_bf16 v26, v57, s64, 0
v_dot2_f32_bf16 v27, v61, s64, 0
v_dot2_f32_bf16 v28, v58, s64, 0
v_dot2_f32_bf16 v29, v62, s64, 0
v_dot2_f32_bf16 v30, v59, s64, 0
v_dot2_f32_bf16 v31, v63, s64, 0
v_dot2_f32_bf16 v24, v64, s65, v24
v_dot2_f32_bf16 v25, v68, s65, v25
v_dot2_f32_bf16 v26, v65, s65, v26
v_dot2_f32_bf16 v27, v69, s65, v27
v_dot2_f32_bf16 v28, v66, s65, v28
v_dot2_f32_bf16 v29, v70, s65, v29
v_dot2_f32_bf16 v30, v67, s65, v30
v_dot2_f32_bf16 v31, v71, s65, v31
v_dot2_f32_bf16 v24, v72, s66, v24
v_dot2_f32_bf16 v25, v76, s66, v25
v_dot2_f32_bf16 v26, v73, s66, v26
v_dot2_f32_bf16 v27, v77, s66, v27
v_dot2_f32_bf16 v28, v74, s66, v28
v_dot2_f32_bf16 v29, v78, s66, v29
v_dot2_f32_bf16 v30, v75, s66, v30
v_dot2_f32_bf16 v31, v79, s66, v31
v_dot2_f32_bf16 v24, v80, s67, v24
v_dot2_f32_bf16 v25, v84, s67, v25
v_dot2_f32_bf16 v26, v81, s67, v26
v_dot2_f32_bf16 v27, v85, s67, v27
v_dot2_f32_bf16 v28, v82, s67, v28
v_dot2_f32_bf16 v29, v86, s67, v29
v_dot2_f32_bf16 v30, v83, s67, v30
v_dot2_f32_bf16 v31, v87, s67, v31
v_dot2_f32_bf16 v24, v88, s68, v24
v_dot2_f32_bf16 v25, v92, s68, v25
v_dot2_f32_bf16 v26, v89, s68, v26
v_dot2_f32_bf16 v27, v93, s68, v27
v_dot2_f32_bf16 v28, v90, s68, v28
v_dot2_f32_bf16 v29, v94, s68, v29
v_dot2_f32_bf16 v30, v91, s68, v30
v_dot2_f32_bf16 v31, v95, s68, v31
v_dot2_f32_bf16 v24, v96, s69, v24
v_dot2_f32_bf16 v25, v100, s69, v25
v_dot2_f32_bf16 v26, v97, s69, v26
v_dot2_f32_bf16 v27, v101, s69, v27
v_dot2_f32_bf16 v28, v98, s69, v28
v_dot2_f32_bf16 v29, v102, s69, v29
v_dot2_f32_bf16 v30, v99, s69, v30
v_dot2_f32_bf16 v31, v103, s69, v31
v_dot2_f32_bf16 v24, v104, s70, v24
v_dot2_f32_bf16 v25, v108, s70, v25
v_dot2_f32_bf16 v26, v105, s70, v26
v_dot2_f32_bf16 v27, v109, s70, v27
v_dot2_f32_bf16 v28, v106, s70, v28
v_dot2_f32_bf16 v29, v110, s70, v29
v_dot2_f32_bf16 v30, v107, s70, v30
v_dot2_f32_bf16 v31, v111, s70, v31
v_dot2_f32_bf16 v24, v112, s71, v24
v_dot2_f32_bf16 v25, v116, s71, v25
v_dot2_f32_bf16 v26, v113, s71, v26
v_dot2_f32_bf16 v27, v117, s71, v27
v_dot2_f32_bf16 v28, v114, s71, v28
v_dot2_f32_bf16 v29, v118, s71, v29
v_dot2_f32_bf16 v30, v115, s71, v30
v_dot2_f32_bf16 v31, v119, s71, v31
v_lshlrev_b32 v32, 5, v3
s_mul_i32 s56, s48, 1792
s_add_u32 s56, s56, 8192
v_add_u32 v32, s56, v32
s_mov_b32 exec_hi, 0x00ffffff
ds_write_b128 v32, v[24:27]
ds_write_b128 v32, v[28:31] offset:16
s_mov_b32 exec_hi, -1
s_waitcnt lgkmcnt(0)
s_barrier
s_mul_i32 s56, s48, 224
v_lshlrev_b32 v33, 2, v3
v_add_u32 v33, s56, v33
v_add_u32 v32, 8192, v33
ds_read_b32 v34, v32 offset:0
ds_read_b32 v35, v32 offset:1792
ds_read_b32 v36, v32 offset:3584
ds_read_b32 v37, v32 offset:5376
ds_read_b32 v38, v32 offset:7168
ds_read_b32 v39, v32 offset:8960
ds_read_b32 v40, v32 offset:10752
ds_read_b32 v41, v32 offset:12544
s_waitcnt lgkmcnt(0)
v_add_f32 v34, v34, v35
v_add_f32 v34, v34, v36
v_add_f32 v34, v34, v37
v_add_f32 v34, v34, v38
v_add_f32 v34, v34, v39
v_add_f32 v34, v34, v40
v_add_f32 v34, v34, v41
v_or_b32 v34, 1, v34
s_mul_i32 s56, s2, 1792
s_add_u32 s56, s56, 0x32a000
s_mov_b32 exec_hi, 0x00ffffff
buffer_store_dword v34, v33, s[44:47], s56 offen sc1
s_mov_b32 exec_hi, -1
s_cmp_eq_u32 s48, 7
s_cbranch_scc1 L_gx_829
v_lshrrev_b32 v36, 4, v3
v_mul_u32_u24 v36, 1792, v36
v_and_b32 v37, 15, v3
v_lshl_add_u32 v36, v37, 4, v36
s_lshl_b32 s56, s48, 8
s_add_u32 s56, s56, 0x32a000
s_mov_b32 s60, 0
L_p_gx_830:
s_nop 4
s_add_u32 s57, s56, 0
buffer_load_dwordx4 v[4:7], v36, s[44:47], s57 offen sc1
s_add_u32 s57, s56, 7168
buffer_load_dwordx4 v[8:11], v36, s[44:47], s57 offen sc1
s_add_u32 s57, s56, 14336
buffer_load_dwordx4 v[12:15], v36, s[44:47], s57 offen sc1
s_add_u32 s57, s56, 21504
buffer_load_dwordx4 v[16:19], v36, s[44:47], s57 offen sc1
s_add_u32 s57, s56, 28672
buffer_load_dwordx4 v[20:23], v36, s[44:47], s57 offen sc1
s_add_u32 s57, s56, 35840
buffer_load_dwordx4 v[24:27], v36, s[44:47], s57 offen sc1
s_add_u32 s57, s56, 43008
buffer_load_dwordx4 v[28:31], v36, s[44:47], s57 offen sc1
s_add_u32 s57, s56, 50176
buffer_load_dwordx4 v[32:35], v36, s[44:47], s57 offen sc1
s_waitcnt vmcnt(0)
v_and_b32 v37, v4, v5
v_and_b32 v37, v37, v6
v_and_b32 v37, v37, v7
v_and_b32 v37, v37, v8
v_and_b32 v37, v37, v9
v_and_b32 v37, v37, v10
v_and_b32 v37, v37, v11
v_and_b32 v37, v37, v12
v_and_b32 v37, v37, v13
v_and_b32 v37, v37, v14
v_and_b32 v37, v37, v15
v_and_b32 v37, v37, v16
v_and_b32 v37, v37, v17
v_and_b32 v37, v37, v18
v_and_b32 v37, v37, v19
v_and_b32 v37, v37, v20
v_and_b32 v37, v37, v21
v_and_b32 v37, v37, v22
v_and_b32 v37, v37, v23
v_and_b32 v37, v37, v24
v_and_b32 v37, v37, v25
v_and_b32 v37, v37, v26
v_and_b32 v37, v37, v27
v_and_b32 v37, v37, v28
v_and_b32 v37, v37, v29
v_and_b32 v37, v37, v30
v_and_b32 v37, v37, v31
v_and_b32 v37, v37, v32
v_and_b32 v37, v37, v33
v_and_b32 v37, v37, v34
v_and_b32 v37, v37, v35
v_and_b32 v37, 1, v37
v_cmp_ne_u32 vcc, 1, v37
s_cbranch_vccz L_d_gx_831
s_sleep 1
s_add_u32 s60, s60, 1
s_cmp_lt_u32 s60, 400000
s_cbranch_scc1 L_p_gx_830
s_endpgm
L_d_gx_831:
s_nop 4
v_add_f32 v4, v4, v8
v_add_f32 v5, v5, v9
v_add_f32 v6, v6, v10
v_add_f32 v7, v7, v11
v_add_f32 v4, v4, v12
v_add_f32 v5, v5, v13
v_add_f32 v6, v6, v14
v_add_f32 v7, v7, v15
v_add_f32 v4, v4, v16
v_add_f32 v5, v5, v17
v_add_f32 v6, v6, v18
v_add_f32 v7, v7, v19
v_add_f32 v4, v4, v20
v_add_f32 v5, v5, v21
v_add_f32 v6, v6, v22
v_add_f32 v7, v7, v23
v_add_f32 v4, v4, v24
v_add_f32 v5, v5, v25
v_add_f32 v6, v6, v26
v_add_f32 v7, v7, v27
v_add_f32 v4, v4, v28
v_add_f32 v5, v5, v29
v_add_f32 v6, v6, v30
v_add_f32 v7, v7, v31
v_add_f32 v4, v4, v32
v_add_f32 v5, v5, v33
v_add_f32 v6, v6, v34
v_add_f32 v7, v7, v35
v_mov_b32 v38, v4
v_mov_b32 v39, v5
v_mov_b32 v40, v6
v_mov_b32 v41, v7
v_permlane16_swap_b32 v4, v38
v_permlane16_swap_b32 v5, v39
v_permlane16_swap_b32 v6, v40
v_permlane16_swap_b32 v7, v41
v_add_f32 v4, v4, v38
v_add_f32 v5, v5, v39
v_add_f32 v6, v6, v40
v_add_f32 v7, v7, v41
v_mov_b32 v38, v4
v_mov_b32 v39, v5
v_mov_b32 v40, v6
v_mov_b32 v41, v7
v_permlane32_swap_b32 v4, v38
v_permlane32_swap_b32 v5, v39
v_permlane32_swap_b32 v6, v40
v_permlane32_swap_b32 v7, v41
v_add_f32 v4, v4, v38
v_add_f32 v5, v5, v39
v_add_f32 v6, v6, v40
v_add_f32 v7, v7, v41
v_cvt_pk_bf16_f32 v4, v4, v4
v_cvt_pk_bf16_f32 v5, v5, v5
v_cvt_pk_bf16_f32 v6, v6, v6
v_cvt_pk_bf16_f32 v7, v7, v7
v_and_b32 v4, s62, v4
v_and_b32 v5, s62, v5
v_and_b32 v6, s62, v6
v_and_b32 v7, s62, v7
v_add_f32 v244, v244, v4
v_add_f32 v245, v245, v5
v_add_f32 v246, v246, v6
v_add_f32 v247, v247, v7
v_cvt_pk_bf16_f32 v244, v244, v244
v_cvt_pk_bf16_f32 v245, v245, v245
v_cvt_pk_bf16_f32 v246, v246, v246
v_cvt_pk_bf16_f32 v247, v247, v247
v_and_b32 v244, s62, v244
v_and_b32 v245, s62, v245
v_and_b32 v246, s62, v246
v_and_b32 v247, s62, v247
v_and_b32 v36, 15, v3
v_lshlrev_b32 v36, 4, v36
s_lshl_b32 s56, s48, 8
s_add_u32 s56, s56, 2048
v_add_u32 v36, s56, v36
v_mov_b32 v4, v244
v_mov_b32 v5, v245
v_mov_b32 v6, v246
v_mov_b32 v7, v247
ds_write_b128 v36, v[4:7]
s_waitcnt lgkmcnt(0)
L_gx_829:
s_nop 4
s_barrier
v_lshlrev_b32 v4, 2, v3
ds_read_b32 v16, v4 offset:2048
ds_read_b32 v17, v4 offset:2304
ds_read_b32 v18, v4 offset:2560
ds_read_b32 v19, v4 offset:2816
ds_read_b32 v20, v4 offset:3072
ds_read_b32 v21, v4 offset:3328
ds_read_b32 v22, v4 offset:3584
v_lshrrev_b32 v5, 3, v3
v_lshlrev_b32 v5, 2, v5
s_mul_i32 s56, s48, 224
v_add_u32 v5, s56, v5
s_waitcnt lgkmcnt(0)
ds_read_b32 v24, v5 offset:2048
ds_read_b32 v25, v5 offset:2080
ds_read_b32 v26, v5 offset:2112
ds_read_b32 v27, v5 offset:2144
ds_read_b32 v28, v5 offset:2176
ds_read_b32 v29, v5 offset:2208
ds_read_b32 v30, v5 offset:2240
v_add_f32 v6, v16, v17
v_add_f32 v6, v6, v18
v_add_f32 v6, v6, v19
v_add_f32 v6, v6, v20
v_add_f32 v6, v6, v21
v_add_f32 v6, v6, v22
s_nop 1
v_add_f32_dpp v6, v6, v6 quad_perm:[1,0,3,2]
s_nop 1
v_add_f32_dpp v6, v6, v6 quad_perm:[2,3,0,1]
s_nop 1
v_add_f32_dpp v6, v6, v6 row_ror:4
s_nop 1
v_add_f32_dpp v6, v6, v6 row_ror:8
v_mov_b32 v7, v6
s_nop 1
v_permlane16_swap_b32 v6, v7
v_add_f32 v6, v6, v7
v_mov_b32 v7, v6
s_nop 1
v_permlane32_swap_b32 v6, v7
v_add_f32 v6, v6, v7
v_mul_f32 v8, 0x3b124925, v6
v_sub_f32 v10, v16, v8
v_sub_f32 v11, v17, v8
v_sub_f32 v12, v18, v8
v_sub_f32 v13, v19, v8
v_sub_f32 v14, v20, v8
v_sub_f32 v15, v21, v8
v_sub_f32 v16, v22, v8
v_mul_f32 v9, v10, v10
v_fmac_f32 v9, v11, v11
v_fmac_f32 v9, v12, v12
v_fmac_f32 v9, v13, v13
v_fmac_f32 v9, v14, v14
v_fmac_f32 v9, v15, v15
v_fmac_f32 v9, v16, v16
s_nop 1
v_add_f32_dpp v9, v9, v9 quad_perm:[1,0,3,2]
s_nop 1
v_add_f32_dpp v9, v9, v9 quad_perm:[2,3,0,1]
s_nop 1
v_add_f32_dpp v9, v9, v9 row_ror:4
s_nop 1
v_add_f32_dpp v9, v9, v9 row_ror:8
v_mov_b32 v7, v9
s_nop 1
v_permlane16_swap_b32 v9, v7
v_add_f32 v9, v9, v7
v_mov_b32 v7, v9
s_nop 1
v_permlane32_swap_b32 v9, v7
v_add_f32 v9, v9, v7
v_mul_f32 v9, 0x3b124925, v9
v_cvt_pk_bf16_f32 v9, v9, v9
v_cvt_pk_bf16_f32 v8, v8, v8
v_and_b32 v9, s62, v9
v_and_b32 v8, s62, v8
v_add_f32 v9, 0x3727c5ac, v9
v_cvt_pk_bf16_f32 v9, v9, v9
v_and_b32 v9, s62, v9
v_sqrt_f32 v9, v9
s_nop 0
v_cvt_pk_bf16_f32 v9, v9, v9
v_and_b32 v9, s62, v9
v_rcp_f32 v6, v9
s_waitcnt lgkmcnt(0)
v_sub_f32 v24, v24, v8
v_sub_f32 v25, v25, v8
v_sub_f32 v26, v26, v8
v_sub_f32 v27, v27, v8
v_sub_f32 v28, v28, v8
v_sub_f32 v29, v29, v8
v_sub_f32 v30, v30, v8
v_cvt_pk_bf16_f32 v24, v24, v24
v_cvt_pk_bf16_f32 v25, v25, v25
v_cvt_pk_bf16_f32 v26, v26, v26
v_cvt_pk_bf16_f32 v27, v27, v27
v_cvt_pk_bf16_f32 v28, v28, v28
v_cvt_pk_bf16_f32 v29, v29, v29
v_cvt_pk_bf16_f32 v30, v30, v30
v_and_b32 v24, s62, v24
v_and_b32 v25, s62, v25
v_and_b32 v26, s62, v26
v_and_b32 v27, s62, v27
v_and_b32 v28, s62, v28
v_and_b32 v29, s62, v29
v_and_b32 v30, s62, v30
v_mul_f32 v38, v24, v6
v_mul_f32 v39, v25, v6
v_mul_f32 v40, v26, v6
v_mul_f32 v41, v27, v6
v_mul_f32 v42, v28, v6
v_mul_f32 v43, v29, v6
v_mul_f32 v44, v30, v6
v_fma_f32 v24, -v38, v9, v24
v_fma_f32 v25, -v39, v9, v25
v_fma_f32 v26, -v40, v9, v26
v_fma_f32 v27, -v41, v9, v27
v_fma_f32 v28, -v42, v9, v28
v_fma_f32 v29, -v43, v9, v29
v_fma_f32 v30, -v44, v9, v30
v_fma_f32 v24, v24, v6, v38
v_fma_f32 v25, v25, v6, v39
v_fma_f32 v26, v26, v6, v40
v_fma_f32 v27, v27, v6, v41
v_fma_f32 v28, v28, v6, v42
v_fma_f32 v29, v29, v6, v43
v_fma_f32 v30, v30, v6, v44
v_cvt_pk_bf16_f32 v24, v24, v24
v_cvt_pk_bf16_f32 v25, v25, v25
v_cvt_pk_bf16_f32 v26, v26, v26
v_cvt_pk_bf16_f32 v27, v27, v27
v_cvt_pk_bf16_f32 v28, v28, v28
v_cvt_pk_bf16_f32 v29, v29, v29
v_cvt_pk_bf16_f32 v30, v30, v30
v_and_b32 v24, s62, v24
v_and_b32 v25, s62, v25
v_and_b32 v26, s62, v26
v_and_b32 v27, s62, v27
v_and_b32 v28, s62, v28
v_and_b32 v29, s62, v29
v_and_b32 v30, s62, v30
ds_read_b128 v[32:35], v2 offset:22528
ds_read_b128 v[36:39], v2 offset:23552
ds_read_b128 v[40:43], v2 offset:24576
ds_read_b128 v[44:47], v2 offset:25600
v_cvt_pk_bf16_f32 v24, v24, v25
v_cvt_pk_bf16_f32 v26, v26, v27
v_cvt_pk_bf16_f32 v28, v28, v29
v_cvt_pk_bf16_f32 v30, v30, 0
v_dot2_f32_bf16 v4, v120, v24, 0
v_dot2_f32_bf16 v5, v124, v24, 0
v_dot2_f32_bf16 v6, v121, v24, 0
v_dot2_f32_bf16 v7, v125, v24, 0
v_dot2_f32_bf16 v8, v122, v24, 0
v_dot2_f32_bf16 v9, v126, v24, 0
v_dot2_f32_bf16 v10, v123, v24, 0
v_dot2_f32_bf16 v11, v127, v24, 0
v_dot2_f32_bf16 v12, v152, v24, 0
v_dot2_f32_bf16 v13, v156, v24, 0
v_dot2_f32_bf16 v14, v153, v24, 0
v_dot2_f32_bf16 v15, v157, v24, 0
v_dot2_f32_bf16 v16, v154, v24, 0
v_dot2_f32_bf16 v17, v158, v24, 0
v_dot2_f32_bf16 v18, v155, v24, 0
v_dot2_f32_bf16 v19, v159, v24, 0
v_dot2_f32_bf16 v4, v128, v26, v4
v_dot2_f32_bf16 v5, v132, v26, v5
v_dot2_f32_bf16 v6, v129, v26, v6
v_dot2_f32_bf16 v7, v133, v26, v7
v_dot2_f32_bf16 v8, v130, v26, v8
v_dot2_f32_bf16 v9, v134, v26, v9
v_dot2_f32_bf16 v10, v131, v26, v10
v_dot2_f32_bf16 v11, v135, v26, v11
v_dot2_f32_bf16 v12, v160, v26, v12
v_dot2_f32_bf16 v13, v164, v26, v13
v_dot2_f32_bf16 v14, v161, v26, v14
v_dot2_f32_bf16 v15, v165, v26, v15
v_dot2_f32_bf16 v16, v162, v26, v16
v_dot2_f32_bf16 v17, v166, v26, v17
v_dot2_f32_bf16 v18, v163, v26, v18
v_dot2_f32_bf16 v19, v167, v26, v19
v_dot2_f32_bf16 v4, v136, v28, v4
v_dot2_f32_bf16 v5, v140, v28, v5
v_dot2_f32_bf16 v6, v137, v28, v6
v_dot2_f32_bf16 v7, v141, v28, v7
v_dot2_f32_bf16 v8, v138, v28, v8
v_dot2_f32_bf16 v9, v142, v28, v9
v_dot2_f32_bf16 v10, v139, v28, v10
v_dot2_f32_bf16 v11, v143, v28, v11
v_dot2_f32_bf16 v12, v168, v28, v12
v_dot2_f32_bf16 v13, v172, v28, v13
v_dot2_f32_bf16 v14, v169, v28, v14
v_dot2_f32_bf16 v15, v173, v28, v15
v_dot2_f32_bf16 v16, v170, v28, v16
v_dot2_f32_bf16 v17, v174, v28, v17
v_dot2_f32_bf16 v18, v171, v28, v18
v_dot2_f32_bf16 v19, v175, v28, v19
v_dot2_f32_bf16 v4, v144, v30, v4
v_dot2_f32_bf16 v5, v148, v30, v5
v_dot2_f32_bf16 v6, v145, v30, v6
v_dot2_f32_bf16 v7, v149, v30, v7
v_dot2_f32_bf16 v8, v146, v30, v8
v_dot2_f32_bf16 v9, v150, v30, v9
v_dot2_f32_bf16 v10, v147, v30, v10
v_dot2_f32_bf16 v11, v151, v30, v11
v_dot2_f32_bf16 v12, v176, v30, v12
v_dot2_f32_bf16 v13, v180, v30, v13
v_dot2_f32_bf16 v14, v177, v30, v14
v_dot2_f32_bf16 v15, v181, v30, v15
v_dot2_f32_bf16 v16, v178, v30, v16
v_dot2_f32_bf16 v17, v182, v30, v17
v_dot2_f32_bf16 v18, v179, v30, v18
v_dot2_f32_bf16 v19, v183, v30, v19
v_permlane32_swap_b32 v4, v12
v_permlane32_swap_b32 v5, v13
v_permlane32_swap_b32 v6, v14
v_permlane32_swap_b32 v7, v15
v_permlane32_swap_b32 v8, v16
v_permlane32_swap_b32 v9, v17
v_permlane32_swap_b32 v10, v18
v_permlane32_swap_b32 v11, v19
v_add_f32 v4, v4, v12
v_add_f32 v5, v5, v13
v_add_f32 v6, v6, v14
v_add_f32 v7, v7, v15
v_add_f32 v8, v8, v16
v_add_f32 v9, v9, v17
v_add_f32 v10, v10, v18
v_add_f32 v11, v11, v19
v_permlane16_swap_b32 v4, v8
v_permlane16_swap_b32 v5, v9
v_permlane16_swap_b32 v6, v10
v_permlane16_swap_b32 v7, v11
v_add_f32 v4, v4, v8
v_add_f32 v5, v5, v9
v_add_f32 v6, v6, v10
v_add_f32 v7, v7, v11
v_add_f32_dpp v4, v4, v4 row_ror:8 row_mask:0xf bank_mask:0x3
v_add_f32_dpp v4, v6, v6 row_ror:8 row_mask:0xf bank_mask:0xc
v_add_f32_dpp v5, v5, v5 row_ror:8 row_mask:0xf bank_mask:0x3
v_add_f32_dpp v5, v7, v7 row_ror:8 row_mask:0xf bank_mask:0xc
s_waitcnt lgkmcnt(0)
v_lshlrev_b32 v12, 3, v3
s_lshl_b32 s56, s48, 9
v_add_u32 v13, s56, v12
ds_write_b64 v13, v[4:5] offset:4096
s_waitcnt lgkmcnt(0)
s_barrier
ds_read_b64 v[14:15], v12 offset:4096
ds_read_b64 v[16:17], v12 offset:4608
ds_read_b64 v[18:19], v12 offset:5120
ds_read_b64 v[20:21], v12 offset:5632
ds_read_b64 v[22:23], v12 offset:6144
ds_read_b64 v[24:25], v12 offset:6656
ds_read_b64 v[26:27], v12 offset:7168
ds_read_b64 v[28:29], v12 offset:7680
s_waitcnt lgkmcnt(0)
v_add_f32 v4, v14, v16
v_add_f32 v5, v15, v17
v_add_f32 v4, v4, v18
v_add_f32 v5, v5, v19
v_add_f32 v4, v4, v20
v_add_f32 v5, v5, v21
v_add_f32 v4, v4, v22
v_add_f32 v5, v5, v23
v_add_f32 v4, v4, v24
v_add_f32 v5, v5, v25
v_add_f32 v4, v4, v26
v_add_f32 v5, v5, v27
v_add_f32 v4, v4, v28
v_add_f32 v5, v5, v29
v_cvt_pk_bf16_f32 v4, v4, v4
v_cvt_pk_bf16_f32 v5, v5, v5
v_and_b32 v4, s62, v4
v_and_b32 v5, s62, v5
v_mov_b32 v6, v4
v_mov_b32 v7, v5
s_nop 0
v_permlane32_swap_b32 v4, v6
v_permlane32_swap_b32 v5, v7
v_mul_f32 v4, v4, v6
v_mul_f32 v5, v5, v7
v_cvt_pk_bf16_f32 v4, v4, v5
s_add_u32 s56, s48, 0
v_readlane_b32 s64, v4, s56
s_add_u32 s56, s48, 8
v_readlane_b32 s65, v4, s56
s_add_u32 s56, s48, 16
v_readlane_b32 s66, v4, s56
s_add_u32 s56, s48, 24
v_readlane_b32 s67, v4, s56
s_cmp_eq_u32 s48, 7
s_cselect_b32 s64, 0, s64
s_cselect_b32 s65, 0, s65
s_cselect_b32 s66, 0, s66
s_cselect_b32 s67, 0, s67
ds_read_b128 v[4:7], v2 offset:26624
ds_read_b128 v[8:11], v2 offset:27648
ds_read_b128 v[20:23], v2 offset:28672
ds_read_b128 v[24:27], v2 offset:29696
v_dot2_f32_bf16 v12, v32, s64, 0
v_dot2_f32_bf16 v13, v36, s64, 0
v_dot2_f32_bf16 v14, v33, s64, 0
v_dot2_f32_bf16 v15, v37, s64, 0
v_dot2_f32_bf16 v16, v34, s64, 0
v_dot2_f32_bf16 v17, v38, s64, 0
v_dot2_f32_bf16 v18, v35, s64, 0
v_dot2_f32_bf16 v19, v39, s64, 0
v_dot2_f32_bf16 v12, v40, s65, v12
v_dot2_f32_bf16 v13, v44, s65, v13
v_dot2_f32_bf16 v14, v41, s65, v14
v_dot2_f32_bf16 v15, v45, s65, v15
v_dot2_f32_bf16 v16, v42, s65, v16
v_dot2_f32_bf16 v17, v46, s65, v17
v_dot2_f32_bf16 v18, v43, s65, v18
v_dot2_f32_bf16 v19, v47, s65, v19
s_waitcnt lgkmcnt(0)
v_dot2_f32_bf16 v12, v4, s66, v12
v_dot2_f32_bf16 v13, v8, s66, v13
v_dot2_f32_bf16 v14, v5, s66, v14
v_dot2_f32_bf16 v15, v9, s66, v15
v_dot2_f32_bf16 v16, v6, s66, v16
v_dot2_f32_bf16 v17, v10, s66, v17
v_dot2_f32_bf16 v18, v7, s66, v18
v_dot2_f32_bf16 v19, v11, s66, v19
v_dot2_f32_bf16 v12, v20, s67, v12
v_dot2_f32_bf16 v13, v24, s67, v13
v_dot2_f32_bf16 v14, v21, s67, v14
v_dot2_f32_bf16 v15, v25, s67, v15
v_dot2_f32_bf16 v16, v22, s67, v16
v_dot2_f32_bf16 v17, v26, s67, v17
v_dot2_f32_bf16 v18, v23, s67, v18
v_dot2_f32_bf16 v19, v27, s67, v19
v_lshlrev_b32 v32, 5, v3
s_mul_i32 s56, s48, 1792
s_add_u32 s56, s56, 8192
v_add_u32 v32, s56, v32
s_mov_b32 exec_hi, 0x00ffffff
ds_write_b128 v32, v[12:15]
ds_write_b128 v32, v[16:19] offset:16
s_mov_b32 exec_hi, -1
s_waitcnt lgkmcnt(0)
s_barrier
s_mul_i32 s56, s48, 224
v_lshlrev_b32 v33, 2, v3
v_add_u32 v33, s56, v33
v_add_u32 v32, 8192, v33
ds_read_b32 v34, v32 offset:0
ds_read_b32 v35, v32 offset:1792
ds_read_b32 v36, v32 offset:3584
ds_read_b32 v37, v32 offset:5376
ds_read_b32 v38, v32 offset:7168
ds_read_b32 v39, v32 offset:8960
ds_read_b32 v40, v32 offset:10752
ds_read_b32 v41, v32 offset:12544
s_waitcnt lgkmcnt(0)
v_add_f32 v34, v34, v35
v_add_f32 v34, v34, v36
v_add_f32 v34, v34, v37
v_add_f32 v34, v34, v38
v_add_f32 v34, v34, v39
v_add_f32 v34, v34, v40
v_add_f32 v34, v34, v41
v_or_b32 v34, 1, v34
s_mul_i32 s56, s2, 1792
s_add_u32 s56, s56, 0x3aa000
s_mov_b32 exec_hi, 0x00ffffff
buffer_store_dword v34, v33, s[44:47], s56 offen sc1
s_mov_b32 exec_hi, -1
s_cmp_lg_u32 s2, 1
s_cbranch_scc1 L_nofinal_883
s_cmp_eq_u32 s48, 7
s_cbranch_scc1 L_gx_884
v_lshrrev_b32 v36, 4, v3
v_mul_u32_u24 v36, 1792, v36
v_and_b32 v37, 15, v3
v_lshl_add_u32 v36, v37, 4, v36
s_lshl_b32 s56, s48, 8
s_add_u32 s56, s56, 0x3aa000
s_mov_b32 s60, 0
L_p_gx_885:
s_nop 4
s_add_u32 s57, s56, 0
buffer_load_dwordx4 v[4:7], v36, s[44:47], s57 offen sc1
s_add_u32 s57, s56, 7168
buffer_load_dwordx4 v[8:11], v36, s[44:47], s57 offen sc1
s_add_u32 s57, s56, 14336
buffer_load_dwordx4 v[12:15], v36, s[44:47], s57 offen sc1
s_add_u32 s57, s56, 21504
buffer_load_dwordx4 v[16:19], v36, s[44:47], s57 offen sc1
s_add_u32 s57, s56, 28672
buffer_load_dwordx4 v[20:23], v36, s[44:47], s57 offen sc1
s_add_u32 s57, s56, 35840
buffer_load_dwordx4 v[24:27], v36, s[44:47], s57 offen sc1
s_add_u32 s57, s56, 43008
buffer_load_dwordx4 v[28:31], v36, s[44:47], s57 offen sc1
s_add_u32 s57, s56, 50176
buffer_load_dwordx4 v[32:35], v36, s[44:47], s57 offen sc1
s_waitcnt vmcnt(0)
v_and_b32 v37, v4, v5
v_and_b32 v37, v37, v6
v_and_b32 v37, v37, v7
v_and_b32 v37, v37, v8
v_and_b32 v37, v37, v9
v_and_b32 v37, v37, v10
v_and_b32 v37, v37, v11
v_and_b32 v37, v37, v12
v_and_b32 v37, v37, v13
v_and_b32 v37, v37, v14
v_and_b32 v37, v37, v15
v_and_b32 v37, v37, v16
v_and_b32 v37, v37, v17
v_and_b32 v37, v37, v18
v_and_b32 v37, v37, v19
v_and_b32 v37, v37, v20
v_and_b32 v37, v37, v21
v_and_b32 v37, v37, v22
v_and_b32 v37, v37, v23
v_and_b32 v37, v37, v24
v_and_b32 v37, v37, v25
v_and_b32 v37, v37, v26
v_and_b32 v37, v37, v27
v_and_b32 v37, v37, v28
v_and_b32 v37, v37, v29
v_and_b32 v37, v37, v30
v_and_b32 v37, v37, v31
v_and_b32 v37, v37, v32
v_and_b32 v37, v37, v33
v_and_b32 v37, v37, v34
v_and_b32 v37, v37, v35
v_and_b32 v37, 1, v37
v_cmp_ne_u32 vcc, 1, v37
s_cbranch_vccz L_d_gx_886
s_sleep 1
s_add_u32 s60, s60, 1
s_cmp_lt_u32 s60, 400000
s_cbranch_scc1 L_p_gx_885
s_endpgm
L_d_gx_886:
s_nop 4
v_add_f32 v4, v4, v8
v_add_f32 v5, v5, v9
v_add_f32 v6, v6, v10
v_add_f32 v7, v7, v11
v_add_f32 v4, v4, v12
v_add_f32 v5, v5, v13
v_add_f32 v6, v6, v14
v_add_f32 v7, v7, v15
v_add_f32 v4, v4, v16
v_add_f32 v5, v5, v17
v_add_f32 v6, v6, v18
v_add_f32 v7, v7, v19
v_add_f32 v4, v4, v20
v_add_f32 v5, v5, v21
v_add_f32 v6, v6, v22
v_add_f32 v7, v7, v23
v_add_f32 v4, v4, v24
v_add_f32 v5, v5, v25
v_add_f32 v6, v6, v26
v_add_f32 v7, v7, v27
v_add_f32 v4, v4, v28
v_add_f32 v5, v5, v29
v_add_f32 v6, v6, v30
v_add_f32 v7, v7, v31
v_add_f32 v4, v4, v32
v_add_f32 v5, v5, v33
v_add_f32 v6, v6, v34
v_add_f32 v7, v7, v35
v_mov_b32 v38, v4
v_mov_b32 v39, v5
v_mov_b32 v40, v6
v_mov_b32 v41, v7
v_permlane16_swap_b32 v4, v38
v_permlane16_swap_b32 v5, v39
v_permlane16_swap_b32 v6, v40
v_permlane16_swap_b32 v7, v41
v_add_f32 v4, v4, v38
v_add_f32 v5, v5, v39
v_add_f32 v6, v6, v40
v_add_f32 v7, v7, v41
v_mov_b32 v38, v4
v_mov_b32 v39, v5
v_mov_b32 v40, v6
v_mov_b32 v41, v7
v_permlane32_swap_b32 v4, v38
v_permlane32_swap_b32 v5, v39
v_permlane32_swap_b32 v6, v40
v_permlane32_swap_b32 v7, v41
v_add_f32 v4, v4, v38
v_add_f32 v5, v5, v39
v_add_f32 v6, v6, v40
v_add_f32 v7, v7, v41
v_cvt_pk_bf16_f32 v4, v4, v4
v_cvt_pk_bf16_f32 v5, v5, v5
v_cvt_pk_bf16_f32 v6, v6, v6
v_cvt_pk_bf16_f32 v7, v7, v7
v_and_b32 v4, s62, v4
v_and_b32 v5, s62, v5
v_and_b32 v6, s62, v6
v_and_b32 v7, s62, v7
v_add_f32 v244, v244, v4
v_add_f32 v245, v245, v5
v_add_f32 v246, v246, v6
v_add_f32 v247, v247, v7
v_cvt_pk_bf16_f32 v244, v244, v244
v_cvt_pk_bf16_f32 v245, v245, v245
v_cvt_pk_bf16_f32 v246, v246, v246
v_cvt_pk_bf16_f32 v247, v247, v247
v_and_b32 v244, s62, v244
v_and_b32 v245, s62, v245
v_and_b32 v246, s62, v246
v_and_b32 v247, s62, v247
v_cvt_pk_bf16_f32 v4, v244, v245
v_cvt_pk_bf16_f32 v5, v246, v247
v_lshlrev_b32 v36, 3, v3
s_lshl_b32 s56, s48, 7
s_add_u32 s56, s56, 896
s_mov_b64 exec, 0xffff
buffer_store_dwordx2 v[4:5], v36, s[36:39], s56 offen
s_mov_b64 exec, -1
L_gx_884:
s_nop 4
L_nofinal_883:
s_nop 4
s_barrier
s_cmp_lg_u32 s2, 1
s_cbranch_scc1 L_nodbgclr_896
s_cmp_lg_u32 s48, 0
s_cbranch_scc1 L_nodbgclr_896
v_mov_b32 v4, 0
v_mov_b32 v5, 0
v_mov_b32 v6, 0
v_mov_b32 v7, 0
s_mov_b64 exec, 1
buffer_store_dwordx4 v[4:7], v4, s[40:43], 0 offen sc1
s_mov_b64 exec, -1
L_nodbgclr_896:
s_nop 4
s_endpgm
L_codeend:
.section .rodata,"a"
.p2align 6
.amdhsa_kernel interleave_layers__mha_block_cached__glu_gated_bilinear__decode_kernel
  .amdhsa_next_free_vgpr 256
  .amdhsa_next_free_sgpr 96
  .amdhsa_accum_offset 256
  .amdhsa_group_segment_fixed_size 0
  .amdhsa_kernarg_size 96
  .amdhsa_user_sgpr_count 2
  .amdhsa_user_sgpr_kernarg_segment_ptr 1
  .amdhsa_system_sgpr_workgroup_id_x 1
.end_amdhsa_kernel
```
